```python
import torch

def _softmax(x, axis=-1):
    return torch.softmax(x, dim=axis)
def _gelu(x):
    return torch.nn.functional.gelu(x, approximate="tanh")
def _silu(x):
    return torch.nn.functional.silu(x)
def _sigmoid(x):
    return torch.sigmoid(x)
def _layernorm(x, axis=-1, eps=1e-5):
    m = x.mean(dim=axis, keepdim=True)
    v = x.var(dim=axis, keepdim=True, unbiased=False)
    return (x - m) / torch.sqrt(v + eps)
def _scatter_add(tgt, idx, src, axis=0):
    return tgt.clone().index_add_(axis, idx, src)
def _segment_sum(src, seg, n):
    out = torch.zeros((n,) + src.shape[1:], dtype=src.dtype)
    return out.index_add_(0, seg, src)
def _pad(x, pw):
    flat = tuple(v for pair in reversed(pw) for v in pair)
    return torch.nn.functional.pad(x, flat)

kernel_name = 'sequential_preLN__linear_attn_block__glu_gated_swiglu__prompt'

def setup_inputs():

    _w = (lambda a: (lambda t: t.to(torch.bfloat16) if t.is_floating_point() else t)(torch.as_tensor(a)))
    def _A_setup():
        B, S, D = 1, 2048, 640
        return {
            "x": _w((lambda *s: torch.randn(*s, dtype=torch.bfloat16) * 0.05)(B, S, D)),
            "wqkv": _w((lambda *s: torch.randn(*s, dtype=torch.bfloat16) * 0.05)(D, 3 * D)),
            "wo": _w((lambda *s: torch.randn(*s, dtype=torch.bfloat16) * 0.05)(D, D)),
        }
    _A_in = _A_setup()

    def _B_setup():
        B, S, D, F = 1, 2048, 640, 1536
        return {
            "x": _w((lambda *s: torch.randn(*s, dtype=torch.bfloat16) * 0.05)(B, S, D)),
            "w1": _w((lambda *s: torch.randn(*s, dtype=torch.bfloat16) * 0.2)(D, F) * (2.0 / D) ** 0.5),
            "w3": _w((lambda *s: torch.randn(*s, dtype=torch.bfloat16) * 0.2)(D, F) * (2.0 / D) ** 0.5),
            "w2": _w((lambda *s: torch.randn(*s, dtype=torch.bfloat16) * 0.2)(F, D) * (2.0 / F) ** 0.5),
        }
    _B_in = _B_setup()

    return {
        "A_x": _A_in["x"],
        "A_wqkv": _A_in["wqkv"],
        "A_wo": _A_in["wo"],
        "B_x": _B_in["x"],
        "B_w1": _B_in["w1"],
        "B_w3": _B_in["w3"],
        "B_w2": _B_in["w2"],
    }

def reference(A_x, A_wqkv, A_wo, B_x, B_w1, B_w3, B_w2):
    def _A_ref(x, wqkv, wo):
        B, S, D = x.shape
        H = 32; Dh = D // H
        qkv = (lambda x, *d: x.permute(*d))((x @ wqkv).reshape(B, S, 3, H, Dh), 2, 0, 3, 1, 4)
        q, k, v = qkv[0], qkv[1], qkv[2]
        phi = lambda t: torch.where(t > 0, t + 1, torch.exp(t)) + 1e-6
        pq, pk = phi(q), phi(k)
        kv = torch.einsum("bhsd,bhse->bhde", pk, v)
        z = torch.einsum("bhsd->bhd", pk)
        num = torch.einsum("bhqd,bhde->bhqe", pq, kv)
        den = torch.einsum("bhqd,bhd->bhq", pq, z)[..., None] + 1e-6
        o = num / den
        return (lambda x, *d: x.permute(*d))(o, 0, 2, 1, 3).reshape(B, S, D) @ wo

    def _B_ref(x, w1, w3, w2):
        gate = torch.einsum("bsd,df->bsf", x, w1)
        up = torch.einsum("bsd,df->bsf", x, w3)
        h = _silu(gate) * up
        out = torch.einsum("bsf,fd->bsd", h, w2)
        return out

    x = A_x
    h = x + _A_ref(_layernorm(x, axis=-1), A_wqkv, A_wo)
    h2 = h + _B_ref(_layernorm(h, axis=-1), B_w1, B_w3, B_w2)
    return h2
```

```asm
; @launch grid=(256,1,1) block=(256,1,1) lds=163840
.amdgcn_target "amdgcn-amd-amdhsa--gfx950"
.text
.globl sequential_preLN__linear_attn_block__glu_gated_swiglu__prompt_kernel
.p2align 8
.type sequential_preLN__linear_attn_block__glu_gated_swiglu__prompt_kernel,@function
sequential_preLN__linear_attn_block__glu_gated_swiglu__prompt_kernel:
    s_load_dwordx2 s[8:9], s[0:1], 0
    s_load_dwordx2 s[12:13], s[0:1], 8
    s_load_dwordx16 s[80:95], s[0:1], 16
    s_cmp_ge_u32 s2, 256
    s_cbranch_scc1 Lexit
    s_getpc_b64 s[60:61]
Lpc:
    s_lshr_b32 s62, s2, 3
    s_mul_i32 s62, s62, 2304
    v_lshrrev_b32 v3, 3, v0
    v_min_u32 v3, 17, v3
    v_lshl_add_u32 v3, v3, 7, s62
    v_min_u32 v3, Lcodeend-Lpc-4, v3
    global_load_dword v248, v3, s[60:61]
    v_lshrrev_b32 v2, 6, v0
    v_and_b32 v1, 63, v0
    v_readfirstlane_b32 s3, v2
    s_mov_b32 s10, 2621440
    s_mov_b32 s11, 0x20000
    s_and_b32 s4, s2, 6
    s_lshl_b32 s4, s4, 1
    s_lshr_b32 s44, s2, 6
    s_add_u32 s4, s4, s44
    s_and_b32 s44, s2, 1
    s_bfe_u32 s5, s2, 0x30003
    s_lshl_b32 s45, s44, 2
    s_lshl_b32 s46, s44, 1
    s_add_u32 s47, s46, 4
    s_add_u32 s46, s46, 6
    s_cmp_lt_u32 s5, 6
    s_cselect_b32 s46, s47, s46
    s_cmp_lt_u32 s5, 4
    s_cselect_b32 s46, s45, s46
    s_add_u32 s5, s5, s46
    s_cmp_ge_u32 s5, 12
    s_cbranch_scc1 Lhelper
    v_lshrrev_b32 v9, 3, v1
    v_mul_u32_u24 v9, 0x500, v9
    v_and_b32 v8, 7, v1
    v_lshrrev_b32 v7, 4, v1
    v_xor_b32 v7, v8, v7
    v_lshlrev_b32 v7, 4, v7
    v_add_u32 v10, v9, v7
    s_lshl_b32 s50, s4, 2
    s_add_u32 s50, s50, s3
    s_mul_i32 s50, s50, 40960
    s_lshl_b32 s55, s3, 12
    v_xor_b32 v9, 64, v10
    v_add_u32 v11, 0x2800, v9
    v_add_u32 v12, 0x5000, v10
    v_add_u32 v13, 0x5000, v11
    s_and_b32 s52, s2, 6
    s_mul_i32 s52, s52, 5
    s_lshr_b32 s52, s52, 2
    s_lshl_b32 s57, s52, 7
    s_add_u32 s53, s50, s57
    s_mov_b32 s14, 2457600
    s_mov_b32 s15, 0x20000
    s_cmp_ge_u32 s5, 8
    s_cbranch_scc1 Lqtouch
    s_waitcnt lgkmcnt(0)
Lqdone:
    s_add_u32 m0, s55, 0
    s_nop 0
    buffer_load_dwordx4 v10, s[8:11], s53 offen lds
    s_add_u32 m0, s55, 1024
    s_nop 0
    buffer_load_dwordx4 v11, s[8:11], s53 offen lds
    s_add_u32 m0, s55, 2048
    s_nop 0
    buffer_load_dwordx4 v12, s[8:11], s53 offen lds
    s_add_u32 m0, s55, 3072
    s_nop 0
    buffer_load_dwordx4 v13, s[8:11], s53 offen lds
    s_lshr_b32 s48, s3, 1
    s_and_b32 s49, s3, 1
    v_lshlrev_b32 v0, 4, v1
    s_cmp_ge_u32 s5, 8
    s_cbranch_scc1 Lq
    s_lshr_b32 s96, s2, 6
    s_lshl_b32 s96, s96, 2
    s_bfe_u32 s57, s2, 0x20003
    s_add_u32 s96, s96, s57
    s_cmp_ge_u32 s96, 5
    s_cselect_b32 s57, 15, 10
    s_add_u32 s57, s57, s96
    s_and_b32 s54, s2, 1
    s_mul_i32 s54, s54, 5
    s_add_u32 s57, s57, s54
    s_lshl_b32 s57, s57, 7
    s_lshl_b32 s54, s52, 2
    s_add_u32 s54, s54, s3
    s_mul_i32 s54, s54, 61440
    s_add_u32 s57, s57, s54
    s_cmp_ge_u32 s96, 10
    s_cselect_b32 s57, 1073741824, s57
    v_min_u32 v25, 15, v1
    v_mul_u32_u24 v25, 3840, v25
    buffer_load_dword v240, v25, s[12:15], s57 offen
    s_lshl_b32 s57, s48, 3
    s_add_u32 s51, s5, s57
    s_add_u32 s51, s51, 8
    s_mul_i32 s51, s51, 160
    s_mul_i32 s57, s49, 122880
    s_add_u32 s51, s51, s57
    s_mul_i32 s56, s48, 10256
    s_mul_i32 s57, s49, 5120
    s_add_u32 s56, s56, s57
    s_add_u32 s56, s56, 65536
    v_mul_u32_u24 v2, 6554, v1
    s_movk_i32 s58, -160
    s_movk_i32 s59, 3840
    s_mul_i32 s57, s52, 245760
    s_add_u32 s54, s51, s57
    s_add_u32 s52, s52, 1
    s_cmp_eq_u32 s52, 10
    s_cselect_b32 s52, 0, s52
    v_lshrrev_b32 v3, 16, v2
    v_lshrrev_b32 v4, 17, v2
    v_xor_b32 v4, v3, v4
    v_and_b32 v4, 4, v4
    v_mul_u32_u24 v4, 3, v4
    v_xor_b32 v4, v3, v4
    v_mad_i32_i24 v3, v3, s58, v0
    v_mad_i32_i24 v14, v4, s59, v3
    s_add_u32 m0, s56, 0
    s_nop 0
    buffer_load_dwordx4 v14, s[12:15], s54 offen lds
    v_add_u32 v2, 419456, v2
    v_lshrrev_b32 v3, 16, v2
    v_lshrrev_b32 v4, 17, v2
    v_xor_b32 v4, v3, v4
    v_and_b32 v4, 4, v4
    v_mul_u32_u24 v4, 3, v4
    v_xor_b32 v4, v3, v4
    v_mad_i32_i24 v3, v3, s58, v0
    v_mad_i32_i24 v15, v4, s59, v3
    v_add_u32 v15, 1024, v15
    s_add_u32 m0, s56, 1024
    s_nop 0
    buffer_load_dwordx4 v15, s[12:15], s54 offen lds
    v_add_u32 v2, 419456, v2
    v_lshrrev_b32 v3, 16, v2
    v_lshrrev_b32 v4, 17, v2
    v_xor_b32 v4, v3, v4
    v_and_b32 v4, 4, v4
    v_mul_u32_u24 v4, 3, v4
    v_xor_b32 v4, v3, v4
    v_mad_i32_i24 v3, v3, s58, v0
    v_mad_i32_i24 v16, v4, s59, v3
    v_add_u32 v16, 2048, v16
    s_add_u32 m0, s56, 2048
    s_nop 0
    buffer_load_dwordx4 v16, s[12:15], s54 offen lds
    v_add_u32 v2, 419456, v2
    v_lshrrev_b32 v3, 16, v2
    v_lshrrev_b32 v4, 17, v2
    v_xor_b32 v4, v3, v4
    v_and_b32 v4, 4, v4
    v_mul_u32_u24 v4, 3, v4
    v_xor_b32 v4, v3, v4
    v_mad_i32_i24 v3, v3, s58, v0
    v_mad_i32_i24 v17, v4, s59, v3
    v_add_u32 v17, 3072, v17
    v_add_u32 v2, 419456, v2
    v_lshrrev_b32 v3, 16, v2
    v_lshrrev_b32 v4, 17, v2
    v_xor_b32 v4, v3, v4
    v_and_b32 v4, 4, v4
    v_mul_u32_u24 v4, 3, v4
    v_xor_b32 v4, v3, v4
    v_mad_i32_i24 v3, v3, s58, v0
    v_mad_i32_i24 v18, v4, s59, v3
    v_add_u32 v18, 4096, v18
    s_branch Lkv
Lqtouch:
    s_lshr_b32 s96, s2, 6
    s_lshl_b32 s96, s96, 1
    s_bfe_u32 s97, s2, 0x10003
    s_add_u32 s96, s96, s97
    s_lshl_b32 s96, s96, 2
    s_add_u32 s96, s96, s3
    s_and_b32 s98, s2, 1
    s_mul_i32 s99, s98, 5
    s_mul_i32 s44, s96, 26
    s_lshr_b32 s44, s44, 8
    s_mul_i32 s97, s44, 10
    s_sub_u32 s97, s96, s97
    s_cmp_ge_u32 s97, 5
    s_cselect_b32 s60, 15, 10
    s_add_u32 s60, s60, s97
    s_add_u32 s60, s60, s99
    s_lshl_b32 s60, s60, 7
    v_mul_u32_u24 v25, 3840, v1
    s_waitcnt lgkmcnt(0)
    s_add_u32 s47, s44, s52
    s_add_u32 s47, s47, 1
    s_cmp_ge_u32 s47, 10
    s_cselect_b32 s7, 10, 0
    s_sub_u32 s47, s47, s7
    s_mul_i32 s47, s47, 245760
    s_add_u32 s47, s47, s60
    s_cmp_ge_u32 s44, 3
    s_cselect_b32 s47, 1073741824, s47
    buffer_load_dword v240, v25, s[12:15], s47 offen
    s_lshr_b32 s46, s96, 2
    s_and_b32 s62, s4, 12
    s_add_u32 s62, s62, s3
    s_lshl_b32 s62, s62, 1
    s_xor_b32 s98, s98, 1
    s_add_u32 s62, s62, s98
    s_mul_i32 s62, s62, 81920
    v_mul_u32_u24 v26, 1280, v1
    s_add_u32 s47, s46, s52
    s_add_u32 s47, s47, 1
    s_cmp_ge_u32 s47, 10
    s_cselect_b32 s7, 10, 0
    s_sub_u32 s47, s47, s7
    s_mul_i32 s47, s47, 128
    s_add_u32 s47, s47, s62
    s_cmp_ge_u32 s46, 8
    s_cselect_b32 s47, 1073741824, s47
    buffer_load_dword v241, v26, s[8:11], s47 offen
    s_add_u32 s47, s44, s52
    s_add_u32 s47, s47, 4
    s_cmp_ge_u32 s47, 10
    s_cselect_b32 s7, 10, 0
    s_sub_u32 s47, s47, s7
    s_mul_i32 s47, s47, 245760
    s_add_u32 s47, s47, s60
    s_cmp_ge_u32 s44, 3
    s_cselect_b32 s47, 1073741824, s47
    buffer_load_dword v242, v25, s[12:15], s47 offen
    s_mul_i32 s45, s96, 52
    s_lshr_b32 s45, s45, 8
    s_mul_i32 s61, s45, 5
    s_sub_u32 s61, s96, s61
    s_add_u32 s61, s61, s99
    s_lshl_b32 s61, s61, 7
    s_add_u32 s47, s45, s52
    s_add_u32 s47, s47, 0
    s_cmp_ge_u32 s47, 10
    s_cselect_b32 s7, 10, 0
    s_sub_u32 s47, s47, s7
    s_mul_i32 s47, s47, 245760
    s_add_u32 s47, s47, s61
    s_cmp_ge_u32 s45, 6
    s_cselect_b32 s47, 1073741824, s47
    buffer_load_dword v243, v25, s[12:15], s47 offen
    s_branch Lqdone
.p2align 12
Lkv:
    s_xor_b32 s57, s48, 0
    s_lshl_b32 s58, s57, 2
    s_lshl_b32 s59, s48, 13
    v_and_b32 v9, 15, v1
    v_lshlrev_b32 v9, 7, v9
    v_lshrrev_b32 v8, 4, v1
    v_add_u32 v8, s58, v8
    v_and_b32 v7, 15, v1
    v_lshrrev_b32 v7, 1, v7
    v_and_b32 v7, 7, v7
    v_xor_b32 v7, v8, v7
    v_lshlrev_b32 v7, 4, v7
    v_add_u32 v7, v9, v7
    v_add_u32 v7, s59, v7
    v_mov_b32 v19, v7
    s_mul_i32 s58, s57, 5120
    s_mul_i32 s59, s49, 80
    s_add_u32 s58, s58, s59
    v_lshrrev_b32 v9, 4, v1
    v_lshrrev_b32 v9, 1, v9
    v_lshlrev_b32 v9, 4, v9
    v_lshrrev_b32 v8, 4, v1
    v_and_b32 v8, 1, v8
    v_lshlrev_b32 v8, 2, v8
    v_add_u32 v8, v9, v8
    v_lshrrev_b32 v9, 2, v1
    v_and_b32 v9, 3, v9
    v_add_u32 v9, v8, v9
    v_mul_u32_u24 v9, 0xa0, v9
    v_add_u32 v9, s58, v9
    v_add_u32 v251, 0x10000, v9
    v_and_b32 v9, 3, v1
    v_lshlrev_b32 v9, 3, v9
    v_add_u32 v21, v251, v9
    v_add_u32 v9, 32, v251
    v_and_b32 v8, 3, v1
    v_and_b32 v8, 1, v8
    v_mul_u32_u24 v8, 40, v8
    v_add_u32 v8, v9, v8
    v_and_b32 v9, 3, v1
    v_lshrrev_b32 v9, 1, v9
    v_mul_u32_u24 v9, 0x2810, v9
    v_add_u32 v22, v8, v9
    s_xor_b32 s57, s48, 1
    s_lshl_b32 s58, s57, 2
    s_lshl_b32 s59, s48, 13
    v_and_b32 v9, 15, v1
    v_lshlrev_b32 v9, 7, v9
    v_lshrrev_b32 v8, 4, v1
    v_add_u32 v8, s58, v8
    v_and_b32 v7, 15, v1
    v_lshrrev_b32 v7, 1, v7
    v_and_b32 v7, 7, v7
    v_xor_b32 v7, v8, v7
    v_lshlrev_b32 v7, 4, v7
    v_add_u32 v7, v9, v7
    v_add_u32 v7, s59, v7
    v_mov_b32 v20, v7
    s_mul_i32 s58, s57, 5120
    s_mul_i32 s59, s49, 80
    s_add_u32 s58, s58, s59
    v_lshrrev_b32 v9, 4, v1
    v_lshrrev_b32 v9, 1, v9
    v_lshlrev_b32 v9, 4, v9
    v_lshrrev_b32 v8, 4, v1
    v_and_b32 v8, 1, v8
    v_lshlrev_b32 v8, 2, v8
    v_add_u32 v8, v9, v8
    v_lshrrev_b32 v9, 2, v1
    v_and_b32 v9, 3, v9
    v_add_u32 v9, v8, v9
    v_mul_u32_u24 v9, 0xa0, v9
    v_add_u32 v9, s58, v9
    v_add_u32 v251, 0x10000, v9
    v_and_b32 v9, 3, v1
    v_lshlrev_b32 v9, 3, v9
    v_add_u32 v23, v251, v9
    v_add_u32 v9, 32, v251
    v_and_b32 v8, 3, v1
    v_and_b32 v8, 1, v8
    v_mul_u32_u24 v8, 40, v8
    v_add_u32 v8, v9, v8
    v_and_b32 v9, 3, v1
    v_lshrrev_b32 v9, 1, v9
    v_mul_u32_u24 v9, 0x2810, v9
    v_add_u32 v24, v8, v9
    v_mov_b32 v26, 0x3f803f80
    v_mov_b32 v27, 0x3f803f80
    v_mov_b32 v28, 0x3f803f80
    v_mov_b32 v29, 0x3f803f80
    s_mov_b64 exec, 0
    s_call_b64 s[98:99], Lwkv_0
    s_mov_b64 exec, -1
    s_add_u32 m0, s56, 3072
    s_nop 0
    buffer_load_dwordx4 v17, s[12:15], s54 offen lds
    s_add_u32 m0, s56, 4096
    s_nop 0
    buffer_load_dwordx4 v18, s[12:15], s54 offen lds
    s_lshl_b32 s57, s52, 7
    s_add_u32 s53, s50, s57
    s_mul_i32 s57, s52, 245760
    s_add_u32 s54, s51, s57
    s_add_u32 s52, s52, 1
    s_cmp_eq_u32 s52, 10
    s_cselect_b32 s52, 0, s52
    s_add_u32 m0, s55, 16384
    s_nop 0
    buffer_load_dwordx4 v10, s[8:11], s53 offen lds
    s_add_u32 m0, s56, 20512
    s_nop 0
    buffer_load_dwordx4 v14, s[12:15], s54 offen lds
    s_add_u32 m0, s56, 21536
    s_nop 0
    buffer_load_dwordx4 v15, s[12:15], s54 offen lds
    s_add_u32 m0, s55, 17408
    s_nop 0
    buffer_load_dwordx4 v11, s[8:11], s53 offen lds
    s_add_u32 m0, s56, 22560
    s_nop 0
    buffer_load_dwordx4 v16, s[12:15], s54 offen lds
    s_waitcnt vmcnt(5)
    s_barrier
    ds_read_b128 v[30:33], v19 offset:0
    ds_read_b64_tr_b16 v[46:47], v21 offset:0
    ds_read_b64_tr_b16 v[48:49], v21 offset:1280
    ds_read_b64_tr_b16 v[50:51], v21 offset:40
    ds_read_b64_tr_b16 v[52:53], v21 offset:1320
    ds_read_b64_tr_b16 v[54:55], v21 offset:10256
    ds_read_b64_tr_b16 v[56:57], v21 offset:11536
    ds_read_b64_tr_b16 v[58:59], v21 offset:10296
    ds_read_b64_tr_b16 v[60:61], v21 offset:11576
    ds_read_b64_tr_b16 v[62:63], v22 offset:0
    ds_read_b64_tr_b16 v[64:65], v22 offset:1280
    ds_read_b128 v[34:37], v19 offset:2048
    ds_read_b128 v[38:41], v19 offset:4096
    ds_read_b128 v[42:45], v19 offset:6144
    s_waitcnt lgkmcnt(11)
    v_mfma_f32_16x16x32_bf16 v[102:105], v[30:33], v[46:49], 0
    s_add_u32 m0, s55, 18432
    ds_read_b128 v[66:69], v20 offset:0
    s_waitcnt lgkmcnt(10)
    v_mfma_f32_16x16x32_bf16 v[106:109], v[30:33], v[50:53], 0
    s_waitcnt lgkmcnt(8)
    buffer_load_dwordx4 v12, s[8:11], s53 offen lds
    v_mfma_f32_16x16x32_bf16 v[110:113], v[30:33], v[54:57], 0
    s_add_u32 m0, s56, 23584
    ds_read_b64_tr_b16 v[82:83], v23 offset:0
    ds_read_b64_tr_b16 v[84:85], v23 offset:1280
    s_waitcnt lgkmcnt(8)
    v_mfma_f32_16x16x32_bf16 v[114:117], v[30:33], v[58:61], 0
    s_waitcnt lgkmcnt(6)
    buffer_load_dwordx4 v17, s[12:15], s54 offen lds
    v_mfma_f32_16x16x32_bf16 v[118:121], v[30:33], v[62:65], 0
    s_add_u32 m0, s55, 19456
    ds_read_b64_tr_b16 v[86:87], v23 offset:40
    ds_read_b64_tr_b16 v[88:89], v23 offset:1320
    s_waitcnt lgkmcnt(7)
    v_mfma_f32_16x16x32_bf16 v[122:125], v[34:37], v[46:49], 0
    buffer_load_dwordx4 v13, s[8:11], s53 offen lds
    v_mfma_f32_16x16x32_bf16 v[126:129], v[34:37], v[50:53], 0
    s_add_u32 m0, s56, 24608
    ds_read_b64_tr_b16 v[90:91], v23 offset:10256
    ds_read_b64_tr_b16 v[92:93], v23 offset:11536
    v_mfma_f32_16x16x32_bf16 v[130:133], v[34:37], v[54:57], 0
    buffer_load_dwordx4 v18, s[12:15], s54 offen lds
    v_mfma_f32_16x16x32_bf16 v[134:137], v[34:37], v[58:61], 0
    s_lshl_b32 s57, s52, 7
    ds_read_b64_tr_b16 v[94:95], v23 offset:10296
    ds_read_b64_tr_b16 v[96:97], v23 offset:11576
    v_mfma_f32_16x16x32_bf16 v[138:141], v[34:37], v[62:65], 0
    s_add_u32 s53, s50, s57
    ds_read_b64_tr_b16 v[98:99], v24 offset:0
    s_mul_i32 s57, s52, 245760
    s_waitcnt lgkmcnt(11)
    v_mfma_f32_16x16x32_bf16 v[142:145], v[38:41], v[46:49], 0
    s_add_u32 s54, s51, s57
    ds_read_b64_tr_b16 v[100:101], v24 offset:1280
    s_add_u32 s52, s52, 1
    v_mfma_f32_16x16x32_bf16 v[146:149], v[38:41], v[50:53], 0
    s_cmp_eq_u32 s52, 10
    s_cselect_b32 s52, 0, s52
    ds_read_b128 v[70:73], v20 offset:2048
    v_mfma_f32_16x16x32_bf16 v[150:153], v[38:41], v[54:57], 0
    s_add_u32 m0, s55, 32768
    ds_read_b128 v[74:77], v20 offset:4096
    v_mfma_f32_16x16x32_bf16 v[154:157], v[38:41], v[58:61], 0
    buffer_load_dwordx4 v10, s[8:11], s53 offen lds
    v_mfma_f32_16x16x32_bf16 v[158:161], v[38:41], v[62:65], 0
    s_add_u32 m0, s56, 41024
    ds_read_b128 v[78:81], v20 offset:6144
    s_waitcnt lgkmcnt(14)
    v_mfma_f32_16x16x32_bf16 v[162:165], v[42:45], v[46:49], 0
    buffer_load_dwordx4 v14, s[12:15], s54 offen lds
    v_mfma_f32_16x16x32_bf16 v[166:169], v[42:45], v[50:53], 0
    s_add_u32 m0, s56, 42048
    v_mfma_f32_16x16x32_bf16 v[170:173], v[42:45], v[54:57], 0
    buffer_load_dwordx4 v15, s[12:15], s54 offen lds
    v_mfma_f32_16x16x32_bf16 v[174:177], v[42:45], v[58:61], 0
    s_add_u32 m0, s55, 33792
    v_mfma_f32_16x16x32_bf16 v[178:181], v[42:45], v[62:65], 0
    buffer_load_dwordx4 v11, s[8:11], s53 offen lds
    v_mfma_f32_16x16x32_bf16 v[182:185], v[26:29], v[46:49], 0
    s_add_u32 m0, s56, 43072
    v_mfma_f32_16x16x32_bf16 v[186:189], v[26:29], v[50:53], 0
    buffer_load_dwordx4 v16, s[12:15], s54 offen lds
    v_mfma_f32_16x16x32_bf16 v[190:193], v[26:29], v[54:57], 0
    s_add_u32 m0, s55, 34816
    v_mfma_f32_16x16x32_bf16 v[194:197], v[26:29], v[58:61], 0
    buffer_load_dwordx4 v12, s[8:11], s53 offen lds
    v_mfma_f32_16x16x32_bf16 v[198:201], v[26:29], v[62:65], 0
    s_waitcnt vmcnt(6) lgkmcnt(0)
    s_barrier
    v_mfma_f32_16x16x32_bf16 v[102:105], v[66:69], v[82:85], v[102:105]
    s_add_u32 m0, s56, 44096
    ds_read_b128 v[30:33], v19 offset:16384
    ds_read_b64_tr_b16 v[46:47], v21 offset:20512
    v_mfma_f32_16x16x32_bf16 v[106:109], v[66:69], v[86:89], v[106:109]
    buffer_load_dwordx4 v17, s[12:15], s54 offen lds
    v_mfma_f32_16x16x32_bf16 v[110:113], v[66:69], v[90:93], v[110:113]
    ds_read_b64_tr_b16 v[48:49], v21 offset:21792
    ds_read_b64_tr_b16 v[50:51], v21 offset:20552
    v_mfma_f32_16x16x32_bf16 v[114:117], v[66:69], v[94:97], v[114:117]
    ds_read_b64_tr_b16 v[52:53], v21 offset:21832
    v_mfma_f32_16x16x32_bf16 v[118:121], v[66:69], v[98:101], v[118:121]
    s_add_u32 m0, s55, 35840
    ds_read_b64_tr_b16 v[54:55], v21 offset:30768
    v_mfma_f32_16x16x32_bf16 v[122:125], v[70:73], v[82:85], v[122:125]
    buffer_load_dwordx4 v13, s[8:11], s53 offen lds
    v_mfma_f32_16x16x32_bf16 v[126:129], v[70:73], v[86:89], v[126:129]
    ds_read_b64_tr_b16 v[56:57], v21 offset:32048
    ds_read_b64_tr_b16 v[58:59], v21 offset:30808
    v_mfma_f32_16x16x32_bf16 v[130:133], v[70:73], v[90:93], v[130:133]
    s_add_u32 m0, s56, 45120
    ds_read_b64_tr_b16 v[60:61], v21 offset:32088
    v_mfma_f32_16x16x32_bf16 v[134:137], v[70:73], v[94:97], v[134:137]
    buffer_load_dwordx4 v18, s[12:15], s54 offen lds
    v_mfma_f32_16x16x32_bf16 v[138:141], v[70:73], v[98:101], v[138:141]
    ds_read_b64_tr_b16 v[62:63], v22 offset:20512
    ds_read_b64_tr_b16 v[64:65], v22 offset:21792
    v_mfma_f32_16x16x32_bf16 v[142:145], v[74:77], v[82:85], v[142:145]
    ds_read_b128 v[34:37], v19 offset:18432
    v_mfma_f32_16x16x32_bf16 v[146:149], v[74:77], v[86:89], v[146:149]
    ds_read_b128 v[38:41], v19 offset:20480
    v_mfma_f32_16x16x32_bf16 v[150:153], v[74:77], v[90:93], v[150:153]
    s_lshl_b32 s57, s52, 7
    ds_read_b128 v[42:45], v19 offset:22528
    s_add_u32 s53, s50, s57
    v_mfma_f32_16x16x32_bf16 v[154:157], v[74:77], v[94:97], v[154:157]
    s_mul_i32 s57, s52, 245760
    s_add_u32 s54, s51, s57
    s_add_u32 s52, s52, 1
    v_mfma_f32_16x16x32_bf16 v[158:161], v[74:77], v[98:101], v[158:161]
    s_cmp_eq_u32 s52, 10
    s_cselect_b32 s52, 0, s52
    v_mfma_f32_16x16x32_bf16 v[162:165], v[78:81], v[82:85], v[162:165]
    s_add_u32 m0, s55, 49152
    v_mfma_f32_16x16x32_bf16 v[166:169], v[78:81], v[86:89], v[166:169]
    buffer_load_dwordx4 v10, s[8:11], s53 offen lds
    v_mfma_f32_16x16x32_bf16 v[170:173], v[78:81], v[90:93], v[170:173]
    v_mfma_f32_16x16x32_bf16 v[174:177], v[78:81], v[94:97], v[174:177]
    s_add_u32 m0, s56, 61536
    v_mfma_f32_16x16x32_bf16 v[178:181], v[78:81], v[98:101], v[178:181]
    s_waitcnt lgkmcnt(11)
    buffer_load_dwordx4 v14, s[12:15], s54 offen lds
    v_mfma_f32_16x16x32_bf16 v[102:105], v[30:33], v[46:49], v[102:105]
    s_waitcnt lgkmcnt(9)
    ds_read_b128 v[66:69], v20 offset:16384
    v_mfma_f32_16x16x32_bf16 v[106:109], v[30:33], v[50:53], v[106:109]
    s_waitcnt lgkmcnt(8)
    ds_read_b64_tr_b16 v[82:83], v23 offset:20512
    v_mfma_f32_16x16x32_bf16 v[110:113], v[30:33], v[54:57], v[110:113]
    s_add_u32 m0, s56, 62560
    ds_read_b64_tr_b16 v[84:85], v23 offset:21792
    s_waitcnt lgkmcnt(8)
    v_mfma_f32_16x16x32_bf16 v[114:117], v[30:33], v[58:61], v[114:117]
    s_waitcnt lgkmcnt(6)
    buffer_load_dwordx4 v15, s[12:15], s54 offen lds
    v_mfma_f32_16x16x32_bf16 v[118:121], v[30:33], v[62:65], v[118:121]
    s_waitcnt lgkmcnt(5)
    ds_read_b64_tr_b16 v[86:87], v23 offset:20552
    ds_read_b64_tr_b16 v[88:89], v23 offset:21832
    v_mfma_f32_16x16x32_bf16 v[122:125], v[34:37], v[46:49], v[122:125]
    s_add_u32 m0, s55, 50176
    ds_read_b64_tr_b16 v[90:91], v23 offset:30768
    s_mov_b64 s[32:33], s[90:91]
    v_mfma_f32_16x16x32_bf16 v[126:129], v[34:37], v[50:53], v[126:129]
    s_mov_b64 s[36:37], s[92:93]
    buffer_load_dwordx4 v11, s[8:11], s53 offen lds
    v_mfma_f32_16x16x32_bf16 v[130:133], v[34:37], v[54:57], v[130:133]
    s_mov_b64 s[40:41], s[94:95]
    ds_read_b64_tr_b16 v[92:93], v23 offset:32048
    ds_read_b64_tr_b16 v[94:95], v23 offset:30808
    v_mfma_f32_16x16x32_bf16 v[134:137], v[34:37], v[58:61], v[134:137]
    s_mov_b32 s34, 2621440
    ds_read_b64_tr_b16 v[96:97], v23 offset:32088
    s_mov_b32 s35, 0x20000
    v_mfma_f32_16x16x32_bf16 v[138:141], v[34:37], v[62:65], v[138:141]
    s_add_u32 m0, s56, 63584
    ds_read_b64_tr_b16 v[98:99], v24 offset:20512
    s_mov_b32 s38, 256
    s_waitcnt lgkmcnt(11)
    v_mfma_f32_16x16x32_bf16 v[142:145], v[38:41], v[46:49], v[142:145]
    s_mov_b32 s39, 0x20000
    buffer_load_dwordx4 v16, s[12:15], s54 offen lds
    v_mfma_f32_16x16x32_bf16 v[146:149], v[38:41], v[50:53], v[146:149]
    s_mov_b32 s42, 25165824
    ds_read_b64_tr_b16 v[100:101], v24 offset:21792
    ds_read_b128 v[70:73], v20 offset:18432
    v_mfma_f32_16x16x32_bf16 v[150:153], v[38:41], v[54:57], v[150:153]
    s_add_u32 m0, s55, 51200
    ds_read_b128 v[74:77], v20 offset:20480
    s_mov_b32 s43, 0x20000
    v_mfma_f32_16x16x32_bf16 v[154:157], v[38:41], v[58:61], v[154:157]
    s_mov_b32 s6, 400000
    buffer_load_dwordx4 v12, s[8:11], s53 offen lds
    v_mfma_f32_16x16x32_bf16 v[158:161], v[38:41], v[62:65], v[158:161]
    s_waitcnt lgkmcnt(13)
    ds_read_b128 v[78:81], v20 offset:22528
    v_lshlrev_b32 v251, 2, v1
    v_mfma_f32_16x16x32_bf16 v[162:165], v[42:45], v[46:49], v[162:165]
    s_lshl_b32 s98, s4, 9
    s_lshl_b32 s58, s48, 13
    s_add_u32 s98, s98, s58
    v_mfma_f32_16x16x32_bf16 v[166:169], v[42:45], v[50:53], v[166:169]
    s_add_u32 m0, s56, 64608
    s_lshl_b32 s58, s49, 8
    s_add_u32 s98, s98, s58
    v_mfma_f32_16x16x32_bf16 v[170:173], v[42:45], v[54:57], v[170:173]
    s_lshl_b32 s99, s3, 8
    buffer_load_dwordx4 v17, s[12:15], s54 offen lds
    v_mfma_f32_16x16x32_bf16 v[174:177], v[42:45], v[58:61], v[174:177]
    s_add_u32 s99, s99, 147584
    s_lshl_b32 s59, s48, 8
    v_lshrrev_b32 v9, 4, v1
    v_mfma_f32_16x16x32_bf16 v[178:181], v[42:45], v[62:65], v[178:181]
    s_add_u32 m0, s55, 52224
    v_lshlrev_b32 v9, 4, v9
    v_add_u32 v9, s59, v9
    v_mfma_f32_16x16x32_bf16 v[182:185], v[26:29], v[46:49], v[182:185]
    buffer_load_dwordx4 v13, s[8:11], s53 offen lds
    v_mfma_f32_16x16x32_bf16 v[186:189], v[26:29], v[50:53], v[186:189]
    v_add_u32 v252, 0x24080, v9
    s_mul_i32 s58, s3, 5120
    v_mfma_f32_16x16x32_bf16 v[190:193], v[26:29], v[54:57], v[190:193]
    v_lshlrev_b32 v9, 2, v1
    v_add_u32 v9, s58, v9
    v_mfma_f32_16x16x32_bf16 v[194:197], v[26:29], v[58:61], v[194:197]
    s_add_u32 m0, s56, 65632
    v_add_u32 v253, 0x8000, v9
    v_lshlrev_b32 v9, 7, v1
    v_mfma_f32_16x16x32_bf16 v[198:201], v[26:29], v[62:65], v[198:201]
    s_waitcnt lgkmcnt(0)
    buffer_load_dwordx4 v18, s[12:15], s54 offen lds
    s_waitcnt vmcnt(9)
    s_barrier
    v_mfma_f32_16x16x32_bf16 v[102:105], v[66:69], v[82:85], v[102:105]
    v_add_u32 v21, 0xa040, v21
    v_add_u32 v22, 0xa040, v22
    v_mfma_f32_16x16x32_bf16 v[106:109], v[66:69], v[86:89], v[106:109]
    ds_read_b128 v[30:33], v19 offset:32768
    v_mov_b32 v8, 0x40000000
    v_mfma_f32_16x16x32_bf16 v[110:113], v[66:69], v[90:93], v[110:113]
    ds_read_b64_tr_b16 v[46:47], v21 offset:0
    v_cmp_lt_i32 s[100:101], v1, 4
    v_mfma_f32_16x16x32_bf16 v[114:117], v[66:69], v[94:97], v[114:117]
    s_lshl_b32 s57, s52, 7
    ds_read_b64_tr_b16 v[48:49], v21 offset:1280
    s_add_u32 s53, s50, s57
    v_mfma_f32_16x16x32_bf16 v[118:121], v[66:69], v[98:101], v[118:121]
    s_mul_i32 s57, s52, 245760
    ds_read_b64_tr_b16 v[50:51], v21 offset:40
    ds_read_b64_tr_b16 v[52:53], v21 offset:1320
    v_mfma_f32_16x16x32_bf16 v[122:125], v[70:73], v[82:85], v[122:125]
    s_add_u32 s54, s51, s57
    ds_read_b64_tr_b16 v[54:55], v21 offset:10256
    s_add_u32 s52, s52, 1
    v_mfma_f32_16x16x32_bf16 v[126:129], v[70:73], v[86:89], v[126:129]
    s_cmp_eq_u32 s52, 10
    s_cselect_b32 s52, 0, s52
    ds_read_b64_tr_b16 v[56:57], v21 offset:11536
    v_mfma_f32_16x16x32_bf16 v[130:133], v[70:73], v[90:93], v[130:133]
    s_add_u32 m0, s55, 0
    ds_read_b64_tr_b16 v[58:59], v21 offset:10296
    v_cndmask_b32 v254, v8, v9, s[100:101]
    v_mfma_f32_16x16x32_bf16 v[134:137], v[70:73], v[94:97], v[134:137]
    s_and_b32 s16, s2, 7
    buffer_load_dwordx4 v10, s[8:11], s53 offen lds
    v_mfma_f32_16x16x32_bf16 v[138:141], v[70:73], v[98:101], v[138:141]
    s_add_u32 m0, s56, 0
    ds_read_b64_tr_b16 v[60:61], v21 offset:11576
    ds_read_b64_tr_b16 v[62:63], v22 offset:0
    v_mfma_f32_16x16x32_bf16 v[142:145], v[74:77], v[82:85], v[142:145]
    s_lshl_b32 s16, s16, 1
    buffer_load_dwordx4 v14, s[12:15], s54 offen lds
    v_mfma_f32_16x16x32_bf16 v[146:149], v[74:77], v[86:89], v[146:149]
    s_lshr_b32 s44, s2, 7
    ds_read_b64_tr_b16 v[64:65], v22 offset:1280
    ds_read_b128 v[34:37], v19 offset:34816
    v_mfma_f32_16x16x32_bf16 v[150:153], v[74:77], v[90:93], v[150:153]
    s_add_u32 s16, s16, s44
    ds_read_b128 v[38:41], v19 offset:36864
    ds_read_b128 v[42:45], v19 offset:38912
    v_mfma_f32_16x16x32_bf16 v[154:157], v[74:77], v[94:97], v[154:157]
    s_add_u32 m0, s56, 1024
    s_bfe_u32 s29, s2, 0x40003
    s_and_b32 s18, s2, 4
    v_mfma_f32_16x16x32_bf16 v[158:161], v[74:77], v[98:101], v[158:161]
    s_lshl_b32 s18, s18, 1
    buffer_load_dwordx4 v15, s[12:15], s54 offen lds
    v_mfma_f32_16x16x32_bf16 v[162:165], v[78:81], v[82:85], v[162:165]
    s_lshr_b32 s44, s2, 5
    s_add_u32 s18, s18, s44
    s_lshr_b32 s19, s2, 3
    v_mfma_f32_16x16x32_bf16 v[166:169], v[78:81], v[86:89], v[166:169]
    s_add_u32 m0, s55, 1024
    s_lshr_b32 s44, s2, 6
    s_add_u32 s19, s19, s44
    v_mfma_f32_16x16x32_bf16 v[170:173], v[78:81], v[90:93], v[170:173]
    s_and_b32 s19, s19, 3
    buffer_load_dwordx4 v11, s[8:11], s53 offen lds
    v_mfma_f32_16x16x32_bf16 v[174:177], v[78:81], v[94:97], v[174:177]
    s_and_b32 s44, s2, 3
    s_lshl_b32 s44, s44, 2
    s_add_u32 s19, s19, s44
    v_mfma_f32_16x16x32_bf16 v[178:181], v[78:81], v[98:101], v[178:181]
    s_mov_b32 s46, 0xc0ba4321
    s_mov_b32 s47, 0xf7ed9865
    s_lshl_b32 s44, s29, 2
    s_waitcnt lgkmcnt(11)
    v_mfma_f32_16x16x32_bf16 v[102:105], v[30:33], v[46:49], v[102:105]
    s_add_u32 m0, s56, 2048
    v_add_u32 v23, 0xa040, v23
    v_add_u32 v24, 0xa040, v24
    s_waitcnt lgkmcnt(9)
    v_mfma_f32_16x16x32_bf16 v[106:109], v[30:33], v[50:53], v[106:109]
    s_lshr_b64 s[46:47], s[46:47], s44
    buffer_load_dwordx4 v16, s[12:15], s54 offen lds
    s_waitcnt lgkmcnt(7)
    v_mfma_f32_16x16x32_bf16 v[110:113], v[30:33], v[54:57], v[110:113]
    s_and_b32 s17, s46, 15
    ds_read_b128 v[66:69], v20 offset:32768
    ds_read_b64_tr_b16 v[82:83], v23 offset:0
    s_waitcnt lgkmcnt(7)
    v_mfma_f32_16x16x32_bf16 v[114:117], v[30:33], v[58:61], v[114:117]
    s_add_u32 m0, s55, 2048
    ds_read_b64_tr_b16 v[84:85], v23 offset:1280
    s_mul_i32 s23, s17, 52
    s_waitcnt lgkmcnt(6)
    v_mfma_f32_16x16x32_bf16 v[118:121], v[30:33], v[62:65], v[118:121]
    s_lshr_b32 s23, s23, 8
    buffer_load_dwordx4 v12, s[8:11], s53 offen lds
    s_waitcnt lgkmcnt(5)
    v_mfma_f32_16x16x32_bf16 v[122:125], v[34:37], v[46:49], v[122:125]
    s_mul_i32 s44, s23, 5
    ds_read_b64_tr_b16 v[86:87], v23 offset:40
    ds_read_b64_tr_b16 v[88:89], v23 offset:1320
    v_mfma_f32_16x16x32_bf16 v[126:129], v[34:37], v[50:53], v[126:129]
    s_sub_u32 s24, s17, s44
    ds_read_b64_tr_b16 v[90:91], v23 offset:10256
    s_and_b32 s45, s16, 1
    v_mfma_f32_16x16x32_bf16 v[130:133], v[34:37], v[54:57], v[130:133]
    s_add_u32 m0, s56, 3072
    ds_read_b64_tr_b16 v[92:93], v23 offset:11536
    s_add_u32 s24, s24, s45
    v_mfma_f32_16x16x32_bf16 v[134:137], v[34:37], v[58:61], v[134:137]
    s_cmp_ge_u32 s24, 5
    s_cselect_b32 s24, 0, s24
    ds_read_b64_tr_b16 v[94:95], v23 offset:10296
    v_mfma_f32_16x16x32_bf16 v[138:141], v[34:37], v[62:65], v[138:141]
    s_cmp_ge_u32 s17, 10
    s_cselect_b32 s45, 10, s44
    ds_read_b64_tr_b16 v[96:97], v23 offset:11576
    s_waitcnt lgkmcnt(10)
    v_mfma_f32_16x16x32_bf16 v[142:145], v[38:41], v[46:49], v[142:145]
    s_add_u32 s17, s45, s24
    buffer_load_dwordx4 v17, s[12:15], s54 offen lds
    v_mfma_f32_16x16x32_bf16 v[146:149], v[38:41], v[50:53], v[146:149]
    s_add_u32 m0, s55, 3072
    ds_read_b64_tr_b16 v[98:99], v24 offset:0
    ds_read_b64_tr_b16 v[100:101], v24 offset:1280
    v_mfma_f32_16x16x32_bf16 v[150:153], v[38:41], v[54:57], v[150:153]
    s_lshr_b32 s44, s2, 6
    buffer_load_dwordx4 v13, s[8:11], s53 offen lds
    v_mfma_f32_16x16x32_bf16 v[154:157], v[38:41], v[58:61], v[154:157]
    s_lshl_b32 s44, s44, 1
    ds_read_b128 v[70:73], v20 offset:34816
    ds_read_b128 v[74:77], v20 offset:36864
    v_mfma_f32_16x16x32_bf16 v[158:161], v[38:41], v[62:65], v[158:161]
    s_add_u32 m0, s56, 4096
    ds_read_b128 v[78:81], v20 offset:38912
    s_add_u32 s44, s44, s29
    s_waitcnt lgkmcnt(14)
    v_mfma_f32_16x16x32_bf16 v[162:165], v[42:45], v[46:49], v[162:165]
    s_and_b32 s44, s44, 7
    buffer_load_dwordx4 v18, s[12:15], s54 offen lds
    v_mfma_f32_16x16x32_bf16 v[166:169], v[42:45], v[50:53], v[166:169]
    s_and_b32 s29, s29, 8
    s_add_u32 s29, s29, s44
    s_lshl_b32 s44, s16, 4
    v_mfma_f32_16x16x32_bf16 v[170:173], v[42:45], v[54:57], v[170:173]
    s_add_u32 s29, s29, s44
    s_lshl_b32 s44, s24, 2
    s_add_u32 s44, s44, s3
    v_mfma_f32_16x16x32_bf16 v[174:177], v[42:45], v[58:61], v[174:177]
    s_mul_i32 s20, s44, 40960
    s_add_u32 s20, s20, 13631488
    s_cmp_ge_u32 s17, 10
    s_cselect_b32 s20, 1073741824, s20
    v_mfma_f32_16x16x32_bf16 v[178:181], v[42:45], v[62:65], v[178:181]
    s_lshl_b32 s57, s52, 7
    s_add_u32 s53, s50, s57
    s_mul_i32 s57, s52, 245760
    v_mfma_f32_16x16x32_bf16 v[182:185], v[26:29], v[46:49], v[182:185]
    s_add_u32 s54, s51, s57
    s_add_u32 s52, s52, 1
    s_cmp_eq_u32 s52, 10
    s_cselect_b32 s52, 0, s52
    v_mfma_f32_16x16x32_bf16 v[186:189], v[26:29], v[50:53], v[186:189]
    s_lshr_b32 s44, s44, 1
    s_lshl_b32 s44, s44, 9
    s_add_u32 s25, s44, 688128
    v_mfma_f32_16x16x32_bf16 v[190:193], v[26:29], v[54:57], v[190:193]
    s_add_u32 m0, s55, 16384
    s_lshl_b32 s44, s19, 2
    s_add_u32 s44, s44, s3
    v_mfma_f32_16x16x32_bf16 v[194:197], v[26:29], v[58:61], v[194:197]
    s_mul_i32 s21, s44, 61440
    buffer_load_dwordx4 v10, s[8:11], s53 offen lds
    v_mfma_f32_16x16x32_bf16 v[198:201], v[26:29], v[62:65], v[198:201]
    s_waitcnt vmcnt(10) lgkmcnt(0)
    s_barrier
    s_add_u32 s21, s21, 14680064
    v_mfma_f32_16x16x32_bf16 v[102:105], v[66:69], v[82:85], v[102:105]
    s_add_u32 m0, s56, 20512
    ds_read_b128 v[30:33], v19 offset:49152
    ds_read_b64_tr_b16 v[46:47], v21 offset:20512
    v_mfma_f32_16x16x32_bf16 v[106:109], v[66:69], v[86:89], v[106:109]
    s_lshr_b32 s44, s19, 1
    buffer_load_dwordx4 v14, s[12:15], s54 offen lds
    v_mfma_f32_16x16x32_bf16 v[110:113], v[66:69], v[90:93], v[110:113]
    s_mul_i32 s44, s44, 2560
    ds_read_b64_tr_b16 v[48:49], v21 offset:21792
    ds_read_b64_tr_b16 v[50:51], v21 offset:20552
    v_mfma_f32_16x16x32_bf16 v[114:117], v[66:69], v[94:97], v[114:117]
    s_add_u32 s26, s44, 655360
    ds_read_b64_tr_b16 v[52:53], v21 offset:21832
    s_and_b32 s44, s29, 7
    v_mfma_f32_16x16x32_bf16 v[118:121], v[66:69], v[98:101], v[118:121]
    s_add_u32 m0, s56, 21536
    ds_read_b64_tr_b16 v[54:55], v21 offset:30768
    s_lshl_b32 s44, s44, 2
    v_mfma_f32_16x16x32_bf16 v[122:125], v[70:73], v[82:85], v[122:125]
    s_add_u32 s44, s44, s3
    buffer_load_dwordx4 v15, s[12:15], s54 offen lds
    v_mfma_f32_16x16x32_bf16 v[126:129], v[70:73], v[86:89], v[126:129]
    s_mul_i32 s22, s44, 61440
    ds_read_b64_tr_b16 v[56:57], v21 offset:32048
    ds_read_b64_tr_b16 v[58:59], v21 offset:30808
    v_mfma_f32_16x16x32_bf16 v[130:133], v[70:73], v[90:93], v[130:133]
    s_add_u32 m0, s55, 17408
    ds_read_b64_tr_b16 v[60:61], v21 offset:32088
    s_add_u32 s22, s22, 18874368
    v_mfma_f32_16x16x32_bf16 v[134:137], v[70:73], v[94:97], v[134:137]
    s_bfe_u32 s44, s29, 0x10002
    buffer_load_dwordx4 v11, s[8:11], s53 offen lds
    v_mfma_f32_16x16x32_bf16 v[138:141], v[70:73], v[98:101], v[138:141]
    s_lshl_b32 s44, s44, 2
    ds_read_b64_tr_b16 v[62:63], v22 offset:20512
    ds_read_b64_tr_b16 v[64:65], v22 offset:21792
    v_mfma_f32_16x16x32_bf16 v[142:145], v[74:77], v[82:85], v[142:145]
    s_add_u32 s44, s44, s3
    ds_read_b128 v[34:37], v19 offset:51200
    s_mul_i32 s44, s44, 1536
    v_mfma_f32_16x16x32_bf16 v[146:149], v[74:77], v[86:89], v[146:149]
    s_add_u32 m0, s56, 22560
    ds_read_b128 v[38:41], v19 offset:53248
    s_add_u32 s27, s44, 675840
    v_mfma_f32_16x16x32_bf16 v[150:153], v[74:77], v[90:93], v[150:153]
    s_mul_i32 s28, s3, 20480
    buffer_load_dwordx4 v16, s[12:15], s54 offen lds
    v_mfma_f32_16x16x32_bf16 v[154:157], v[74:77], v[94:97], v[154:157]
    s_mov_b32 s60, 0x358637bd
    ds_read_b128 v[42:45], v19 offset:55296
    s_mov_b32 s61, 0x358637bd
    v_mfma_f32_16x16x32_bf16 v[158:161], v[74:77], v[98:101], v[158:161]
    s_add_u32 m0, s55, 18432
    s_mov_b32 s62, 0x3fb8aa3b
    s_mov_b32 s63, 0x3fb8aa3b
    v_mfma_f32_16x16x32_bf16 v[162:165], v[78:81], v[82:85], v[162:165]
    buffer_load_dwordx4 v12, s[8:11], s53 offen lds
    v_mfma_f32_16x16x32_bf16 v[166:169], v[78:81], v[86:89], v[166:169]
    v_mfma_f32_16x16x32_bf16 v[170:173], v[78:81], v[90:93], v[170:173]
    v_mfma_f32_16x16x32_bf16 v[174:177], v[78:81], v[94:97], v[174:177]
    s_add_u32 m0, s56, 23584
    v_mfma_f32_16x16x32_bf16 v[178:181], v[78:81], v[98:101], v[178:181]
    s_waitcnt lgkmcnt(11)
    buffer_load_dwordx4 v17, s[12:15], s54 offen lds
    v_mfma_f32_16x16x32_bf16 v[102:105], v[30:33], v[46:49], v[102:105]
    s_waitcnt lgkmcnt(9)
    ds_read_b128 v[66:69], v20 offset:49152
    v_mfma_f32_16x16x32_bf16 v[106:109], v[30:33], v[50:53], v[106:109]
    s_add_u32 m0, s55, 19456
    ds_read_b64_tr_b16 v[82:83], v23 offset:20512
    s_waitcnt lgkmcnt(9)
    v_mfma_f32_16x16x32_bf16 v[110:113], v[30:33], v[54:57], v[110:113]
    s_waitcnt lgkmcnt(7)
    buffer_load_dwordx4 v13, s[8:11], s53 offen lds
    v_mfma_f32_16x16x32_bf16 v[114:117], v[30:33], v[58:61], v[114:117]
    s_waitcnt lgkmcnt(5)
    ds_read_b64_tr_b16 v[84:85], v23 offset:21792
    ds_read_b64_tr_b16 v[86:87], v23 offset:20552
    v_mfma_f32_16x16x32_bf16 v[118:121], v[30:33], v[62:65], v[118:121]
    s_waitcnt lgkmcnt(6)
    ds_read_b64_tr_b16 v[88:89], v23 offset:21832
    v_mfma_f32_16x16x32_bf16 v[122:125], v[34:37], v[46:49], v[122:125]
    s_add_u32 m0, s56, 24608
    ds_read_b64_tr_b16 v[90:91], v23 offset:30768
    v_mfma_f32_16x16x32_bf16 v[126:129], v[34:37], v[50:53], v[126:129]
    buffer_load_dwordx4 v18, s[12:15], s54 offen lds
    v_mfma_f32_16x16x32_bf16 v[130:133], v[34:37], v[54:57], v[130:133]
    ds_read_b64_tr_b16 v[92:93], v23 offset:32048
    ds_read_b64_tr_b16 v[94:95], v23 offset:30808
    v_mfma_f32_16x16x32_bf16 v[134:137], v[34:37], v[58:61], v[134:137]
    ds_read_b64_tr_b16 v[96:97], v23 offset:32088
    v_mfma_f32_16x16x32_bf16 v[138:141], v[34:37], v[62:65], v[138:141]
    s_waitcnt lgkmcnt(10)
    ds_read_b64_tr_b16 v[98:99], v24 offset:20512
    v_mfma_f32_16x16x32_bf16 v[142:145], v[38:41], v[46:49], v[142:145]
    s_lshl_b32 s57, s52, 7
    ds_read_b64_tr_b16 v[100:101], v24 offset:21792
Lwkv_0:
    s_cbranch_execz Lwkv_1
    s_add_u32 s53, s50, s57
    v_mfma_f32_16x16x32_bf16 v[146:149], v[38:41], v[50:53], v[146:149]
    s_mul_i32 s57, s52, 245760
    ds_read_b128 v[70:73], v20 offset:51200
    s_add_u32 s54, s51, s57
    v_mfma_f32_16x16x32_bf16 v[150:153], v[38:41], v[54:57], v[150:153]
    s_add_u32 s52, s52, 1
    ds_read_b128 v[74:77], v20 offset:53248
    s_cmp_eq_u32 s52, 10
    s_cselect_b32 s52, 0, s52
    v_mfma_f32_16x16x32_bf16 v[154:157], v[38:41], v[58:61], v[154:157]
    s_add_u32 m0, s55, 32768
    ds_read_b128 v[78:81], v20 offset:55296
    v_mfma_f32_16x16x32_bf16 v[158:161], v[38:41], v[62:65], v[158:161]
    s_waitcnt lgkmcnt(14)
    buffer_load_dwordx4 v10, s[8:11], s53 offen lds
    v_mfma_f32_16x16x32_bf16 v[162:165], v[42:45], v[46:49], v[162:165]
    v_mfma_f32_16x16x32_bf16 v[166:169], v[42:45], v[50:53], v[166:169]
    v_mfma_f32_16x16x32_bf16 v[170:173], v[42:45], v[54:57], v[170:173]
    s_add_u32 m0, s56, 41024
    v_mfma_f32_16x16x32_bf16 v[174:177], v[42:45], v[58:61], v[174:177]
    buffer_load_dwordx4 v14, s[12:15], s54 offen lds
    v_mfma_f32_16x16x32_bf16 v[178:181], v[42:45], v[62:65], v[178:181]
    v_mfma_f32_16x16x32_bf16 v[182:185], v[26:29], v[46:49], v[182:185]
    v_mfma_f32_16x16x32_bf16 v[186:189], v[26:29], v[50:53], v[186:189]
    s_add_u32 m0, s56, 42048
    v_mfma_f32_16x16x32_bf16 v[190:193], v[26:29], v[54:57], v[190:193]
    buffer_load_dwordx4 v15, s[12:15], s54 offen lds
    v_mfma_f32_16x16x32_bf16 v[194:197], v[26:29], v[58:61], v[194:197]
    v_mfma_f32_16x16x32_bf16 v[198:201], v[26:29], v[62:65], v[198:201]
    s_waitcnt vmcnt(12) lgkmcnt(0)
    s_barrier
    v_mfma_f32_16x16x32_bf16 v[102:105], v[66:69], v[82:85], v[102:105]
    s_add_u32 m0, s55, 33792
    v_add_u32 v21, 0xffff5fc0, v21
    v_add_u32 v22, 0xffff5fc0, v22
    v_mfma_f32_16x16x32_bf16 v[106:109], v[66:69], v[86:89], v[106:109]
    buffer_load_dwordx4 v11, s[8:11], s53 offen lds
    v_mfma_f32_16x16x32_bf16 v[110:113], v[66:69], v[90:93], v[110:113]
    ds_read_b128 v[30:33], v19 offset:0
    ds_read_b64_tr_b16 v[46:47], v21 offset:0
    v_mfma_f32_16x16x32_bf16 v[114:117], v[66:69], v[94:97], v[114:117]
    ds_read_b64_tr_b16 v[48:49], v21 offset:1280
    v_mfma_f32_16x16x32_bf16 v[118:121], v[66:69], v[98:101], v[118:121]
    s_add_u32 m0, s56, 43072
    ds_read_b64_tr_b16 v[50:51], v21 offset:40
    ds_read_b64_tr_b16 v[52:53], v21 offset:1320
    v_mfma_f32_16x16x32_bf16 v[122:125], v[70:73], v[82:85], v[122:125]
    buffer_load_dwordx4 v16, s[12:15], s54 offen lds
    v_mfma_f32_16x16x32_bf16 v[126:129], v[70:73], v[86:89], v[126:129]
    ds_read_b64_tr_b16 v[54:55], v21 offset:10256
    ds_read_b64_tr_b16 v[56:57], v21 offset:11536
    v_mfma_f32_16x16x32_bf16 v[130:133], v[70:73], v[90:93], v[130:133]
    ds_read_b64_tr_b16 v[58:59], v21 offset:10296
    v_mfma_f32_16x16x32_bf16 v[134:137], v[70:73], v[94:97], v[134:137]
    s_add_u32 m0, s55, 34816
    ds_read_b64_tr_b16 v[60:61], v21 offset:11576
    ds_read_b64_tr_b16 v[62:63], v22 offset:0
    v_mfma_f32_16x16x32_bf16 v[138:141], v[70:73], v[98:101], v[138:141]
    buffer_load_dwordx4 v12, s[8:11], s53 offen lds
    v_mfma_f32_16x16x32_bf16 v[142:145], v[74:77], v[82:85], v[142:145]
    ds_read_b64_tr_b16 v[64:65], v22 offset:1280
    ds_read_b128 v[34:37], v19 offset:2048
    v_mfma_f32_16x16x32_bf16 v[146:149], v[74:77], v[86:89], v[146:149]
    ds_read_b128 v[38:41], v19 offset:4096
    v_mfma_f32_16x16x32_bf16 v[150:153], v[74:77], v[90:93], v[150:153]
    s_add_u32 m0, s56, 44096
    ds_read_b128 v[42:45], v19 offset:6144
    v_mfma_f32_16x16x32_bf16 v[154:157], v[74:77], v[94:97], v[154:157]
    buffer_load_dwordx4 v17, s[12:15], s54 offen lds
    v_mfma_f32_16x16x32_bf16 v[158:161], v[74:77], v[98:101], v[158:161]
    v_mfma_f32_16x16x32_bf16 v[162:165], v[78:81], v[82:85], v[162:165]
    v_mfma_f32_16x16x32_bf16 v[166:169], v[78:81], v[86:89], v[166:169]
    s_add_u32 m0, s55, 35840
    v_mfma_f32_16x16x32_bf16 v[170:173], v[78:81], v[90:93], v[170:173]
    buffer_load_dwordx4 v13, s[8:11], s53 offen lds
    v_mfma_f32_16x16x32_bf16 v[174:177], v[78:81], v[94:97], v[174:177]
    v_mfma_f32_16x16x32_bf16 v[178:181], v[78:81], v[98:101], v[178:181]
    s_waitcnt lgkmcnt(11)
    v_mfma_f32_16x16x32_bf16 v[102:105], v[30:33], v[46:49], v[102:105]
    s_add_u32 m0, s56, 45120
    v_add_u32 v23, 0xffff5fc0, v23
    v_add_u32 v24, 0xffff5fc0, v24
    s_waitcnt lgkmcnt(9)
    v_mfma_f32_16x16x32_bf16 v[106:109], v[30:33], v[50:53], v[106:109]
    s_waitcnt lgkmcnt(7)
    buffer_load_dwordx4 v18, s[12:15], s54 offen lds
    v_mfma_f32_16x16x32_bf16 v[110:113], v[30:33], v[54:57], v[110:113]
    s_waitcnt lgkmcnt(5)
    ds_read_b128 v[66:69], v20 offset:0
    ds_read_b64_tr_b16 v[82:83], v23 offset:0
    v_mfma_f32_16x16x32_bf16 v[114:117], v[30:33], v[58:61], v[114:117]
    s_waitcnt lgkmcnt(5)
    ds_read_b64_tr_b16 v[84:85], v23 offset:1280
    v_mfma_f32_16x16x32_bf16 v[118:121], v[30:33], v[62:65], v[118:121]
    s_waitcnt lgkmcnt(5)
    ds_read_b64_tr_b16 v[86:87], v23 offset:40
    v_mfma_f32_16x16x32_bf16 v[122:125], v[34:37], v[46:49], v[122:125]
    s_lshl_b32 s57, s52, 7
    ds_read_b64_tr_b16 v[88:89], v23 offset:1320
    s_add_u32 s53, s50, s57
    v_mfma_f32_16x16x32_bf16 v[126:129], v[34:37], v[50:53], v[126:129]
    s_mul_i32 s57, s52, 245760
    ds_read_b64_tr_b16 v[90:91], v23 offset:10256
    s_add_u32 s54, s51, s57
    v_mfma_f32_16x16x32_bf16 v[130:133], v[34:37], v[54:57], v[130:133]
    s_add_u32 s52, s52, 1
    ds_read_b64_tr_b16 v[92:93], v23 offset:11536
    s_cmp_eq_u32 s52, 10
    s_cselect_b32 s52, 0, s52
    v_mfma_f32_16x16x32_bf16 v[134:137], v[34:37], v[58:61], v[134:137]
    s_add_u32 m0, s55, 49152
    ds_read_b64_tr_b16 v[94:95], v23 offset:10296
    v_mfma_f32_16x16x32_bf16 v[138:141], v[34:37], v[62:65], v[138:141]
    s_waitcnt lgkmcnt(9)
    buffer_load_dwordx4 v10, s[8:11], s53 offen lds
    v_mfma_f32_16x16x32_bf16 v[142:145], v[38:41], v[46:49], v[142:145]
    ds_read_b64_tr_b16 v[96:97], v23 offset:11576
    ds_read_b64_tr_b16 v[98:99], v24 offset:0
    v_mfma_f32_16x16x32_bf16 v[146:149], v[38:41], v[50:53], v[146:149]
    ds_read_b64_tr_b16 v[100:101], v24 offset:1280
    v_mfma_f32_16x16x32_bf16 v[150:153], v[38:41], v[54:57], v[150:153]
    ds_read_b128 v[70:73], v20 offset:2048
    v_mfma_f32_16x16x32_bf16 v[154:157], v[38:41], v[58:61], v[154:157]
    s_add_u32 m0, s56, 61536
    ds_read_b128 v[74:77], v20 offset:4096
    v_mfma_f32_16x16x32_bf16 v[158:161], v[38:41], v[62:65], v[158:161]
    s_waitcnt lgkmcnt(13)
    buffer_load_dwordx4 v14, s[12:15], s54 offen lds
    v_mfma_f32_16x16x32_bf16 v[162:165], v[42:45], v[46:49], v[162:165]
    ds_read_b128 v[78:81], v20 offset:6144
    v_mfma_f32_16x16x32_bf16 v[166:169], v[42:45], v[50:53], v[166:169]
    v_mfma_f32_16x16x32_bf16 v[170:173], v[42:45], v[54:57], v[170:173]
    v_mfma_f32_16x16x32_bf16 v[174:177], v[42:45], v[58:61], v[174:177]
    v_mfma_f32_16x16x32_bf16 v[178:181], v[42:45], v[62:65], v[178:181]
    s_add_u32 m0, s56, 62560
    v_mfma_f32_16x16x32_bf16 v[182:185], v[26:29], v[46:49], v[182:185]
    buffer_load_dwordx4 v15, s[12:15], s54 offen lds
    v_mfma_f32_16x16x32_bf16 v[186:189], v[26:29], v[50:53], v[186:189]
    v_mfma_f32_16x16x32_bf16 v[190:193], v[26:29], v[54:57], v[190:193]
    v_mfma_f32_16x16x32_bf16 v[194:197], v[26:29], v[58:61], v[194:197]
    v_mfma_f32_16x16x32_bf16 v[198:201], v[26:29], v[62:65], v[198:201]
    s_waitcnt vmcnt(12) lgkmcnt(0)
    s_barrier
    v_mfma_f32_16x16x32_bf16 v[102:105], v[66:69], v[82:85], v[102:105]
    s_add_u32 m0, s55, 50176
    ds_read_b128 v[30:33], v19 offset:16384
    ds_read_b64_tr_b16 v[46:47], v21 offset:20512
    v_mfma_f32_16x16x32_bf16 v[106:109], v[66:69], v[86:89], v[106:109]
    buffer_load_dwordx4 v11, s[8:11], s53 offen lds
    v_mfma_f32_16x16x32_bf16 v[110:113], v[66:69], v[90:93], v[110:113]
    ds_read_b64_tr_b16 v[48:49], v21 offset:21792
    ds_read_b64_tr_b16 v[50:51], v21 offset:20552
    v_mfma_f32_16x16x32_bf16 v[114:117], v[66:69], v[94:97], v[114:117]
    ds_read_b64_tr_b16 v[52:53], v21 offset:21832
    v_mfma_f32_16x16x32_bf16 v[118:121], v[66:69], v[98:101], v[118:121]
    ds_read_b64_tr_b16 v[54:55], v21 offset:30768
    v_mfma_f32_16x16x32_bf16 v[122:125], v[70:73], v[82:85], v[122:125]
    ds_read_b64_tr_b16 v[56:57], v21 offset:32048
    v_mfma_f32_16x16x32_bf16 v[126:129], v[70:73], v[86:89], v[126:129]
    s_add_u32 m0, s56, 63584
    ds_read_b64_tr_b16 v[58:59], v21 offset:30808
    v_mfma_f32_16x16x32_bf16 v[130:133], v[70:73], v[90:93], v[130:133]
    buffer_load_dwordx4 v16, s[12:15], s54 offen lds
    v_mfma_f32_16x16x32_bf16 v[134:137], v[70:73], v[94:97], v[134:137]
    ds_read_b64_tr_b16 v[60:61], v21 offset:32088
    ds_read_b64_tr_b16 v[62:63], v22 offset:20512
    v_mfma_f32_16x16x32_bf16 v[138:141], v[70:73], v[98:101], v[138:141]
    ds_read_b64_tr_b16 v[64:65], v22 offset:21792
    v_mfma_f32_16x16x32_bf16 v[142:145], v[74:77], v[82:85], v[142:145]
    ds_read_b128 v[34:37], v19 offset:18432
    v_mfma_f32_16x16x32_bf16 v[146:149], v[74:77], v[86:89], v[146:149]
    s_add_u32 m0, s55, 51200
    ds_read_b128 v[38:41], v19 offset:20480
    v_mfma_f32_16x16x32_bf16 v[150:153], v[74:77], v[90:93], v[150:153]
    buffer_load_dwordx4 v12, s[8:11], s53 offen lds
    v_mfma_f32_16x16x32_bf16 v[154:157], v[74:77], v[94:97], v[154:157]
    ds_read_b128 v[42:45], v19 offset:22528
    v_mfma_f32_16x16x32_bf16 v[158:161], v[74:77], v[98:101], v[158:161]
    v_mfma_f32_16x16x32_bf16 v[162:165], v[78:81], v[82:85], v[162:165]
    v_mfma_f32_16x16x32_bf16 v[166:169], v[78:81], v[86:89], v[166:169]
    v_mfma_f32_16x16x32_bf16 v[170:173], v[78:81], v[90:93], v[170:173]
    s_add_u32 m0, s56, 64608
    v_mfma_f32_16x16x32_bf16 v[174:177], v[78:81], v[94:97], v[174:177]
    buffer_load_dwordx4 v17, s[12:15], s54 offen lds
    v_mfma_f32_16x16x32_bf16 v[178:181], v[78:81], v[98:101], v[178:181]
    s_waitcnt lgkmcnt(11)
    v_mfma_f32_16x16x32_bf16 v[102:105], v[30:33], v[46:49], v[102:105]
    s_waitcnt lgkmcnt(9)
    ds_read_b128 v[66:69], v20 offset:16384
    v_mfma_f32_16x16x32_bf16 v[106:109], v[30:33], v[50:53], v[106:109]
    s_waitcnt lgkmcnt(8)
    ds_read_b64_tr_b16 v[82:83], v23 offset:20512
    v_mfma_f32_16x16x32_bf16 v[110:113], v[30:33], v[54:57], v[110:113]
    s_waitcnt lgkmcnt(7)
    ds_read_b64_tr_b16 v[84:85], v23 offset:21792
    v_mfma_f32_16x16x32_bf16 v[114:117], v[30:33], v[58:61], v[114:117]
    s_add_u32 m0, s55, 52224
    ds_read_b64_tr_b16 v[86:87], v23 offset:20552
    s_waitcnt lgkmcnt(7)
    v_mfma_f32_16x16x32_bf16 v[118:121], v[30:33], v[62:65], v[118:121]
    s_waitcnt lgkmcnt(6)
    buffer_load_dwordx4 v13, s[8:11], s53 offen lds
    v_mfma_f32_16x16x32_bf16 v[122:125], v[34:37], v[46:49], v[122:125]
    ds_read_b64_tr_b16 v[88:89], v23 offset:21832
    ds_read_b64_tr_b16 v[90:91], v23 offset:30768
    v_mfma_f32_16x16x32_bf16 v[126:129], v[34:37], v[50:53], v[126:129]
    ds_read_b64_tr_b16 v[92:93], v23 offset:32048
    v_mfma_f32_16x16x32_bf16 v[130:133], v[34:37], v[54:57], v[130:133]
    ds_read_b64_tr_b16 v[94:95], v23 offset:30808
    v_mfma_f32_16x16x32_bf16 v[134:137], v[34:37], v[58:61], v[134:137]
    ds_read_b64_tr_b16 v[96:97], v23 offset:32088
    v_mfma_f32_16x16x32_bf16 v[138:141], v[34:37], v[62:65], v[138:141]
    s_add_u32 m0, s56, 65632
    ds_read_b64_tr_b16 v[98:99], v24 offset:20512
    s_waitcnt lgkmcnt(11)
    v_mfma_f32_16x16x32_bf16 v[142:145], v[38:41], v[46:49], v[142:145]
    buffer_load_dwordx4 v18, s[12:15], s54 offen lds
    v_mfma_f32_16x16x32_bf16 v[146:149], v[38:41], v[50:53], v[146:149]
    ds_read_b64_tr_b16 v[100:101], v24 offset:21792
    ds_read_b128 v[70:73], v20 offset:18432
    v_mfma_f32_16x16x32_bf16 v[150:153], v[38:41], v[54:57], v[150:153]
    ds_read_b128 v[74:77], v20 offset:20480
    v_mfma_f32_16x16x32_bf16 v[154:157], v[38:41], v[58:61], v[154:157]
    ds_read_b128 v[78:81], v20 offset:22528
    v_mfma_f32_16x16x32_bf16 v[158:161], v[38:41], v[62:65], v[158:161]
    s_waitcnt lgkmcnt(14)
    v_mfma_f32_16x16x32_bf16 v[162:165], v[42:45], v[46:49], v[162:165]
    buffer_load_dword v250, v251, s[36:39], 0 offen offset:0 sc1
    v_mfma_f32_16x16x32_bf16 v[166:169], v[42:45], v[50:53], v[166:169]
    s_lshl_b32 s57, s52, 7
    s_add_u32 s53, s50, s57
    s_mul_i32 s57, s52, 245760
    v_mfma_f32_16x16x32_bf16 v[170:173], v[42:45], v[54:57], v[170:173]
    s_add_u32 s54, s51, s57
    s_add_u32 s52, s52, 1
    s_cmp_eq_u32 s52, 10
    s_cselect_b32 s52, 0, s52
    v_mfma_f32_16x16x32_bf16 v[174:177], v[42:45], v[58:61], v[174:177]
    v_mfma_f32_16x16x32_bf16 v[178:181], v[42:45], v[62:65], v[178:181]
    s_add_u32 m0, s55, 0
    v_mfma_f32_16x16x32_bf16 v[182:185], v[26:29], v[46:49], v[182:185]
    buffer_load_dwordx4 v10, s[8:11], s53 offen lds
    v_mfma_f32_16x16x32_bf16 v[186:189], v[26:29], v[50:53], v[186:189]
    v_mfma_f32_16x16x32_bf16 v[190:193], v[26:29], v[54:57], v[190:193]
    v_mfma_f32_16x16x32_bf16 v[194:197], v[26:29], v[58:61], v[194:197]
    v_mfma_f32_16x16x32_bf16 v[198:201], v[26:29], v[62:65], v[198:201]
    s_waitcnt vmcnt(11) lgkmcnt(0)
    s_barrier
    s_add_u32 m0, s56, 0
    v_mfma_f32_16x16x32_bf16 v[102:105], v[66:69], v[82:85], v[102:105]
    buffer_load_dwordx4 v14, s[12:15], s54 offen lds
    v_mfma_f32_16x16x32_bf16 v[106:109], v[66:69], v[86:89], v[106:109]
    v_add_u32 v21, 0xa040, v21
    v_add_u32 v22, 0xa040, v22
    v_mfma_f32_16x16x32_bf16 v[110:113], v[66:69], v[90:93], v[110:113]
    ds_read_b128 v[30:33], v19 offset:32768
    ds_read_b64_tr_b16 v[46:47], v21 offset:0
    v_mfma_f32_16x16x32_bf16 v[114:117], v[66:69], v[94:97], v[114:117]
    ds_read_b64_tr_b16 v[48:49], v21 offset:1280
    v_mfma_f32_16x16x32_bf16 v[118:121], v[66:69], v[98:101], v[118:121]
    ds_read_b64_tr_b16 v[50:51], v21 offset:40
    ds_read_b64_tr_b16 v[52:53], v21 offset:1320
    v_mfma_f32_16x16x32_bf16 v[122:125], v[70:73], v[82:85], v[122:125]
    s_add_u32 m0, s56, 1024
    ds_read_b64_tr_b16 v[54:55], v21 offset:10256
    v_mfma_f32_16x16x32_bf16 v[126:129], v[70:73], v[86:89], v[126:129]
    buffer_load_dwordx4 v15, s[12:15], s54 offen lds
    v_mfma_f32_16x16x32_bf16 v[130:133], v[70:73], v[90:93], v[130:133]
    ds_read_b64_tr_b16 v[56:57], v21 offset:11536
    ds_read_b64_tr_b16 v[58:59], v21 offset:10296
    v_mfma_f32_16x16x32_bf16 v[134:137], v[70:73], v[94:97], v[134:137]
    ds_read_b64_tr_b16 v[60:61], v21 offset:11576
    ds_read_b64_tr_b16 v[62:63], v22 offset:0
    v_mfma_f32_16x16x32_bf16 v[138:141], v[70:73], v[98:101], v[138:141]
    ds_read_b64_tr_b16 v[64:65], v22 offset:1280
    v_mfma_f32_16x16x32_bf16 v[142:145], v[74:77], v[82:85], v[142:145]
    ds_read_b128 v[34:37], v19 offset:34816
    v_mfma_f32_16x16x32_bf16 v[146:149], v[74:77], v[86:89], v[146:149]
    s_add_u32 m0, s55, 1024
    ds_read_b128 v[38:41], v19 offset:36864
    v_mfma_f32_16x16x32_bf16 v[150:153], v[74:77], v[90:93], v[150:153]
    buffer_load_dwordx4 v11, s[8:11], s53 offen lds
    v_mfma_f32_16x16x32_bf16 v[154:157], v[74:77], v[94:97], v[154:157]
    ds_read_b128 v[42:45], v19 offset:38912
    v_mfma_f32_16x16x32_bf16 v[158:161], v[74:77], v[98:101], v[158:161]
    v_mfma_f32_16x16x32_bf16 v[162:165], v[78:81], v[82:85], v[162:165]
    v_mfma_f32_16x16x32_bf16 v[166:169], v[78:81], v[86:89], v[166:169]
    v_mfma_f32_16x16x32_bf16 v[170:173], v[78:81], v[90:93], v[170:173]
    s_add_u32 m0, s56, 2048
    v_mfma_f32_16x16x32_bf16 v[174:177], v[78:81], v[94:97], v[174:177]
    buffer_load_dwordx4 v16, s[12:15], s54 offen lds
    v_mfma_f32_16x16x32_bf16 v[178:181], v[78:81], v[98:101], v[178:181]
    s_waitcnt lgkmcnt(11)
    v_mfma_f32_16x16x32_bf16 v[102:105], v[30:33], v[46:49], v[102:105]
    s_waitcnt lgkmcnt(9)
    v_add_u32 v23, 0xa040, v23
    v_add_u32 v24, 0xa040, v24
    v_mfma_f32_16x16x32_bf16 v[106:109], v[30:33], v[50:53], v[106:109]
    s_waitcnt lgkmcnt(7)
    ds_read_b128 v[66:69], v20 offset:32768
    v_mfma_f32_16x16x32_bf16 v[110:113], v[30:33], v[54:57], v[110:113]
    s_add_u32 m0, s55, 2048
    ds_read_b64_tr_b16 v[82:83], v23 offset:0
    s_waitcnt lgkmcnt(7)
    v_mfma_f32_16x16x32_bf16 v[114:117], v[30:33], v[58:61], v[114:117]
    s_waitcnt lgkmcnt(5)
    buffer_load_dwordx4 v12, s[8:11], s53 offen lds
    v_mfma_f32_16x16x32_bf16 v[118:121], v[30:33], v[62:65], v[118:121]
    s_waitcnt lgkmcnt(4)
    ds_read_b64_tr_b16 v[84:85], v23 offset:1280
    ds_read_b64_tr_b16 v[86:87], v23 offset:40
    v_mfma_f32_16x16x32_bf16 v[122:125], v[34:37], v[46:49], v[122:125]
    ds_read_b64_tr_b16 v[88:89], v23 offset:1320
    v_mfma_f32_16x16x32_bf16 v[126:129], v[34:37], v[50:53], v[126:129]
    ds_read_b64_tr_b16 v[90:91], v23 offset:10256
    v_mfma_f32_16x16x32_bf16 v[130:133], v[34:37], v[54:57], v[130:133]
    ds_read_b64_tr_b16 v[92:93], v23 offset:11536
    v_mfma_f32_16x16x32_bf16 v[134:137], v[34:37], v[58:61], v[134:137]
    s_add_u32 m0, s56, 3072
    ds_read_b64_tr_b16 v[94:95], v23 offset:10296
    v_mfma_f32_16x16x32_bf16 v[138:141], v[34:37], v[62:65], v[138:141]
    s_waitcnt lgkmcnt(9)
    buffer_load_dwordx4 v17, s[12:15], s54 offen lds
    v_mfma_f32_16x16x32_bf16 v[142:145], v[38:41], v[46:49], v[142:145]
    ds_read_b64_tr_b16 v[96:97], v23 offset:11576
    ds_read_b64_tr_b16 v[98:99], v24 offset:0
    v_mfma_f32_16x16x32_bf16 v[146:149], v[38:41], v[50:53], v[146:149]
    ds_read_b64_tr_b16 v[100:101], v24 offset:1280
    v_mfma_f32_16x16x32_bf16 v[150:153], v[38:41], v[54:57], v[150:153]
    ds_read_b128 v[70:73], v20 offset:34816
    v_mfma_f32_16x16x32_bf16 v[154:157], v[38:41], v[58:61], v[154:157]
    ds_read_b128 v[74:77], v20 offset:36864
    v_mfma_f32_16x16x32_bf16 v[158:161], v[38:41], v[62:65], v[158:161]
    s_add_u32 m0, s55, 3072
    ds_read_b128 v[78:81], v20 offset:38912
    s_waitcnt lgkmcnt(14)
    v_mfma_f32_16x16x32_bf16 v[162:165], v[42:45], v[46:49], v[162:165]
    buffer_load_dwordx4 v13, s[8:11], s53 offen lds
    v_mfma_f32_16x16x32_bf16 v[166:169], v[42:45], v[50:53], v[166:169]
    v_mfma_f32_16x16x32_bf16 v[170:173], v[42:45], v[54:57], v[170:173]
    v_mfma_f32_16x16x32_bf16 v[174:177], v[42:45], v[58:61], v[174:177]
    v_mfma_f32_16x16x32_bf16 v[178:181], v[42:45], v[62:65], v[178:181]
    v_mfma_f32_16x16x32_bf16 v[182:185], v[26:29], v[46:49], v[182:185]
    s_add_u32 m0, s56, 4096
    v_mfma_f32_16x16x32_bf16 v[186:189], v[26:29], v[50:53], v[186:189]
    buffer_load_dwordx4 v18, s[12:15], s54 offen lds
    v_mfma_f32_16x16x32_bf16 v[190:193], v[26:29], v[54:57], v[190:193]
    v_mfma_f32_16x16x32_bf16 v[194:197], v[26:29], v[58:61], v[194:197]
    v_mfma_f32_16x16x32_bf16 v[198:201], v[26:29], v[62:65], v[198:201]
    s_waitcnt vmcnt(10) lgkmcnt(0)
    s_barrier
    v_mfma_f32_16x16x32_bf16 v[102:105], v[66:69], v[82:85], v[102:105]
    ds_read_b128 v[30:33], v19 offset:49152
    ds_read_b64_tr_b16 v[46:47], v21 offset:20512
    v_mfma_f32_16x16x32_bf16 v[106:109], v[66:69], v[86:89], v[106:109]
    ds_read_b64_tr_b16 v[48:49], v21 offset:21792
    s_waitcnt vmcnt(9)
    v_cmp_gt_u32 vcc, 1, v250
    v_mfma_f32_16x16x32_bf16 v[110:113], v[66:69], v[90:93], v[110:113]
    ds_read_b64_tr_b16 v[50:51], v21 offset:20552
    s_cbranch_vccnz Lslow1
Lback1:
    v_mfma_f32_16x16x32_bf16 v[114:117], v[66:69], v[94:97], v[114:117]
    s_mov_b32 m0, s99
    ds_read_b64_tr_b16 v[52:53], v21 offset:21832
    v_mfma_f32_16x16x32_bf16 v[118:121], v[66:69], v[98:101], v[118:121]
    buffer_load_dword v251, s[40:43], s98 offen sc1 lds
    v_mfma_f32_16x16x32_bf16 v[122:125], v[70:73], v[82:85], v[122:125]
    s_lshl_b32 s57, s52, 7
    ds_read_b64_tr_b16 v[54:55], v21 offset:30768
    ds_read_b64_tr_b16 v[56:57], v21 offset:32048
    v_mfma_f32_16x16x32_bf16 v[126:129], v[70:73], v[86:89], v[126:129]
    s_add_u32 s53, s50, s57
    ds_read_b64_tr_b16 v[58:59], v21 offset:30808
    s_mul_i32 s57, s52, 245760
    v_mfma_f32_16x16x32_bf16 v[130:133], v[70:73], v[90:93], v[130:133]
    s_add_u32 s54, s51, s57
    ds_read_b64_tr_b16 v[60:61], v21 offset:32088
    s_add_u32 s52, s52, 1
    v_mfma_f32_16x16x32_bf16 v[134:137], v[70:73], v[94:97], v[134:137]
    s_cmp_eq_u32 s52, 10
    s_cselect_b32 s52, 0, s52
    ds_read_b64_tr_b16 v[62:63], v22 offset:20512
    v_mfma_f32_16x16x32_bf16 v[138:141], v[70:73], v[98:101], v[138:141]
    s_add_u32 m0, s55, 16384
    ds_read_b64_tr_b16 v[64:65], v22 offset:21792
    v_mfma_f32_16x16x32_bf16 v[142:145], v[74:77], v[82:85], v[142:145]
    buffer_load_dwordx4 v10, s[8:11], s53 offen lds
    v_mfma_f32_16x16x32_bf16 v[146:149], v[74:77], v[86:89], v[146:149]
    s_add_u32 m0, s56, 20512
    ds_read_b128 v[34:37], v19 offset:51200
    ds_read_b128 v[38:41], v19 offset:53248
    v_mfma_f32_16x16x32_bf16 v[150:153], v[74:77], v[90:93], v[150:153]
    buffer_load_dwordx4 v14, s[12:15], s54 offen lds
    v_mfma_f32_16x16x32_bf16 v[154:157], v[74:77], v[94:97], v[154:157]
    ds_read_b128 v[42:45], v19 offset:55296
    v_mfma_f32_16x16x32_bf16 v[158:161], v[74:77], v[98:101], v[158:161]
    v_mfma_f32_16x16x32_bf16 v[162:165], v[78:81], v[82:85], v[162:165]
    v_mfma_f32_16x16x32_bf16 v[166:169], v[78:81], v[86:89], v[166:169]
    s_add_u32 m0, s56, 21536
    v_mfma_f32_16x16x32_bf16 v[170:173], v[78:81], v[90:93], v[170:173]
    buffer_load_dwordx4 v15, s[12:15], s54 offen lds
    v_mfma_f32_16x16x32_bf16 v[174:177], v[78:81], v[94:97], v[174:177]
    v_mfma_f32_16x16x32_bf16 v[178:181], v[78:81], v[98:101], v[178:181]
    s_waitcnt lgkmcnt(11)
    v_mfma_f32_16x16x32_bf16 v[102:105], v[30:33], v[46:49], v[102:105]
    s_waitcnt lgkmcnt(9)
    ds_read_b128 v[66:69], v20 offset:49152
    v_mfma_f32_16x16x32_bf16 v[106:109], v[30:33], v[50:53], v[106:109]
    s_waitcnt lgkmcnt(8)
    ds_read_b64_tr_b16 v[82:83], v23 offset:20512
    v_mfma_f32_16x16x32_bf16 v[110:113], v[30:33], v[54:57], v[110:113]
    s_add_u32 m0, s55, 17408
    ds_read_b64_tr_b16 v[84:85], v23 offset:21792
    s_waitcnt lgkmcnt(8)
    v_mfma_f32_16x16x32_bf16 v[114:117], v[30:33], v[58:61], v[114:117]
    s_waitcnt lgkmcnt(6)
    buffer_load_dwordx4 v11, s[8:11], s53 offen lds
    v_mfma_f32_16x16x32_bf16 v[118:121], v[30:33], v[62:65], v[118:121]
    s_waitcnt lgkmcnt(5)
    ds_read_b64_tr_b16 v[86:87], v23 offset:20552
    ds_read_b64_tr_b16 v[88:89], v23 offset:21832
    v_mfma_f32_16x16x32_bf16 v[122:125], v[34:37], v[46:49], v[122:125]
    ds_read_b64_tr_b16 v[90:91], v23 offset:30768
    v_mfma_f32_16x16x32_bf16 v[126:129], v[34:37], v[50:53], v[126:129]
    ds_read_b64_tr_b16 v[92:93], v23 offset:32048
    v_mfma_f32_16x16x32_bf16 v[130:133], v[34:37], v[54:57], v[130:133]
    ds_read_b64_tr_b16 v[94:95], v23 offset:30808
    v_mfma_f32_16x16x32_bf16 v[134:137], v[34:37], v[58:61], v[134:137]
    s_add_u32 m0, s56, 22560
    ds_read_b64_tr_b16 v[96:97], v23 offset:32088
    v_mfma_f32_16x16x32_bf16 v[138:141], v[34:37], v[62:65], v[138:141]
    s_waitcnt lgkmcnt(10)
    buffer_load_dwordx4 v16, s[12:15], s54 offen lds
    v_mfma_f32_16x16x32_bf16 v[142:145], v[38:41], v[46:49], v[142:145]
    ds_read_b64_tr_b16 v[98:99], v24 offset:20512
    ds_read_b64_tr_b16 v[100:101], v24 offset:21792
    v_mfma_f32_16x16x32_bf16 v[146:149], v[38:41], v[50:53], v[146:149]
    buffer_load_dword v250, v254, s[40:43], s25 offen offset:0 sc1
    v_mfma_f32_16x16x32_bf16 v[150:153], v[38:41], v[54:57], v[150:153]
    ds_read_b128 v[70:73], v20 offset:51200
    ds_read_b128 v[74:77], v20 offset:53248
    v_mfma_f32_16x16x32_bf16 v[154:157], v[38:41], v[58:61], v[154:157]
    s_add_u32 m0, s55, 18432
    ds_read_b128 v[78:81], v20 offset:55296
    v_mfma_f32_16x16x32_bf16 v[158:161], v[38:41], v[62:65], v[158:161]
    s_waitcnt lgkmcnt(14)
    buffer_load_dwordx4 v12, s[8:11], s53 offen lds
    v_mfma_f32_16x16x32_bf16 v[162:165], v[42:45], v[46:49], v[162:165]
    v_mfma_f32_16x16x32_bf16 v[166:169], v[42:45], v[50:53], v[166:169]
    v_mfma_f32_16x16x32_bf16 v[170:173], v[42:45], v[54:57], v[170:173]
    v_mfma_f32_16x16x32_bf16 v[174:177], v[42:45], v[58:61], v[174:177]
    v_mfma_f32_16x16x32_bf16 v[178:181], v[42:45], v[62:65], v[178:181]
    s_add_u32 m0, s56, 23584
    v_mfma_f32_16x16x32_bf16 v[182:185], v[26:29], v[46:49], v[182:185]
    buffer_load_dwordx4 v17, s[12:15], s54 offen lds
    v_mfma_f32_16x16x32_bf16 v[186:189], v[26:29], v[50:53], v[186:189]
    v_mfma_f32_16x16x32_bf16 v[190:193], v[26:29], v[54:57], v[190:193]
    v_mfma_f32_16x16x32_bf16 v[194:197], v[26:29], v[58:61], v[194:197]
    v_mfma_f32_16x16x32_bf16 v[198:201], v[26:29], v[62:65], v[198:201]
    s_waitcnt vmcnt(9) lgkmcnt(0)
    s_barrier
    s_waitcnt vmcnt(8)
    v_mfma_f32_16x16x32_bf16 v[102:105], v[66:69], v[82:85], v[102:105]
    s_add_u32 m0, s55, 19456
    v_add_u32 v21, 0xffff5fc0, v21
    v_add_u32 v22, 0xffff5fc0, v22
    v_mfma_f32_16x16x32_bf16 v[106:109], v[66:69], v[86:89], v[106:109]
    buffer_load_dwordx4 v13, s[8:11], s53 offen lds
    v_mfma_f32_16x16x32_bf16 v[110:113], v[66:69], v[90:93], v[110:113]
    ds_read_b128 v[30:33], v19 offset:0
    ds_read_b64_tr_b16 v[46:47], v21 offset:0
    v_mfma_f32_16x16x32_bf16 v[114:117], v[66:69], v[94:97], v[114:117]
    ds_read_b64_tr_b16 v[48:49], v21 offset:1280
    v_mfma_f32_16x16x32_bf16 v[118:121], v[66:69], v[98:101], v[118:121]
    ds_read_b64_tr_b16 v[50:51], v21 offset:40
    ds_read_b64_tr_b16 v[52:53], v21 offset:1320
    v_mfma_f32_16x16x32_bf16 v[122:125], v[70:73], v[82:85], v[122:125]
    ds_read_b64_tr_b16 v[54:55], v21 offset:10256
    v_mfma_f32_16x16x32_bf16 v[126:129], v[70:73], v[86:89], v[126:129]
    s_add_u32 m0, s56, 24608
    ds_read_b64_tr_b16 v[56:57], v21 offset:11536
    v_mfma_f32_16x16x32_bf16 v[130:133], v[70:73], v[90:93], v[130:133]
    buffer_load_dwordx4 v18, s[12:15], s54 offen lds
    v_mfma_f32_16x16x32_bf16 v[134:137], v[70:73], v[94:97], v[134:137]
    ds_read_b64_tr_b16 v[58:59], v21 offset:10296
    ds_read_b64_tr_b16 v[60:61], v21 offset:11576
    v_mfma_f32_16x16x32_bf16 v[138:141], v[70:73], v[98:101], v[138:141]
    ds_read_b64_tr_b16 v[62:63], v22 offset:0
    ds_read_b64_tr_b16 v[64:65], v22 offset:1280
    v_mfma_f32_16x16x32_bf16 v[142:145], v[74:77], v[82:85], v[142:145]
    ds_read_b128 v[34:37], v19 offset:2048
    v_mfma_f32_16x16x32_bf16 v[146:149], v[74:77], v[86:89], v[146:149]
    ds_read_b128 v[38:41], v19 offset:4096
    v_mfma_f32_16x16x32_bf16 v[150:153], v[74:77], v[90:93], v[150:153]
    ds_read_b128 v[42:45], v19 offset:6144
    v_mfma_f32_16x16x32_bf16 v[154:157], v[74:77], v[94:97], v[154:157]
    s_xor_b32 s44, s3, 2
    s_sub_u32 s44, s44, s3
    s_mul_i32 s44, s44, 5120
    v_mfma_f32_16x16x32_bf16 v[158:161], v[74:77], v[98:101], v[158:161]
    v_add_u32 v255, s44, v253
    v_lshlrev_b32 v9, 7, v1
    v_mfma_f32_16x16x32_bf16 v[162:165], v[78:81], v[82:85], v[162:165]
    v_mov_b32 v8, 0x40000000
    v_cmp_lt_i32 s[100:101], v1, 20
    v_mfma_f32_16x16x32_bf16 v[166:169], v[78:81], v[86:89], v[166:169]
    s_nop 0
    v_cndmask_b32 v251, v8, v9, s[100:101]
    s_mul_i32 s45, s48, 7168
    v_mfma_f32_16x16x32_bf16 v[170:173], v[78:81], v[90:93], v[170:173]
    s_mul_i32 s46, s49, 3584
    s_add_u32 s45, s45, s46
    v_and_b32 v9, 15, v1
    v_mfma_f32_16x16x32_bf16 v[174:177], v[78:81], v[94:97], v[174:177]
    v_and_b32 v9, 3, v9
    v_lshlrev_b32 v9, 4, v9
    v_mfma_f32_16x16x32_bf16 v[178:181], v[78:81], v[98:101], v[178:181]
    s_waitcnt lgkmcnt(11)
    v_mov_b32 v8, 0x40000000
    v_and_b32 v7, 15, v1
    v_mfma_f32_16x16x32_bf16 v[102:105], v[30:33], v[46:49], v[102:105]
    s_waitcnt lgkmcnt(9)
    v_add_u32 v23, 0xffff5fc0, v23
    v_add_u32 v24, 0xffff5fc0, v24
    v_mfma_f32_16x16x32_bf16 v[106:109], v[30:33], v[50:53], v[106:109]
    s_waitcnt lgkmcnt(7)
    ds_read_b128 v[66:69], v20 offset:0
    v_cmp_ge_i32 s[100:101], v7, 8
    v_mfma_f32_16x16x32_bf16 v[110:113], v[30:33], v[54:57], v[110:113]
    s_waitcnt lgkmcnt(6)
    ds_read_b64_tr_b16 v[82:83], v23 offset:0
    v_cndmask_b32 v8, v8, v9, s[100:101]
    v_mfma_f32_16x16x32_bf16 v[114:117], v[30:33], v[58:61], v[114:117]
    s_waitcnt lgkmcnt(5)
    ds_read_b64_tr_b16 v[84:85], v23 offset:1280
    v_and_b32 v9, 15, v1
    v_mfma_f32_16x16x32_bf16 v[118:121], v[30:33], v[62:65], v[118:121]
    s_waitcnt lgkmcnt(5)
    ds_read_b64_tr_b16 v[86:87], v23 offset:40
    v_cmp_lt_i32 s[100:101], v9, 2
    v_mfma_f32_16x16x32_bf16 v[122:125], v[34:37], v[46:49], v[122:125]
    ds_read_b64_tr_b16 v[88:89], v23 offset:1320
    v_cndmask_b32 v16, v8, 64, s[100:101]
    v_mfma_f32_16x16x32_bf16 v[126:129], v[34:37], v[50:53], v[126:129]
    ds_read_b64_tr_b16 v[90:91], v23 offset:10256
    v_and_b32 v9, 15, v1
    v_mfma_f32_16x16x32_bf16 v[130:133], v[34:37], v[54:57], v[130:133]
    ds_read_b64_tr_b16 v[92:93], v23 offset:11536
    v_and_b32 v8, 15, v1
    v_mfma_f32_16x16x32_bf16 v[134:137], v[34:37], v[58:61], v[134:137]
    ds_read_b64_tr_b16 v[94:95], v23 offset:10296
    s_waitcnt vmcnt(4)
    v_cmp_gt_u32 vcc, 1, v250
    v_mfma_f32_16x16x32_bf16 v[138:141], v[34:37], v[62:65], v[138:141]
    s_and_b32 vcc_lo, vcc_lo, 0xf
    s_cbranch_scc1 Lslow2
Lback2:
    ds_read_b64_tr_b16 v[96:97], v23 offset:11576
    s_waitcnt lgkmcnt(10)
    v_mfma_f32_16x16x32_bf16 v[142:145], v[38:41], v[46:49], v[142:145]
Lwkv_1:
    s_cbranch_execz Lwkv_2
    buffer_load_dwordx4 a[0:3], v0, s[40:43], s20 offen offset:0 sc1
    v_mfma_f32_16x16x32_bf16 v[146:149], v[38:41], v[50:53], v[146:149]
    ds_read_b64_tr_b16 v[98:99], v24 offset:0
    ds_read_b64_tr_b16 v[100:101], v24 offset:1280
    v_mfma_f32_16x16x32_bf16 v[150:153], v[38:41], v[54:57], v[150:153]
    buffer_load_dwordx4 a[4:7], v0, s[40:43], s20 offen offset:1024 sc1
    v_mfma_f32_16x16x32_bf16 v[154:157], v[38:41], v[58:61], v[154:157]
    ds_read_b128 v[70:73], v20 offset:2048
    ds_read_b128 v[74:77], v20 offset:4096
    v_mfma_f32_16x16x32_bf16 v[158:161], v[38:41], v[62:65], v[158:161]
    s_waitcnt lgkmcnt(13)
    ds_read_b128 v[78:81], v20 offset:6144
    v_lshrrev_b32 v8, 2, v8
    v_mfma_f32_16x16x32_bf16 v[162:165], v[42:45], v[46:49], v[162:165]
    v_and_b32 v8, 1, v8
    v_and_b32 v7, 15, v1
    v_mfma_f32_16x16x32_bf16 v[166:169], v[42:45], v[50:53], v[166:169]
    buffer_load_dwordx4 a[8:11], v0, s[40:43], s20 offen offset:2048 sc1
    v_mfma_f32_16x16x32_bf16 v[170:173], v[42:45], v[54:57], v[170:173]
    v_cmp_lt_i32 s[100:101], v7, 2
    v_mfma_f32_16x16x32_bf16 v[174:177], v[42:45], v[58:61], v[174:177]
    s_nop 0
    v_cndmask_b32 v17, v8, v9, s[100:101]
    v_mul_u32_u24 v9, 0x700, v17
    v_mfma_f32_16x16x32_bf16 v[178:181], v[42:45], v[62:65], v[178:181]
    v_add_u32 v9, v16, v9
    v_add_u32 v9, 0x500, v9
    v_mfma_f32_16x16x32_bf16 v[182:185], v[26:29], v[46:49], v[182:185]
    buffer_load_dwordx4 a[12:15], v0, s[40:43], s20 offen offset:3072 sc1
    v_mfma_f32_16x16x32_bf16 v[186:189], v[26:29], v[50:53], v[186:189]
    v_add_u32 v16, s45, v9
    v_lshrrev_b32 v9, 4, v1
    v_mfma_f32_16x16x32_bf16 v[190:193], v[26:29], v[54:57], v[190:193]
    v_lshlrev_b32 v9, 8, v9
    v_and_b32 v8, 15, v1
    v_mfma_f32_16x16x32_bf16 v[194:197], v[26:29], v[58:61], v[194:197]
    s_add_u32 s20, s20, 4096
    v_lshlrev_b32 v8, 4, v8
    v_add_u32 v8, v9, v8
    v_mfma_f32_16x16x32_bf16 v[198:201], v[26:29], v[62:65], v[198:201]
    s_waitcnt vmcnt(4) lgkmcnt(0)
    s_barrier
    ds_read_b128 v[202:205], v252 offset:0
    v_mfma_f32_16x16x32_bf16 v[102:105], v[66:69], v[82:85], v[102:105]
    ds_read_b128 v[30:33], v19 offset:16384
    ds_read_b64_tr_b16 v[46:47], v21 offset:20512
    v_mfma_f32_16x16x32_bf16 v[106:109], v[66:69], v[86:89], v[106:109]
    ds_read_b64_tr_b16 v[48:49], v21 offset:21792
    ds_read_b128 v[206:209], v252 offset:64
    v_mfma_f32_16x16x32_bf16 v[110:113], v[66:69], v[90:93], v[110:113]
    buffer_load_dwordx4 a[16:19], v0, s[40:43], s20 offen offset:0 sc1
    v_mfma_f32_16x16x32_bf16 v[114:117], v[66:69], v[94:97], v[114:117]
    ds_read_b64_tr_b16 v[50:51], v21 offset:20552
    ds_read_b64_tr_b16 v[52:53], v21 offset:21832
    v_mfma_f32_16x16x32_bf16 v[118:121], v[66:69], v[98:101], v[118:121]
    ds_read_b64_tr_b16 v[54:55], v21 offset:30768
    ds_read_b128 v[210:213], v252 offset:128
    v_mfma_f32_16x16x32_bf16 v[122:125], v[70:73], v[82:85], v[122:125]
    ds_read_b64_tr_b16 v[56:57], v21 offset:32048
    ds_read_b128 v[214:217], v252 offset:192
    v_mfma_f32_16x16x32_bf16 v[126:129], v[70:73], v[86:89], v[126:129]
    buffer_load_dwordx4 a[20:23], v0, s[40:43], s20 offen offset:1024 sc1
    v_mfma_f32_16x16x32_bf16 v[130:133], v[70:73], v[90:93], v[130:133]
    ds_read_b64_tr_b16 v[58:59], v21 offset:30808
    ds_read_b64_tr_b16 v[60:61], v21 offset:32088
    v_mfma_f32_16x16x32_bf16 v[134:137], v[70:73], v[94:97], v[134:137]
    ds_read_b64_tr_b16 v[62:63], v22 offset:20512
    ds_read_b128 v[218:221], v252 offset:512
    v_mfma_f32_16x16x32_bf16 v[138:141], v[70:73], v[98:101], v[138:141]
    buffer_load_dwordx4 a[24:27], v0, s[40:43], s20 offen offset:2048 sc1
    v_mfma_f32_16x16x32_bf16 v[142:145], v[74:77], v[82:85], v[142:145]
    ds_read_b64_tr_b16 v[64:65], v22 offset:21792
    ds_read_b128 v[34:37], v19 offset:18432
    v_mfma_f32_16x16x32_bf16 v[146:149], v[74:77], v[86:89], v[146:149]
    ds_read_b128 v[38:41], v19 offset:20480
    ds_read_b128 v[222:225], v252 offset:576
    v_mfma_f32_16x16x32_bf16 v[150:153], v[74:77], v[90:93], v[150:153]
    ds_read_b128 v[42:45], v19 offset:22528
    ds_read_b128 v[226:229], v252 offset:640
    v_mfma_f32_16x16x32_bf16 v[154:157], v[74:77], v[94:97], v[154:157]
    buffer_load_dwordx4 a[28:31], v0, s[40:43], s20 offen offset:3072 sc1
    v_mfma_f32_16x16x32_bf16 v[158:161], v[74:77], v[98:101], v[158:161]
    ds_write_b32 v253, v182 offset:0
    ds_write_b32 v253, v186 offset:256
    v_mfma_f32_16x16x32_bf16 v[162:165], v[78:81], v[82:85], v[162:165]
    ds_write_b32 v253, v190 offset:512
    ds_write_b32 v253, v194 offset:768
    v_mfma_f32_16x16x32_bf16 v[166:169], v[78:81], v[86:89], v[166:169]
    ds_write_b32 v253, v198 offset:1024
    ds_read_b128 v[230:233], v252 offset:704
    v_mfma_f32_16x16x32_bf16 v[170:173], v[78:81], v[90:93], v[170:173]
    s_add_u32 s20, s20, 4096
    v_add_u32 v10, s45, v8
    v_lshrrev_b32 v9, 4, v1
    v_mfma_f32_16x16x32_bf16 v[174:177], v[78:81], v[94:97], v[174:177]
    v_mul_u32_u24 v9, 0x50, v9
    v_add_u32 v9, v9, v16
    v_mfma_f32_16x16x32_bf16 v[178:181], v[78:81], v[98:101], v[178:181]
    s_waitcnt lgkmcnt(15)
    v_add_u32 v8, 0x4000, v0
    v_min_u32 v11, v9, v8
    v_mfma_f32_16x16x32_bf16 v[102:105], v[30:33], v[46:49], v[102:105]
    s_waitcnt lgkmcnt(15)
    buffer_load_dwordx4 a[32:35], v0, s[40:43], s20 offen offset:0 sc1
    v_mfma_f32_16x16x32_bf16 v[106:109], v[30:33], v[50:53], v[106:109]
    s_waitcnt lgkmcnt(15)
    ds_read_b128 v[66:69], v20 offset:16384
    ds_read_b64_tr_b16 v[82:83], v23 offset:20512
    v_mfma_f32_16x16x32_bf16 v[110:113], v[30:33], v[54:57], v[110:113]
    s_waitcnt lgkmcnt(15)
    ds_read_b64_tr_b16 v[84:85], v23 offset:21792
    v_lshrrev_b32 v9, 4, v1
    v_mfma_f32_16x16x32_bf16 v[114:117], v[30:33], v[58:61], v[114:117]
    s_waitcnt lgkmcnt(14)
    ds_read_b64_tr_b16 v[86:87], v23 offset:20552
    v_mul_u32_u24 v9, 0x700, v9
    v_mfma_f32_16x16x32_bf16 v[118:121], v[30:33], v[62:65], v[118:121]
    s_waitcnt lgkmcnt(14)
    buffer_load_dwordx4 a[36:39], v0, s[40:43], s20 offen offset:1024 sc1
    v_mfma_f32_16x16x32_bf16 v[122:125], v[34:37], v[46:49], v[122:125]
    ds_read_b64_tr_b16 v[88:89], v23 offset:21832
    ds_read_b64_tr_b16 v[90:91], v23 offset:30768
    v_mfma_f32_16x16x32_bf16 v[126:129], v[34:37], v[50:53], v[126:129]
    ds_read_b64_tr_b16 v[92:93], v23 offset:32048
    v_and_b32 v8, 15, v1
    v_mfma_f32_16x16x32_bf16 v[130:133], v[34:37], v[54:57], v[130:133]
    ds_read_b64_tr_b16 v[94:95], v23 offset:30808
    v_lshlrev_b32 v8, 4, v8
    v_mfma_f32_16x16x32_bf16 v[134:137], v[34:37], v[58:61], v[134:137]
    buffer_load_dwordx4 a[40:43], v0, s[40:43], s20 offen offset:2048 sc1
    v_mfma_f32_16x16x32_bf16 v[138:141], v[34:37], v[62:65], v[138:141]
    s_waitcnt lgkmcnt(15)
    ds_read_b64_tr_b16 v[96:97], v23 offset:32088
    ds_read_b64_tr_b16 v[98:99], v24 offset:20512
    v_mfma_f32_16x16x32_bf16 v[142:145], v[38:41], v[46:49], v[142:145]
    ds_read_b64_tr_b16 v[100:101], v24 offset:21792
    v_add_u32 v8, v9, v8
    v_mfma_f32_16x16x32_bf16 v[146:149], v[38:41], v[50:53], v[146:149]
    ds_read_b128 v[70:73], v20 offset:18432
    v_add_u32 v8, 0x400, v8
    v_mfma_f32_16x16x32_bf16 v[150:153], v[38:41], v[54:57], v[150:153]
    buffer_load_dwordx4 a[44:47], v0, s[40:43], s20 offen offset:3072 sc1
    v_mfma_f32_16x16x32_bf16 v[154:157], v[38:41], v[58:61], v[154:157]
    ds_read_b128 v[74:77], v20 offset:20480
    ds_read_b128 v[78:81], v20 offset:22528
    v_mfma_f32_16x16x32_bf16 v[158:161], v[38:41], v[62:65], v[158:161]
    s_waitcnt lgkmcnt(15)
    v_add_u32 v8, s45, v8
    v_add_u32 v9, 0x4000, v0
    v_mfma_f32_16x16x32_bf16 v[162:165], v[42:45], v[46:49], v[162:165]
    s_add_u32 s20, s20, 4096
    v_lshrrev_b32 v7, 4, v1
    v_cmp_lt_i32 s[100:101], v7, 2
    v_mfma_f32_16x16x32_bf16 v[166:169], v[42:45], v[50:53], v[166:169]
    s_nop 0
    v_cndmask_b32 v12, v9, v8, s[100:101]
    v_add_u32 v9, 0x140, v16
    v_mfma_f32_16x16x32_bf16 v[170:173], v[42:45], v[54:57], v[170:173]
    v_mov_b32 v8, 0x40000000
    v_lshrrev_b32 v7, 4, v1
    v_mfma_f32_16x16x32_bf16 v[174:177], v[42:45], v[58:61], v[174:177]
    v_cmp_eq_i32 s[100:101], v7, v17
    v_mfma_f32_16x16x32_bf16 v[178:181], v[42:45], v[62:65], v[178:181]
    buffer_load_dwordx4 a[48:51], v0, s[40:43], s20 offen offset:0 sc1
    v_mfma_f32_16x16x32_bf16 v[182:185], v[26:29], v[46:49], v[182:185]
    v_cndmask_b32 v8, v8, v9, s[100:101]
    v_add_u32 v9, 0x4000, v0
    v_mfma_f32_16x16x32_bf16 v[186:189], v[26:29], v[50:53], v[186:189]
    v_min_u32 v13, v8, v9
    s_mul_i32 s45, s3, 1792
    v_mfma_f32_16x16x32_bf16 v[190:193], v[26:29], v[54:57], v[190:193]
    v_lshlrev_b32 v17, 2, v1
    v_add_u32 v16, s45, v17
    v_mfma_f32_16x16x32_bf16 v[194:197], v[26:29], v[58:61], v[194:197]
    buffer_load_dwordx4 a[52:55], v0, s[40:43], s20 offen offset:1024 sc1
    v_mfma_f32_16x16x32_bf16 v[198:201], v[26:29], v[62:65], v[198:201]
    s_waitcnt lgkmcnt(0)
    s_barrier
    v_mov_b32 v9, 0x40000000
    v_mfma_f32_16x16x32_bf16 v[102:105], v[66:69], v[82:85], v[102:105]
    ds_read_b32 v30, v255 offset:0
    ds_read_b32 v31, v255 offset:256
    v_mfma_f32_16x16x32_bf16 v[106:109], v[66:69], v[86:89], v[106:109]
    buffer_load_dwordx4 a[56:59], v0, s[40:43], s20 offen offset:2048 sc1
    v_mfma_f32_16x16x32_bf16 v[110:113], v[66:69], v[90:93], v[110:113]
    ds_read_b32 v32, v255 offset:512
    ds_read_b32 v33, v255 offset:768
    v_mfma_f32_16x16x32_bf16 v[114:117], v[66:69], v[94:97], v[114:117]
    ds_read_b32 v34, v255 offset:1024
    v_cmp_lt_i32 s[100:101], v1, 36
    v_mfma_f32_16x16x32_bf16 v[118:121], v[66:69], v[98:101], v[118:121]
    s_nop 0
    v_cndmask_b32 v18, v9, v17, s[100:101]
    s_lshl_b32 s58, s5, 2
    v_mfma_f32_16x16x32_bf16 v[122:125], v[70:73], v[82:85], v[122:125]
    s_add_u32 s58, s58, s3
    buffer_load_dwordx4 a[60:63], v0, s[40:43], s20 offen offset:3072 sc1
    v_mfma_f32_16x16x32_bf16 v[126:129], v[70:73], v[86:89], v[126:129]
    s_mul_i32 s58, s58, 1792
    s_add_u32 s58, s58, 16384
    s_mov_b32 s44, 0xf002f002
    v_mfma_f32_16x16x32_bf16 v[130:133], v[70:73], v[90:93], v[130:133]
    s_mov_b32 s45, 0xf002f002
    s_bfm_b64 s[46:47], 16, 16
    v_mfma_f32_16x16x32_bf16 v[134:137], v[70:73], v[94:97], v[134:137]
    v_mfma_f32_16x16x32_bf16 v[138:141], v[70:73], v[98:101], v[138:141]
    s_add_u32 s20, s20, 4096
    v_mfma_f32_16x16x32_bf16 v[142:145], v[74:77], v[82:85], v[142:145]
    v_mfma_f32_16x16x32_bf16 v[146:149], v[74:77], v[86:89], v[146:149]
    v_mfma_f32_16x16x32_bf16 v[150:153], v[74:77], v[90:93], v[150:153]
    buffer_load_dwordx4 a[64:67], v0, s[40:43], s20 offen offset:0 sc1
    v_mfma_f32_16x16x32_bf16 v[154:157], v[74:77], v[94:97], v[154:157]
    v_mfma_f32_16x16x32_bf16 v[158:161], v[74:77], v[98:101], v[158:161]
    v_mfma_f32_16x16x32_bf16 v[162:165], v[78:81], v[82:85], v[162:165]
    v_mfma_f32_16x16x32_bf16 v[166:169], v[78:81], v[86:89], v[166:169]
    buffer_load_dwordx4 a[68:71], v0, s[40:43], s20 offen offset:1024 sc1
    v_mfma_f32_16x16x32_bf16 v[170:173], v[78:81], v[90:93], v[170:173]
    v_mfma_f32_16x16x32_bf16 v[174:177], v[78:81], v[94:97], v[174:177]
    v_mfma_f32_16x16x32_bf16 v[178:181], v[78:81], v[98:101], v[178:181]
    v_mfma_f32_16x16x32_bf16 v[182:185], v[26:29], v[82:85], v[182:185]
    buffer_load_dwordx4 a[72:75], v0, s[40:43], s20 offen offset:2048 sc1
    v_mfma_f32_16x16x32_bf16 v[186:189], v[26:29], v[86:89], v[186:189]
    v_mfma_f32_16x16x32_bf16 v[190:193], v[26:29], v[90:93], v[190:193]
    v_mfma_f32_16x16x32_bf16 v[194:197], v[26:29], v[94:97], v[194:197]
    v_mfma_f32_16x16x32_bf16 v[198:201], v[26:29], v[98:101], v[198:201]
    s_waitcnt lgkmcnt(4)
    s_nop 1
    v_add_f32 v50, v182, v30
    s_waitcnt lgkmcnt(3)
    v_add_f32 v51, v186, v31
    s_waitcnt lgkmcnt(2)
    v_add_f32 v52, v190, v32
    s_waitcnt lgkmcnt(1)
    v_add_f32 v53, v194, v33
    s_waitcnt lgkmcnt(0)
    v_add_f32 v54, v198, v34
    v_pk_mul_f32 v[234:235], v[202:203], s[62:63]
    v_pk_mul_f32 v[236:237], v[204:205], s[62:63]
    v_pk_mul_f32 v[238:239], v[206:207], s[62:63]
    v_pk_mul_f32 v[240:241], v[208:209], s[62:63]
    v_pk_mul_f32 v[242:243], v[210:211], s[62:63]
    v_pk_mul_f32 v[244:245], v[212:213], s[62:63]
    v_pk_mul_f32 v[246:247], v[214:215], s[62:63]
    v_pk_mul_f32 v[248:249], v[216:217], s[62:63]
    v_and_b32 v96, 8, v1
    v_cmp_eq_u32 vcc, 0, v96
    v_mov_b32 v97, 0x3f803f80
    v_pk_fma_f32 v[102:103], v[218:219], v[50:51], v[102:103] op_sel:[0,0,0] op_sel_hi:[1,0,1]
    buffer_load_dwordx4 a[76:79], v0, s[40:43], s20 offen offset:3072 sc1
    s_add_u32 s20, s20, 4096
    v_pk_fma_f32 v[104:105], v[220:221], v[50:51], v[104:105] op_sel:[0,0,0] op_sel_hi:[1,0,1]
    v_pk_fma_f32 v[106:107], v[218:219], v[50:51], v[106:107] op_sel:[0,1,0] op_sel_hi:[1,1,1]
    v_pk_fma_f32 v[108:109], v[220:221], v[50:51], v[108:109] op_sel:[0,1,0] op_sel_hi:[1,1,1]
    v_pk_fma_f32 v[110:111], v[218:219], v[52:53], v[110:111] op_sel:[0,0,0] op_sel_hi:[1,0,1]
    v_pk_fma_f32 v[112:113], v[220:221], v[52:53], v[112:113] op_sel:[0,0,0] op_sel_hi:[1,0,1]
    v_pk_fma_f32 v[114:115], v[218:219], v[52:53], v[114:115] op_sel:[0,1,0] op_sel_hi:[1,1,1]
    v_pk_fma_f32 v[116:117], v[220:221], v[52:53], v[116:117] op_sel:[0,1,0] op_sel_hi:[1,1,1]
    v_pk_fma_f32 v[118:119], v[218:219], v[54:55], v[118:119] op_sel:[0,0,0] op_sel_hi:[1,0,1]
    v_pk_fma_f32 v[120:121], v[220:221], v[54:55], v[120:121] op_sel:[0,0,0] op_sel_hi:[1,0,1]
    v_pk_mul_f32 v[70:71], v[102:103], v[234:235]
    v_pk_fma_f32 v[66:67], v[102:103], v[202:203], s[60:61]
    v_pk_mul_f32 v[72:73], v[104:105], v[236:237]
    v_pk_fma_f32 v[68:69], v[104:105], v[204:205], s[60:61]
    v_exp_f32 v70, v70 clamp
    v_exp_f32 v71, v71 clamp
    buffer_load_dwordx4 a[80:83], v0, s[40:43], s20 offen offset:0 sc1
    v_exp_f32 v72, v72 clamp
    v_exp_f32 v73, v73 clamp
    v_max_f32 v66, s60, v66
    v_max_f32 v67, s60, v67
    v_max_f32 v68, s60, v68
    v_max_f32 v69, s60, v69
    v_pk_add_f32 v[66:67], v[66:67], v[70:71]
    v_pk_add_f32 v[68:69], v[68:69], v[72:73]
    v_cvt_pk_bf16_f32 v182, v66, v67
    v_cvt_pk_bf16_f32 v183, v68, v69
    v_pk_mul_f32 v[78:79], v[106:107], v[234:235]
    v_pk_fma_f32 v[74:75], v[106:107], v[202:203], s[60:61]
    v_pk_mul_f32 v[80:81], v[108:109], v[236:237]
    v_pk_fma_f32 v[76:77], v[108:109], v[204:205], s[60:61]
    v_exp_f32 v78, v78 clamp
    buffer_load_dwordx4 a[84:87], v0, s[40:43], s20 offen offset:1024 sc1
    v_exp_f32 v79, v79 clamp
    v_exp_f32 v80, v80 clamp
    v_exp_f32 v81, v81 clamp
    v_max_f32 v74, s60, v74
    v_max_f32 v75, s60, v75
    v_max_f32 v76, s60, v76
    v_max_f32 v77, s60, v77
    v_pk_add_f32 v[74:75], v[74:75], v[78:79]
    v_pk_add_f32 v[76:77], v[76:77], v[80:81]
    v_cvt_pk_bf16_f32 v190, v74, v75
    v_cvt_pk_bf16_f32 v191, v76, v77
    v_pk_mul_f32 v[86:87], v[118:119], v[234:235]
    v_pk_fma_f32 v[82:83], v[118:119], v[202:203], s[60:61]
    v_pk_mul_f32 v[88:89], v[120:121], v[236:237]
    buffer_load_dwordx4 a[88:91], v0, s[40:43], s20 offen offset:2048 sc1
    v_pk_fma_f32 v[84:85], v[120:121], v[204:205], s[60:61]
    v_exp_f32 v86, v86 clamp
    v_exp_f32 v87, v87 clamp
    v_exp_f32 v88, v88 clamp
    v_exp_f32 v89, v89 clamp
    v_max_f32 v82, s60, v82
    v_max_f32 v83, s60, v83
    v_max_f32 v84, s60, v84
    v_max_f32 v85, s60, v85
    v_pk_add_f32 v[82:83], v[82:83], v[86:87]
    v_pk_add_f32 v[84:85], v[84:85], v[88:89]
    v_cvt_pk_bf16_f32 v30, v82, v83
    v_cvt_pk_bf16_f32 v31, v84, v85
    buffer_load_dwordx4 a[92:95], v0, s[40:43], s20 offen offset:3072 sc1
    s_add_u32 s20, s20, 4096
    v_pk_mul_f32 v[110:111], v[110:111], v[202:203]
    v_pk_mul_f32 v[112:113], v[112:113], v[204:205]
    v_cvt_pk_bf16_f32 v56, v110, v111
    v_cvt_pk_bf16_f32 v57, v112, v113
    v_pk_mul_f32 v[114:115], v[114:115], v[202:203]
    v_pk_mul_f32 v[116:117], v[116:117], v[204:205]
    v_cvt_pk_bf16_f32 v20, v114, v115
    v_cvt_pk_bf16_f32 v21, v116, v117
    v_pk_mul_f32 v[118:119], v[118:119], v[202:203]
    v_pk_mul_f32 v[120:121], v[120:121], v[204:205]
    v_cvt_pk_bf16_f32 v38, v118, v119
    v_cvt_pk_bf16_f32 v39, v120, v121
    v_cndmask_b32 v38, v38, v97, vcc
    v_cndmask_b32 v39, v39, v97, vcc
    v_pk_fma_f32 v[122:123], v[222:223], v[50:51], v[122:123] op_sel:[0,0,0] op_sel_hi:[1,0,1]
    v_pk_fma_f32 v[124:125], v[224:225], v[50:51], v[124:125] op_sel:[0,0,0] op_sel_hi:[1,0,1]
    v_pk_fma_f32 v[126:127], v[222:223], v[50:51], v[126:127] op_sel:[0,1,0] op_sel_hi:[1,1,1]
    buffer_load_dwordx4 a[96:99], v0, s[40:43], s20 offen offset:0 sc1
    v_pk_fma_f32 v[128:129], v[224:225], v[50:51], v[128:129] op_sel:[0,1,0] op_sel_hi:[1,1,1]
    v_pk_fma_f32 v[130:131], v[222:223], v[52:53], v[130:131] op_sel:[0,0,0] op_sel_hi:[1,0,1]
    v_pk_fma_f32 v[132:133], v[224:225], v[52:53], v[132:133] op_sel:[0,0,0] op_sel_hi:[1,0,1]
    v_pk_fma_f32 v[134:135], v[222:223], v[52:53], v[134:135] op_sel:[0,1,0] op_sel_hi:[1,1,1]
    v_pk_fma_f32 v[136:137], v[224:225], v[52:53], v[136:137] op_sel:[0,1,0] op_sel_hi:[1,1,1]
    v_pk_fma_f32 v[138:139], v[222:223], v[54:55], v[138:139] op_sel:[0,0,0] op_sel_hi:[1,0,1]
    v_pk_fma_f32 v[140:141], v[224:225], v[54:55], v[140:141] op_sel:[0,0,0] op_sel_hi:[1,0,1]
    v_pk_mul_f32 v[70:71], v[122:123], v[238:239]
    v_pk_fma_f32 v[66:67], v[122:123], v[206:207], s[60:61]
    v_pk_mul_f32 v[72:73], v[124:125], v[240:241]
    v_pk_fma_f32 v[68:69], v[124:125], v[208:209], s[60:61]
    v_exp_f32 v70, v70 clamp
    v_exp_f32 v71, v71 clamp
    v_exp_f32 v72, v72 clamp
    buffer_load_dwordx4 a[100:103], v0, s[40:43], s20 offen offset:1024 sc1
    v_exp_f32 v73, v73 clamp
    v_max_f32 v66, s60, v66
    v_max_f32 v67, s60, v67
    v_max_f32 v68, s60, v68
    v_max_f32 v69, s60, v69
    v_pk_add_f32 v[66:67], v[66:67], v[70:71]
    v_pk_add_f32 v[68:69], v[68:69], v[72:73]
    v_cvt_pk_bf16_f32 v184, v66, v67
    v_cvt_pk_bf16_f32 v185, v68, v69
    v_pk_mul_f32 v[78:79], v[126:127], v[238:239]
    v_pk_fma_f32 v[74:75], v[126:127], v[206:207], s[60:61]
    v_pk_mul_f32 v[80:81], v[128:129], v[240:241]
    v_pk_fma_f32 v[76:77], v[128:129], v[208:209], s[60:61]
    v_exp_f32 v78, v78 clamp
    v_exp_f32 v79, v79 clamp
    buffer_load_dwordx4 a[104:107], v0, s[40:43], s20 offen offset:2048 sc1
    v_exp_f32 v80, v80 clamp
    v_exp_f32 v81, v81 clamp
    v_max_f32 v74, s60, v74
    v_max_f32 v75, s60, v75
    v_max_f32 v76, s60, v76
    v_max_f32 v77, s60, v77
    v_pk_add_f32 v[74:75], v[74:75], v[78:79]
    v_pk_add_f32 v[76:77], v[76:77], v[80:81]
    v_cvt_pk_bf16_f32 v192, v74, v75
    v_cvt_pk_bf16_f32 v193, v76, v77
    v_pk_mul_f32 v[86:87], v[138:139], v[238:239]
    v_pk_fma_f32 v[82:83], v[138:139], v[206:207], s[60:61]
    v_pk_mul_f32 v[88:89], v[140:141], v[240:241]
    v_pk_fma_f32 v[84:85], v[140:141], v[208:209], s[60:61]
    v_exp_f32 v86, v86 clamp
    buffer_load_dword v250, v251, s[40:43], s26 offen offset:0 sc1
    buffer_load_dwordx4 a[108:111], v0, s[40:43], s20 offen offset:3072 sc1
    s_add_u32 s20, s20, 4096
    v_exp_f32 v87, v87 clamp
    v_exp_f32 v88, v88 clamp
    v_exp_f32 v89, v89 clamp
    v_max_f32 v82, s60, v82
    v_max_f32 v83, s60, v83
    v_max_f32 v84, s60, v84
    v_max_f32 v85, s60, v85
    v_pk_add_f32 v[82:83], v[82:83], v[86:87]
    v_pk_add_f32 v[84:85], v[84:85], v[88:89]
    v_cvt_pk_bf16_f32 v32, v82, v83
    v_cvt_pk_bf16_f32 v33, v84, v85
    v_pk_mul_f32 v[130:131], v[130:131], v[206:207]
    v_pk_mul_f32 v[132:133], v[132:133], v[208:209]
    v_cvt_pk_bf16_f32 v58, v130, v131
    buffer_load_dwordx4 a[112:115], v0, s[40:43], s20 offen offset:0 sc1
    v_cvt_pk_bf16_f32 v59, v132, v133
    v_pk_mul_f32 v[134:135], v[134:135], v[206:207]
    v_pk_mul_f32 v[136:137], v[136:137], v[208:209]
    v_cvt_pk_bf16_f32 v22, v134, v135
    v_cvt_pk_bf16_f32 v23, v136, v137
    v_pk_mul_f32 v[138:139], v[138:139], v[206:207]
    v_pk_mul_f32 v[140:141], v[140:141], v[208:209]
    v_cvt_pk_bf16_f32 v40, v138, v139
    v_cvt_pk_bf16_f32 v41, v140, v141
    v_cndmask_b32 v40, v40, v97, vcc
    v_cndmask_b32 v41, v41, v97, vcc
    v_pk_fma_f32 v[142:143], v[226:227], v[50:51], v[142:143] op_sel:[0,0,0] op_sel_hi:[1,0,1]
    v_pk_fma_f32 v[144:145], v[228:229], v[50:51], v[144:145] op_sel:[0,0,0] op_sel_hi:[1,0,1]
    v_pk_fma_f32 v[146:147], v[226:227], v[50:51], v[146:147] op_sel:[0,1,0] op_sel_hi:[1,1,1]
    v_pk_fma_f32 v[148:149], v[228:229], v[50:51], v[148:149] op_sel:[0,1,0] op_sel_hi:[1,1,1]
    v_pk_fma_f32 v[150:151], v[226:227], v[52:53], v[150:151] op_sel:[0,0,0] op_sel_hi:[1,0,1]
    v_pk_fma_f32 v[152:153], v[228:229], v[52:53], v[152:153] op_sel:[0,0,0] op_sel_hi:[1,0,1]
    buffer_load_dwordx4 a[116:119], v0, s[40:43], s20 offen offset:1024 sc1
    v_pk_fma_f32 v[154:155], v[226:227], v[52:53], v[154:155] op_sel:[0,1,0] op_sel_hi:[1,1,1]
    v_pk_fma_f32 v[156:157], v[228:229], v[52:53], v[156:157] op_sel:[0,1,0] op_sel_hi:[1,1,1]
    v_pk_fma_f32 v[158:159], v[226:227], v[54:55], v[158:159] op_sel:[0,0,0] op_sel_hi:[1,0,1]
    v_pk_fma_f32 v[160:161], v[228:229], v[54:55], v[160:161] op_sel:[0,0,0] op_sel_hi:[1,0,1]
    v_pk_mul_f32 v[70:71], v[142:143], v[242:243]
    v_pk_fma_f32 v[66:67], v[142:143], v[210:211], s[60:61]
    v_pk_mul_f32 v[72:73], v[144:145], v[244:245]
    v_pk_fma_f32 v[68:69], v[144:145], v[212:213], s[60:61]
    v_pk_mul_f32 v[78:79], v[146:147], v[242:243]
    v_pk_fma_f32 v[74:75], v[146:147], v[210:211], s[60:61]
    v_pk_mul_f32 v[80:81], v[148:149], v[244:245]
    v_pk_fma_f32 v[76:77], v[148:149], v[212:213], s[60:61]
    v_pk_mul_f32 v[86:87], v[158:159], v[242:243]
    v_pk_fma_f32 v[82:83], v[158:159], v[210:211], s[60:61]
    v_pk_mul_f32 v[88:89], v[160:161], v[244:245]
    v_pk_fma_f32 v[84:85], v[160:161], v[212:213], s[60:61]
    v_mfma_f32_16x16x32_bf16 v[102:105], v[182:185], v[56:59], 0
    v_exp_f32 v70, v70 clamp
    buffer_load_dwordx4 a[120:123], v0, s[40:43], s20 offen offset:2048 sc1
    v_mfma_f32_16x16x32_bf16 v[106:109], v[190:193], v[20:23], 0
    v_exp_f32 v71, v71 clamp
    v_mfma_f32_16x16x32_bf16 v[110:113], v[182:185], v[38:41], 0
    v_exp_f32 v72, v72 clamp
    v_mfma_f32_16x16x32_bf16 v[114:117], v[190:193], v[38:41], 0
    v_exp_f32 v73, v73 clamp
    v_mfma_f32_16x16x32_bf16 v[118:121], v[30:33], v[56:59], 0
    v_max_f32 v66, s60, v66
    v_max_f32 v67, s60, v67
    v_mfma_f32_16x16x32_bf16 v[122:125], v[30:33], v[20:23], 0
    v_max_f32 v68, s60, v68
    v_max_f32 v69, s60, v69
    v_mfma_f32_16x16x32_bf16 v[126:129], v[30:33], v[38:41], 0
    v_exp_f32 v78, v78 clamp
    buffer_load_dwordx4 a[124:127], v0, s[40:43], s20 offen offset:3072 sc1
    s_add_u32 s20, s20, 4096
    v_exp_f32 v79, v79 clamp
    v_exp_f32 v80, v80 clamp
    v_exp_f32 v81, v81 clamp
    v_max_f32 v74, s60, v74
    v_max_f32 v75, s60, v75
    v_max_f32 v76, s60, v76
    v_max_f32 v77, s60, v77
    v_exp_f32 v86, v86 clamp
    v_exp_f32 v87, v87 clamp
    v_exp_f32 v88, v88 clamp
    v_exp_f32 v89, v89 clamp
    buffer_load_dwordx4 a[128:131], v0, s[40:43], s20 offen offset:0 sc1
    v_max_f32 v82, s60, v82
    v_max_f32 v83, s60, v83
    v_max_f32 v84, s60, v84
    v_max_f32 v85, s60, v85
    v_pk_add_f32 v[66:67], v[66:67], v[70:71]
    v_pk_add_f32 v[68:69], v[68:69], v[72:73]
    v_cvt_pk_bf16_f32 v186, v66, v67
    v_cvt_pk_bf16_f32 v187, v68, v69
    v_pk_add_f32 v[74:75], v[74:75], v[78:79]
    v_pk_add_f32 v[76:77], v[76:77], v[80:81]
    v_cvt_pk_bf16_f32 v194, v74, v75
    v_cvt_pk_bf16_f32 v195, v76, v77
    v_pk_add_f32 v[82:83], v[82:83], v[86:87]
    v_pk_add_f32 v[84:85], v[84:85], v[88:89]
    v_cvt_pk_bf16_f32 v34, v82, v83
    v_cvt_pk_bf16_f32 v35, v84, v85
    v_pk_mul_f32 v[150:151], v[150:151], v[210:211]
    buffer_load_dwordx4 a[132:135], v0, s[40:43], s20 offen offset:1024 sc1
    v_pk_mul_f32 v[152:153], v[152:153], v[212:213]
    v_cvt_pk_bf16_f32 v60, v150, v151
    v_cvt_pk_bf16_f32 v61, v152, v153
    v_pk_mul_f32 v[154:155], v[154:155], v[210:211]
    v_pk_mul_f32 v[156:157], v[156:157], v[212:213]
    v_cvt_pk_bf16_f32 v24, v154, v155
    v_cvt_pk_bf16_f32 v25, v156, v157
    v_pk_mul_f32 v[158:159], v[158:159], v[210:211]
    v_pk_mul_f32 v[160:161], v[160:161], v[212:213]
    v_cvt_pk_bf16_f32 v42, v158, v159
    v_cvt_pk_bf16_f32 v43, v160, v161
    v_cndmask_b32 v42, v42, v97, vcc
    v_cndmask_b32 v43, v43, v97, vcc
    v_pk_fma_f32 v[162:163], v[230:231], v[50:51], v[162:163] op_sel:[0,0,0] op_sel_hi:[1,0,1]
    v_pk_fma_f32 v[164:165], v[232:233], v[50:51], v[164:165] op_sel:[0,0,0] op_sel_hi:[1,0,1]
    v_pk_fma_f32 v[166:167], v[230:231], v[50:51], v[166:167] op_sel:[0,1,0] op_sel_hi:[1,1,1]
    v_pk_fma_f32 v[168:169], v[232:233], v[50:51], v[168:169] op_sel:[0,1,0] op_sel_hi:[1,1,1]
    buffer_load_dwordx4 a[136:139], v0, s[40:43], s20 offen offset:2048 sc1
    v_pk_fma_f32 v[170:171], v[230:231], v[52:53], v[170:171] op_sel:[0,0,0] op_sel_hi:[1,0,1]
    v_pk_fma_f32 v[172:173], v[232:233], v[52:53], v[172:173] op_sel:[0,0,0] op_sel_hi:[1,0,1]
    v_pk_fma_f32 v[174:175], v[230:231], v[52:53], v[174:175] op_sel:[0,1,0] op_sel_hi:[1,1,1]
    v_pk_fma_f32 v[176:177], v[232:233], v[52:53], v[176:177] op_sel:[0,1,0] op_sel_hi:[1,1,1]
    v_pk_fma_f32 v[178:179], v[230:231], v[54:55], v[178:179] op_sel:[0,0,0] op_sel_hi:[1,0,1]
    v_pk_fma_f32 v[180:181], v[232:233], v[54:55], v[180:181] op_sel:[0,0,0] op_sel_hi:[1,0,1]
    v_pk_mul_f32 v[70:71], v[162:163], v[246:247]
    v_pk_fma_f32 v[66:67], v[162:163], v[214:215], s[60:61]
    v_pk_mul_f32 v[72:73], v[164:165], v[248:249]
    v_pk_fma_f32 v[68:69], v[164:165], v[216:217], s[60:61]
    v_exp_f32 v70, v70 clamp
    v_exp_f32 v71, v71 clamp
    v_exp_f32 v72, v72 clamp
    v_exp_f32 v73, v73 clamp
    buffer_load_dwordx4 a[140:143], v0, s[40:43], s20 offen offset:3072 sc1
    s_add_u32 s20, s20, 4096
    v_max_f32 v66, s60, v66
    v_max_f32 v67, s60, v67
    v_max_f32 v68, s60, v68
    v_max_f32 v69, s60, v69
    v_pk_add_f32 v[66:67], v[66:67], v[70:71]
    v_pk_add_f32 v[68:69], v[68:69], v[72:73]
    v_cvt_pk_bf16_f32 v188, v66, v67
    v_cvt_pk_bf16_f32 v189, v68, v69
    v_pk_mul_f32 v[78:79], v[166:167], v[246:247]
    v_pk_fma_f32 v[74:75], v[166:167], v[214:215], s[60:61]
    v_pk_mul_f32 v[80:81], v[168:169], v[248:249]
    v_pk_fma_f32 v[76:77], v[168:169], v[216:217], s[60:61]
    v_exp_f32 v78, v78 clamp
    v_exp_f32 v79, v79 clamp
    v_exp_f32 v80, v80 clamp
    buffer_load_dwordx4 a[144:147], v0, s[40:43], s20 offen offset:0 sc1
    v_exp_f32 v81, v81 clamp
    v_max_f32 v74, s60, v74
    v_max_f32 v75, s60, v75
    v_max_f32 v76, s60, v76
    v_max_f32 v77, s60, v77
    v_pk_add_f32 v[74:75], v[74:75], v[78:79]
    v_pk_add_f32 v[76:77], v[76:77], v[80:81]
    v_cvt_pk_bf16_f32 v196, v74, v75
    v_cvt_pk_bf16_f32 v197, v76, v77
    v_pk_mul_f32 v[86:87], v[178:179], v[246:247]
    v_pk_fma_f32 v[82:83], v[178:179], v[214:215], s[60:61]
    v_pk_mul_f32 v[88:89], v[180:181], v[248:249]
    v_pk_fma_f32 v[84:85], v[180:181], v[216:217], s[60:61]
    v_exp_f32 v86, v86 clamp
    v_exp_f32 v87, v87 clamp
    buffer_load_dwordx4 a[148:151], v0, s[40:43], s20 offen offset:1024 sc1
    v_exp_f32 v88, v88 clamp
    v_exp_f32 v89, v89 clamp
    v_max_f32 v82, s60, v82
    v_max_f32 v83, s60, v83
    v_max_f32 v84, s60, v84
    v_max_f32 v85, s60, v85
    v_pk_add_f32 v[82:83], v[82:83], v[86:87]
    v_pk_add_f32 v[84:85], v[84:85], v[88:89]
    v_cvt_pk_bf16_f32 v36, v82, v83
    v_cvt_pk_bf16_f32 v37, v84, v85
    v_pk_mul_f32 v[170:171], v[170:171], v[214:215]
    v_pk_mul_f32 v[172:173], v[172:173], v[216:217]
    v_cvt_pk_bf16_f32 v62, v170, v171
    v_cvt_pk_bf16_f32 v63, v172, v173
    v_pk_mul_f32 v[174:175], v[174:175], v[214:215]
    buffer_load_dwordx4 a[152:155], v0, s[40:43], s20 offen offset:2048 sc1
    v_pk_mul_f32 v[176:177], v[176:177], v[216:217]
    v_cvt_pk_bf16_f32 v26, v174, v175
    v_cvt_pk_bf16_f32 v27, v176, v177
    v_pk_mul_f32 v[178:179], v[178:179], v[214:215]
    v_pk_mul_f32 v[180:181], v[180:181], v[216:217]
    v_cvt_pk_bf16_f32 v44, v178, v179
    v_cvt_pk_bf16_f32 v45, v180, v181
    v_cndmask_b32 v44, v44, v97, vcc
    v_cndmask_b32 v45, v45, v97, vcc
    v_mfma_f32_16x16x32_bf16 v[102:105], v[186:189], v[60:63], v[102:105]
Lwkv_2:
    s_cbranch_execz Lwkv_3
    v_mfma_f32_16x16x32_bf16 v[106:109], v[194:197], v[24:27], v[106:109]
    v_mfma_f32_16x16x32_bf16 v[110:113], v[186:189], v[42:45], v[110:113]
    v_mfma_f32_16x16x32_bf16 v[114:117], v[194:197], v[42:45], v[114:117]
    v_mfma_f32_16x16x32_bf16 v[118:121], v[34:37], v[60:63], v[118:121]
    v_mfma_f32_16x16x32_bf16 v[122:125], v[34:37], v[24:27], v[122:125]
    v_mfma_f32_16x16x32_bf16 v[126:129], v[34:37], v[42:45], v[126:129]
    s_nop 1
    ds_write_b128 v10, v[102:105]
    ds_write_b128 v10, v[106:109] offset:1792
    s_nop 0
    v_cndmask_b32 v110, v110, v114, s[44:45]
    v_cndmask_b32 v111, v111, v115, s[44:45]
    v_cndmask_b32 v112, v112, v116, s[44:45]
    v_cndmask_b32 v113, v113, v117, s[44:45]
    ds_write_b128 v11, v[110:113]
    v_cndmask_b32 v118, v118, v122, s[46:47]
    v_cndmask_b32 v119, v119, v123, s[46:47]
    v_cndmask_b32 v120, v120, v124, s[46:47]
    v_cndmask_b32 v121, v121, v125, s[46:47]
    ds_write_b128 v12, v[118:121]
    ds_write_b128 v13, v[126:129]
    buffer_load_dwordx4 a[156:159], v0, s[40:43], s20 offen offset:3072 sc1
    s_add_u32 s20, s20, 4096
    s_waitcnt vmcnt(13)
    v_cmp_gt_u32 s[96:97], 1, v250
    s_nop 0
    s_and_b32 s96, s96, 0xfffff
    s_cbranch_scc1 Lslow3
Lback3:
    buffer_load_dwordx4 a[160:163], v0, s[40:43], s21 offen offset:0 sc1
    s_waitcnt lgkmcnt(0)
    s_barrier
    ds_read2st64_b32 v[146:147], v16 offset0:0 offset1:28
    ds_read2st64_b32 v[148:149], v16 offset0:1 offset1:29
    ds_read2st64_b32 v[150:151], v16 offset0:2 offset1:30
    ds_read2st64_b32 v[152:153], v16 offset0:3 offset1:31
    ds_read2st64_b32 v[154:155], v16 offset0:4 offset1:32
    ds_read2st64_b32 v[156:157], v16 offset0:5 offset1:33
    ds_read2st64_b32 v[158:159], v16 offset0:6 offset1:34
    s_waitcnt lgkmcnt(6)
    v_add_f32 v146, v146, v147
    buffer_atomic_add_f32 v146, v17, s[40:43], s58 offen offset:0
    s_waitcnt lgkmcnt(5)
    v_add_f32 v148, v148, v149
    buffer_atomic_add_f32 v148, v17, s[40:43], s58 offen offset:256
    s_waitcnt lgkmcnt(4)
    v_add_f32 v150, v150, v151
    buffer_atomic_add_f32 v150, v17, s[40:43], s58 offen offset:512
    s_waitcnt lgkmcnt(3)
    v_add_f32 v152, v152, v153
    buffer_atomic_add_f32 v152, v17, s[40:43], s58 offen offset:768
    s_waitcnt lgkmcnt(2)
    v_add_f32 v154, v154, v155
    buffer_atomic_add_f32 v154, v17, s[40:43], s58 offen offset:1024
    s_waitcnt lgkmcnt(1)
    v_add_f32 v156, v156, v157
    buffer_atomic_add_f32 v156, v17, s[40:43], s58 offen offset:1280
    s_waitcnt lgkmcnt(0)
    v_add_f32 v158, v158, v159
    buffer_atomic_add_f32 v158, v18, s[40:43], s58 offen offset:1536
    s_lshl_b32 s57, s5, 7
    s_add_u32 s7, s57, 22020096
    s_cmp_eq_u32 s3, 0
    s_cselect_b32 s58, 16, 0
    v_mul_u32_u24 v9, 0x1800, v1
    v_mov_b32 v8, 0x40000000
    v_cmp_lt_i32 s[100:101], v1, s58
    s_nop 1
    v_cndmask_b32 v44, v8, v9, s[100:101]
    v_mov_b32 v11, 1
    v_mov_b32 v9, 0x40000000
    v_cmp_eq_i32 s[100:101], v1, 0
    s_nop 1
    v_cndmask_b32 v15, v9, 0, s[100:101]
    s_lshl_b32 s55, s16, 3
    s_add_u32 s55, s55, s23
    s_mul_i32 s52, s55, 20
    s_lshl_b32 s51, s24, 2
    s_add_u32 s52, s52, s51
    s_add_u32 s52, s52, s3
    s_lshl_b32 s52, s52, 10
    s_add_u32 s52, s52, 4194304
    s_mul_i32 s58, s16, 6144
    s_lshl_b32 s51, s3, 7
    s_add_u32 s58, s58, s51
    s_add_u32 s58, s58, 22021632
    s_cmp_ge_u32 s17, 10
    s_cselect_b32 s52, 1073741824, s52
    s_cselect_b32 s58, 1073741824, s58
    s_add_u32 s63, s52, 40960
    v_mov_b32 v34, -1
    v_mov_b32 v35, -1
    v_mov_b32 v36, -1
    v_mov_b32 v37, -1
    buffer_store_dwordx4 v[34:37], v0, s[40:43], s52 offen sc1
    buffer_store_dwordx4 v[34:37], v0, s[40:43], s63 offen sc1
    v_lshlrev_b32 v10, 3, v1
    v_lshlrev_b32 v9, 7, v1
    v_mov_b32 v8, 0x40000000
    v_cmp_lt_i32 s[100:101], v1, 12
    s_nop 1
    v_cndmask_b32 v30, v8, v9, s[100:101]
    s_mul_i32 s50, s3, 5120
    v_add_u32 v13, s50, v0
    v_and_b32 v9, 15, v1
    buffer_load_dwordx4 a[164:167], v0, s[40:43], s21 offen offset:1024 sc1
    v_lshlrev_b32 v9, 3, v9
    v_lshrrev_b32 v8, 5, v1
    v_lshlrev_b32 v8, 2, v8
    v_add_u32 v8, v9, v8
    v_mov_b32 v9, 0x40000000
    v_and_b32 v7, 16, v1
    v_cmp_eq_i32 s[100:101], v7, 0
    s_nop 1
    v_cndmask_b32 v14, v9, v8, s[100:101]
    buffer_load_dwordx4 a[168:171], v0, s[40:43], s21 offen offset:2048 sc1
    s_lshl_b32 s51, s24, 2
    s_add_u32 s51, s51, s3
    s_lshl_b32 s51, s51, 6
    v_lshrrev_b32 v9, 2, v1
    v_mul_u32_u24 v9, 0x500, v9
    v_and_b32 v8, 3, v1
    v_lshlrev_b32 v8, 4, v8
    v_add_u32 v8, v9, v8
    buffer_load_dwordx4 a[172:175], v0, s[40:43], s21 offen offset:3072 sc1
    s_add_u32 s21, s21, 4096
    v_add_u32 v16, s51, v8
    s_lshl_b32 s31, s3, 12
    s_add_u32 s31, s31, 143360
    v_and_b32 v9, 15, v1
    v_lshlrev_b32 v9, 6, v9
    v_lshrrev_b32 v8, 4, v1
    v_lshlrev_b32 v8, 4, v8
    v_add_u32 v8, v9, v8
    buffer_load_dwordx4 a[176:179], v0, s[40:43], s21 offen offset:0 sc1
    v_add_u32 v17, s31, v8
    v_lshlrev_b32 v9, 7, v1
    v_mov_b32 v8, 0x40000000
    v_cmp_lt_i32 s[100:101], v1, 4
    s_nop 1
    v_cndmask_b32 v19, v8, v9, s[100:101]
    v_add_u32 v20, s28, v0
    s_lshl_b32 s51, s3, 12
    s_add_u32 s51, s51, 143360
    v_and_b32 v9, 15, v1
    buffer_load_dwordx4 a[180:183], v0, s[40:43], s21 offen offset:1024 sc1
    v_lshlrev_b32 v9, 4, v9
    v_add_u32 v21, s51, v9
    v_and_b32 v9, 15, v1
    v_mul_u32_u24 v9, 48, v9
    v_add_u32 v9, s51, v9
    v_add_u32 v22, 0xa00, v9
    v_lshrrev_b32 v9, 4, v1
    v_lshlrev_b32 v9, 3, v9
    buffer_load_dwordx4 a[184:187], v0, s[40:43], s21 offen offset:2048 sc1
    v_add_u32 v23, v22, v9
    v_add_u32 v9, 32, v22
    v_lshrrev_b32 v8, 4, v1
    v_lshlrev_b32 v8, 2, v8
    v_add_u32 v24, v9, v8
    v_lshrrev_b32 v9, 4, v1
    v_min_u32 v9, 2, v9
    v_lshlrev_b32 v9, 4, v9
    buffer_load_dwordx4 a[188:191], v0, s[40:43], s21 offen offset:3072 sc1
    s_add_u32 s21, s21, 4096
    v_add_u32 v22, v22, v9
    v_mov_b32 v9, 0x40000000
    v_cmp_lt_i32 s[100:101], v1, 48
    s_nop 1
    v_cndmask_b32 v25, v9, v0, s[100:101]
    s_mul_i32 s48, s18, 6144
    s_add_u32 s48, s48, 22020096
    s_mul_i32 s49, s18, 163840
    s_add_u32 s49, s49, s50
    s_add_u32 s49, s49, 4194304
    s_mul_i32 s51, s3, 5376
    s_add_u32 s51, s51, 81920
    v_and_b32 v9, 15, v1
    buffer_load_dwordx4 a[192:195], v0, s[40:43], s21 offen offset:0 sc1
    v_mul_u32_u24 v9, 0x150, v9
    v_lshrrev_b32 v8, 4, v1
    v_lshlrev_b32 v8, 4, v8
    v_add_u32 v8, v9, v8
    v_add_u32 v26, s51, v8
    v_mul_u32_u24 v9, 0x199a, v1
    v_lshrrev_b32 v32, 16, v9
    v_mul_u32_u24 v9, 10, v32
    s_waitcnt vmcnt(10)
    s_barrier
    buffer_atomic_add v11, v44, s[40:43], s7 offen offset:0 sc1
    v_sub_u32 v33, v1, v9
    s_lshl_b32 s51, s3, 2
    v_min_u32 v9, 3, v32
    v_add_u32 v32, s51, v9
    v_mul_u32_u24 v9, 0x150, v32
    v_lshlrev_b32 v8, 5, v33
    v_add_u32 v8, v9, v8
    v_add_u32 v27, 0x14000, v8
    s_waitcnt vmcnt(9)
    buffer_atomic_add v11, v15, s[40:43], s58 offen offset:0 sc1
    s_add_u32 s58, s58, 512
    s_and_b32 s51, s29, 7
    s_mul_i32 s51, s51, 10
    v_add_u32 v33, s51, v33
    s_lshl_b32 s51, s51, 8
    s_lshl_b32 s53, s3, 6
    s_add_u32 s51, s51, s53
    v_lshrrev_b32 v9, 2, v1
    v_lshlrev_b32 v9, 8, v9
    buffer_load_dwordx4 a[196:199], v0, s[40:43], s21 offen offset:1024 sc1
    v_and_b32 v8, 3, v1
    v_lshlrev_b32 v8, 4, v8
    v_add_u32 v8, v9, v8
    v_add_u32 v8, s51, v8
    v_mov_b32 v9, 0x40000000
    v_cmp_lt_i32 s[100:101], v1, 40
    s_nop 1
    v_cndmask_b32 v28, v9, v8, s[100:101]
    v_mul_u32_u24 v9, 0x500, v32
    buffer_load_dwordx4 a[200:203], v0, s[40:43], s21 offen offset:2048 sc1
    v_lshlrev_b32 v8, 4, v33
    v_add_u32 v8, v9, v8
    v_mov_b32 v9, 0x40000000
    v_cmp_lt_i32 s[100:101], v1, 40
    s_nop 1
    v_cndmask_b32 v29, v9, v8, s[100:101]
    v_mul_u32_u24 v9, 0x300, v1
    v_add_u32 v9, 0x2fc, v9
    v_mov_b32 v8, 0x40000000
    buffer_load_dwordx4 a[204:207], v0, s[40:43], s21 offen offset:3072 sc1
    s_add_u32 s21, s21, 4096
    v_cmp_lt_i32 s[100:101], v1, 16
    s_nop 1
    v_cndmask_b32 v31, v8, v9, s[100:101]
    buffer_load_dwordx4 a[208:211], v0, s[40:43], s21 offen offset:0 sc1
    buffer_load_dwordx4 a[212:215], v0, s[40:43], s21 offen offset:1024 sc1
    buffer_load_dwordx4 a[216:219], v0, s[40:43], s21 offen offset:2048 sc1
    s_mov_b64 exec, 0
    s_cmp_eq_u32 s3, 2
    s_cbranch_scc1 Lidbkv
    s_cmp_eq_u32 s3, 3
    s_cbranch_scc1 Lidckv
    s_cmp_eq_u32 s3, 0
    s_cbranch_scc1 Liddkv
    s_call_b64 s[98:99], Lwc0_0
    s_branch Liddkv
Lidbkv:
    s_call_b64 s[98:99], Lwc1_0
    s_branch Liddkv
Lidckv:
    s_call_b64 s[98:99], Lwc2_0
Liddkv:
    s_mov_b64 exec, -1
    buffer_load_dwordx4 a[220:223], v0, s[40:43], s21 offen offset:3072 sc1
    s_add_u32 s21, s21, 4096
    buffer_load_dwordx4 a[224:227], v0, s[40:43], s21 offen offset:0 sc1
    buffer_load_dwordx4 a[228:231], v0, s[40:43], s21 offen offset:1024 sc1
    buffer_load_dwordx4 a[232:235], v0, s[40:43], s21 offen offset:2048 sc1
    buffer_load_dwordx4 a[236:239], v0, s[40:43], s21 offen offset:3072 sc1
    s_add_u32 s21, s21, 4096
    buffer_load_dwordx4 a[240:243], v0, s[40:43], s21 offen offset:0 sc1
    buffer_load_dwordx4 a[244:247], v0, s[40:43], s21 offen offset:1024 sc1
    buffer_load_dwordx4 a[248:251], v0, s[40:43], s21 offen offset:2048 sc1
    buffer_load_dwordx4 a[252:255], v0, s[40:43], s21 offen offset:3072 sc1
    s_add_u32 s21, s21, 4096
    buffer_load_dwordx4 v[168:171], v0, s[40:43], s21 offen offset:0 sc1
    buffer_load_dwordx4 v[172:175], v0, s[40:43], s21 offen offset:1024 sc1
    buffer_load_dwordx4 v[176:179], v0, s[40:43], s21 offen offset:2048 sc1
    buffer_load_dwordx4 v[180:183], v0, s[40:43], s21 offen offset:3072 sc1
    s_add_u32 s21, s21, 4096
    buffer_load_dwordx4 v[184:187], v0, s[40:43], s21 offen offset:0 sc1
    buffer_load_dwordx4 v[188:191], v0, s[40:43], s21 offen offset:1024 sc1
    buffer_load_dwordx4 v[192:195], v0, s[40:43], s21 offen offset:2048 sc1
    buffer_load_dwordx4 v[196:199], v0, s[40:43], s21 offen offset:3072 sc1
    s_add_u32 s21, s21, 4096
    buffer_load_dwordx4 v[200:203], v0, s[40:43], s21 offen offset:0 sc1
    buffer_load_dwordx4 v[204:207], v0, s[40:43], s21 offen offset:1024 sc1
    buffer_load_dwordx4 v[208:211], v0, s[40:43], s21 offen offset:2048 sc1
    buffer_load_dwordx4 v[212:215], v0, s[40:43], s21 offen offset:3072 sc1
    s_add_u32 s21, s21, 4096
    buffer_load_dwordx4 v[216:219], v0, s[40:43], s21 offen offset:0 sc1
    buffer_load_dwordx4 v[220:223], v0, s[40:43], s21 offen offset:1024 sc1
    buffer_load_dwordx4 v[224:227], v0, s[40:43], s21 offen offset:2048 sc1
    buffer_load_dwordx4 v[228:231], v0, s[40:43], s21 offen offset:3072 sc1
    s_add_u32 s21, s21, 4096
    buffer_load_dwordx4 v[232:235], v0, s[40:43], s21 offen offset:0 sc1
    buffer_load_dwordx4 v[236:239], v0, s[40:43], s21 offen offset:1024 sc1
    buffer_load_dwordx4 v[240:243], v0, s[40:43], s21 offen offset:2048 sc1
    buffer_load_dwordx4 v[244:247], v0, s[40:43], s21 offen offset:3072 sc1
    s_add_u32 s21, s21, 4096
    buffer_load_dwordx4 v[248:251], v0, s[40:43], s21 offen offset:0 sc1
    buffer_load_dwordx4 v[252:255], v0, s[40:43], s21 offen offset:1024 sc1
    s_branch Ljoin
Lq:
    v_mul_u32_u24 v9, 0xccd, v1
    v_lshrrev_b32 v251, 16, v9
    v_mul_u32_u24 v9, 0xf00, v251
    v_mul_u32_u24 v8, 20, v251
    v_sub_u32 v8, v1, v8
    v_lshrrev_b32 v7, 2, v251
    v_and_b32 v7, 2, v7
    v_xor_b32 v7, v8, v7
    v_lshlrev_b32 v7, 4, v7
    v_add_u32 v14, v9, v7
    v_add_u32 v9, 64, v1
    v_mul_u32_u24 v9, 0xccd, v9
    v_lshrrev_b32 v251, 16, v9
    v_mul_u32_u24 v9, 0xf00, v251
    v_add_u32 v8, 64, v1
    v_mul_u32_u24 v7, 20, v251
    v_sub_u32 v7, v8, v7
    v_lshrrev_b32 v8, 2, v251
    v_and_b32 v8, 2, v8
    v_xor_b32 v8, v7, v8
    v_lshlrev_b32 v8, 4, v8
    v_add_u32 v15, v9, v8
    v_add_u32 v9, 0x80, v1
    v_mul_u32_u24 v9, 0xccd, v9
    v_lshrrev_b32 v251, 16, v9
    v_mul_u32_u24 v9, 0xf00, v251
    v_add_u32 v8, 0x80, v1
    v_mul_u32_u24 v7, 20, v251
    v_sub_u32 v7, v8, v7
    v_lshrrev_b32 v8, 2, v251
    v_and_b32 v8, 2, v8
    v_xor_b32 v8, v7, v8
    v_lshlrev_b32 v8, 4, v8
    v_add_u32 v16, v9, v8
    v_add_u32 v9, 0xc0, v1
    v_mul_u32_u24 v9, 0xccd, v9
    v_lshrrev_b32 v251, 16, v9
    v_mul_u32_u24 v9, 0xf00, v251
    v_add_u32 v8, 0xc0, v1
    v_mul_u32_u24 v7, 20, v251
    v_sub_u32 v7, v8, v7
    v_lshrrev_b32 v8, 2, v251
    v_and_b32 v8, 2, v8
    v_xor_b32 v8, v7, v8
    v_lshlrev_b32 v8, 4, v8
    v_add_u32 v17, v9, v8
    v_add_u32 v9, 0x100, v1
    v_mul_u32_u24 v9, 0xccd, v9
    v_lshrrev_b32 v251, 16, v9
    v_mul_u32_u24 v9, 0xf00, v251
    v_add_u32 v8, 0x100, v1
    v_mul_u32_u24 v7, 20, v251
    v_sub_u32 v7, v8, v7
    v_lshrrev_b32 v8, 2, v251
    v_and_b32 v8, 2, v8
    v_xor_b32 v8, v7, v8
    v_lshlrev_b32 v8, 4, v8
    v_add_u32 v18, v9, v8
    s_sub_u32 s51, s5, 8
    s_mul_i32 s51, s51, 320
    s_mul_i32 s57, s3, 61440
    s_add_u32 s51, s51, s57
    s_mul_i32 s56, s3, 5120
    s_add_u32 s56, s56, 65536
    s_mul_i32 s57, s52, 245760
    s_add_u32 s54, s51, s57
    s_add_u32 s52, s52, 1
    s_cmp_eq_u32 s52, 10
    s_cselect_b32 s52, 0, s52
    s_xor_b32 s57, s48, 0
    s_lshl_b32 s58, s57, 2
    s_lshl_b32 s59, s48, 11
    v_and_b32 v9, 15, v1
    v_lshlrev_b32 v9, 7, v9
    v_lshrrev_b32 v8, 4, v1
    v_add_u32 v8, s58, v8
    v_and_b32 v7, 15, v1
    v_lshrrev_b32 v7, 1, v7
    v_and_b32 v7, 7, v7
    v_xor_b32 v7, v8, v7
    v_lshlrev_b32 v7, 4, v7
    v_add_u32 v7, v9, v7
    v_add_u32 v7, s59, v7
    v_mov_b32 v19, v7
    s_mul_i32 s58, s57, 10240
    s_mul_i32 s59, s49, 160
    v_lshrrev_b32 v9, 4, v1
    v_lshlrev_b32 v9, 3, v9
    v_lshrrev_b32 v8, 2, v1
    v_and_b32 v8, 3, v8
    v_add_u32 v8, v9, v8
    v_mul_u32_u24 v8, 0x140, v8
    v_add_u32 v8, s58, v8
    v_add_u32 v251, 0x10000, v8
    v_and_b32 v9, 3, v1
    v_lshlrev_b32 v9, 3, v9
    v_add_u32 v21, s59, v9
    v_lshrrev_b32 v9, 4, v1
    v_and_b32 v9, 1, v9
    v_lshlrev_b32 v22, 5, v9
    v_xor_b32 v9, v21, v22
    v_add_u32 v224, v9, v251
    v_add_u32 v9, 40, v21
    v_xor_b32 v9, v9, v22
    v_add_u32 v225, v9, v251
    v_add_u32 v9, 0x50, v21
    v_xor_b32 v9, v9, v22
    v_add_u32 v226, v9, v251
    v_add_u32 v9, 0x78, v21
    v_xor_b32 v9, v9, v22
    v_add_u32 v227, v9, v251
    v_and_b32 v9, 3, v1
    v_lshlrev_b32 v9, 5, v9
    v_add_u32 v9, v21, v9
    v_add_u32 v9, 32, v9
    v_xor_b32 v9, v9, v22
    v_add_u32 v228, v9, v251
    s_xor_b32 s57, s48, 1
    s_lshl_b32 s58, s57, 2
    s_lshl_b32 s59, s48, 11
    v_and_b32 v9, 15, v1
    v_lshlrev_b32 v9, 7, v9
    v_lshrrev_b32 v8, 4, v1
    v_add_u32 v8, s58, v8
    v_and_b32 v7, 15, v1
    v_lshrrev_b32 v7, 1, v7
    v_and_b32 v7, 7, v7
    v_xor_b32 v7, v8, v7
    v_lshlrev_b32 v7, 4, v7
    v_add_u32 v7, v9, v7
    v_add_u32 v7, s59, v7
    v_mov_b32 v20, v7
    s_mul_i32 s58, s48, -20480
    s_add_u32 s58, s58, 10240
    v_add_u32 v229, s58, v224
    v_add_u32 v230, s58, v225
    v_add_u32 v231, s58, v226
    v_add_u32 v232, s58, v227
    v_add_u32 v233, s58, v228
    v_mov_b32 v26, 0x3f803f80
    v_mov_b32 v27, 0x3f803f80
    v_mov_b32 v28, 0x3f803f80
    v_mov_b32 v29, 0x3f803f80
    s_mov_b64 exec, 0
    s_call_b64 s[98:99], Lwq_0
    s_mov_b64 exec, -1
    s_add_u32 m0, s56, 0
    s_nop 0
    buffer_load_dwordx4 v14, s[12:15], s54 offen lds
    s_add_u32 m0, s56, 1024
    s_nop 0
    buffer_load_dwordx4 v15, s[12:15], s54 offen lds
    s_add_u32 m0, s56, 2048
    s_nop 0
    buffer_load_dwordx4 v16, s[12:15], s54 offen lds
    s_add_u32 m0, s56, 3072
    s_nop 0
    buffer_load_dwordx4 v17, s[12:15], s54 offen lds
    s_add_u32 m0, s56, 4096
    s_nop 0
    buffer_load_dwordx4 v18, s[12:15], s54 offen lds
    s_lshl_b32 s57, s52, 7
    s_add_u32 s53, s50, s57
    s_mul_i32 s57, s52, 245760
    s_add_u32 s54, s51, s57
    s_add_u32 s52, s52, 1
    s_cmp_eq_u32 s52, 10
    s_cselect_b32 s52, 0, s52
    s_add_u32 m0, s55, 16384
    s_nop 0
    buffer_load_dwordx4 v10, s[8:11], s53 offen lds
    s_add_u32 m0, s56, 20512
    s_nop 0
    buffer_load_dwordx4 v14, s[12:15], s54 offen lds
    s_add_u32 m0, s56, 21536
    s_nop 0
    buffer_load_dwordx4 v15, s[12:15], s54 offen lds
    s_add_u32 m0, s55, 17408
    s_nop 0
    buffer_load_dwordx4 v11, s[8:11], s53 offen lds
    s_add_u32 m0, s56, 22560
    s_nop 0
    buffer_load_dwordx4 v16, s[12:15], s54 offen lds
    s_waitcnt vmcnt(5)
    s_barrier
    ds_read_b128 v[30:33], v19 offset:0
    ds_read_b64_tr_b16 v[46:47], v224 offset:0
    ds_read_b64_tr_b16 v[48:49], v224 offset:1280
    ds_read_b64_tr_b16 v[50:51], v225 offset:0
    ds_read_b64_tr_b16 v[52:53], v225 offset:1280
    ds_read_b64_tr_b16 v[54:55], v226 offset:0
    ds_read_b64_tr_b16 v[56:57], v226 offset:1280
    ds_read_b64_tr_b16 v[58:59], v227 offset:0
    ds_read_b64_tr_b16 v[60:61], v227 offset:1280
    ds_read_b64_tr_b16 v[62:63], v228 offset:0
    ds_read_b64_tr_b16 v[64:65], v228 offset:1280
    ds_read_b128 v[34:37], v19 offset:4096
    ds_read_b128 v[38:41], v19 offset:8192
    ds_read_b128 v[42:45], v19 offset:12288
    s_waitcnt lgkmcnt(11)
    v_mfma_f32_16x16x32_bf16 v[102:105], v[46:49], v[30:33], 0
    s_add_u32 m0, s55, 18432
    ds_read_b128 v[66:69], v20 offset:0
    s_waitcnt lgkmcnt(10)
    v_mfma_f32_16x16x32_bf16 v[106:109], v[50:53], v[30:33], 0
    s_waitcnt lgkmcnt(8)
    buffer_load_dwordx4 v12, s[8:11], s53 offen lds
    v_mfma_f32_16x16x32_bf16 v[110:113], v[54:57], v[30:33], 0
    s_add_u32 m0, s56, 23584
    ds_read_b64_tr_b16 v[82:83], v229 offset:0
    ds_read_b64_tr_b16 v[84:85], v229 offset:1280
    s_waitcnt lgkmcnt(8)
    v_mfma_f32_16x16x32_bf16 v[114:117], v[58:61], v[30:33], 0
    s_waitcnt lgkmcnt(6)
    buffer_load_dwordx4 v17, s[12:15], s54 offen lds
    v_mfma_f32_16x16x32_bf16 v[118:121], v[62:65], v[30:33], 0
    s_add_u32 m0, s55, 19456
    ds_read_b64_tr_b16 v[86:87], v230 offset:0
    ds_read_b64_tr_b16 v[88:89], v230 offset:1280
    s_waitcnt lgkmcnt(7)
    v_mfma_f32_16x16x32_bf16 v[122:125], v[46:49], v[34:37], 0
    buffer_load_dwordx4 v13, s[8:11], s53 offen lds
    v_mfma_f32_16x16x32_bf16 v[126:129], v[50:53], v[34:37], 0
    s_add_u32 m0, s56, 24608
    ds_read_b64_tr_b16 v[90:91], v231 offset:0
    ds_read_b64_tr_b16 v[92:93], v231 offset:1280
    v_mfma_f32_16x16x32_bf16 v[130:133], v[54:57], v[34:37], 0
    buffer_load_dwordx4 v18, s[12:15], s54 offen lds
    v_mfma_f32_16x16x32_bf16 v[134:137], v[58:61], v[34:37], 0
    s_lshl_b32 s57, s52, 7
    ds_read_b64_tr_b16 v[94:95], v232 offset:0
    ds_read_b64_tr_b16 v[96:97], v232 offset:1280
    v_mfma_f32_16x16x32_bf16 v[138:141], v[62:65], v[34:37], 0
    s_add_u32 s53, s50, s57
    ds_read_b64_tr_b16 v[98:99], v233 offset:0
    s_mul_i32 s57, s52, 245760
    s_waitcnt lgkmcnt(11)
    v_mfma_f32_16x16x32_bf16 v[142:145], v[46:49], v[38:41], 0
    s_add_u32 s54, s51, s57
    ds_read_b64_tr_b16 v[100:101], v233 offset:1280
    s_add_u32 s52, s52, 1
    v_mfma_f32_16x16x32_bf16 v[146:149], v[50:53], v[38:41], 0
    s_cmp_eq_u32 s52, 10
    s_cselect_b32 s52, 0, s52
    ds_read_b128 v[70:73], v20 offset:4096
    v_mfma_f32_16x16x32_bf16 v[150:153], v[54:57], v[38:41], 0
    s_add_u32 m0, s55, 32768
    ds_read_b128 v[74:77], v20 offset:8192
    v_mfma_f32_16x16x32_bf16 v[154:157], v[58:61], v[38:41], 0
    buffer_load_dwordx4 v10, s[8:11], s53 offen lds
    v_mfma_f32_16x16x32_bf16 v[158:161], v[62:65], v[38:41], 0
    s_add_u32 m0, s56, 41024
    ds_read_b128 v[78:81], v20 offset:12288
    s_waitcnt lgkmcnt(14)
    v_mfma_f32_16x16x32_bf16 v[162:165], v[46:49], v[42:45], 0
    buffer_load_dwordx4 v14, s[12:15], s54 offen lds
    v_mfma_f32_16x16x32_bf16 v[166:169], v[50:53], v[42:45], 0
    s_add_u32 m0, s56, 42048
    v_mfma_f32_16x16x32_bf16 v[170:173], v[54:57], v[42:45], 0
    buffer_load_dwordx4 v15, s[12:15], s54 offen lds
    v_mfma_f32_16x16x32_bf16 v[174:177], v[58:61], v[42:45], 0
    s_add_u32 m0, s55, 33792
    v_mfma_f32_16x16x32_bf16 v[178:181], v[62:65], v[42:45], 0
    buffer_load_dwordx4 v11, s[8:11], s53 offen lds
    v_mfma_f32_16x16x32_bf16 v[182:185], v[46:49], v[26:29], 0
    s_add_u32 m0, s56, 43072
    v_mfma_f32_16x16x32_bf16 v[186:189], v[50:53], v[26:29], 0
    buffer_load_dwordx4 v16, s[12:15], s54 offen lds
    v_mfma_f32_16x16x32_bf16 v[190:193], v[54:57], v[26:29], 0
    s_add_u32 m0, s55, 34816
    v_mfma_f32_16x16x32_bf16 v[194:197], v[58:61], v[26:29], 0
    buffer_load_dwordx4 v12, s[8:11], s53 offen lds
    v_mfma_f32_16x16x32_bf16 v[198:201], v[62:65], v[26:29], 0
    s_waitcnt vmcnt(6) lgkmcnt(0)
    s_barrier
    s_add_u32 m0, s56, 44096
    v_mfma_f32_16x16x32_bf16 v[102:105], v[82:85], v[66:69], v[102:105]
    buffer_load_dwordx4 v17, s[12:15], s54 offen lds
    v_mfma_f32_16x16x32_bf16 v[106:109], v[86:89], v[66:69], v[106:109]
    s_add_u32 m0, s55, 35840
    ds_read_b128 v[30:33], v19 offset:16384
    ds_read_b64_tr_b16 v[46:47], v224 offset:20512
    v_mfma_f32_16x16x32_bf16 v[110:113], v[90:93], v[66:69], v[110:113]
    buffer_load_dwordx4 v13, s[8:11], s53 offen lds
    v_mfma_f32_16x16x32_bf16 v[114:117], v[94:97], v[66:69], v[114:117]
    s_add_u32 m0, s56, 45120
    ds_read_b64_tr_b16 v[48:49], v224 offset:21792
    ds_read_b64_tr_b16 v[50:51], v225 offset:20512
    v_mfma_f32_16x16x32_bf16 v[118:121], v[98:101], v[66:69], v[118:121]
    buffer_load_dwordx4 v18, s[12:15], s54 offen lds
    v_mfma_f32_16x16x32_bf16 v[122:125], v[82:85], v[70:73], v[122:125]
    ds_read_b64_tr_b16 v[52:53], v225 offset:21792
    ds_read_b64_tr_b16 v[54:55], v226 offset:20512
    v_mfma_f32_16x16x32_bf16 v[126:129], v[86:89], v[70:73], v[126:129]
    ds_read_b64_tr_b16 v[56:57], v226 offset:21792
    ds_read_b64_tr_b16 v[58:59], v227 offset:20512
    v_mfma_f32_16x16x32_bf16 v[130:133], v[90:93], v[70:73], v[130:133]
    s_lshl_b32 s57, s52, 7
    ds_read_b64_tr_b16 v[60:61], v227 offset:21792
    s_add_u32 s53, s50, s57
    v_mfma_f32_16x16x32_bf16 v[134:137], v[94:97], v[70:73], v[134:137]
    s_mul_i32 s57, s52, 245760
    ds_read_b64_tr_b16 v[62:63], v228 offset:20512
    s_add_u32 s54, s51, s57
    v_mfma_f32_16x16x32_bf16 v[138:141], v[98:101], v[70:73], v[138:141]
    s_add_u32 s52, s52, 1
    ds_read_b64_tr_b16 v[64:65], v228 offset:21792
    s_cmp_eq_u32 s52, 10
    s_cselect_b32 s52, 0, s52
    v_mfma_f32_16x16x32_bf16 v[142:145], v[82:85], v[74:77], v[142:145]
    s_add_u32 m0, s55, 49152
    ds_read_b128 v[34:37], v19 offset:20480
    v_mfma_f32_16x16x32_bf16 v[146:149], v[86:89], v[74:77], v[146:149]
    buffer_load_dwordx4 v10, s[8:11], s53 offen lds
    v_mfma_f32_16x16x32_bf16 v[150:153], v[90:93], v[74:77], v[150:153]
    ds_read_b128 v[38:41], v19 offset:24576
    ds_read_b128 v[42:45], v19 offset:28672
    v_mfma_f32_16x16x32_bf16 v[154:157], v[94:97], v[74:77], v[154:157]
    v_mfma_f32_16x16x32_bf16 v[158:161], v[98:101], v[74:77], v[158:161]
    s_add_u32 m0, s56, 61536
    v_mfma_f32_16x16x32_bf16 v[162:165], v[82:85], v[78:81], v[162:165]
    buffer_load_dwordx4 v14, s[12:15], s54 offen lds
    v_mfma_f32_16x16x32_bf16 v[166:169], v[86:89], v[78:81], v[166:169]
    v_mfma_f32_16x16x32_bf16 v[170:173], v[90:93], v[78:81], v[170:173]
    v_mfma_f32_16x16x32_bf16 v[174:177], v[94:97], v[78:81], v[174:177]
    s_add_u32 m0, s56, 62560
    v_mfma_f32_16x16x32_bf16 v[178:181], v[98:101], v[78:81], v[178:181]
    s_waitcnt lgkmcnt(11)
    buffer_load_dwordx4 v15, s[12:15], s54 offen lds
    v_mfma_f32_16x16x32_bf16 v[102:105], v[46:49], v[30:33], v[102:105]
    s_waitcnt lgkmcnt(9)
    ds_read_b128 v[66:69], v20 offset:16384
    v_mfma_f32_16x16x32_bf16 v[106:109], v[50:53], v[30:33], v[106:109]
    s_waitcnt lgkmcnt(8)
    ds_read_b64_tr_b16 v[82:83], v229 offset:20512
    v_mfma_f32_16x16x32_bf16 v[110:113], v[54:57], v[30:33], v[110:113]
    s_add_u32 m0, s55, 50176
    ds_read_b64_tr_b16 v[84:85], v229 offset:21792
    s_waitcnt lgkmcnt(8)
    v_mfma_f32_16x16x32_bf16 v[114:117], v[58:61], v[30:33], v[114:117]
    s_waitcnt lgkmcnt(6)
    buffer_load_dwordx4 v11, s[8:11], s53 offen lds
    v_mfma_f32_16x16x32_bf16 v[118:121], v[62:65], v[30:33], v[118:121]
    s_waitcnt lgkmcnt(5)
    ds_read_b64_tr_b16 v[86:87], v230 offset:20512
    ds_read_b64_tr_b16 v[88:89], v230 offset:21792
    v_mfma_f32_16x16x32_bf16 v[122:125], v[46:49], v[34:37], v[122:125]
    s_mov_b64 s[32:33], s[90:91]
    ds_read_b64_tr_b16 v[90:91], v231 offset:20512
    s_mov_b64 s[36:37], s[92:93]
    v_mfma_f32_16x16x32_bf16 v[126:129], v[50:53], v[34:37], v[126:129]
    s_add_u32 m0, s56, 63584
    ds_read_b64_tr_b16 v[92:93], v231 offset:21792
    s_mov_b64 s[40:41], s[94:95]
    v_mfma_f32_16x16x32_bf16 v[130:133], v[54:57], v[34:37], v[130:133]
    s_mov_b32 s34, 2621440
    buffer_load_dwordx4 v16, s[12:15], s54 offen lds
    v_mfma_f32_16x16x32_bf16 v[134:137], v[58:61], v[34:37], v[134:137]
    s_mov_b32 s35, 0x20000
    ds_read_b64_tr_b16 v[94:95], v232 offset:20512
    ds_read_b64_tr_b16 v[96:97], v232 offset:21792
    v_mfma_f32_16x16x32_bf16 v[138:141], v[62:65], v[34:37], v[138:141]
    s_mov_b32 s38, 256
    ds_read_b64_tr_b16 v[98:99], v233 offset:20512
    s_mov_b32 s39, 0x20000
    s_waitcnt lgkmcnt(11)
    v_mfma_f32_16x16x32_bf16 v[142:145], v[46:49], v[38:41], v[142:145]
    s_mov_b32 s42, 25165824
    ds_read_b64_tr_b16 v[100:101], v233 offset:21792
    s_mov_b32 s43, 0x20000
    v_mfma_f32_16x16x32_bf16 v[146:149], v[50:53], v[38:41], v[146:149]
    s_add_u32 m0, s55, 51200
    ds_read_b128 v[70:73], v20 offset:20480
    s_mov_b32 s6, 400000
    v_mfma_f32_16x16x32_bf16 v[150:153], v[54:57], v[38:41], v[150:153]
Lwq_0:
    s_cbranch_execz Lwq_1
    buffer_load_dwordx4 v12, s[8:11], s53 offen lds
    v_mfma_f32_16x16x32_bf16 v[154:157], v[58:61], v[38:41], v[154:157]
    ds_read_b128 v[74:77], v20 offset:24576
    ds_read_b128 v[78:81], v20 offset:28672
    v_mfma_f32_16x16x32_bf16 v[158:161], v[62:65], v[38:41], v[158:161]
    v_lshlrev_b32 v251, 2, v1
    s_lshl_b32 s98, s4, 9
    s_waitcnt lgkmcnt(14)
    v_mfma_f32_16x16x32_bf16 v[162:165], v[46:49], v[42:45], v[162:165]
    s_add_u32 m0, s56, 64608
    s_lshl_b32 s58, s48, 13
    s_add_u32 s98, s98, s58
    v_mfma_f32_16x16x32_bf16 v[166:169], v[50:53], v[42:45], v[166:169]
    s_lshl_b32 s58, s49, 8
    buffer_load_dwordx4 v17, s[12:15], s54 offen lds
    v_mfma_f32_16x16x32_bf16 v[170:173], v[54:57], v[42:45], v[170:173]
    s_add_u32 s98, s98, s58
    s_lshl_b32 s99, s3, 8
    s_add_u32 s99, s99, 147584
    v_mfma_f32_16x16x32_bf16 v[174:177], v[58:61], v[42:45], v[174:177]
    s_lshl_b32 s59, s48, 6
    v_and_b32 v9, 15, v1
    v_lshlrev_b32 v9, 2, v9
    v_mfma_f32_16x16x32_bf16 v[178:181], v[62:65], v[42:45], v[178:181]
    s_add_u32 m0, s55, 52224
    v_add_u32 v9, s59, v9
    v_add_u32 v252, 0x24080, v9
    v_mfma_f32_16x16x32_bf16 v[182:185], v[46:49], v[26:29], v[182:185]
    s_mul_i32 s58, s3, 5120
    buffer_load_dwordx4 v13, s[8:11], s53 offen lds
    v_mfma_f32_16x16x32_bf16 v[186:189], v[50:53], v[26:29], v[186:189]
    v_lshlrev_b32 v9, 4, v1
    v_add_u32 v9, s58, v9
    v_mfma_f32_16x16x32_bf16 v[190:193], v[54:57], v[26:29], v[190:193]
    v_add_u32 v253, 0x8000, v9
    v_lshlrev_b32 v9, 7, v1
    v_mfma_f32_16x16x32_bf16 v[194:197], v[58:61], v[26:29], v[194:197]
    s_add_u32 m0, s56, 65632
    v_mov_b32 v8, 0x40000000
    v_cmp_lt_i32 s[100:101], v1, 4
    v_mfma_f32_16x16x32_bf16 v[198:201], v[62:65], v[26:29], v[198:201]
    s_waitcnt lgkmcnt(0)
    buffer_load_dwordx4 v18, s[12:15], s54 offen lds
    s_waitcnt vmcnt(9)
    s_barrier
    v_mfma_f32_16x16x32_bf16 v[102:105], v[82:85], v[66:69], v[102:105]
    v_add_u32 v224, 0xa040, v224
    v_add_u32 v225, 0xa040, v225
    v_mfma_f32_16x16x32_bf16 v[106:109], v[86:89], v[66:69], v[106:109]
    v_add_u32 v226, 0xa040, v226
    v_cndmask_b32 v254, v8, v9, s[100:101]
    v_mfma_f32_16x16x32_bf16 v[110:113], v[90:93], v[66:69], v[110:113]
    s_and_b32 s16, s2, 7
    v_add_u32 v227, 0xa040, v227
    v_add_u32 v228, 0xa040, v228
    v_mfma_f32_16x16x32_bf16 v[114:117], v[94:97], v[66:69], v[114:117]
    s_lshl_b32 s16, s16, 1
    ds_read_b128 v[30:33], v19 offset:32768
    s_lshr_b32 s44, s2, 7
    v_mfma_f32_16x16x32_bf16 v[118:121], v[98:101], v[66:69], v[118:121]
    s_lshl_b32 s57, s52, 7
    ds_read_b64_tr_b16 v[46:47], v224 offset:0
    ds_read_b64_tr_b16 v[48:49], v224 offset:1280
    v_mfma_f32_16x16x32_bf16 v[122:125], v[82:85], v[70:73], v[122:125]
    s_add_u32 s53, s50, s57
    ds_read_b64_tr_b16 v[50:51], v225 offset:0
    s_mul_i32 s57, s52, 245760
    v_mfma_f32_16x16x32_bf16 v[126:129], v[86:89], v[70:73], v[126:129]
    s_add_u32 s54, s51, s57
    ds_read_b64_tr_b16 v[52:53], v225 offset:1280
    ds_read_b64_tr_b16 v[54:55], v226 offset:0
    v_mfma_f32_16x16x32_bf16 v[130:133], v[90:93], v[70:73], v[130:133]
    s_add_u32 s52, s52, 1
    ds_read_b64_tr_b16 v[56:57], v226 offset:1280
    s_cmp_eq_u32 s52, 10
    s_cselect_b32 s52, 0, s52
    v_mfma_f32_16x16x32_bf16 v[134:137], v[94:97], v[70:73], v[134:137]
    s_add_u32 m0, s55, 0
    ds_read_b64_tr_b16 v[58:59], v227 offset:0
    ds_read_b64_tr_b16 v[60:61], v227 offset:1280
    v_mfma_f32_16x16x32_bf16 v[138:141], v[98:101], v[70:73], v[138:141]
    s_add_u32 s16, s16, s44
    buffer_load_dwordx4 v10, s[8:11], s53 offen lds
    v_mfma_f32_16x16x32_bf16 v[142:145], v[82:85], v[74:77], v[142:145]
    s_bfe_u32 s29, s2, 0x40003
    ds_read_b64_tr_b16 v[62:63], v228 offset:0
    ds_read_b64_tr_b16 v[64:65], v228 offset:1280
    v_mfma_f32_16x16x32_bf16 v[146:149], v[86:89], v[74:77], v[146:149]
    s_add_u32 m0, s56, 0
    ds_read_b128 v[34:37], v19 offset:36864
    ds_read_b128 v[38:41], v19 offset:40960
    v_mfma_f32_16x16x32_bf16 v[150:153], v[90:93], v[74:77], v[150:153]
    s_and_b32 s18, s2, 4
    buffer_load_dwordx4 v14, s[12:15], s54 offen lds
    v_mfma_f32_16x16x32_bf16 v[154:157], v[94:97], v[74:77], v[154:157]
    s_lshl_b32 s18, s18, 1
    ds_read_b128 v[42:45], v19 offset:45056
    s_lshr_b32 s44, s2, 5
    v_mfma_f32_16x16x32_bf16 v[158:161], v[98:101], v[74:77], v[158:161]
    s_add_u32 s18, s18, s44
    s_lshr_b32 s19, s2, 3
    s_lshr_b32 s44, s2, 6
    v_mfma_f32_16x16x32_bf16 v[162:165], v[82:85], v[78:81], v[162:165]
    s_add_u32 m0, s56, 1024
    s_add_u32 s19, s19, s44
    s_and_b32 s19, s19, 3
    v_mfma_f32_16x16x32_bf16 v[166:169], v[86:89], v[78:81], v[166:169]
    s_and_b32 s44, s2, 3
    buffer_load_dwordx4 v15, s[12:15], s54 offen lds
    v_mfma_f32_16x16x32_bf16 v[170:173], v[90:93], v[78:81], v[170:173]
    s_lshl_b32 s44, s44, 2
    s_add_u32 s19, s19, s44
    s_mov_b32 s46, 0xc0ba4321
    v_mfma_f32_16x16x32_bf16 v[174:177], v[94:97], v[78:81], v[174:177]
    s_mov_b32 s47, 0xf7ed9865
    s_lshl_b32 s44, s29, 2
    s_lshr_b64 s[46:47], s[46:47], s44
    v_mfma_f32_16x16x32_bf16 v[178:181], v[98:101], v[78:81], v[178:181]
    s_and_b32 s17, s46, 15
    s_mul_i32 s23, s17, 52
    s_lshr_b32 s23, s23, 8
    s_waitcnt lgkmcnt(11)
    v_mfma_f32_16x16x32_bf16 v[102:105], v[46:49], v[30:33], v[102:105]
    s_add_u32 m0, s55, 1024
    v_add_u32 v229, 0xa040, v229
    v_add_u32 v230, 0xa040, v230
    s_waitcnt lgkmcnt(9)
    v_mfma_f32_16x16x32_bf16 v[106:109], v[50:53], v[30:33], v[106:109]
    s_mul_i32 s44, s23, 5
    buffer_load_dwordx4 v11, s[8:11], s53 offen lds
    s_waitcnt lgkmcnt(7)
    v_mfma_f32_16x16x32_bf16 v[110:113], v[54:57], v[30:33], v[110:113]
    s_sub_u32 s24, s17, s44
    v_add_u32 v231, 0xa040, v231
    v_add_u32 v232, 0xa040, v232
    s_waitcnt lgkmcnt(5)
    v_mfma_f32_16x16x32_bf16 v[114:117], v[58:61], v[30:33], v[114:117]
    s_and_b32 s45, s16, 1
    v_add_u32 v233, 0xa040, v233
    ds_read_b128 v[66:69], v20 offset:32768
    s_waitcnt lgkmcnt(4)
    v_mfma_f32_16x16x32_bf16 v[118:121], v[62:65], v[30:33], v[118:121]
    s_add_u32 m0, s56, 2048
    ds_read_b64_tr_b16 v[82:83], v229 offset:0
    s_add_u32 s24, s24, s45
    s_waitcnt lgkmcnt(4)
    v_mfma_f32_16x16x32_bf16 v[122:125], v[46:49], v[34:37], v[122:125]
    s_cmp_ge_u32 s24, 5
    s_cselect_b32 s24, 0, s24
    ds_read_b64_tr_b16 v[84:85], v229 offset:1280
    v_mfma_f32_16x16x32_bf16 v[126:129], v[50:53], v[34:37], v[126:129]
    s_cmp_ge_u32 s17, 10
    s_cselect_b32 s45, 10, s44
    ds_read_b64_tr_b16 v[86:87], v230 offset:0
    v_mfma_f32_16x16x32_bf16 v[130:133], v[54:57], v[34:37], v[130:133]
    s_add_u32 s17, s45, s24
    buffer_load_dwordx4 v16, s[12:15], s54 offen lds
    v_mfma_f32_16x16x32_bf16 v[134:137], v[58:61], v[34:37], v[134:137]
    s_lshr_b32 s44, s2, 6
    ds_read_b64_tr_b16 v[88:89], v230 offset:1280
    ds_read_b64_tr_b16 v[90:91], v231 offset:0
    v_mfma_f32_16x16x32_bf16 v[138:141], v[62:65], v[34:37], v[138:141]
    s_add_u32 m0, s55, 2048
    ds_read_b64_tr_b16 v[92:93], v231 offset:1280
    ds_read_b64_tr_b16 v[94:95], v232 offset:0
    s_waitcnt lgkmcnt(9)
    v_mfma_f32_16x16x32_bf16 v[142:145], v[46:49], v[38:41], v[142:145]
    s_lshl_b32 s44, s44, 1
    buffer_load_dwordx4 v12, s[8:11], s53 offen lds
    v_mfma_f32_16x16x32_bf16 v[146:149], v[50:53], v[38:41], v[146:149]
    s_add_u32 s44, s44, s29
    ds_read_b64_tr_b16 v[96:97], v232 offset:1280
    ds_read_b64_tr_b16 v[98:99], v233 offset:0
    v_mfma_f32_16x16x32_bf16 v[150:153], v[54:57], v[38:41], v[150:153]
    s_and_b32 s44, s44, 7
    ds_read_b64_tr_b16 v[100:101], v233 offset:1280
    ds_read_b128 v[70:73], v20 offset:36864
    v_mfma_f32_16x16x32_bf16 v[154:157], v[58:61], v[38:41], v[154:157]
    s_add_u32 m0, s56, 3072
    ds_read_b128 v[74:77], v20 offset:40960
    s_and_b32 s29, s29, 8
    v_mfma_f32_16x16x32_bf16 v[158:161], v[62:65], v[38:41], v[158:161]
    s_add_u32 s29, s29, s44
    buffer_load_dwordx4 v17, s[12:15], s54 offen lds
    s_waitcnt lgkmcnt(13)
    v_mfma_f32_16x16x32_bf16 v[162:165], v[46:49], v[42:45], v[162:165]
    s_lshl_b32 s44, s16, 4
    ds_read_b128 v[78:81], v20 offset:45056
    s_add_u32 s29, s29, s44
    v_mfma_f32_16x16x32_bf16 v[166:169], v[50:53], v[42:45], v[166:169]
    s_lshl_b32 s44, s24, 2
    s_add_u32 s44, s44, s3
    s_mul_i32 s20, s44, 40960
    v_mfma_f32_16x16x32_bf16 v[170:173], v[54:57], v[42:45], v[170:173]
    s_add_u32 s20, s20, 13631488
    s_cmp_ge_u32 s17, 10
    s_cselect_b32 s20, 1073741824, s20
    v_mfma_f32_16x16x32_bf16 v[174:177], v[58:61], v[42:45], v[174:177]
    s_add_u32 m0, s55, 3072
    s_lshr_b32 s44, s44, 1
    s_lshl_b32 s44, s44, 9
    v_mfma_f32_16x16x32_bf16 v[178:181], v[62:65], v[42:45], v[178:181]
    s_add_u32 s25, s44, 688128
    buffer_load_dwordx4 v13, s[8:11], s53 offen lds
    v_mfma_f32_16x16x32_bf16 v[182:185], v[46:49], v[26:29], v[182:185]
    s_lshl_b32 s44, s19, 2
    s_add_u32 s44, s44, s3
    s_mul_i32 s21, s44, 61440
    v_mfma_f32_16x16x32_bf16 v[186:189], v[50:53], v[26:29], v[186:189]
    s_add_u32 s21, s21, 14680064
    s_lshr_b32 s44, s19, 1
    s_mul_i32 s44, s44, 2560
    v_mfma_f32_16x16x32_bf16 v[190:193], v[54:57], v[26:29], v[190:193]
    s_add_u32 m0, s56, 4096
    s_add_u32 s26, s44, 655360
    s_and_b32 s44, s29, 7
    v_mfma_f32_16x16x32_bf16 v[194:197], v[58:61], v[26:29], v[194:197]
    s_lshl_b32 s44, s44, 2
    buffer_load_dwordx4 v18, s[12:15], s54 offen lds
    v_mfma_f32_16x16x32_bf16 v[198:201], v[62:65], v[26:29], v[198:201]
    s_waitcnt vmcnt(9) lgkmcnt(0)
    s_barrier
    s_add_u32 s44, s44, s3
    v_mfma_f32_16x16x32_bf16 v[102:105], v[82:85], v[66:69], v[102:105]
    s_mul_i32 s22, s44, 61440
    ds_read_b128 v[30:33], v19 offset:49152
    ds_read_b64_tr_b16 v[46:47], v224 offset:20512
    v_mfma_f32_16x16x32_bf16 v[106:109], v[86:89], v[66:69], v[106:109]
    s_add_u32 s22, s22, 18874368
    ds_read_b64_tr_b16 v[48:49], v224 offset:21792
    s_bfe_u32 s44, s29, 0x10002
    v_mfma_f32_16x16x32_bf16 v[110:113], v[90:93], v[66:69], v[110:113]
    s_lshl_b32 s44, s44, 2
    ds_read_b64_tr_b16 v[50:51], v225 offset:20512
    s_add_u32 s44, s44, s3
    v_mfma_f32_16x16x32_bf16 v[114:117], v[94:97], v[66:69], v[114:117]
    s_lshl_b32 s57, s52, 7
    ds_read_b64_tr_b16 v[52:53], v225 offset:21792
    s_add_u32 s53, s50, s57
    v_mfma_f32_16x16x32_bf16 v[118:121], v[98:101], v[66:69], v[118:121]
    s_mul_i32 s57, s52, 245760
    ds_read_b64_tr_b16 v[54:55], v226 offset:20512
    s_add_u32 s54, s51, s57
    v_mfma_f32_16x16x32_bf16 v[122:125], v[82:85], v[70:73], v[122:125]
    s_add_u32 s52, s52, 1
    ds_read_b64_tr_b16 v[56:57], v226 offset:21792
    s_cmp_eq_u32 s52, 10
    s_cselect_b32 s52, 0, s52
    v_mfma_f32_16x16x32_bf16 v[126:129], v[86:89], v[70:73], v[126:129]
    s_add_u32 m0, s55, 16384
    ds_read_b64_tr_b16 v[58:59], v227 offset:20512
    s_mul_i32 s44, s44, 1536
    v_mfma_f32_16x16x32_bf16 v[130:133], v[90:93], v[70:73], v[130:133]
    s_add_u32 s27, s44, 675840
    buffer_load_dwordx4 v10, s[8:11], s53 offen lds
    v_mfma_f32_16x16x32_bf16 v[134:137], v[94:97], v[70:73], v[134:137]
    s_mul_i32 s28, s3, 20480
    ds_read_b64_tr_b16 v[60:61], v227 offset:21792
    ds_read_b64_tr_b16 v[62:63], v228 offset:20512
    v_mfma_f32_16x16x32_bf16 v[138:141], v[98:101], v[70:73], v[138:141]
    s_lshl_b32 s30, s4, 3
    ds_read_b64_tr_b16 v[64:65], v228 offset:21792
    s_add_u32 s30, s30, s48
    v_mfma_f32_16x16x32_bf16 v[142:145], v[82:85], v[74:77], v[142:145]
    s_add_u32 m0, s56, 20512
    ds_read_b128 v[34:37], v19 offset:53248
    s_lshl_b32 s30, s30, 2
    v_mfma_f32_16x16x32_bf16 v[146:149], v[86:89], v[74:77], v[146:149]
    s_add_u32 s30, s30, s5
    buffer_load_dwordx4 v14, s[12:15], s54 offen lds
    v_mfma_f32_16x16x32_bf16 v[150:153], v[90:93], v[74:77], v[150:153]
    s_sub_u32 s30, s30, 8
    ds_read_b128 v[38:41], v19 offset:57344
    ds_read_b128 v[42:45], v19 offset:61440
    v_mfma_f32_16x16x32_bf16 v[154:157], v[94:97], v[74:77], v[154:157]
    s_lshl_b32 s30, s30, 1
    s_add_u32 s30, s30, s49
    s_mul_i32 s30, s30, 2560
    v_mfma_f32_16x16x32_bf16 v[158:161], v[98:101], v[74:77], v[158:161]
    s_add_u32 m0, s56, 21536
    s_add_u32 s30, s30, 1048576
    s_mov_b32 s31, s30
    v_mfma_f32_16x16x32_bf16 v[162:165], v[82:85], v[78:81], v[162:165]
    buffer_load_dwordx4 v15, s[12:15], s54 offen lds
    v_mfma_f32_16x16x32_bf16 v[166:169], v[86:89], v[78:81], v[166:169]
    v_mov_b32 v9, 0x40000000
    v_cmp_lt_i32 s[100:101], v1, 32
    v_mfma_f32_16x16x32_bf16 v[170:173], v[90:93], v[78:81], v[170:173]
    s_nop 0
    v_cndmask_b32 v222, v9, v0, s[100:101]
    v_mov_b32 v218, -1
    v_mfma_f32_16x16x32_bf16 v[174:177], v[94:97], v[78:81], v[174:177]
    v_mov_b32 v219, -1
    v_mov_b32 v220, -1
    v_mfma_f32_16x16x32_bf16 v[178:181], v[98:101], v[78:81], v[178:181]
    s_add_u32 m0, s55, 17408
    v_mov_b32 v221, -1
    s_mov_b32 s60, 0x358637bd
    s_waitcnt lgkmcnt(11)
    v_mfma_f32_16x16x32_bf16 v[102:105], v[46:49], v[30:33], v[102:105]
    s_mov_b32 s61, 0x358637bd
    buffer_load_dwordx4 v11, s[8:11], s53 offen lds
    s_waitcnt lgkmcnt(9)
    v_mfma_f32_16x16x32_bf16 v[106:109], v[50:53], v[30:33], v[106:109]
    s_mov_b32 s62, 0x3fb8aa3b
    ds_read_b128 v[66:69], v20 offset:49152
    ds_read_b64_tr_b16 v[82:83], v229 offset:20512
    s_waitcnt lgkmcnt(9)
    v_mfma_f32_16x16x32_bf16 v[110:113], v[54:57], v[30:33], v[110:113]
    s_mov_b32 s63, 0x3fb8aa3b
    ds_read_b64_tr_b16 v[84:85], v229 offset:21792
    s_waitcnt lgkmcnt(8)
    v_mfma_f32_16x16x32_bf16 v[114:117], v[58:61], v[30:33], v[114:117]
    s_add_u32 m0, s56, 22560
    ds_read_b64_tr_b16 v[86:87], v230 offset:20512
    s_waitcnt lgkmcnt(7)
    v_mfma_f32_16x16x32_bf16 v[118:121], v[62:65], v[30:33], v[118:121]
    s_waitcnt lgkmcnt(6)
    buffer_load_dwordx4 v16, s[12:15], s54 offen lds
    v_mfma_f32_16x16x32_bf16 v[122:125], v[46:49], v[34:37], v[122:125]
    ds_read_b64_tr_b16 v[88:89], v230 offset:21792
    ds_read_b64_tr_b16 v[90:91], v231 offset:20512
    v_mfma_f32_16x16x32_bf16 v[126:129], v[50:53], v[34:37], v[126:129]
    ds_read_b64_tr_b16 v[92:93], v231 offset:21792
    v_mfma_f32_16x16x32_bf16 v[130:133], v[54:57], v[34:37], v[130:133]
    ds_read_b64_tr_b16 v[94:95], v232 offset:20512
    v_mfma_f32_16x16x32_bf16 v[134:137], v[58:61], v[34:37], v[134:137]
    s_add_u32 m0, s55, 18432
    ds_read_b64_tr_b16 v[96:97], v232 offset:21792
    v_mfma_f32_16x16x32_bf16 v[138:141], v[62:65], v[34:37], v[138:141]
    s_waitcnt lgkmcnt(10)
    buffer_load_dwordx4 v12, s[8:11], s53 offen lds
    v_mfma_f32_16x16x32_bf16 v[142:145], v[46:49], v[38:41], v[142:145]
    ds_read_b64_tr_b16 v[98:99], v233 offset:20512
    ds_read_b64_tr_b16 v[100:101], v233 offset:21792
    v_mfma_f32_16x16x32_bf16 v[146:149], v[50:53], v[38:41], v[146:149]
    ds_read_b128 v[70:73], v20 offset:53248
    v_mfma_f32_16x16x32_bf16 v[150:153], v[54:57], v[38:41], v[150:153]
    s_add_u32 m0, s56, 23584
    ds_read_b128 v[74:77], v20 offset:57344
    v_mfma_f32_16x16x32_bf16 v[154:157], v[58:61], v[38:41], v[154:157]
    buffer_load_dwordx4 v17, s[12:15], s54 offen lds
    v_mfma_f32_16x16x32_bf16 v[158:161], v[62:65], v[38:41], v[158:161]
    s_waitcnt lgkmcnt(13)
    ds_read_b128 v[78:81], v20 offset:61440
    v_mfma_f32_16x16x32_bf16 v[162:165], v[46:49], v[42:45], v[162:165]
    v_mfma_f32_16x16x32_bf16 v[166:169], v[50:53], v[42:45], v[166:169]
    v_mfma_f32_16x16x32_bf16 v[170:173], v[54:57], v[42:45], v[170:173]
    s_add_u32 m0, s55, 19456
    v_mfma_f32_16x16x32_bf16 v[174:177], v[58:61], v[42:45], v[174:177]
    buffer_load_dwordx4 v13, s[8:11], s53 offen lds
    v_mfma_f32_16x16x32_bf16 v[178:181], v[62:65], v[42:45], v[178:181]
    v_mfma_f32_16x16x32_bf16 v[182:185], v[46:49], v[26:29], v[182:185]
    v_mfma_f32_16x16x32_bf16 v[186:189], v[50:53], v[26:29], v[186:189]
    s_add_u32 m0, s56, 24608
    v_mfma_f32_16x16x32_bf16 v[190:193], v[54:57], v[26:29], v[190:193]
    buffer_load_dwordx4 v18, s[12:15], s54 offen lds
    v_mfma_f32_16x16x32_bf16 v[194:197], v[58:61], v[26:29], v[194:197]
    v_mfma_f32_16x16x32_bf16 v[198:201], v[62:65], v[26:29], v[198:201]
    s_waitcnt vmcnt(9) lgkmcnt(0)
    s_barrier
    v_mfma_f32_16x16x32_bf16 v[102:105], v[82:85], v[66:69], v[102:105]
    v_add_u32 v224, 0xffff5fc0, v224
    v_add_u32 v225, 0xffff5fc0, v225
    v_mfma_f32_16x16x32_bf16 v[106:109], v[86:89], v[66:69], v[106:109]
    v_add_u32 v226, 0xffff5fc0, v226
    v_mfma_f32_16x16x32_bf16 v[110:113], v[90:93], v[66:69], v[110:113]
    s_lshl_b32 s57, s52, 7
    v_add_u32 v227, 0xffff5fc0, v227
    v_add_u32 v228, 0xffff5fc0, v228
    v_mfma_f32_16x16x32_bf16 v[114:117], v[94:97], v[66:69], v[114:117]
    s_add_u32 s53, s50, s57
    ds_read_b128 v[30:33], v19 offset:0
    s_mul_i32 s57, s52, 245760
    v_mfma_f32_16x16x32_bf16 v[118:121], v[98:101], v[66:69], v[118:121]
    s_add_u32 s54, s51, s57
    ds_read_b64_tr_b16 v[46:47], v224 offset:0
    ds_read_b64_tr_b16 v[48:49], v224 offset:1280
    v_mfma_f32_16x16x32_bf16 v[122:125], v[82:85], v[70:73], v[122:125]
    s_add_u32 s52, s52, 1
    ds_read_b64_tr_b16 v[50:51], v225 offset:0
    s_cmp_eq_u32 s52, 10
    s_cselect_b32 s52, 0, s52
    v_mfma_f32_16x16x32_bf16 v[126:129], v[86:89], v[70:73], v[126:129]
    s_add_u32 m0, s55, 32768
    ds_read_b64_tr_b16 v[52:53], v225 offset:1280
    ds_read_b64_tr_b16 v[54:55], v226 offset:0
    v_mfma_f32_16x16x32_bf16 v[130:133], v[90:93], v[70:73], v[130:133]
    buffer_load_dwordx4 v10, s[8:11], s53 offen lds
    v_mfma_f32_16x16x32_bf16 v[134:137], v[94:97], v[70:73], v[134:137]
    ds_read_b64_tr_b16 v[56:57], v226 offset:1280
    ds_read_b64_tr_b16 v[58:59], v227 offset:0
    v_mfma_f32_16x16x32_bf16 v[138:141], v[98:101], v[70:73], v[138:141]
    s_add_u32 m0, s56, 41024
    ds_read_b64_tr_b16 v[60:61], v227 offset:1280
    ds_read_b64_tr_b16 v[62:63], v228 offset:0
    v_mfma_f32_16x16x32_bf16 v[142:145], v[82:85], v[74:77], v[142:145]
    buffer_load_dwordx4 v14, s[12:15], s54 offen lds
    v_mfma_f32_16x16x32_bf16 v[146:149], v[86:89], v[74:77], v[146:149]
    ds_read_b64_tr_b16 v[64:65], v228 offset:1280
    ds_read_b128 v[34:37], v19 offset:4096
    v_mfma_f32_16x16x32_bf16 v[150:153], v[90:93], v[74:77], v[150:153]
    ds_read_b128 v[38:41], v19 offset:8192
    ds_read_b128 v[42:45], v19 offset:12288
    v_mfma_f32_16x16x32_bf16 v[154:157], v[94:97], v[74:77], v[154:157]
    s_add_u32 m0, s56, 42048
    v_mfma_f32_16x16x32_bf16 v[158:161], v[98:101], v[74:77], v[158:161]
    buffer_load_dwordx4 v15, s[12:15], s54 offen lds
    v_mfma_f32_16x16x32_bf16 v[162:165], v[82:85], v[78:81], v[162:165]
    v_mfma_f32_16x16x32_bf16 v[166:169], v[86:89], v[78:81], v[166:169]
    v_mfma_f32_16x16x32_bf16 v[170:173], v[90:93], v[78:81], v[170:173]
    v_mfma_f32_16x16x32_bf16 v[174:177], v[94:97], v[78:81], v[174:177]
    s_add_u32 m0, s55, 33792
    v_mfma_f32_16x16x32_bf16 v[178:181], v[98:101], v[78:81], v[178:181]
    s_waitcnt lgkmcnt(11)
    buffer_load_dwordx4 v11, s[8:11], s53 offen lds
    v_mfma_f32_16x16x32_bf16 v[102:105], v[46:49], v[30:33], v[102:105]
    s_waitcnt lgkmcnt(9)
    v_add_u32 v229, 0xffff5fc0, v229
    v_add_u32 v230, 0xffff5fc0, v230
    v_mfma_f32_16x16x32_bf16 v[106:109], v[50:53], v[30:33], v[106:109]
    s_waitcnt lgkmcnt(7)
    v_add_u32 v231, 0xffff5fc0, v231
    v_mfma_f32_16x16x32_bf16 v[110:113], v[54:57], v[30:33], v[110:113]
    s_add_u32 m0, s56, 43072
    v_add_u32 v232, 0xffff5fc0, v232
    s_waitcnt lgkmcnt(5)
    v_mfma_f32_16x16x32_bf16 v[114:117], v[58:61], v[30:33], v[114:117]
    s_waitcnt lgkmcnt(3)
    buffer_load_dwordx4 v16, s[12:15], s54 offen lds
    v_mfma_f32_16x16x32_bf16 v[118:121], v[62:65], v[30:33], v[118:121]
    s_waitcnt lgkmcnt(2)
    v_add_u32 v233, 0xffff5fc0, v233
    ds_read_b128 v[66:69], v20 offset:0
    v_mfma_f32_16x16x32_bf16 v[122:125], v[46:49], v[34:37], v[122:125]
    ds_read_b64_tr_b16 v[82:83], v229 offset:0
    ds_read_b64_tr_b16 v[84:85], v229 offset:1280
    v_mfma_f32_16x16x32_bf16 v[126:129], v[50:53], v[34:37], v[126:129]
    ds_read_b64_tr_b16 v[86:87], v230 offset:0
    v_mfma_f32_16x16x32_bf16 v[130:133], v[54:57], v[34:37], v[130:133]
    s_add_u32 m0, s55, 34816
    ds_read_b64_tr_b16 v[88:89], v230 offset:1280
    ds_read_b64_tr_b16 v[90:91], v231 offset:0
    v_mfma_f32_16x16x32_bf16 v[134:137], v[58:61], v[34:37], v[134:137]
    buffer_load_dwordx4 v12, s[8:11], s53 offen lds
    v_mfma_f32_16x16x32_bf16 v[138:141], v[62:65], v[34:37], v[138:141]
    s_waitcnt lgkmcnt(7)
    ds_read_b64_tr_b16 v[92:93], v231 offset:1280
    ds_read_b64_tr_b16 v[94:95], v232 offset:0
    v_mfma_f32_16x16x32_bf16 v[142:145], v[46:49], v[38:41], v[142:145]
    ds_read_b64_tr_b16 v[96:97], v232 offset:1280
    v_mfma_f32_16x16x32_bf16 v[146:149], v[50:53], v[38:41], v[146:149]
    s_add_u32 m0, s56, 44096
    ds_read_b64_tr_b16 v[98:99], v233 offset:0
    ds_read_b64_tr_b16 v[100:101], v233 offset:1280
    v_mfma_f32_16x16x32_bf16 v[150:153], v[54:57], v[38:41], v[150:153]
    buffer_load_dwordx4 v17, s[12:15], s54 offen lds
    v_mfma_f32_16x16x32_bf16 v[154:157], v[58:61], v[38:41], v[154:157]
    ds_read_b128 v[70:73], v20 offset:4096
    ds_read_b128 v[74:77], v20 offset:8192
    v_mfma_f32_16x16x32_bf16 v[158:161], v[62:65], v[38:41], v[158:161]
    s_waitcnt lgkmcnt(13)
    ds_read_b128 v[78:81], v20 offset:12288
    v_mfma_f32_16x16x32_bf16 v[162:165], v[46:49], v[42:45], v[162:165]
    v_mfma_f32_16x16x32_bf16 v[166:169], v[50:53], v[42:45], v[166:169]
    s_add_u32 m0, s55, 35840
    v_mfma_f32_16x16x32_bf16 v[170:173], v[54:57], v[42:45], v[170:173]
    buffer_load_dwordx4 v13, s[8:11], s53 offen lds
    v_mfma_f32_16x16x32_bf16 v[174:177], v[58:61], v[42:45], v[174:177]
    v_mfma_f32_16x16x32_bf16 v[178:181], v[62:65], v[42:45], v[178:181]
    v_mfma_f32_16x16x32_bf16 v[182:185], v[46:49], v[26:29], v[182:185]
    s_add_u32 m0, s56, 45120
    v_mfma_f32_16x16x32_bf16 v[186:189], v[50:53], v[26:29], v[186:189]
    buffer_load_dwordx4 v18, s[12:15], s54 offen lds
    v_mfma_f32_16x16x32_bf16 v[190:193], v[54:57], v[26:29], v[190:193]
    v_mfma_f32_16x16x32_bf16 v[194:197], v[58:61], v[26:29], v[194:197]
    v_mfma_f32_16x16x32_bf16 v[198:201], v[62:65], v[26:29], v[198:201]
    s_waitcnt vmcnt(9) lgkmcnt(0)
    s_barrier
    v_mfma_f32_16x16x32_bf16 v[102:105], v[82:85], v[66:69], v[102:105]
    ds_read_b128 v[30:33], v19 offset:16384
    ds_read_b64_tr_b16 v[46:47], v224 offset:20512
    v_mfma_f32_16x16x32_bf16 v[106:109], v[86:89], v[66:69], v[106:109]
    s_lshl_b32 s57, s52, 7
    ds_read_b64_tr_b16 v[48:49], v224 offset:21792
    s_add_u32 s53, s50, s57
    v_mfma_f32_16x16x32_bf16 v[110:113], v[90:93], v[66:69], v[110:113]
    s_mul_i32 s57, s52, 245760
    ds_read_b64_tr_b16 v[50:51], v225 offset:20512
    s_add_u32 s54, s51, s57
    v_mfma_f32_16x16x32_bf16 v[114:117], v[94:97], v[66:69], v[114:117]
    s_add_u32 s52, s52, 1
    ds_read_b64_tr_b16 v[52:53], v225 offset:21792
    s_cmp_eq_u32 s52, 10
    s_cselect_b32 s52, 0, s52
    v_mfma_f32_16x16x32_bf16 v[118:121], v[98:101], v[66:69], v[118:121]
    s_add_u32 m0, s55, 49152
    ds_read_b64_tr_b16 v[54:55], v226 offset:20512
    v_mfma_f32_16x16x32_bf16 v[122:125], v[82:85], v[70:73], v[122:125]
    buffer_load_dwordx4 v10, s[8:11], s53 offen lds
    v_mfma_f32_16x16x32_bf16 v[126:129], v[86:89], v[70:73], v[126:129]
    ds_read_b64_tr_b16 v[56:57], v226 offset:21792
    ds_read_b64_tr_b16 v[58:59], v227 offset:20512
    v_mfma_f32_16x16x32_bf16 v[130:133], v[90:93], v[70:73], v[130:133]
    ds_read_b64_tr_b16 v[60:61], v227 offset:21792
    v_mfma_f32_16x16x32_bf16 v[134:137], v[94:97], v[70:73], v[134:137]
    s_add_u32 m0, s56, 61536
    ds_read_b64_tr_b16 v[62:63], v228 offset:20512
    v_mfma_f32_16x16x32_bf16 v[138:141], v[98:101], v[70:73], v[138:141]
    buffer_load_dwordx4 v14, s[12:15], s54 offen lds
    v_mfma_f32_16x16x32_bf16 v[142:145], v[82:85], v[74:77], v[142:145]
    ds_read_b64_tr_b16 v[64:65], v228 offset:21792
    ds_read_b128 v[34:37], v19 offset:20480
    v_mfma_f32_16x16x32_bf16 v[146:149], v[86:89], v[74:77], v[146:149]
    ds_read_b128 v[38:41], v19 offset:24576
    v_mfma_f32_16x16x32_bf16 v[150:153], v[90:93], v[74:77], v[150:153]
    s_add_u32 m0, s56, 62560
    ds_read_b128 v[42:45], v19 offset:28672
    v_mfma_f32_16x16x32_bf16 v[154:157], v[94:97], v[74:77], v[154:157]
    buffer_load_dwordx4 v15, s[12:15], s54 offen lds
    v_mfma_f32_16x16x32_bf16 v[158:161], v[98:101], v[74:77], v[158:161]
    v_mfma_f32_16x16x32_bf16 v[162:165], v[82:85], v[78:81], v[162:165]
    v_mfma_f32_16x16x32_bf16 v[166:169], v[86:89], v[78:81], v[166:169]
    v_mfma_f32_16x16x32_bf16 v[170:173], v[90:93], v[78:81], v[170:173]
    s_add_u32 m0, s55, 50176
    v_mfma_f32_16x16x32_bf16 v[174:177], v[94:97], v[78:81], v[174:177]
    buffer_load_dwordx4 v11, s[8:11], s53 offen lds
    v_mfma_f32_16x16x32_bf16 v[178:181], v[98:101], v[78:81], v[178:181]
    s_waitcnt lgkmcnt(11)
    v_mfma_f32_16x16x32_bf16 v[102:105], v[46:49], v[30:33], v[102:105]
    s_waitcnt lgkmcnt(9)
    ds_read_b128 v[66:69], v20 offset:16384
    v_mfma_f32_16x16x32_bf16 v[106:109], v[50:53], v[30:33], v[106:109]
    s_add_u32 m0, s56, 63584
    ds_read_b64_tr_b16 v[82:83], v229 offset:20512
    s_waitcnt lgkmcnt(9)
    v_mfma_f32_16x16x32_bf16 v[110:113], v[54:57], v[30:33], v[110:113]
    s_waitcnt lgkmcnt(7)
    buffer_load_dwordx4 v16, s[12:15], s54 offen lds
    v_mfma_f32_16x16x32_bf16 v[114:117], v[58:61], v[30:33], v[114:117]
    s_waitcnt lgkmcnt(5)
    ds_read_b64_tr_b16 v[84:85], v229 offset:21792
    ds_read_b64_tr_b16 v[86:87], v230 offset:20512
    v_mfma_f32_16x16x32_bf16 v[118:121], v[62:65], v[30:33], v[118:121]
    s_waitcnt lgkmcnt(6)
    ds_read_b64_tr_b16 v[88:89], v230 offset:21792
    v_mfma_f32_16x16x32_bf16 v[122:125], v[46:49], v[34:37], v[122:125]
    ds_read_b64_tr_b16 v[90:91], v231 offset:20512
    v_mfma_f32_16x16x32_bf16 v[126:129], v[50:53], v[34:37], v[126:129]
    s_add_u32 m0, s55, 51200
    ds_read_b64_tr_b16 v[92:93], v231 offset:21792
    v_mfma_f32_16x16x32_bf16 v[130:133], v[54:57], v[34:37], v[130:133]
    buffer_load_dwordx4 v12, s[8:11], s53 offen lds
    v_mfma_f32_16x16x32_bf16 v[134:137], v[58:61], v[34:37], v[134:137]
    ds_read_b64_tr_b16 v[94:95], v232 offset:20512
    ds_read_b64_tr_b16 v[96:97], v232 offset:21792
    v_mfma_f32_16x16x32_bf16 v[138:141], v[62:65], v[34:37], v[138:141]
    s_waitcnt lgkmcnt(10)
    ds_read_b64_tr_b16 v[98:99], v233 offset:20512
    v_mfma_f32_16x16x32_bf16 v[142:145], v[46:49], v[38:41], v[142:145]
    s_add_u32 m0, s56, 64608
    ds_read_b64_tr_b16 v[100:101], v233 offset:21792
    v_mfma_f32_16x16x32_bf16 v[146:149], v[50:53], v[38:41], v[146:149]
    buffer_load_dwordx4 v17, s[12:15], s54 offen lds
    v_mfma_f32_16x16x32_bf16 v[150:153], v[54:57], v[38:41], v[150:153]
    ds_read_b128 v[70:73], v20 offset:20480
    ds_read_b128 v[74:77], v20 offset:24576
    v_mfma_f32_16x16x32_bf16 v[154:157], v[58:61], v[38:41], v[154:157]
    ds_read_b128 v[78:81], v20 offset:28672
    v_mfma_f32_16x16x32_bf16 v[158:161], v[62:65], v[38:41], v[158:161]
    s_waitcnt lgkmcnt(14)
    v_mfma_f32_16x16x32_bf16 v[162:165], v[46:49], v[42:45], v[162:165]
    s_add_u32 m0, s55, 52224
    v_mfma_f32_16x16x32_bf16 v[166:169], v[50:53], v[42:45], v[166:169]
    buffer_load_dwordx4 v13, s[8:11], s53 offen lds
    v_mfma_f32_16x16x32_bf16 v[170:173], v[54:57], v[42:45], v[170:173]
    v_mfma_f32_16x16x32_bf16 v[174:177], v[58:61], v[42:45], v[174:177]
    v_mfma_f32_16x16x32_bf16 v[178:181], v[62:65], v[42:45], v[178:181]
    s_add_u32 m0, s56, 65632
    v_mfma_f32_16x16x32_bf16 v[182:185], v[46:49], v[26:29], v[182:185]
    buffer_load_dwordx4 v18, s[12:15], s54 offen lds
    v_mfma_f32_16x16x32_bf16 v[186:189], v[50:53], v[26:29], v[186:189]
    v_mfma_f32_16x16x32_bf16 v[190:193], v[54:57], v[26:29], v[190:193]
    v_mfma_f32_16x16x32_bf16 v[194:197], v[58:61], v[26:29], v[194:197]
    v_mfma_f32_16x16x32_bf16 v[198:201], v[62:65], v[26:29], v[198:201]
    s_waitcnt lgkmcnt(0)
    buffer_load_dword v250, v251, s[36:39], 0 offen offset:0 sc1
    s_waitcnt vmcnt(10)
    s_barrier
    v_mfma_f32_16x16x32_bf16 v[102:105], v[82:85], v[66:69], v[102:105]
    s_lshl_b32 s57, s52, 7
    v_add_u32 v224, 0xa040, v224
Lwq_1:
    s_cbranch_execz Lwq_2
    v_add_u32 v225, 0xa040, v225
    v_mfma_f32_16x16x32_bf16 v[106:109], v[86:89], v[66:69], v[106:109]
    s_add_u32 s53, s50, s57
    v_add_u32 v226, 0xa040, v226
    s_mul_i32 s57, s52, 245760
    v_mfma_f32_16x16x32_bf16 v[110:113], v[90:93], v[66:69], v[110:113]
    s_add_u32 s54, s51, s57
    v_add_u32 v227, 0xa040, v227
    v_add_u32 v228, 0xa040, v228
    v_mfma_f32_16x16x32_bf16 v[114:117], v[94:97], v[66:69], v[114:117]
    s_add_u32 s52, s52, 1
    ds_read_b128 v[30:33], v19 offset:32768
    s_cmp_eq_u32 s52, 10
    s_cselect_b32 s52, 0, s52
    v_mfma_f32_16x16x32_bf16 v[118:121], v[98:101], v[66:69], v[118:121]
    s_add_u32 m0, s55, 0
    ds_read_b64_tr_b16 v[46:47], v224 offset:0
    ds_read_b64_tr_b16 v[48:49], v224 offset:1280
    v_mfma_f32_16x16x32_bf16 v[122:125], v[82:85], v[70:73], v[122:125]
    buffer_load_dwordx4 v10, s[8:11], s53 offen lds
    v_mfma_f32_16x16x32_bf16 v[126:129], v[86:89], v[70:73], v[126:129]
    ds_read_b64_tr_b16 v[50:51], v225 offset:0
    ds_read_b64_tr_b16 v[52:53], v225 offset:1280
    v_mfma_f32_16x16x32_bf16 v[130:133], v[90:93], v[70:73], v[130:133]
    s_add_u32 m0, s56, 0
    ds_read_b64_tr_b16 v[54:55], v226 offset:0
    ds_read_b64_tr_b16 v[56:57], v226 offset:1280
    v_mfma_f32_16x16x32_bf16 v[134:137], v[94:97], v[70:73], v[134:137]
    buffer_load_dwordx4 v14, s[12:15], s54 offen lds
    v_mfma_f32_16x16x32_bf16 v[138:141], v[98:101], v[70:73], v[138:141]
    ds_read_b64_tr_b16 v[58:59], v227 offset:0
    ds_read_b64_tr_b16 v[60:61], v227 offset:1280
    v_mfma_f32_16x16x32_bf16 v[142:145], v[82:85], v[74:77], v[142:145]
    ds_read_b64_tr_b16 v[62:63], v228 offset:0
    ds_read_b64_tr_b16 v[64:65], v228 offset:1280
    v_mfma_f32_16x16x32_bf16 v[146:149], v[86:89], v[74:77], v[146:149]
    s_add_u32 m0, s56, 1024
    ds_read_b128 v[34:37], v19 offset:36864
    ds_read_b128 v[38:41], v19 offset:40960
    v_mfma_f32_16x16x32_bf16 v[150:153], v[90:93], v[74:77], v[150:153]
    buffer_load_dwordx4 v15, s[12:15], s54 offen lds
    v_mfma_f32_16x16x32_bf16 v[154:157], v[94:97], v[74:77], v[154:157]
    ds_read_b128 v[42:45], v19 offset:45056
    v_mfma_f32_16x16x32_bf16 v[158:161], v[98:101], v[74:77], v[158:161]
    v_mfma_f32_16x16x32_bf16 v[162:165], v[82:85], v[78:81], v[162:165]
    v_mfma_f32_16x16x32_bf16 v[166:169], v[86:89], v[78:81], v[166:169]
    s_add_u32 m0, s55, 1024
    v_mfma_f32_16x16x32_bf16 v[170:173], v[90:93], v[78:81], v[170:173]
    buffer_load_dwordx4 v11, s[8:11], s53 offen lds
    v_mfma_f32_16x16x32_bf16 v[174:177], v[94:97], v[78:81], v[174:177]
    v_mfma_f32_16x16x32_bf16 v[178:181], v[98:101], v[78:81], v[178:181]
    s_waitcnt lgkmcnt(11)
    v_mfma_f32_16x16x32_bf16 v[102:105], v[46:49], v[30:33], v[102:105]
    s_add_u32 m0, s56, 2048
    v_add_u32 v229, 0xa040, v229
    v_add_u32 v230, 0xa040, v230
    s_waitcnt lgkmcnt(9)
    v_mfma_f32_16x16x32_bf16 v[106:109], v[50:53], v[30:33], v[106:109]
    s_waitcnt lgkmcnt(7)
    buffer_load_dwordx4 v16, s[12:15], s54 offen lds
    v_mfma_f32_16x16x32_bf16 v[110:113], v[54:57], v[30:33], v[110:113]
    s_waitcnt lgkmcnt(5)
    v_add_u32 v231, 0xa040, v231
    v_add_u32 v232, 0xa040, v232
    v_mfma_f32_16x16x32_bf16 v[114:117], v[58:61], v[30:33], v[114:117]
    s_waitcnt lgkmcnt(3)
    v_add_u32 v233, 0xa040, v233
    ds_read_b128 v[66:69], v20 offset:32768
    v_mfma_f32_16x16x32_bf16 v[118:121], v[62:65], v[30:33], v[118:121]
    s_waitcnt lgkmcnt(3)
    ds_read_b64_tr_b16 v[82:83], v229 offset:0
    v_mfma_f32_16x16x32_bf16 v[122:125], v[46:49], v[34:37], v[122:125]
    s_add_u32 m0, s55, 2048
    ds_read_b64_tr_b16 v[84:85], v229 offset:1280
    v_mfma_f32_16x16x32_bf16 v[126:129], v[50:53], v[34:37], v[126:129]
    buffer_load_dwordx4 v12, s[8:11], s53 offen lds
    v_mfma_f32_16x16x32_bf16 v[130:133], v[54:57], v[34:37], v[130:133]
    ds_read_b64_tr_b16 v[86:87], v230 offset:0
    ds_read_b64_tr_b16 v[88:89], v230 offset:1280
    v_mfma_f32_16x16x32_bf16 v[134:137], v[58:61], v[34:37], v[134:137]
    ds_read_b64_tr_b16 v[90:91], v231 offset:0
    ds_read_b64_tr_b16 v[92:93], v231 offset:1280
    v_mfma_f32_16x16x32_bf16 v[138:141], v[62:65], v[34:37], v[138:141]
    s_add_u32 m0, s56, 3072
    ds_read_b64_tr_b16 v[94:95], v232 offset:0
    s_waitcnt lgkmcnt(9)
    v_mfma_f32_16x16x32_bf16 v[142:145], v[46:49], v[38:41], v[142:145]
    buffer_load_dwordx4 v17, s[12:15], s54 offen lds
    v_mfma_f32_16x16x32_bf16 v[146:149], v[50:53], v[38:41], v[146:149]
    ds_read_b64_tr_b16 v[96:97], v232 offset:1280
    ds_read_b64_tr_b16 v[98:99], v233 offset:0
    v_mfma_f32_16x16x32_bf16 v[150:153], v[54:57], v[38:41], v[150:153]
    ds_read_b64_tr_b16 v[100:101], v233 offset:1280
    ds_read_b128 v[70:73], v20 offset:36864
    v_mfma_f32_16x16x32_bf16 v[154:157], v[58:61], v[38:41], v[154:157]
    ds_read_b128 v[74:77], v20 offset:40960
    v_mfma_f32_16x16x32_bf16 v[158:161], v[62:65], v[38:41], v[158:161]
    s_add_u32 m0, s55, 3072
    ds_read_b128 v[78:81], v20 offset:45056
    s_waitcnt lgkmcnt(14)
    v_mfma_f32_16x16x32_bf16 v[162:165], v[46:49], v[42:45], v[162:165]
    buffer_load_dwordx4 v13, s[8:11], s53 offen lds
    v_mfma_f32_16x16x32_bf16 v[166:169], v[50:53], v[42:45], v[166:169]
    v_mfma_f32_16x16x32_bf16 v[170:173], v[54:57], v[42:45], v[170:173]
    v_mfma_f32_16x16x32_bf16 v[174:177], v[58:61], v[42:45], v[174:177]
    s_add_u32 m0, s56, 4096
    v_mfma_f32_16x16x32_bf16 v[178:181], v[62:65], v[42:45], v[178:181]
    buffer_load_dwordx4 v18, s[12:15], s54 offen lds
    v_mfma_f32_16x16x32_bf16 v[182:185], v[46:49], v[26:29], v[182:185]
    v_mfma_f32_16x16x32_bf16 v[186:189], v[50:53], v[26:29], v[186:189]
    v_mfma_f32_16x16x32_bf16 v[190:193], v[54:57], v[26:29], v[190:193]
    v_mfma_f32_16x16x32_bf16 v[194:197], v[58:61], v[26:29], v[194:197]
    s_waitcnt vmcnt(9)
    v_cmp_gt_u32 vcc, 1, v250
    v_mfma_f32_16x16x32_bf16 v[198:201], v[62:65], v[26:29], v[198:201]
    s_waitcnt lgkmcnt(0)
    s_barrier
    s_cbranch_vccnz Lslow4
Lback4:
    v_mfma_f32_16x16x32_bf16 v[102:105], v[82:85], v[66:69], v[102:105]
    s_mov_b32 m0, s99
    ds_read_b128 v[30:33], v19 offset:49152
    ds_read_b64_tr_b16 v[46:47], v224 offset:20512
    v_mfma_f32_16x16x32_bf16 v[106:109], v[86:89], v[66:69], v[106:109]
    buffer_load_dword v251, s[40:43], s98 offen sc1 lds
    v_mfma_f32_16x16x32_bf16 v[110:113], v[90:93], v[66:69], v[110:113]
    s_lshl_b32 s57, s52, 7
    ds_read_b64_tr_b16 v[48:49], v224 offset:21792
    ds_read_b64_tr_b16 v[50:51], v225 offset:20512
    v_mfma_f32_16x16x32_bf16 v[114:117], v[94:97], v[66:69], v[114:117]
    s_add_u32 s53, s50, s57
    ds_read_b64_tr_b16 v[52:53], v225 offset:21792
    s_mul_i32 s57, s52, 245760
    v_mfma_f32_16x16x32_bf16 v[118:121], v[98:101], v[66:69], v[118:121]
    s_add_u32 s54, s51, s57
    ds_read_b64_tr_b16 v[54:55], v226 offset:20512
    s_add_u32 s52, s52, 1
    v_mfma_f32_16x16x32_bf16 v[122:125], v[82:85], v[70:73], v[122:125]
    s_cmp_eq_u32 s52, 10
    s_cselect_b32 s52, 0, s52
    ds_read_b64_tr_b16 v[56:57], v226 offset:21792
    v_mfma_f32_16x16x32_bf16 v[126:129], v[86:89], v[70:73], v[126:129]
    s_add_u32 m0, s55, 16384
    ds_read_b64_tr_b16 v[58:59], v227 offset:20512
    v_mfma_f32_16x16x32_bf16 v[130:133], v[90:93], v[70:73], v[130:133]
    buffer_load_dwordx4 v10, s[8:11], s53 offen lds
    v_mfma_f32_16x16x32_bf16 v[134:137], v[94:97], v[70:73], v[134:137]
    s_add_u32 m0, s56, 20512
    ds_read_b64_tr_b16 v[60:61], v227 offset:21792
    ds_read_b64_tr_b16 v[62:63], v228 offset:20512
    v_mfma_f32_16x16x32_bf16 v[138:141], v[98:101], v[70:73], v[138:141]
    buffer_load_dwordx4 v14, s[12:15], s54 offen lds
    v_mfma_f32_16x16x32_bf16 v[142:145], v[82:85], v[74:77], v[142:145]
    s_add_u32 m0, s56, 21536
    ds_read_b64_tr_b16 v[64:65], v228 offset:21792
    ds_read_b128 v[34:37], v19 offset:53248
    v_mfma_f32_16x16x32_bf16 v[146:149], v[86:89], v[74:77], v[146:149]
    buffer_load_dwordx4 v15, s[12:15], s54 offen lds
    v_mfma_f32_16x16x32_bf16 v[150:153], v[90:93], v[74:77], v[150:153]
    ds_read_b128 v[38:41], v19 offset:57344
    ds_read_b128 v[42:45], v19 offset:61440
    v_mfma_f32_16x16x32_bf16 v[154:157], v[94:97], v[74:77], v[154:157]
    v_mfma_f32_16x16x32_bf16 v[158:161], v[98:101], v[74:77], v[158:161]
    v_mfma_f32_16x16x32_bf16 v[162:165], v[82:85], v[78:81], v[162:165]
    s_add_u32 m0, s55, 17408
    v_mfma_f32_16x16x32_bf16 v[166:169], v[86:89], v[78:81], v[166:169]
    buffer_load_dwordx4 v11, s[8:11], s53 offen lds
    v_mfma_f32_16x16x32_bf16 v[170:173], v[90:93], v[78:81], v[170:173]
    v_mfma_f32_16x16x32_bf16 v[174:177], v[94:97], v[78:81], v[174:177]
    v_mfma_f32_16x16x32_bf16 v[178:181], v[98:101], v[78:81], v[178:181]
    s_add_u32 m0, s56, 22560
    s_waitcnt lgkmcnt(11)
    v_mfma_f32_16x16x32_bf16 v[102:105], v[46:49], v[30:33], v[102:105]
    s_waitcnt lgkmcnt(9)
    buffer_load_dwordx4 v16, s[12:15], s54 offen lds
    v_mfma_f32_16x16x32_bf16 v[106:109], v[50:53], v[30:33], v[106:109]
    s_waitcnt lgkmcnt(7)
    ds_read_b128 v[66:69], v20 offset:49152
    ds_read_b64_tr_b16 v[82:83], v229 offset:20512
    v_mfma_f32_16x16x32_bf16 v[110:113], v[54:57], v[30:33], v[110:113]
    s_waitcnt lgkmcnt(7)
    ds_read_b64_tr_b16 v[84:85], v229 offset:21792
    v_mfma_f32_16x16x32_bf16 v[114:117], v[58:61], v[30:33], v[114:117]
    s_waitcnt lgkmcnt(6)
    ds_read_b64_tr_b16 v[86:87], v230 offset:20512
    v_mfma_f32_16x16x32_bf16 v[118:121], v[62:65], v[30:33], v[118:121]
    s_add_u32 m0, s55, 18432
    ds_read_b64_tr_b16 v[88:89], v230 offset:21792
    s_waitcnt lgkmcnt(7)
    v_mfma_f32_16x16x32_bf16 v[122:125], v[46:49], v[34:37], v[122:125]
    buffer_load_dwordx4 v12, s[8:11], s53 offen lds
    v_mfma_f32_16x16x32_bf16 v[126:129], v[50:53], v[34:37], v[126:129]
    ds_read_b64_tr_b16 v[90:91], v231 offset:20512
    ds_read_b64_tr_b16 v[92:93], v231 offset:21792
    v_mfma_f32_16x16x32_bf16 v[130:133], v[54:57], v[34:37], v[130:133]
    ds_read_b64_tr_b16 v[94:95], v232 offset:20512
    v_mfma_f32_16x16x32_bf16 v[134:137], v[58:61], v[34:37], v[134:137]
    s_add_u32 m0, s56, 23584
    ds_read_b64_tr_b16 v[96:97], v232 offset:21792
    v_mfma_f32_16x16x32_bf16 v[138:141], v[62:65], v[34:37], v[138:141]
    s_waitcnt lgkmcnt(10)
    buffer_load_dwordx4 v17, s[12:15], s54 offen lds
    v_mfma_f32_16x16x32_bf16 v[142:145], v[46:49], v[38:41], v[142:145]
    ds_read_b64_tr_b16 v[98:99], v233 offset:20512
    ds_read_b64_tr_b16 v[100:101], v233 offset:21792
    v_mfma_f32_16x16x32_bf16 v[146:149], v[50:53], v[38:41], v[146:149]
    ds_read_b128 v[70:73], v20 offset:53248
    v_mfma_f32_16x16x32_bf16 v[150:153], v[54:57], v[38:41], v[150:153]
    ds_read_b128 v[74:77], v20 offset:57344
    v_mfma_f32_16x16x32_bf16 v[154:157], v[58:61], v[38:41], v[154:157]
    s_add_u32 m0, s55, 19456
    ds_read_b128 v[78:81], v20 offset:61440
    v_mfma_f32_16x16x32_bf16 v[158:161], v[62:65], v[38:41], v[158:161]
    s_waitcnt lgkmcnt(14)
    buffer_load_dwordx4 v13, s[8:11], s53 offen lds
    v_mfma_f32_16x16x32_bf16 v[162:165], v[46:49], v[42:45], v[162:165]
    v_mfma_f32_16x16x32_bf16 v[166:169], v[50:53], v[42:45], v[166:169]
    v_mfma_f32_16x16x32_bf16 v[170:173], v[54:57], v[42:45], v[170:173]
    s_add_u32 m0, s56, 24608
    v_mfma_f32_16x16x32_bf16 v[174:177], v[58:61], v[42:45], v[174:177]
    buffer_load_dwordx4 v18, s[12:15], s54 offen lds
    v_mfma_f32_16x16x32_bf16 v[178:181], v[62:65], v[42:45], v[178:181]
    v_mfma_f32_16x16x32_bf16 v[182:185], v[46:49], v[26:29], v[182:185]
    v_mfma_f32_16x16x32_bf16 v[186:189], v[50:53], v[26:29], v[186:189]
    s_waitcnt vmcnt(9)
    v_mfma_f32_16x16x32_bf16 v[190:193], v[54:57], v[26:29], v[190:193]
    v_mfma_f32_16x16x32_bf16 v[194:197], v[58:61], v[26:29], v[194:197]
    s_xor_b32 s44, s3, 2
    buffer_store_dwordx4 v[218:221], v0, s[40:43], s31 offen sc1
    v_mfma_f32_16x16x32_bf16 v[198:201], v[62:65], v[26:29], v[198:201]
    s_waitcnt lgkmcnt(0)
    s_barrier
    s_sub_u32 s44, s44, s3
    v_mfma_f32_16x16x32_bf16 v[102:105], v[82:85], v[66:69], v[102:105]
    s_mul_i32 s44, s44, 5120
    buffer_store_dwordx4 v[218:221], v0, s[40:43], s31 offen offset:1024 sc1
    v_mfma_f32_16x16x32_bf16 v[106:109], v[86:89], v[66:69], v[106:109]
    v_add_u32 v224, 0xffff5fc0, v224
    v_add_u32 v225, 0xffff5fc0, v225
    v_mfma_f32_16x16x32_bf16 v[110:113], v[90:93], v[66:69], v[110:113]
    v_add_u32 v226, 0xffff5fc0, v226
    v_add_u32 v227, 0xffff5fc0, v227
    v_mfma_f32_16x16x32_bf16 v[114:117], v[94:97], v[66:69], v[114:117]
    buffer_store_dwordx4 v[218:221], v222, s[40:43], s31 offen offset:2048 sc1
    v_mfma_f32_16x16x32_bf16 v[118:121], v[98:101], v[66:69], v[118:121]
    v_add_u32 v228, 0xffff5fc0, v228
    ds_read_b128 v[30:33], v19 offset:0
    v_mfma_f32_16x16x32_bf16 v[122:125], v[82:85], v[70:73], v[122:125]
    ds_read_b64_tr_b16 v[46:47], v224 offset:0
    ds_read_b64_tr_b16 v[48:49], v224 offset:1280
    v_mfma_f32_16x16x32_bf16 v[126:129], v[86:89], v[70:73], v[126:129]
    s_add_u32 s31, s31, 40960
    ds_read_b64_tr_b16 v[50:51], v225 offset:0
    ds_read_b64_tr_b16 v[52:53], v225 offset:1280
    v_mfma_f32_16x16x32_bf16 v[130:133], v[90:93], v[70:73], v[130:133]
    ds_read_b64_tr_b16 v[54:55], v226 offset:0
    ds_read_b64_tr_b16 v[56:57], v226 offset:1280
    v_mfma_f32_16x16x32_bf16 v[134:137], v[94:97], v[70:73], v[134:137]
    ds_read_b64_tr_b16 v[58:59], v227 offset:0
    ds_read_b64_tr_b16 v[60:61], v227 offset:1280
    v_mfma_f32_16x16x32_bf16 v[138:141], v[98:101], v[70:73], v[138:141]
    ds_read_b64_tr_b16 v[62:63], v228 offset:0
    v_add_u32 v255, s44, v253
    v_mfma_f32_16x16x32_bf16 v[142:145], v[82:85], v[74:77], v[142:145]
    ds_read_b64_tr_b16 v[64:65], v228 offset:1280
    ds_read_b128 v[34:37], v19 offset:4096
    v_mfma_f32_16x16x32_bf16 v[146:149], v[86:89], v[74:77], v[146:149]
    ds_read_b128 v[38:41], v19 offset:8192
    v_lshlrev_b32 v9, 7, v1
    v_mfma_f32_16x16x32_bf16 v[150:153], v[90:93], v[74:77], v[150:153]
    ds_read_b128 v[42:45], v19 offset:12288
    v_mov_b32 v8, 0x40000000
    v_mfma_f32_16x16x32_bf16 v[154:157], v[94:97], v[74:77], v[154:157]
    v_cmp_lt_i32 s[100:101], v1, 20
    v_mfma_f32_16x16x32_bf16 v[158:161], v[98:101], v[74:77], v[158:161]
    s_nop 0
    v_cndmask_b32 v251, v8, v9, s[100:101]
    v_and_b32 v9, 15, v1
    v_mfma_f32_16x16x32_bf16 v[162:165], v[82:85], v[78:81], v[162:165]
    buffer_load_dword v250, v251, s[40:43], s26 offen offset:0 sc1
    v_mfma_f32_16x16x32_bf16 v[166:169], v[86:89], v[78:81], v[166:169]
    buffer_store_dwordx4 v[218:221], v0, s[40:43], s31 offen sc1
    v_mfma_f32_16x16x32_bf16 v[170:173], v[90:93], v[78:81], v[170:173]
    buffer_store_dwordx4 v[218:221], v0, s[40:43], s31 offen offset:1024 sc1
    v_mfma_f32_16x16x32_bf16 v[174:177], v[94:97], v[78:81], v[174:177]
    buffer_store_dwordx4 v[218:221], v222, s[40:43], s31 offen offset:2048 sc1
    v_mfma_f32_16x16x32_bf16 v[178:181], v[98:101], v[78:81], v[178:181]
    s_waitcnt lgkmcnt(11)
    v_lshrrev_b32 v9, 2, v9
    v_lshlrev_b32 v9, 4, v9
    v_mfma_f32_16x16x32_bf16 v[102:105], v[46:49], v[30:33], v[102:105]
    s_add_u32 s31, s31, 40960
    v_add_u32 v229, 0xffff5fc0, v229
    v_add_u32 v230, 0xffff5fc0, v230
    s_waitcnt lgkmcnt(9)
    v_mfma_f32_16x16x32_bf16 v[106:109], v[50:53], v[30:33], v[106:109]
    s_waitcnt lgkmcnt(7)
    v_add_u32 v231, 0xffff5fc0, v231
    v_and_b32 v8, 1, v1
    v_mfma_f32_16x16x32_bf16 v[110:113], v[54:57], v[30:33], v[110:113]
    s_waitcnt lgkmcnt(5)
    v_add_u32 v232, 0xffff5fc0, v232
    v_cmp_eq_i32 s[100:101], v8, 0
    v_mfma_f32_16x16x32_bf16 v[114:117], v[58:61], v[30:33], v[114:117]
    s_waitcnt lgkmcnt(3)
    buffer_store_dwordx4 v[218:221], v0, s[40:43], s31 offen sc1
    v_mfma_f32_16x16x32_bf16 v[118:121], v[62:65], v[30:33], v[118:121]
    s_waitcnt lgkmcnt(2)
    v_add_u32 v233, 0xffff5fc0, v233
    ds_read_b128 v[66:69], v20 offset:0
    v_mfma_f32_16x16x32_bf16 v[122:125], v[46:49], v[34:37], v[122:125]
    ds_read_b64_tr_b16 v[82:83], v229 offset:0
    ds_read_b64_tr_b16 v[84:85], v229 offset:1280
    v_mfma_f32_16x16x32_bf16 v[126:129], v[50:53], v[34:37], v[126:129]
    buffer_store_dwordx4 v[218:221], v0, s[40:43], s31 offen offset:1024 sc1
    v_mfma_f32_16x16x32_bf16 v[130:133], v[54:57], v[34:37], v[130:133]
    ds_read_b64_tr_b16 v[86:87], v230 offset:0
    ds_read_b64_tr_b16 v[88:89], v230 offset:1280
    v_mfma_f32_16x16x32_bf16 v[134:137], v[58:61], v[34:37], v[134:137]
    ds_read_b64_tr_b16 v[90:91], v231 offset:0
    ds_read_b64_tr_b16 v[92:93], v231 offset:1280
    v_mfma_f32_16x16x32_bf16 v[138:141], v[62:65], v[34:37], v[138:141]
    s_waitcnt lgkmcnt(8)
    buffer_store_dwordx4 v[218:221], v222, s[40:43], s31 offen offset:2048 sc1
    v_mfma_f32_16x16x32_bf16 v[142:145], v[46:49], v[38:41], v[142:145]
    ds_read_b64_tr_b16 v[94:95], v232 offset:0
    ds_read_b64_tr_b16 v[96:97], v232 offset:1280
    v_mfma_f32_16x16x32_bf16 v[146:149], v[50:53], v[38:41], v[146:149]
    s_add_u32 s31, s31, 40960
    ds_read_b64_tr_b16 v[98:99], v233 offset:0
    ds_read_b64_tr_b16 v[100:101], v233 offset:1280
    v_mfma_f32_16x16x32_bf16 v[150:153], v[54:57], v[38:41], v[150:153]
    ds_read_b128 v[70:73], v20 offset:4096
    v_cndmask_b32 v9, 64, v9, s[100:101]
    v_mfma_f32_16x16x32_bf16 v[154:157], v[58:61], v[38:41], v[154:157]
    ds_read_b128 v[74:77], v20 offset:8192
    v_add_u32 v14, 0x500, v9
    v_mfma_f32_16x16x32_bf16 v[158:161], v[62:65], v[38:41], v[158:161]
    s_waitcnt lgkmcnt(13)
    buffer_store_dwordx4 v[218:221], v0, s[40:43], s31 offen sc1
    v_mfma_f32_16x16x32_bf16 v[162:165], v[46:49], v[42:45], v[162:165]
    ds_read_b128 v[78:81], v20 offset:12288
    v_lshrrev_b32 v9, 1, v1
    v_mfma_f32_16x16x32_bf16 v[166:169], v[50:53], v[42:45], v[166:169]
    v_and_b32 v9, 1, v9
    v_mul_u32_u24 v9, 0x700, v9
    v_mfma_f32_16x16x32_bf16 v[170:173], v[54:57], v[42:45], v[170:173]
    buffer_store_dwordx4 v[218:221], v0, s[40:43], s31 offen offset:1024 sc1
    v_mfma_f32_16x16x32_bf16 v[174:177], v[58:61], v[42:45], v[174:177]
    v_lshrrev_b32 v8, 4, v1
    v_mul_u32_u24 v8, 0x50, v8
    v_mfma_f32_16x16x32_bf16 v[178:181], v[62:65], v[42:45], v[178:181]
    v_add_u32 v8, v9, v8
    v_add_u32 v13, v8, v14
    v_mfma_f32_16x16x32_bf16 v[182:185], v[46:49], v[26:29], v[182:185]
    buffer_store_dwordx4 v[218:221], v222, s[40:43], s31 offen offset:2048 sc1
    v_mfma_f32_16x16x32_bf16 v[186:189], v[50:53], v[26:29], v[186:189]
    v_lshrrev_b32 v9, 4, v1
    v_mul_u32_u24 v9, 0x700, v9
    v_mfma_f32_16x16x32_bf16 v[190:193], v[54:57], v[26:29], v[190:193]
    v_add_u32 v9, 0x140, v9
    v_add_u32 v14, v9, v14
    v_mfma_f32_16x16x32_bf16 v[194:197], v[58:61], v[26:29], v[194:197]
    s_add_u32 s31, s31, 40960
    v_lshrrev_b32 v9, 4, v1
    v_mul_u32_u24 v9, 0x700, v9
    v_mfma_f32_16x16x32_bf16 v[198:201], v[62:65], v[26:29], v[198:201]
    s_waitcnt vmcnt(13) lgkmcnt(0)
    s_barrier
    ds_read_b32 v202, v252 offset:0
    v_mfma_f32_16x16x32_bf16 v[102:105], v[82:85], v[66:69], v[102:105]
    ds_read_b128 v[30:33], v19 offset:16384
    ds_read_b64_tr_b16 v[46:47], v224 offset:20512
    v_mfma_f32_16x16x32_bf16 v[106:109], v[86:89], v[66:69], v[106:109]
    ds_read_b64_tr_b16 v[48:49], v224 offset:21792
    ds_read_b32 v203, v252 offset:128
    v_mfma_f32_16x16x32_bf16 v[110:113], v[90:93], v[66:69], v[110:113]
    ds_read_b64_tr_b16 v[50:51], v225 offset:20512
    ds_read_b32 v204, v252 offset:256
    v_mfma_f32_16x16x32_bf16 v[114:117], v[94:97], v[66:69], v[114:117]
    ds_read_b64_tr_b16 v[52:53], v225 offset:21792
    ds_read_b32 v205, v252 offset:384
    v_mfma_f32_16x16x32_bf16 v[118:121], v[98:101], v[66:69], v[118:121]
    ds_read_b64_tr_b16 v[54:55], v226 offset:20512
    s_waitcnt vmcnt(9)
    v_cmp_gt_u32 s[96:97], 1, v250
    v_mfma_f32_16x16x32_bf16 v[122:125], v[82:85], v[70:73], v[122:125]
    ds_read_b64_tr_b16 v[56:57], v226 offset:21792
    ds_read_b32 v206, v252 offset:512
    v_mfma_f32_16x16x32_bf16 v[126:129], v[86:89], v[70:73], v[126:129]
    ds_read_b64_tr_b16 v[58:59], v227 offset:20512
    ds_read_b32 v207, v252 offset:640
    v_mfma_f32_16x16x32_bf16 v[130:133], v[90:93], v[70:73], v[130:133]
    s_and_b32 s96, s96, 0xfffff
    s_cbranch_scc1 Lslow5
Lback5:
    ds_read_b64_tr_b16 v[60:61], v227 offset:21792
    v_mfma_f32_16x16x32_bf16 v[134:137], v[94:97], v[70:73], v[134:137]
    ds_read_b64_tr_b16 v[62:63], v228 offset:20512
    ds_read_b32 v208, v252 offset:768
    v_mfma_f32_16x16x32_bf16 v[138:141], v[98:101], v[70:73], v[138:141]
    ds_read_b64_tr_b16 v[64:65], v228 offset:21792
    ds_read_b32 v209, v252 offset:896
    v_mfma_f32_16x16x32_bf16 v[142:145], v[82:85], v[74:77], v[142:145]
    ds_read_b128 v[34:37], v19 offset:20480
    v_add_u32 v9, 0x400, v9
    v_mfma_f32_16x16x32_bf16 v[146:149], v[86:89], v[74:77], v[146:149]
    ds_read_b128 v[38:41], v19 offset:24576
    v_and_b32 v8, 15, v1
    v_mfma_f32_16x16x32_bf16 v[150:153], v[90:93], v[74:77], v[150:153]
    ds_read_b128 v[42:45], v19 offset:28672
    v_lshlrev_b32 v8, 4, v8
    v_mfma_f32_16x16x32_bf16 v[154:157], v[94:97], v[74:77], v[154:157]
    v_add_u32 v10, v9, v8
    v_lshlrev_b32 v9, 3, v1
    v_mfma_f32_16x16x32_bf16 v[158:161], v[98:101], v[74:77], v[158:161]
    ds_write_b128 v253, v[182:185] offset:0
    v_mov_b32 v8, 0x40000000
    v_mfma_f32_16x16x32_bf16 v[162:165], v[82:85], v[78:81], v[162:165]
    v_and_b32 v7, 1, v1
    v_cmp_eq_i32 s[100:101], v7, 0
    v_mfma_f32_16x16x32_bf16 v[166:169], v[86:89], v[78:81], v[166:169]
    s_nop 0
    v_cndmask_b32 v16, v8, v9, s[100:101]
    v_lshlrev_b32 v9, 7, v1
    v_mfma_f32_16x16x32_bf16 v[170:173], v[90:93], v[78:81], v[170:173]
    buffer_load_dwordx4 a[160:163], v0, s[40:43], s21 offen offset:0 sc1
    v_mfma_f32_16x16x32_bf16 v[174:177], v[94:97], v[78:81], v[174:177]
    ds_write_b128 v253, v[186:189] offset:1024
    v_mov_b32 v8, 0x40000000
    v_mfma_f32_16x16x32_bf16 v[178:181], v[98:101], v[78:81], v[178:181]
    s_waitcnt lgkmcnt(15)
    v_cmp_lt_i32 s[100:101], v1, 2
    v_mfma_f32_16x16x32_bf16 v[102:105], v[46:49], v[30:33], v[102:105]
    s_waitcnt lgkmcnt(15)
    v_cndmask_b32 v17, v8, v9, s[100:101]
    v_mov_b32 v9, 0x40000000
    v_mfma_f32_16x16x32_bf16 v[106:109], v[50:53], v[30:33], v[106:109]
    s_waitcnt lgkmcnt(13)
    buffer_load_dwordx4 a[164:167], v0, s[40:43], s21 offen offset:1024 sc1
    v_mfma_f32_16x16x32_bf16 v[110:113], v[54:57], v[30:33], v[110:113]
    s_waitcnt lgkmcnt(9)
    ds_write_b128 v253, v[190:193] offset:2048
    v_cmp_eq_i32 s[100:101], v1, 0
    v_mfma_f32_16x16x32_bf16 v[114:117], v[58:61], v[30:33], v[114:117]
    s_waitcnt lgkmcnt(7)
    v_cndmask_b32 v15, v9, 0, s[100:101]
    v_mov_b32 v11, 1
    v_mfma_f32_16x16x32_bf16 v[118:121], v[62:65], v[30:33], v[118:121]
    s_waitcnt lgkmcnt(5)
    buffer_load_dwordx4 a[168:171], v0, s[40:43], s21 offen offset:2048 sc1
    v_mfma_f32_16x16x32_bf16 v[122:125], v[46:49], v[34:37], v[122:125]
    v_mov_b32 v246, 0
    v_mov_b32 v247, 0x358637bd
    v_mfma_f32_16x16x32_bf16 v[126:129], v[50:53], v[34:37], v[126:129]
    ds_write_b128 v253, v[194:197] offset:3072
    v_mov_b32 v248, 0
    v_mfma_f32_16x16x32_bf16 v[130:133], v[54:57], v[34:37], v[130:133]
    buffer_load_dwordx4 a[172:175], v0, s[40:43], s21 offen offset:3072 sc1
    v_mfma_f32_16x16x32_bf16 v[134:137], v[58:61], v[34:37], v[134:137]
    v_mov_b32 v249, 0x358637bd
    v_mfma_f32_16x16x32_bf16 v[138:141], v[62:65], v[34:37], v[138:141]
    s_waitcnt lgkmcnt(5)
    v_mfma_f32_16x16x32_bf16 v[142:145], v[46:49], v[38:41], v[142:145]
    ds_write_b128 v253, v[198:201] offset:4096
    ds_read_b128 v[66:69], v20 offset:16384
    v_mfma_f32_16x16x32_bf16 v[146:149], v[50:53], v[38:41], v[146:149]
    s_add_u32 s21, s21, 4096
    ds_read_b64_tr_b16 v[82:83], v229 offset:20512
    ds_read_b64_tr_b16 v[84:85], v229 offset:21792
    v_mfma_f32_16x16x32_bf16 v[150:153], v[54:57], v[38:41], v[150:153]
    ds_read_b64_tr_b16 v[86:87], v230 offset:20512
    ds_read_b64_tr_b16 v[88:89], v230 offset:21792
    v_mfma_f32_16x16x32_bf16 v[154:157], v[58:61], v[38:41], v[154:157]
    ds_read_b64_tr_b16 v[90:91], v231 offset:20512
    ds_read_b64_tr_b16 v[92:93], v231 offset:21792
    v_mfma_f32_16x16x32_bf16 v[158:161], v[62:65], v[38:41], v[158:161]
    s_waitcnt lgkmcnt(12)
    buffer_load_dwordx4 a[176:179], v0, s[40:43], s21 offen offset:0 sc1
    v_mfma_f32_16x16x32_bf16 v[162:165], v[46:49], v[42:45], v[162:165]
    ds_read_b64_tr_b16 v[94:95], v232 offset:20512
    ds_read_b64_tr_b16 v[96:97], v232 offset:21792
    v_mfma_f32_16x16x32_bf16 v[166:169], v[50:53], v[42:45], v[166:169]
    ds_read_b64_tr_b16 v[98:99], v233 offset:20512
    ds_read_b64_tr_b16 v[100:101], v233 offset:21792
    v_mfma_f32_16x16x32_bf16 v[170:173], v[54:57], v[42:45], v[170:173]
    ds_read_b128 v[70:73], v20 offset:20480
    ds_read_b128 v[74:77], v20 offset:24576
    v_mfma_f32_16x16x32_bf16 v[174:177], v[58:61], v[42:45], v[174:177]
    buffer_load_dwordx4 a[180:183], v0, s[40:43], s21 offen offset:1024 sc1
    v_mfma_f32_16x16x32_bf16 v[178:181], v[62:65], v[42:45], v[178:181]
    ds_read_b128 v[78:81], v20 offset:28672
    v_mfma_f32_16x16x32_bf16 v[182:185], v[46:49], v[26:29], v[182:185]
    v_mfma_f32_16x16x32_bf16 v[186:189], v[50:53], v[26:29], v[186:189]
    buffer_load_dwordx4 a[184:187], v0, s[40:43], s21 offen offset:2048 sc1
    v_mfma_f32_16x16x32_bf16 v[190:193], v[54:57], v[26:29], v[190:193]
    v_mfma_f32_16x16x32_bf16 v[194:197], v[58:61], v[26:29], v[194:197]
    v_mfma_f32_16x16x32_bf16 v[198:201], v[62:65], v[26:29], v[198:201]
    s_waitcnt lgkmcnt(0)
    s_barrier
    v_mfma_f32_16x16x32_bf16 v[102:105], v[82:85], v[66:69], v[102:105]
    buffer_load_dwordx4 a[188:191], v0, s[40:43], s21 offen offset:3072 sc1
    v_mfma_f32_16x16x32_bf16 v[106:109], v[86:89], v[66:69], v[106:109]
    ds_read_b128 v[30:33], v255 offset:0
    ds_read_b128 v[34:37], v255 offset:1024
    v_mfma_f32_16x16x32_bf16 v[110:113], v[90:93], v[66:69], v[110:113]
    ds_read_b128 v[38:41], v255 offset:2048
    ds_read_b128 v[42:45], v255 offset:3072
    v_mfma_f32_16x16x32_bf16 v[114:117], v[94:97], v[66:69], v[114:117]
    s_add_u32 s21, s21, 4096
    ds_read_b128 v[46:49], v255 offset:4096
    v_mfma_f32_16x16x32_bf16 v[118:121], v[98:101], v[66:69], v[118:121]
    v_mfma_f32_16x16x32_bf16 v[122:125], v[82:85], v[70:73], v[122:125]
    v_mfma_f32_16x16x32_bf16 v[126:129], v[86:89], v[70:73], v[126:129]
    buffer_load_dwordx4 a[192:195], v0, s[40:43], s21 offen offset:0 sc1
    v_mfma_f32_16x16x32_bf16 v[130:133], v[90:93], v[70:73], v[130:133]
    v_mfma_f32_16x16x32_bf16 v[134:137], v[94:97], v[70:73], v[134:137]
    v_mfma_f32_16x16x32_bf16 v[138:141], v[98:101], v[70:73], v[138:141]
    v_mfma_f32_16x16x32_bf16 v[142:145], v[82:85], v[74:77], v[142:145]
    buffer_load_dwordx4 a[196:199], v0, s[40:43], s21 offen offset:1024 sc1
    v_mfma_f32_16x16x32_bf16 v[146:149], v[86:89], v[74:77], v[146:149]
    v_mfma_f32_16x16x32_bf16 v[150:153], v[90:93], v[74:77], v[150:153]
    v_mfma_f32_16x16x32_bf16 v[154:157], v[94:97], v[74:77], v[154:157]
    buffer_load_dwordx4 a[200:203], v0, s[40:43], s21 offen offset:2048 sc1
    v_mfma_f32_16x16x32_bf16 v[158:161], v[98:101], v[74:77], v[158:161]
    v_mfma_f32_16x16x32_bf16 v[162:165], v[82:85], v[78:81], v[162:165]
    v_mfma_f32_16x16x32_bf16 v[166:169], v[86:89], v[78:81], v[166:169]
    v_mfma_f32_16x16x32_bf16 v[170:173], v[90:93], v[78:81], v[170:173]
    buffer_load_dwordx4 a[204:207], v0, s[40:43], s21 offen offset:3072 sc1
    v_mfma_f32_16x16x32_bf16 v[174:177], v[94:97], v[78:81], v[174:177]
    v_mfma_f32_16x16x32_bf16 v[178:181], v[98:101], v[78:81], v[178:181]
    v_mfma_f32_16x16x32_bf16 v[182:185], v[82:85], v[26:29], v[182:185]
    s_add_u32 s21, s21, 4096
    v_mfma_f32_16x16x32_bf16 v[186:189], v[86:89], v[26:29], v[186:189]
    v_mfma_f32_16x16x32_bf16 v[190:193], v[90:93], v[26:29], v[190:193]
    v_mfma_f32_16x16x32_bf16 v[194:197], v[94:97], v[26:29], v[194:197]
    v_mfma_f32_16x16x32_bf16 v[198:201], v[98:101], v[26:29], v[198:201]
    s_waitcnt lgkmcnt(4)
    s_nop 1
    v_pk_add_f32 v[182:183], v[182:183], v[30:31]
    v_pk_add_f32 v[184:185], v[184:185], v[32:33]
    s_waitcnt lgkmcnt(3)
    v_pk_add_f32 v[186:187], v[186:187], v[34:35]
    v_pk_add_f32 v[188:189], v[188:189], v[36:37]
    s_waitcnt lgkmcnt(2)
    v_pk_add_f32 v[190:191], v[190:191], v[38:39]
    v_pk_add_f32 v[192:193], v[192:193], v[40:41]
    s_waitcnt lgkmcnt(1)
    v_pk_add_f32 v[194:195], v[194:195], v[42:43]
    v_pk_add_f32 v[196:197], v[196:197], v[44:45]
    s_waitcnt lgkmcnt(0)
    v_pk_add_f32 v[198:199], v[198:199], v[46:47]
    v_pk_add_f32 v[200:201], v[200:201], v[48:49]
    v_pk_mul_f32 v[210:211], v[202:203], s[62:63]
    v_pk_mul_f32 v[212:213], v[204:205], s[62:63]
    v_pk_fma_f32 v[102:103], v[182:183], v[206:207], v[102:103] op_sel:[0,0,0] op_sel_hi:[1,0,1]
    v_pk_fma_f32 v[104:105], v[184:185], v[206:207], v[104:105] op_sel:[0,0,0] op_sel_hi:[1,0,1]
    v_pk_mul_f32 v[24:25], v[102:103], v[210:211] op_sel:[0,0] op_sel_hi:[1,0]
    v_pk_fma_f32 v[20:21], v[102:103], v[202:203], s[60:61] op_sel:[0,0,0] op_sel_hi:[1,0,1]
    v_pk_mul_f32 v[26:27], v[104:105], v[210:211] op_sel:[0,0] op_sel_hi:[1,0]
    v_pk_fma_f32 v[22:23], v[104:105], v[202:203], s[60:61] op_sel:[0,0,0] op_sel_hi:[1,0,1]
    v_exp_f32 v24, v24 clamp
Lwq_2:
    s_cbranch_execz Lwq_3
    v_exp_f32 v25, v25 clamp
    v_exp_f32 v26, v26 clamp
    v_exp_f32 v27, v27 clamp
    v_max_f32 v20, s60, v20
    v_max_f32 v21, s60, v21
    v_max_f32 v22, s60, v22
    v_max_f32 v23, s60, v23
    v_pk_add_f32 v[20:21], v[20:21], v[24:25]
    v_pk_add_f32 v[22:23], v[22:23], v[26:27]
    v_cvt_pk_bf16_f32 v44, v20, v21
    v_cvt_pk_bf16_f32 v45, v22, v23
    v_pk_fma_f32 v[106:107], v[186:187], v[206:207], v[106:107] op_sel:[0,0,0] op_sel_hi:[1,0,1]
    v_pk_fma_f32 v[108:109], v[188:189], v[206:207], v[108:109] op_sel:[0,0,0] op_sel_hi:[1,0,1]
    v_pk_mul_f32 v[32:33], v[106:107], v[210:211] op_sel:[0,0] op_sel_hi:[1,0]
    v_pk_fma_f32 v[28:29], v[106:107], v[202:203], s[60:61] op_sel:[0,0,0] op_sel_hi:[1,0,1]
    v_pk_mul_f32 v[34:35], v[108:109], v[210:211] op_sel:[0,0] op_sel_hi:[1,0]
    v_pk_fma_f32 v[30:31], v[108:109], v[202:203], s[60:61] op_sel:[0,0,0] op_sel_hi:[1,0,1]
    v_exp_f32 v32, v32 clamp
    v_exp_f32 v33, v33 clamp
    v_exp_f32 v34, v34 clamp
    v_exp_f32 v35, v35 clamp
    v_max_f32 v28, s60, v28
    v_max_f32 v29, s60, v29
    v_max_f32 v30, s60, v30
    v_max_f32 v31, s60, v31
    v_pk_add_f32 v[28:29], v[28:29], v[32:33]
    v_pk_add_f32 v[30:31], v[30:31], v[34:35]
    v_cvt_pk_bf16_f32 v48, v28, v29
    v_cvt_pk_bf16_f32 v49, v30, v31
    v_pk_fma_f32 v[110:111], v[190:191], v[206:207], v[110:111] op_sel:[0,0,0] op_sel_hi:[1,0,1]
    v_pk_fma_f32 v[112:113], v[192:193], v[206:207], v[112:113] op_sel:[0,0,0] op_sel_hi:[1,0,1]
    v_pk_mul_f32 v[40:41], v[110:111], v[210:211] op_sel:[0,0] op_sel_hi:[1,0]
    v_pk_fma_f32 v[36:37], v[110:111], v[202:203], s[60:61] op_sel:[0,0,0] op_sel_hi:[1,0,1]
    v_pk_mul_f32 v[42:43], v[112:113], v[210:211] op_sel:[0,0] op_sel_hi:[1,0]
    v_pk_fma_f32 v[38:39], v[112:113], v[202:203], s[60:61] op_sel:[0,0,0] op_sel_hi:[1,0,1]
    v_exp_f32 v40, v40 clamp
    v_exp_f32 v41, v41 clamp
    v_exp_f32 v42, v42 clamp
    v_exp_f32 v43, v43 clamp
    v_max_f32 v36, s60, v36
    v_max_f32 v37, s60, v37
    v_max_f32 v38, s60, v38
    v_max_f32 v39, s60, v39
    v_pk_add_f32 v[36:37], v[36:37], v[40:41]
    v_pk_add_f32 v[38:39], v[38:39], v[42:43]
    v_cvt_pk_bf16_f32 v50, v36, v37
    v_cvt_pk_bf16_f32 v51, v38, v39
    v_pk_fma_f32 v[114:115], v[194:195], v[206:207], v[114:115] op_sel:[0,0,0] op_sel_hi:[1,0,1]
    v_pk_fma_f32 v[116:117], v[196:197], v[206:207], v[116:117] op_sel:[0,0,0] op_sel_hi:[1,0,1]
    v_pk_mul_f32 v[24:25], v[114:115], v[210:211] op_sel:[0,0] op_sel_hi:[1,0]
    v_pk_fma_f32 v[20:21], v[114:115], v[202:203], s[60:61] op_sel:[0,0,0] op_sel_hi:[1,0,1]
    v_pk_mul_f32 v[26:27], v[116:117], v[210:211] op_sel:[0,0] op_sel_hi:[1,0]
    v_pk_fma_f32 v[22:23], v[116:117], v[202:203], s[60:61] op_sel:[0,0,0] op_sel_hi:[1,0,1]
    v_exp_f32 v24, v24 clamp
    v_exp_f32 v25, v25 clamp
    v_exp_f32 v26, v26 clamp
    v_exp_f32 v27, v27 clamp
    v_max_f32 v20, s60, v20
    v_max_f32 v21, s60, v21
    v_max_f32 v22, s60, v22
    v_max_f32 v23, s60, v23
    v_pk_add_f32 v[20:21], v[20:21], v[24:25]
    v_pk_add_f32 v[22:23], v[22:23], v[26:27]
    v_cvt_pk_bf16_f32 v54, v20, v21
    v_cvt_pk_bf16_f32 v55, v22, v23
    v_pk_fma_f32 v[118:119], v[198:199], v[206:207], v[118:119] op_sel:[0,0,0] op_sel_hi:[1,0,1]
    v_pk_fma_f32 v[120:121], v[200:201], v[206:207], v[120:121] op_sel:[0,0,0] op_sel_hi:[1,0,1]
    v_pk_mul_f32 v[32:33], v[118:119], v[210:211] op_sel:[0,0] op_sel_hi:[1,0]
    v_pk_fma_f32 v[28:29], v[118:119], v[202:203], s[60:61] op_sel:[0,0,0] op_sel_hi:[1,0,1]
    v_pk_mul_f32 v[34:35], v[120:121], v[210:211] op_sel:[0,0] op_sel_hi:[1,0]
    v_pk_fma_f32 v[30:31], v[120:121], v[202:203], s[60:61] op_sel:[0,0,0] op_sel_hi:[1,0,1]
    v_exp_f32 v32, v32 clamp
    v_exp_f32 v33, v33 clamp
    v_exp_f32 v34, v34 clamp
    v_exp_f32 v35, v35 clamp
    v_max_f32 v28, s60, v28
    v_max_f32 v29, s60, v29
    v_max_f32 v30, s60, v30
    v_max_f32 v31, s60, v31
    v_pk_add_f32 v[28:29], v[28:29], v[32:33]
    v_pk_add_f32 v[30:31], v[30:31], v[34:35]
    v_cvt_pk_bf16_f32 v46, v28, v29
    v_cvt_pk_bf16_f32 v47, v30, v31
    v_mov_b32 v52, v46
    v_mov_b32 v53, v47
    v_pk_fma_f32 v[122:123], v[182:183], v[206:207], v[122:123] op_sel:[0,1,0] op_sel_hi:[1,1,1]
    v_pk_fma_f32 v[124:125], v[184:185], v[206:207], v[124:125] op_sel:[0,1,0] op_sel_hi:[1,1,1]
    v_pk_mul_f32 v[40:41], v[122:123], v[210:211] op_sel:[0,1] op_sel_hi:[1,1]
    v_pk_fma_f32 v[36:37], v[122:123], v[202:203], s[60:61] op_sel:[0,1,0] op_sel_hi:[1,1,1]
    v_pk_mul_f32 v[42:43], v[124:125], v[210:211] op_sel:[0,1] op_sel_hi:[1,1]
    v_pk_fma_f32 v[38:39], v[124:125], v[202:203], s[60:61] op_sel:[0,1,0] op_sel_hi:[1,1,1]
    v_exp_f32 v40, v40 clamp
    v_exp_f32 v41, v41 clamp
    v_exp_f32 v42, v42 clamp
    v_exp_f32 v43, v43 clamp
    v_max_f32 v36, s60, v36
    v_max_f32 v37, s60, v37
    v_max_f32 v38, s60, v38
    v_max_f32 v39, s60, v39
    v_pk_add_f32 v[36:37], v[36:37], v[40:41]
    v_pk_add_f32 v[38:39], v[38:39], v[42:43]
    v_cvt_pk_bf16_f32 v56, v36, v37
    v_cvt_pk_bf16_f32 v57, v38, v39
    v_pk_fma_f32 v[126:127], v[186:187], v[206:207], v[126:127] op_sel:[0,1,0] op_sel_hi:[1,1,1]
    v_pk_fma_f32 v[128:129], v[188:189], v[206:207], v[128:129] op_sel:[0,1,0] op_sel_hi:[1,1,1]
    v_pk_mul_f32 v[24:25], v[126:127], v[210:211] op_sel:[0,1] op_sel_hi:[1,1]
    v_pk_fma_f32 v[20:21], v[126:127], v[202:203], s[60:61] op_sel:[0,1,0] op_sel_hi:[1,1,1]
    v_pk_mul_f32 v[26:27], v[128:129], v[210:211] op_sel:[0,1] op_sel_hi:[1,1]
    v_pk_fma_f32 v[22:23], v[128:129], v[202:203], s[60:61] op_sel:[0,1,0] op_sel_hi:[1,1,1]
    v_exp_f32 v24, v24 clamp
    v_exp_f32 v25, v25 clamp
    v_exp_f32 v26, v26 clamp
    v_exp_f32 v27, v27 clamp
    v_max_f32 v20, s60, v20
    v_max_f32 v21, s60, v21
    v_max_f32 v22, s60, v22
    v_max_f32 v23, s60, v23
    v_pk_add_f32 v[20:21], v[20:21], v[24:25]
    v_pk_add_f32 v[22:23], v[22:23], v[26:27]
    v_cvt_pk_bf16_f32 v60, v20, v21
    v_cvt_pk_bf16_f32 v61, v22, v23
    v_pk_fma_f32 v[130:131], v[190:191], v[206:207], v[130:131] op_sel:[0,1,0] op_sel_hi:[1,1,1]
    v_pk_fma_f32 v[132:133], v[192:193], v[206:207], v[132:133] op_sel:[0,1,0] op_sel_hi:[1,1,1]
    v_pk_mul_f32 v[32:33], v[130:131], v[210:211] op_sel:[0,1] op_sel_hi:[1,1]
    v_pk_fma_f32 v[28:29], v[130:131], v[202:203], s[60:61] op_sel:[0,1,0] op_sel_hi:[1,1,1]
    v_pk_mul_f32 v[34:35], v[132:133], v[210:211] op_sel:[0,1] op_sel_hi:[1,1]
    v_pk_fma_f32 v[30:31], v[132:133], v[202:203], s[60:61] op_sel:[0,1,0] op_sel_hi:[1,1,1]
    v_exp_f32 v32, v32 clamp
    v_exp_f32 v33, v33 clamp
    v_exp_f32 v34, v34 clamp
    v_exp_f32 v35, v35 clamp
    v_max_f32 v28, s60, v28
    v_max_f32 v29, s60, v29
    v_max_f32 v30, s60, v30
    v_max_f32 v31, s60, v31
    v_pk_add_f32 v[28:29], v[28:29], v[32:33]
    v_pk_add_f32 v[30:31], v[30:31], v[34:35]
    v_cvt_pk_bf16_f32 v62, v28, v29
    v_cvt_pk_bf16_f32 v63, v30, v31
    v_pk_fma_f32 v[134:135], v[194:195], v[206:207], v[134:135] op_sel:[0,1,0] op_sel_hi:[1,1,1]
    v_pk_fma_f32 v[136:137], v[196:197], v[206:207], v[136:137] op_sel:[0,1,0] op_sel_hi:[1,1,1]
    v_pk_mul_f32 v[40:41], v[134:135], v[210:211] op_sel:[0,1] op_sel_hi:[1,1]
    v_pk_fma_f32 v[36:37], v[134:135], v[202:203], s[60:61] op_sel:[0,1,0] op_sel_hi:[1,1,1]
    v_pk_mul_f32 v[42:43], v[136:137], v[210:211] op_sel:[0,1] op_sel_hi:[1,1]
    v_pk_fma_f32 v[38:39], v[136:137], v[202:203], s[60:61] op_sel:[0,1,0] op_sel_hi:[1,1,1]
    v_exp_f32 v40, v40 clamp
    v_exp_f32 v41, v41 clamp
    v_exp_f32 v42, v42 clamp
    v_exp_f32 v43, v43 clamp
    v_max_f32 v36, s60, v36
    v_max_f32 v37, s60, v37
    v_max_f32 v38, s60, v38
    v_max_f32 v39, s60, v39
    v_pk_add_f32 v[36:37], v[36:37], v[40:41]
    v_pk_add_f32 v[38:39], v[38:39], v[42:43]
    v_cvt_pk_bf16_f32 v66, v36, v37
    v_cvt_pk_bf16_f32 v67, v38, v39
    v_pk_fma_f32 v[138:139], v[198:199], v[206:207], v[138:139] op_sel:[0,1,0] op_sel_hi:[1,1,1]
    v_pk_fma_f32 v[140:141], v[200:201], v[206:207], v[140:141] op_sel:[0,1,0] op_sel_hi:[1,1,1]
    v_pk_mul_f32 v[24:25], v[138:139], v[210:211] op_sel:[0,1] op_sel_hi:[1,1]
    v_pk_fma_f32 v[20:21], v[138:139], v[202:203], s[60:61] op_sel:[0,1,0] op_sel_hi:[1,1,1]
    v_pk_mul_f32 v[26:27], v[140:141], v[210:211] op_sel:[0,1] op_sel_hi:[1,1]
    v_pk_fma_f32 v[22:23], v[140:141], v[202:203], s[60:61] op_sel:[0,1,0] op_sel_hi:[1,1,1]
    v_exp_f32 v24, v24 clamp
    v_exp_f32 v25, v25 clamp
    v_exp_f32 v26, v26 clamp
    v_exp_f32 v27, v27 clamp
    v_max_f32 v20, s60, v20
    v_max_f32 v21, s60, v21
    v_max_f32 v22, s60, v22
    v_max_f32 v23, s60, v23
    v_pk_add_f32 v[20:21], v[20:21], v[24:25]
    v_pk_add_f32 v[22:23], v[22:23], v[26:27]
    v_cvt_pk_bf16_f32 v58, v20, v21
    v_cvt_pk_bf16_f32 v59, v22, v23
    v_mov_b32 v64, v58
    v_mov_b32 v65, v59
    s_sub_u32 s57, s5, 8
    s_lshl_b32 s59, s57, 1
    s_add_u32 s59, s59, s49
    s_mul_i32 s59, s59, 7168
    s_add_u32 s59, s59, 16384
    s_mul_i32 s7, s4, 6144
    s_add_u32 s7, s7, 22020096
    s_lshl_b32 s57, s57, 8
    s_add_u32 s56, s7, s57
    s_lshl_b32 s57, s48, 7
    s_add_u32 s7, s7, s57
    s_waitcnt vmcnt(12)
    s_bfm_b64 s[44:45], 16, 0
    s_bfm_b64 s[46:47], 16, 16
    s_bfm_b64 s[52:53], 16, 32
    s_bfm_b64 s[54:55], 16, 48
    s_cmp_lg_u32 s3, 0
    s_cbranch_scc1 Lidle6
    v_mov_b32 v12, 0
    buffer_atomic_or v12, v17, s[40:43], s56 offen offset:0 sc0 sc1
    s_waitcnt vmcnt(0)
    v_cmp_gt_u32 vcc, 16, v12
    s_nop 0
    s_and_b32 vcc_lo, vcc_lo, 0x3
    s_cbranch_scc1 Lslow6
Lback6:
    s_branch Lmeet6
Lidle6:
    s_mov_b64 exec, 0
    s_cmp_eq_u32 s3, 2
    s_cbranch_scc1 Lidb6
    s_cmp_eq_u32 s3, 3
    s_cbranch_scc1 Lidc6
    s_cmp_eq_u32 s3, 0
    s_cbranch_scc1 Lidd6
    s_call_b64 s[98:99], Lwc0_0
    s_branch Lidd6
Lidb6:
    s_call_b64 s[98:99], Lwc1_0
    s_branch Lidd6
Lidc6:
    s_call_b64 s[98:99], Lwc2_0
Lidd6:
    s_mov_b64 exec, -1
Lmeet6:
    s_barrier
    buffer_load_dwordx4 v[6:9], v14, s[40:43], s59 offen sc1
    buffer_load_dwordx4 v[2:5], v10, s[40:43], s59 offen sc1
    buffer_load_dwordx4 v[108:111], v13, s[40:43], s59 offen sc1
    buffer_load_dwordx4 v[92:95], v0, s[40:43], s59 offen sc1
    buffer_load_dwordx4 v[96:99], v0, s[40:43], s59 offen offset:1792 sc1
    s_add_u32 s59, s59, 3584
    buffer_load_dwordx4 v[114:117], v13, s[40:43], s59 offen sc1
    buffer_load_dwordx4 v[100:103], v0, s[40:43], s59 offen sc1
    buffer_load_dwordx4 v[104:107], v0, s[40:43], s59 offen offset:1792 sc1
    s_add_u32 s59, s59, 3584
    v_pk_fma_f32 v[142:143], v[182:183], v[208:209], v[142:143] op_sel:[0,0,0] op_sel_hi:[1,0,1]
    v_pk_fma_f32 v[144:145], v[184:185], v[208:209], v[144:145] op_sel:[0,0,0] op_sel_hi:[1,0,1]
    v_pk_mul_f32 v[32:33], v[142:143], v[212:213] op_sel:[0,0] op_sel_hi:[1,0]
    v_pk_fma_f32 v[28:29], v[142:143], v[204:205], s[60:61] op_sel:[0,0,0] op_sel_hi:[1,0,1]
    v_pk_mul_f32 v[34:35], v[144:145], v[212:213] op_sel:[0,0] op_sel_hi:[1,0]
    v_pk_fma_f32 v[30:31], v[144:145], v[204:205], s[60:61] op_sel:[0,0,0] op_sel_hi:[1,0,1]
    v_exp_f32 v32, v32 clamp
    v_exp_f32 v33, v33 clamp
    v_exp_f32 v34, v34 clamp
    v_exp_f32 v35, v35 clamp
    v_max_f32 v28, s60, v28
    v_max_f32 v29, s60, v29
    v_max_f32 v30, s60, v30
    v_max_f32 v31, s60, v31
    v_pk_add_f32 v[28:29], v[28:29], v[32:33]
    v_pk_add_f32 v[30:31], v[30:31], v[34:35]
    v_cvt_pk_bf16_f32 v68, v28, v29
    v_cvt_pk_bf16_f32 v69, v30, v31
    v_pk_fma_f32 v[146:147], v[186:187], v[208:209], v[146:147] op_sel:[0,0,0] op_sel_hi:[1,0,1]
    v_pk_fma_f32 v[148:149], v[188:189], v[208:209], v[148:149] op_sel:[0,0,0] op_sel_hi:[1,0,1]
    v_pk_mul_f32 v[40:41], v[146:147], v[212:213] op_sel:[0,0] op_sel_hi:[1,0]
    v_pk_fma_f32 v[36:37], v[146:147], v[204:205], s[60:61] op_sel:[0,0,0] op_sel_hi:[1,0,1]
    v_pk_mul_f32 v[42:43], v[148:149], v[212:213] op_sel:[0,0] op_sel_hi:[1,0]
    v_pk_fma_f32 v[38:39], v[148:149], v[204:205], s[60:61] op_sel:[0,0,0] op_sel_hi:[1,0,1]
    v_exp_f32 v40, v40 clamp
    v_exp_f32 v41, v41 clamp
    v_exp_f32 v42, v42 clamp
    v_exp_f32 v43, v43 clamp
    v_max_f32 v36, s60, v36
    v_max_f32 v37, s60, v37
    v_max_f32 v38, s60, v38
    v_max_f32 v39, s60, v39
    v_pk_add_f32 v[36:37], v[36:37], v[40:41]
    v_pk_add_f32 v[38:39], v[38:39], v[42:43]
    v_cvt_pk_bf16_f32 v72, v36, v37
    v_cvt_pk_bf16_f32 v73, v38, v39
    v_pk_fma_f32 v[150:151], v[190:191], v[208:209], v[150:151] op_sel:[0,0,0] op_sel_hi:[1,0,1]
    v_pk_fma_f32 v[152:153], v[192:193], v[208:209], v[152:153] op_sel:[0,0,0] op_sel_hi:[1,0,1]
    v_pk_mul_f32 v[24:25], v[150:151], v[212:213] op_sel:[0,0] op_sel_hi:[1,0]
    v_pk_fma_f32 v[20:21], v[150:151], v[204:205], s[60:61] op_sel:[0,0,0] op_sel_hi:[1,0,1]
    v_pk_mul_f32 v[26:27], v[152:153], v[212:213] op_sel:[0,0] op_sel_hi:[1,0]
    v_pk_fma_f32 v[22:23], v[152:153], v[204:205], s[60:61] op_sel:[0,0,0] op_sel_hi:[1,0,1]
    v_exp_f32 v24, v24 clamp
    v_exp_f32 v25, v25 clamp
    v_exp_f32 v26, v26 clamp
    v_exp_f32 v27, v27 clamp
    v_max_f32 v20, s60, v20
    v_max_f32 v21, s60, v21
    v_max_f32 v22, s60, v22
    v_max_f32 v23, s60, v23
    v_pk_add_f32 v[20:21], v[20:21], v[24:25]
    v_pk_add_f32 v[22:23], v[22:23], v[26:27]
    v_cvt_pk_bf16_f32 v74, v20, v21
    v_cvt_pk_bf16_f32 v75, v22, v23
    v_pk_fma_f32 v[154:155], v[194:195], v[208:209], v[154:155] op_sel:[0,0,0] op_sel_hi:[1,0,1]
    v_pk_fma_f32 v[156:157], v[196:197], v[208:209], v[156:157] op_sel:[0,0,0] op_sel_hi:[1,0,1]
    v_pk_mul_f32 v[32:33], v[154:155], v[212:213] op_sel:[0,0] op_sel_hi:[1,0]
    v_pk_fma_f32 v[28:29], v[154:155], v[204:205], s[60:61] op_sel:[0,0,0] op_sel_hi:[1,0,1]
    v_pk_mul_f32 v[34:35], v[156:157], v[212:213] op_sel:[0,0] op_sel_hi:[1,0]
    v_pk_fma_f32 v[30:31], v[156:157], v[204:205], s[60:61] op_sel:[0,0,0] op_sel_hi:[1,0,1]
    v_exp_f32 v32, v32 clamp
    v_exp_f32 v33, v33 clamp
    v_exp_f32 v34, v34 clamp
    v_exp_f32 v35, v35 clamp
    v_max_f32 v28, s60, v28
    v_max_f32 v29, s60, v29
    v_max_f32 v30, s60, v30
    v_max_f32 v31, s60, v31
    v_pk_add_f32 v[28:29], v[28:29], v[32:33]
    v_pk_add_f32 v[30:31], v[30:31], v[34:35]
    v_cvt_pk_bf16_f32 v78, v28, v29
    v_cvt_pk_bf16_f32 v79, v30, v31
    v_pk_fma_f32 v[158:159], v[198:199], v[208:209], v[158:159] op_sel:[0,0,0] op_sel_hi:[1,0,1]
    v_pk_fma_f32 v[160:161], v[200:201], v[208:209], v[160:161] op_sel:[0,0,0] op_sel_hi:[1,0,1]
    v_pk_mul_f32 v[40:41], v[158:159], v[212:213] op_sel:[0,0] op_sel_hi:[1,0]
    v_pk_fma_f32 v[36:37], v[158:159], v[204:205], s[60:61] op_sel:[0,0,0] op_sel_hi:[1,0,1]
    v_pk_mul_f32 v[42:43], v[160:161], v[212:213] op_sel:[0,0] op_sel_hi:[1,0]
    v_pk_fma_f32 v[38:39], v[160:161], v[204:205], s[60:61] op_sel:[0,0,0] op_sel_hi:[1,0,1]
    v_exp_f32 v40, v40 clamp
    v_exp_f32 v41, v41 clamp
    v_exp_f32 v42, v42 clamp
    v_exp_f32 v43, v43 clamp
    v_max_f32 v36, s60, v36
    v_max_f32 v37, s60, v37
    v_max_f32 v38, s60, v38
    v_max_f32 v39, s60, v39
    v_pk_add_f32 v[36:37], v[36:37], v[40:41]
    v_pk_add_f32 v[38:39], v[38:39], v[42:43]
    v_cvt_pk_bf16_f32 v70, v36, v37
    v_cvt_pk_bf16_f32 v71, v38, v39
    v_mov_b32 v76, v70
    v_mov_b32 v77, v71
    s_waitcnt vmcnt(7)
    v_cvt_pk_bf16_f32 v6, v6, v7
    v_cvt_pk_bf16_f32 v7, v8, v9
    s_waitcnt vmcnt(6)
    v_cvt_pk_bf16_f32 v2, v2, v3
    v_cvt_pk_bf16_f32 v3, v4, v5
    s_waitcnt vmcnt(5)
    v_cvt_pk_bf16_f32 v111, v110, v111
    v_cvt_pk_bf16_f32 v110, v108, v109
    v_cndmask_b32 v108, 0, v6, s[46:47]
    v_cndmask_b32 v109, 0, v7, s[46:47]
    v_cndmask_b32 v112, 0, v6, s[44:45]
    v_cndmask_b32 v113, 0, v7, s[44:45]
    s_waitcnt vmcnt(4)
    v_cvt_pk_bf16_f32 v92, v92, v93
    v_cvt_pk_bf16_f32 v93, v94, v95
    v_cndmask_b32 v94, 0, v2, s[44:45]
    v_cndmask_b32 v95, 0, v3, s[44:45]
    s_waitcnt vmcnt(3)
    v_cvt_pk_bf16_f32 v99, v98, v99
    v_cvt_pk_bf16_f32 v98, v96, v97
    v_cndmask_b32 v96, 0, v2, s[46:47]
    v_cndmask_b32 v97, 0, v3, s[46:47]
    v_mfma_f32_16x16x32_bf16 v[230:233], v[110:113], v[44:47], v[246:249]
    s_waitcnt vmcnt(2)
    v_cvt_pk_bf16_f32 v117, v116, v117
    v_cvt_pk_bf16_f32 v116, v114, v115
    v_mfma_f32_16x16x32_bf16 v[234:237], v[108:111], v[46:49], v[246:249]
    v_cndmask_b32 v114, 0, v6, s[54:55]
    v_cndmask_b32 v115, 0, v7, s[54:55]
    v_mfma_f32_16x16x32_bf16 v[214:217], v[92:95], v[44:47], 0
    v_cndmask_b32 v118, 0, v6, s[52:53]
    v_cndmask_b32 v119, 0, v7, s[52:53]
    v_mfma_f32_16x16x32_bf16 v[218:221], v[96:99], v[46:49], 0
    s_waitcnt vmcnt(1)
    v_cvt_pk_bf16_f32 v100, v100, v101
    v_cvt_pk_bf16_f32 v101, v102, v103
    v_cndmask_b32 v102, 0, v2, s[52:53]
    v_cndmask_b32 v103, 0, v3, s[52:53]
    s_waitcnt vmcnt(0)
    v_cvt_pk_bf16_f32 v107, v106, v107
    v_cvt_pk_bf16_f32 v106, v104, v105
    v_cndmask_b32 v104, 0, v2, s[54:55]
    v_cndmask_b32 v105, 0, v3, s[54:55]
    v_mfma_f32_16x16x32_bf16 v[238:241], v[116:119], v[50:53], v[246:249]
    v_rcp_f32 v231, v231
    v_mfma_f32_16x16x32_bf16 v[242:245], v[114:117], v[52:55], v[246:249]
    v_rcp_f32 v237, v237
    v_mfma_f32_16x16x32_bf16 v[222:225], v[100:103], v[50:53], 0
    v_mul_f32 v214, v231, v214
    v_mul_f32 v215, v231, v215
    v_mfma_f32_16x16x32_bf16 v[226:229], v[104:107], v[52:55], 0
    v_mul_f32 v216, v231, v216
    v_mul_f32 v217, v231, v217
    v_mul_f32 v230, v231, v230
    v_mul_f32 v218, v237, v218
    v_mul_f32 v219, v237, v219
    v_mul_f32 v220, v237, v220
    v_mul_f32 v221, v237, v221
    v_mul_f32 v236, v237, v236
    v_cvt_pk_bf16_f32 v214, v214, v215
    v_cvt_pk_bf16_f32 v215, v216, v217
    v_cvt_pk_bf16_f32 v216, v218, v219
    v_cvt_pk_bf16_f32 v217, v220, v221
    v_cvt_pk_bf16_f32 v128, v230, v236
    buffer_store_dwordx4 v[214:217], v0, s[40:43], s30 offen offset:0 sc1
    v_mfma_f32_16x16x32_bf16 v[230:233], v[110:113], v[56:59], v[246:249]
    v_rcp_f32 v239, v239
    v_mfma_f32_16x16x32_bf16 v[234:237], v[108:111], v[58:61], v[246:249]
    v_rcp_f32 v245, v245
    v_mfma_f32_16x16x32_bf16 v[214:217], v[92:95], v[56:59], 0
    v_mul_f32 v222, v239, v222
    v_mul_f32 v223, v239, v223
    v_mfma_f32_16x16x32_bf16 v[218:221], v[96:99], v[58:61], 0
    v_mul_f32 v224, v239, v224
    v_mul_f32 v225, v239, v225
    v_mul_f32 v238, v239, v238
    v_mul_f32 v226, v245, v226
    v_mul_f32 v227, v245, v227
    v_mul_f32 v228, v245, v228
    v_mul_f32 v229, v245, v229
    v_mul_f32 v244, v245, v244
    v_cvt_pk_bf16_f32 v222, v222, v223
    v_cvt_pk_bf16_f32 v223, v224, v225
    v_cvt_pk_bf16_f32 v224, v226, v227
    v_cvt_pk_bf16_f32 v225, v228, v229
    v_cvt_pk_bf16_f32 v129, v238, v244
    v_mov_b32_dpp v130, v128 quad_perm:[1,1,3,3] row_mask:0xf bank_mask:0xf
    buffer_store_dwordx4 v[222:225], v0, s[40:43], s30 offen offset:1024 sc1
    v_mov_b32_dpp v131, v129 quad_perm:[1,1,3,3] row_mask:0xf bank_mask:0xf
    buffer_store_dwordx4 v[128:131], v16, s[40:43], s30 offen offset:2048 sc1
    s_add_u32 s30, s30, 40960
    buffer_atomic_add v11, v15, s[40:43], s7 offen offset:1024 sc1
    v_mfma_f32_16x16x32_bf16 v[238:241], v[116:119], v[62:65], v[246:249]
    v_rcp_f32 v231, v231
    v_mfma_f32_16x16x32_bf16 v[242:245], v[114:117], v[64:67], v[246:249]
    v_rcp_f32 v237, v237
    v_mfma_f32_16x16x32_bf16 v[222:225], v[100:103], v[62:65], 0
    v_mul_f32 v214, v231, v214
    v_mul_f32 v215, v231, v215
    v_mfma_f32_16x16x32_bf16 v[226:229], v[104:107], v[64:67], 0
    v_mul_f32 v216, v231, v216
    v_mul_f32 v217, v231, v217
    v_mul_f32 v230, v231, v230
    v_mul_f32 v218, v237, v218
    v_mul_f32 v219, v237, v219
    v_mul_f32 v220, v237, v220
    v_mul_f32 v221, v237, v221
    v_mul_f32 v236, v237, v236
    v_cvt_pk_bf16_f32 v214, v214, v215
    v_cvt_pk_bf16_f32 v215, v216, v217
    v_cvt_pk_bf16_f32 v216, v218, v219
    v_cvt_pk_bf16_f32 v217, v220, v221
    v_cvt_pk_bf16_f32 v132, v230, v236
    buffer_store_dwordx4 v[214:217], v0, s[40:43], s30 offen offset:0 sc1
    v_mfma_f32_16x16x32_bf16 v[230:233], v[110:113], v[68:71], v[246:249]
    v_rcp_f32 v239, v239
    v_mfma_f32_16x16x32_bf16 v[234:237], v[108:111], v[70:73], v[246:249]
    v_rcp_f32 v245, v245
    v_mfma_f32_16x16x32_bf16 v[214:217], v[92:95], v[68:71], 0
    v_mul_f32 v222, v239, v222
    v_mul_f32 v223, v239, v223
    v_mfma_f32_16x16x32_bf16 v[218:221], v[96:99], v[70:73], 0
    v_mul_f32 v224, v239, v224
    v_mul_f32 v225, v239, v225
    v_mul_f32 v238, v239, v238
    v_mul_f32 v226, v245, v226
    v_mul_f32 v227, v245, v227
    v_mul_f32 v228, v245, v228
    v_mul_f32 v229, v245, v229
    v_mul_f32 v244, v245, v244
    v_cvt_pk_bf16_f32 v222, v222, v223
    v_cvt_pk_bf16_f32 v223, v224, v225
    v_cvt_pk_bf16_f32 v224, v226, v227
    v_cvt_pk_bf16_f32 v225, v228, v229
    v_cvt_pk_bf16_f32 v133, v238, v244
    v_mov_b32_dpp v134, v132 quad_perm:[1,1,3,3] row_mask:0xf bank_mask:0xf
    buffer_store_dwordx4 v[222:225], v0, s[40:43], s30 offen offset:1024 sc1
    v_mov_b32_dpp v135, v133 quad_perm:[1,1,3,3] row_mask:0xf bank_mask:0xf
    buffer_store_dwordx4 v[132:135], v16, s[40:43], s30 offen offset:2048 sc1
    s_add_u32 s30, s30, 40960
    v_pk_fma_f32 v[162:163], v[182:183], v[208:209], v[162:163] op_sel:[0,1,0] op_sel_hi:[1,1,1]
    v_pk_fma_f32 v[164:165], v[184:185], v[208:209], v[164:165] op_sel:[0,1,0] op_sel_hi:[1,1,1]
    v_pk_mul_f32 v[24:25], v[162:163], v[212:213] op_sel:[0,1] op_sel_hi:[1,1]
    v_pk_fma_f32 v[20:21], v[162:163], v[204:205], s[60:61] op_sel:[0,1,0] op_sel_hi:[1,1,1]
    v_pk_mul_f32 v[26:27], v[164:165], v[212:213] op_sel:[0,1] op_sel_hi:[1,1]
    v_pk_fma_f32 v[22:23], v[164:165], v[204:205], s[60:61] op_sel:[0,1,0] op_sel_hi:[1,1,1]
    v_exp_f32 v24, v24 clamp
    v_exp_f32 v25, v25 clamp
    v_exp_f32 v26, v26 clamp
    v_exp_f32 v27, v27 clamp
    v_max_f32 v20, s60, v20
    v_max_f32 v21, s60, v21
    v_max_f32 v22, s60, v22
    v_max_f32 v23, s60, v23
    v_pk_add_f32 v[20:21], v[20:21], v[24:25]
    v_pk_add_f32 v[22:23], v[22:23], v[26:27]
    v_cvt_pk_bf16_f32 v80, v20, v21
    v_cvt_pk_bf16_f32 v81, v22, v23
    v_pk_fma_f32 v[166:167], v[186:187], v[208:209], v[166:167] op_sel:[0,1,0] op_sel_hi:[1,1,1]
    v_pk_fma_f32 v[168:169], v[188:189], v[208:209], v[168:169] op_sel:[0,1,0] op_sel_hi:[1,1,1]
    v_pk_mul_f32 v[32:33], v[166:167], v[212:213] op_sel:[0,1] op_sel_hi:[1,1]
    v_pk_fma_f32 v[28:29], v[166:167], v[204:205], s[60:61] op_sel:[0,1,0] op_sel_hi:[1,1,1]
    v_pk_mul_f32 v[34:35], v[168:169], v[212:213] op_sel:[0,1] op_sel_hi:[1,1]
    v_pk_fma_f32 v[30:31], v[168:169], v[204:205], s[60:61] op_sel:[0,1,0] op_sel_hi:[1,1,1]
    v_exp_f32 v32, v32 clamp
    v_exp_f32 v33, v33 clamp
    v_exp_f32 v34, v34 clamp
    v_exp_f32 v35, v35 clamp
    v_max_f32 v28, s60, v28
    v_max_f32 v29, s60, v29
    v_max_f32 v30, s60, v30
    v_max_f32 v31, s60, v31
    v_pk_add_f32 v[28:29], v[28:29], v[32:33]
    v_pk_add_f32 v[30:31], v[30:31], v[34:35]
    v_cvt_pk_bf16_f32 v84, v28, v29
    v_cvt_pk_bf16_f32 v85, v30, v31
    v_pk_fma_f32 v[170:171], v[190:191], v[208:209], v[170:171] op_sel:[0,1,0] op_sel_hi:[1,1,1]
    v_pk_fma_f32 v[172:173], v[192:193], v[208:209], v[172:173] op_sel:[0,1,0] op_sel_hi:[1,1,1]
    v_pk_mul_f32 v[40:41], v[170:171], v[212:213] op_sel:[0,1] op_sel_hi:[1,1]
    v_pk_fma_f32 v[36:37], v[170:171], v[204:205], s[60:61] op_sel:[0,1,0] op_sel_hi:[1,1,1]
    v_pk_mul_f32 v[42:43], v[172:173], v[212:213] op_sel:[0,1] op_sel_hi:[1,1]
    v_pk_fma_f32 v[38:39], v[172:173], v[204:205], s[60:61] op_sel:[0,1,0] op_sel_hi:[1,1,1]
    v_exp_f32 v40, v40 clamp
    v_exp_f32 v41, v41 clamp
    v_exp_f32 v42, v42 clamp
    v_exp_f32 v43, v43 clamp
    v_max_f32 v36, s60, v36
    v_max_f32 v37, s60, v37
    v_max_f32 v38, s60, v38
    v_max_f32 v39, s60, v39
    v_pk_add_f32 v[36:37], v[36:37], v[40:41]
    v_pk_add_f32 v[38:39], v[38:39], v[42:43]
    v_cvt_pk_bf16_f32 v86, v36, v37
    v_cvt_pk_bf16_f32 v87, v38, v39
    v_pk_fma_f32 v[174:175], v[194:195], v[208:209], v[174:175] op_sel:[0,1,0] op_sel_hi:[1,1,1]
    v_pk_fma_f32 v[176:177], v[196:197], v[208:209], v[176:177] op_sel:[0,1,0] op_sel_hi:[1,1,1]
    v_pk_mul_f32 v[24:25], v[174:175], v[212:213] op_sel:[0,1] op_sel_hi:[1,1]
    v_pk_fma_f32 v[20:21], v[174:175], v[204:205], s[60:61] op_sel:[0,1,0] op_sel_hi:[1,1,1]
    v_pk_mul_f32 v[26:27], v[176:177], v[212:213] op_sel:[0,1] op_sel_hi:[1,1]
    v_pk_fma_f32 v[22:23], v[176:177], v[204:205], s[60:61] op_sel:[0,1,0] op_sel_hi:[1,1,1]
    v_exp_f32 v24, v24 clamp
    v_exp_f32 v25, v25 clamp
    v_exp_f32 v26, v26 clamp
    v_exp_f32 v27, v27 clamp
    v_max_f32 v20, s60, v20
    v_max_f32 v21, s60, v21
    v_max_f32 v22, s60, v22
    v_max_f32 v23, s60, v23
    v_pk_add_f32 v[20:21], v[20:21], v[24:25]
    v_pk_add_f32 v[22:23], v[22:23], v[26:27]
    v_cvt_pk_bf16_f32 v90, v20, v21
    v_cvt_pk_bf16_f32 v91, v22, v23
    v_pk_fma_f32 v[178:179], v[198:199], v[208:209], v[178:179] op_sel:[0,1,0] op_sel_hi:[1,1,1]
    v_pk_fma_f32 v[180:181], v[200:201], v[208:209], v[180:181] op_sel:[0,1,0] op_sel_hi:[1,1,1]
    v_pk_mul_f32 v[32:33], v[178:179], v[212:213] op_sel:[0,1] op_sel_hi:[1,1]
    v_pk_fma_f32 v[28:29], v[178:179], v[204:205], s[60:61] op_sel:[0,1,0] op_sel_hi:[1,1,1]
    v_pk_mul_f32 v[34:35], v[180:181], v[212:213] op_sel:[0,1] op_sel_hi:[1,1]
    v_pk_fma_f32 v[30:31], v[180:181], v[204:205], s[60:61] op_sel:[0,1,0] op_sel_hi:[1,1,1]
    v_exp_f32 v32, v32 clamp
    v_exp_f32 v33, v33 clamp
    v_exp_f32 v34, v34 clamp
    v_exp_f32 v35, v35 clamp
    v_max_f32 v28, s60, v28
    v_max_f32 v29, s60, v29
    v_max_f32 v30, s60, v30
    v_max_f32 v31, s60, v31
    v_pk_add_f32 v[28:29], v[28:29], v[32:33]
    v_pk_add_f32 v[30:31], v[30:31], v[34:35]
    v_cvt_pk_bf16_f32 v82, v28, v29
    v_cvt_pk_bf16_f32 v83, v30, v31
    v_mov_b32 v88, v82
    v_mov_b32 v89, v83
    v_mfma_f32_16x16x32_bf16 v[238:241], v[116:119], v[74:77], v[246:249]
    v_rcp_f32 v231, v231
    v_mfma_f32_16x16x32_bf16 v[242:245], v[114:117], v[76:79], v[246:249]
    v_rcp_f32 v237, v237
    v_mfma_f32_16x16x32_bf16 v[222:225], v[100:103], v[74:77], 0
    v_mul_f32 v214, v231, v214
    v_mul_f32 v215, v231, v215
    v_mfma_f32_16x16x32_bf16 v[226:229], v[104:107], v[76:79], 0
    v_mul_f32 v216, v231, v216
    v_mul_f32 v217, v231, v217
    v_mul_f32 v230, v231, v230
    v_mul_f32 v218, v237, v218
    v_mul_f32 v219, v237, v219
    v_mul_f32 v220, v237, v220
    v_mul_f32 v221, v237, v221
    v_mul_f32 v236, v237, v236
    v_cvt_pk_bf16_f32 v214, v214, v215
    v_cvt_pk_bf16_f32 v215, v216, v217
    v_cvt_pk_bf16_f32 v216, v218, v219
    v_cvt_pk_bf16_f32 v217, v220, v221
    v_cvt_pk_bf16_f32 v128, v230, v236
    buffer_store_dwordx4 v[214:217], v0, s[40:43], s30 offen offset:0 sc1
    v_mfma_f32_16x16x32_bf16 v[230:233], v[110:113], v[80:83], v[246:249]
    v_rcp_f32 v239, v239
    v_mfma_f32_16x16x32_bf16 v[234:237], v[108:111], v[82:85], v[246:249]
    v_rcp_f32 v245, v245
    v_mfma_f32_16x16x32_bf16 v[214:217], v[92:95], v[80:83], 0
    v_mul_f32 v222, v239, v222
    v_mul_f32 v223, v239, v223
    v_mfma_f32_16x16x32_bf16 v[218:221], v[96:99], v[82:85], 0
    v_mul_f32 v224, v239, v224
    v_mul_f32 v225, v239, v225
    v_mul_f32 v238, v239, v238
    v_mul_f32 v226, v245, v226
    v_mul_f32 v227, v245, v227
    v_mul_f32 v228, v245, v228
    v_mul_f32 v229, v245, v229
    v_mul_f32 v244, v245, v244
    v_cvt_pk_bf16_f32 v222, v222, v223
    v_cvt_pk_bf16_f32 v223, v224, v225
    v_cvt_pk_bf16_f32 v224, v226, v227
    v_cvt_pk_bf16_f32 v225, v228, v229
    v_cvt_pk_bf16_f32 v129, v238, v244
    v_mov_b32_dpp v130, v128 quad_perm:[1,1,3,3] row_mask:0xf bank_mask:0xf
    buffer_store_dwordx4 v[222:225], v0, s[40:43], s30 offen offset:1024 sc1
    v_mov_b32_dpp v131, v129 quad_perm:[1,1,3,3] row_mask:0xf bank_mask:0xf
    buffer_store_dwordx4 v[128:131], v16, s[40:43], s30 offen offset:2048 sc1
    s_add_u32 s30, s30, 40960
    v_mfma_f32_16x16x32_bf16 v[238:241], v[116:119], v[86:89], v[246:249]
    v_rcp_f32 v231, v231
    v_mfma_f32_16x16x32_bf16 v[242:245], v[114:117], v[88:91], v[246:249]
    v_rcp_f32 v237, v237
    v_mfma_f32_16x16x32_bf16 v[222:225], v[100:103], v[86:89], 0
    v_mul_f32 v214, v231, v214
    v_mul_f32 v215, v231, v215
    v_mfma_f32_16x16x32_bf16 v[226:229], v[104:107], v[88:91], 0
    v_mul_f32 v216, v231, v216
    v_mul_f32 v217, v231, v217
    v_mul_f32 v230, v231, v230
    v_mul_f32 v218, v237, v218
    v_mul_f32 v219, v237, v219
    v_mul_f32 v220, v237, v220
    v_mul_f32 v221, v237, v221
    v_mul_f32 v236, v237, v236
    v_cvt_pk_bf16_f32 v214, v214, v215
    v_cvt_pk_bf16_f32 v215, v216, v217
    v_cvt_pk_bf16_f32 v216, v218, v219
Lwq_3:
    s_cbranch_execz Lwq_4
    v_cvt_pk_bf16_f32 v217, v220, v221
    v_cvt_pk_bf16_f32 v132, v230, v236
    buffer_store_dwordx4 v[214:217], v0, s[40:43], s30 offen offset:0 sc1
    v_rcp_f32 v239, v239
    v_rcp_f32 v245, v245
    v_mul_f32 v222, v239, v222
    v_mul_f32 v223, v239, v223
    v_mul_f32 v224, v239, v224
    v_mul_f32 v225, v239, v225
    v_mul_f32 v238, v239, v238
    v_mul_f32 v226, v245, v226
    v_mul_f32 v227, v245, v227
    v_mul_f32 v228, v245, v228
    v_mul_f32 v229, v245, v229
    v_mul_f32 v244, v245, v244
    v_cvt_pk_bf16_f32 v222, v222, v223
    v_cvt_pk_bf16_f32 v223, v224, v225
    v_cvt_pk_bf16_f32 v224, v226, v227
    v_cvt_pk_bf16_f32 v225, v228, v229
    v_cvt_pk_bf16_f32 v133, v238, v244
    v_mov_b32_dpp v134, v132 quad_perm:[1,1,3,3] row_mask:0xf bank_mask:0xf
    buffer_store_dwordx4 v[222:225], v0, s[40:43], s30 offen offset:1024 sc1
    v_mov_b32_dpp v135, v133 quad_perm:[1,1,3,3] row_mask:0xf bank_mask:0xf
    buffer_store_dwordx4 v[132:135], v16, s[40:43], s30 offen offset:2048 sc1
    s_add_u32 s30, s30, 40960
    v_mov_b32 v11, 1
    v_mov_b32 v9, 0x40000000
    v_cmp_eq_i32 s[100:101], v1, 0
    s_nop 1
    v_cndmask_b32 v15, v9, 0, s[100:101]
    s_lshl_b32 s55, s16, 3
    s_add_u32 s55, s55, s23
    s_mul_i32 s52, s55, 20
    s_lshl_b32 s51, s24, 2
    s_add_u32 s52, s52, s51
    s_add_u32 s52, s52, s3
    s_lshl_b32 s52, s52, 10
    s_add_u32 s52, s52, 4194304
    s_mul_i32 s58, s16, 6144
    s_lshl_b32 s51, s3, 7
    s_add_u32 s58, s58, s51
    s_add_u32 s58, s58, 22021632
    s_cmp_ge_u32 s17, 10
    s_cselect_b32 s52, 1073741824, s52
    s_cselect_b32 s58, 1073741824, s58
    s_add_u32 s63, s52, 40960
    v_mov_b32 v34, -1
    v_mov_b32 v35, -1
    v_mov_b32 v36, -1
    v_mov_b32 v37, -1
    buffer_store_dwordx4 v[34:37], v0, s[40:43], s52 offen sc1
    buffer_store_dwordx4 v[34:37], v0, s[40:43], s63 offen sc1
    v_lshlrev_b32 v10, 3, v1
    v_lshlrev_b32 v9, 7, v1
    v_mov_b32 v8, 0x40000000
    v_cmp_lt_i32 s[100:101], v1, 12
    s_nop 1
    v_cndmask_b32 v30, v8, v9, s[100:101]
    s_mul_i32 s50, s3, 5120
    v_add_u32 v13, s50, v0
    v_and_b32 v9, 15, v1
    v_lshlrev_b32 v9, 3, v9
    v_lshrrev_b32 v8, 5, v1
    v_lshlrev_b32 v8, 2, v8
    v_add_u32 v8, v9, v8
    v_mov_b32 v9, 0x40000000
    v_and_b32 v7, 16, v1
    v_cmp_eq_i32 s[100:101], v7, 0
    s_nop 1
    v_cndmask_b32 v14, v9, v8, s[100:101]
    buffer_load_dwordx4 a[208:211], v0, s[40:43], s21 offen offset:0 sc1
    s_lshl_b32 s51, s24, 2
    s_add_u32 s51, s51, s3
    s_lshl_b32 s51, s51, 6
    v_lshrrev_b32 v9, 2, v1
    v_mul_u32_u24 v9, 0x500, v9
    v_and_b32 v8, 3, v1
    v_lshlrev_b32 v8, 4, v8
    v_add_u32 v8, v9, v8
    buffer_load_dwordx4 a[212:215], v0, s[40:43], s21 offen offset:1024 sc1
    v_add_u32 v16, s51, v8
    s_lshl_b32 s31, s3, 12
    s_add_u32 s31, s31, 143360
    v_and_b32 v9, 15, v1
    v_lshlrev_b32 v9, 6, v9
    v_lshrrev_b32 v8, 4, v1
    v_lshlrev_b32 v8, 4, v8
    v_add_u32 v8, v9, v8
    buffer_load_dwordx4 a[216:219], v0, s[40:43], s21 offen offset:2048 sc1
    v_add_u32 v17, s31, v8
    v_lshlrev_b32 v9, 7, v1
    v_mov_b32 v8, 0x40000000
    v_cmp_lt_i32 s[100:101], v1, 4
    s_nop 1
    v_cndmask_b32 v19, v8, v9, s[100:101]
    v_add_u32 v20, s28, v0
    s_lshl_b32 s51, s3, 12
    s_add_u32 s51, s51, 143360
    v_and_b32 v9, 15, v1
    buffer_load_dwordx4 a[220:223], v0, s[40:43], s21 offen offset:3072 sc1
    s_add_u32 s21, s21, 4096
    v_lshlrev_b32 v9, 4, v9
    v_add_u32 v21, s51, v9
    v_and_b32 v9, 15, v1
    v_mul_u32_u24 v9, 48, v9
    v_add_u32 v9, s51, v9
    v_add_u32 v22, 0xa00, v9
    v_lshrrev_b32 v9, 4, v1
    v_lshlrev_b32 v9, 3, v9
    buffer_load_dwordx4 a[224:227], v0, s[40:43], s21 offen offset:0 sc1
    v_add_u32 v23, v22, v9
    v_add_u32 v9, 32, v22
    v_lshrrev_b32 v8, 4, v1
    v_lshlrev_b32 v8, 2, v8
    v_add_u32 v24, v9, v8
    v_lshrrev_b32 v9, 4, v1
    v_min_u32 v9, 2, v9
    v_lshlrev_b32 v9, 4, v9
    buffer_load_dwordx4 a[228:231], v0, s[40:43], s21 offen offset:1024 sc1
    v_add_u32 v22, v22, v9
    v_mov_b32 v9, 0x40000000
    v_cmp_lt_i32 s[100:101], v1, 48
    s_nop 1
    v_cndmask_b32 v25, v9, v0, s[100:101]
    s_mul_i32 s48, s18, 6144
    s_add_u32 s48, s48, 22020096
    s_mul_i32 s49, s18, 163840
    s_add_u32 s49, s49, s50
    s_add_u32 s49, s49, 4194304
    s_mul_i32 s51, s3, 5376
    s_add_u32 s51, s51, 81920
    v_and_b32 v9, 15, v1
    buffer_load_dwordx4 a[232:235], v0, s[40:43], s21 offen offset:2048 sc1
    v_mul_u32_u24 v9, 0x150, v9
    v_lshrrev_b32 v8, 4, v1
    v_lshlrev_b32 v8, 4, v8
    v_add_u32 v8, v9, v8
    v_add_u32 v26, s51, v8
    v_mul_u32_u24 v9, 0x199a, v1
    v_lshrrev_b32 v32, 16, v9
    v_mul_u32_u24 v9, 10, v32
    buffer_load_dwordx4 a[236:239], v0, s[40:43], s21 offen offset:3072 sc1
    s_add_u32 s21, s21, 4096
    v_sub_u32 v33, v1, v9
    s_lshl_b32 s51, s3, 2
    v_min_u32 v9, 3, v32
    v_add_u32 v32, s51, v9
    v_mul_u32_u24 v9, 0x150, v32
    v_lshlrev_b32 v8, 5, v33
    v_add_u32 v8, v9, v8
    v_add_u32 v27, 0x14000, v8
    s_waitcnt vmcnt(8)
    buffer_atomic_add v11, v15, s[40:43], s58 offen offset:0 sc1
    s_add_u32 s58, s58, 512
    s_and_b32 s51, s29, 7
    s_mul_i32 s51, s51, 10
    v_add_u32 v33, s51, v33
    s_lshl_b32 s51, s51, 8
    s_lshl_b32 s53, s3, 6
    s_add_u32 s51, s51, s53
    v_lshrrev_b32 v9, 2, v1
    v_lshlrev_b32 v9, 8, v9
    buffer_load_dwordx4 a[240:243], v0, s[40:43], s21 offen offset:0 sc1
    v_and_b32 v8, 3, v1
    v_lshlrev_b32 v8, 4, v8
    v_add_u32 v8, v9, v8
    v_add_u32 v8, s51, v8
    v_mov_b32 v9, 0x40000000
    v_cmp_lt_i32 s[100:101], v1, 40
    s_nop 1
    v_cndmask_b32 v28, v9, v8, s[100:101]
    v_mul_u32_u24 v9, 0x500, v32
    buffer_load_dwordx4 a[244:247], v0, s[40:43], s21 offen offset:1024 sc1
    v_lshlrev_b32 v8, 4, v33
    v_add_u32 v8, v9, v8
    v_mov_b32 v9, 0x40000000
    v_cmp_lt_i32 s[100:101], v1, 40
    s_nop 1
    v_cndmask_b32 v29, v9, v8, s[100:101]
    v_mul_u32_u24 v9, 0x300, v1
    v_add_u32 v9, 0x2fc, v9
    v_mov_b32 v8, 0x40000000
    buffer_load_dwordx4 a[248:251], v0, s[40:43], s21 offen offset:2048 sc1
    v_cmp_lt_i32 s[100:101], v1, 16
    s_nop 1
    v_cndmask_b32 v31, v8, v9, s[100:101]
    buffer_load_dwordx4 a[252:255], v0, s[40:43], s21 offen offset:3072 sc1
    s_add_u32 s21, s21, 4096
    buffer_load_dwordx4 v[168:171], v0, s[40:43], s21 offen offset:0 sc1
    buffer_load_dwordx4 v[172:175], v0, s[40:43], s21 offen offset:1024 sc1
    buffer_load_dwordx4 v[176:179], v0, s[40:43], s21 offen offset:2048 sc1
    buffer_load_dwordx4 v[180:183], v0, s[40:43], s21 offen offset:3072 sc1
    s_add_u32 s21, s21, 4096
    buffer_load_dwordx4 v[184:187], v0, s[40:43], s21 offen offset:0 sc1
    buffer_load_dwordx4 v[188:191], v0, s[40:43], s21 offen offset:1024 sc1
    buffer_load_dwordx4 v[192:195], v0, s[40:43], s21 offen offset:2048 sc1
    buffer_load_dwordx4 v[196:199], v0, s[40:43], s21 offen offset:3072 sc1
    s_add_u32 s21, s21, 4096
    buffer_load_dwordx4 v[200:203], v0, s[40:43], s21 offen offset:0 sc1
    buffer_load_dwordx4 v[204:207], v0, s[40:43], s21 offen offset:1024 sc1
    buffer_load_dwordx4 v[208:211], v0, s[40:43], s21 offen offset:2048 sc1
    buffer_load_dwordx4 v[212:215], v0, s[40:43], s21 offen offset:3072 sc1
    s_add_u32 s21, s21, 4096
    buffer_load_dwordx4 v[216:219], v0, s[40:43], s21 offen offset:0 sc1
    buffer_load_dwordx4 v[220:223], v0, s[40:43], s21 offen offset:1024 sc1
    buffer_load_dwordx4 v[224:227], v0, s[40:43], s21 offen offset:2048 sc1
    buffer_load_dwordx4 v[228:231], v0, s[40:43], s21 offen offset:3072 sc1
    s_add_u32 s21, s21, 4096
    buffer_load_dwordx4 v[232:235], v0, s[40:43], s21 offen offset:0 sc1
    buffer_load_dwordx4 v[236:239], v0, s[40:43], s21 offen offset:1024 sc1
    buffer_load_dwordx4 v[240:243], v0, s[40:43], s21 offen offset:2048 sc1
    buffer_load_dwordx4 v[244:247], v0, s[40:43], s21 offen offset:3072 sc1
    s_add_u32 s21, s21, 4096
    buffer_load_dwordx4 v[248:251], v0, s[40:43], s21 offen offset:0 sc1
    buffer_load_dwordx4 v[252:255], v0, s[40:43], s21 offen offset:1024 sc1
    buffer_load_dwordx4 v[112:115], v0, s[40:43], s21 offen offset:2048 sc1
    buffer_load_dwordx4 v[116:119], v0, s[40:43], s21 offen offset:3072 sc1
    s_add_u32 s21, s21, 4096
    buffer_load_dwordx4 v[120:123], v0, s[40:43], s21 offen offset:0 sc1
    buffer_load_dwordx4 v[124:127], v0, s[40:43], s21 offen offset:1024 sc1
    buffer_load_dwordx4 v[128:131], v0, s[40:43], s21 offen offset:2048 sc1
    buffer_load_dwordx4 v[132:135], v0, s[40:43], s21 offen offset:3072 sc1
    s_add_u32 s21, s21, 4096
    buffer_load_dwordx4 v[136:139], v0, s[40:43], s21 offen offset:0 sc1
    buffer_load_dwordx4 v[140:143], v0, s[40:43], s21 offen offset:1024 sc1
    buffer_load_dwordx4 v[144:147], v0, s[40:43], s21 offen offset:2048 sc1
    buffer_load_dwordx4 v[148:151], v0, s[40:43], s21 offen offset:3072 sc1
    s_add_u32 s21, s21, 4096
    buffer_load_dwordx4 v[152:155], v0, s[40:43], s21 offen offset:0 sc1
    buffer_load_dwordx4 v[156:159], v0, s[40:43], s21 offen offset:1024 sc1
    buffer_load_dwordx4 v[160:163], v0, s[40:43], s21 offen offset:2048 sc1
    buffer_load_dwordx4 v[164:167], v0, s[40:43], s21 offen offset:3072 sc1
    s_add_u32 s21, s21, 4096
    s_lshl_b32 s30, s18, 7
    s_add_u32 s30, s30, s19
    s_lshl_b32 s30, s30, 2
    s_add_u32 s30, s30, s3
    s_mul_i32 s30, s30, 768
    s_add_u32 s30, s30, 7536640
    v_mov_b32 v6, -1
    v_mov_b32 v7, -1
    v_mov_b32 v8, -1
    v_mov_b32 v9, -1
    v_add_u32 v5, 81920, v13
    s_branch LidleQ
Lhelper:
    s_lshl_b32 s48, s4, 2
    s_add_u32 s48, s48, s5
    s_sub_u32 s48, s48, 12
    v_lshrrev_b32 v9, 3, v1
    v_mul_u32_u24 v9, 0x500, v9
    v_and_b32 v8, 7, v1
    v_lshlrev_b32 v8, 4, v8
    v_add_u32 v10, v9, v8
    s_lshl_b32 s49, s48, 2
    s_add_u32 s49, s49, s3
    s_mul_i32 s50, s49, 10240
    s_lshl_b32 s52, s3, 6
    s_add_u32 s52, s52, s48
    s_waitcnt lgkmcnt(0)
    buffer_load_dwordx4 v[16:19], v10, s[8:11], s50 offen offset:0
    buffer_load_dwordx4 v[20:23], v10, s[8:11], s50 offen offset:128
    buffer_load_dwordx4 v[24:27], v10, s[8:11], s50 offen offset:256
    buffer_load_dwordx4 v[28:31], v10, s[8:11], s50 offen offset:384
    buffer_load_dwordx4 v[32:35], v10, s[8:11], s50 offen offset:512
    buffer_load_dwordx4 v[36:39], v10, s[8:11], s50 offen offset:640
    buffer_load_dwordx4 v[40:43], v10, s[8:11], s50 offen offset:768
    buffer_load_dwordx4 v[44:47], v10, s[8:11], s50 offen offset:896
    buffer_load_dwordx4 v[48:51], v10, s[8:11], s50 offen offset:1024
    buffer_load_dwordx4 v[52:55], v10, s[8:11], s50 offen offset:1152
    v_lshlrev_b32 v0, 4, v1
    s_mov_b32 s18, 819200
    s_mov_b32 s19, 0x20000
    s_mov_b32 s22, 1966080
    s_mov_b32 s23, 0x20000
    s_mov_b32 s26, 1966080
    s_mov_b32 s27, 0x20000
    s_mov_b64 s[32:33], s[90:91]
    s_mov_b64 s[36:37], s[92:93]
    s_mov_b64 s[40:41], s[94:95]
    s_mov_b32 s34, 2621440
    s_mov_b32 s35, 0x20000
    s_mov_b32 s38, 256
    s_mov_b32 s39, 0x20000
    s_mov_b32 s42, 25165824
    s_mov_b32 s43, 0x20000
    s_mov_b32 s6, 400000
    s_mov_b64 s[16:17], s[80:81]
    s_mov_b64 s[20:21], s[84:85]
    s_mov_b64 s[24:25], s[86:87]
    s_mov_b64 exec, 0
    s_call_b64 s[98:99], Lwh_0
    s_mov_b64 exec, -1
    v_mov_b32 v12, 0
    v_mov_b32 v13, 0
    v_mov_b32 v14, 0
    v_mov_b32 v15, 0
    v_lshlrev_b32 v9, 4, v1
    v_mov_b32 v8, 0x40000000
    v_cmp_lt_i32 s[100:101], v1, 21
    s_nop 1
    v_cndmask_b32 v11, v8, v9, s[100:101]
    s_mul_i32 s59, s49, 336
    s_add_u32 s59, s59, 16384
    buffer_store_dwordx4 v[12:15], v11, s[40:43], s59 offen sc1
    v_lshlrev_b32 v9, 4, v1
    v_mov_b32 v8, 0x40000000
    v_cmp_lt_i32 s[100:101], v1, 24
    s_nop 1
    v_cndmask_b32 v11, v8, v9, s[100:101]
    s_mul_i32 s59, s49, 384
    s_add_u32 s59, s59, 22020096
    buffer_store_dwordx4 v[12:15], v11, s[40:43], s59 offen sc1
    v_lshlrev_b32 v9, 4, v1
    v_mov_b32 v8, 0x40000000
    v_cmp_lt_i32 s[100:101], v1, 8
    s_nop 1
    v_cndmask_b32 v11, v8, v9, s[100:101]
    s_lshl_b32 s53, s52, 7
    s_add_u32 s53, s53, 655360
    buffer_store_dwordx4 v[12:15], v11, s[40:43], s53 offen sc1
    s_sub_u32 s51, s52, 216
    s_cmp_lt_u32 s52, 160
    s_cbranch_scc1 Lh13
    s_cmp_lt_i32 s51, 0
    s_cbranch_scc1 Lh2
    s_add_u32 s53, s53, 5120
    buffer_store_dwordx4 v[12:15], v11, s[40:43], s53 offen sc1
    s_mul_i32 s55, s3, 40960
    s_add_u32 s55, s55, 0
    v_lshrrev_b32 v9, 3, v1
    v_mul_u32_u24 v9, 0x500, v9
    v_and_b32 v8, 7, v1
    v_lshlrev_b32 v8, 4, v8
    v_add_u32 v64, v9, v8
    s_and_b32 s57, s51, 3
    s_lshr_b32 s58, s51, 2
    s_mul_i32 s54, s57, 204800
    s_lshl_b32 s56, s58, 7
    s_add_u32 s54, s54, s56
    s_add_u32 m0, s55, 0
    s_nop 0
    buffer_load_dwordx4 v64, s[16:19], s54 offen lds
    s_add_u32 s54, s54, 10240
    s_add_u32 m0, s55, 1024
    s_nop 0
    buffer_load_dwordx4 v64, s[16:19], s54 offen lds
    s_add_u32 s54, s54, 10240
    s_add_u32 m0, s55, 2048
    s_nop 0
    buffer_load_dwordx4 v64, s[16:19], s54 offen lds
    s_add_u32 s54, s54, 10240
    s_add_u32 m0, s55, 3072
    s_nop 0
    buffer_load_dwordx4 v64, s[16:19], s54 offen lds
    s_add_u32 s54, s54, 10240
    s_add_u32 m0, s55, 4096
    s_nop 0
    buffer_load_dwordx4 v64, s[16:19], s54 offen lds
    s_add_u32 s54, s54, 10240
    s_add_u32 m0, s55, 5120
    s_nop 0
    buffer_load_dwordx4 v64, s[16:19], s54 offen lds
    s_add_u32 s54, s54, 10240
    s_add_u32 m0, s55, 6144
    s_nop 0
    buffer_load_dwordx4 v64, s[16:19], s54 offen lds
    s_add_u32 s54, s54, 10240
    s_add_u32 m0, s55, 7168
    s_nop 0
    buffer_load_dwordx4 v64, s[16:19], s54 offen lds
    s_add_u32 s54, s54, 10240
    s_add_u32 m0, s55, 8192
    s_nop 0
    buffer_load_dwordx4 v64, s[16:19], s54 offen lds
    s_add_u32 s54, s54, 10240
    s_add_u32 m0, s55, 9216
    s_nop 0
    buffer_load_dwordx4 v64, s[16:19], s54 offen lds
    s_add_u32 s54, s54, 10240
    s_add_u32 m0, s55, 10240
    s_nop 0
    buffer_load_dwordx4 v64, s[16:19], s54 offen lds
    s_add_u32 s54, s54, 10240
    s_add_u32 m0, s55, 11264
    s_nop 0
    buffer_load_dwordx4 v64, s[16:19], s54 offen lds
    s_add_u32 s54, s54, 10240
    s_add_u32 m0, s55, 12288
    s_nop 0
    buffer_load_dwordx4 v64, s[16:19], s54 offen lds
    s_add_u32 s54, s54, 10240
    s_add_u32 m0, s55, 13312
    s_nop 0
    buffer_load_dwordx4 v64, s[16:19], s54 offen lds
    s_add_u32 s54, s54, 10240
    s_add_u32 m0, s55, 14336
    s_nop 0
    buffer_load_dwordx4 v64, s[16:19], s54 offen lds
    s_add_u32 s54, s54, 10240
    s_add_u32 m0, s55, 15360
    s_nop 0
    buffer_load_dwordx4 v64, s[16:19], s54 offen lds
    s_add_u32 s54, s54, 10240
    s_add_u32 m0, s55, 16384
    s_nop 0
    buffer_load_dwordx4 v64, s[16:19], s54 offen lds
    s_add_u32 s54, s54, 10240
    s_add_u32 m0, s55, 17408
    s_nop 0
    buffer_load_dwordx4 v64, s[16:19], s54 offen lds
    s_add_u32 s54, s54, 10240
    s_add_u32 m0, s55, 18432
    s_nop 0
    buffer_load_dwordx4 v64, s[16:19], s54 offen lds
    s_add_u32 s54, s54, 10240
    s_add_u32 m0, s55, 19456
    s_nop 0
    buffer_load_dwordx4 v64, s[16:19], s54 offen lds
    s_add_u32 s54, s54, 10240
    v_mov_b32 v60, 0
    v_mov_b32 v61, 0
    v_mov_b32 v62, 0x3f803f80
    s_waitcnt vmcnt(33)
    v_dot2_f32_bf16 v60, v16, v62, v60
    v_dot2_f32_bf16 v61, v16, v16, v61
    v_dot2_f32_bf16 v60, v17, v62, v60
    v_dot2_f32_bf16 v61, v17, v17, v61
    v_dot2_f32_bf16 v60, v18, v62, v60
    v_dot2_f32_bf16 v61, v18, v18, v61
    v_dot2_f32_bf16 v60, v19, v62, v60
    v_dot2_f32_bf16 v61, v19, v19, v61
    s_waitcnt vmcnt(32)
    v_dot2_f32_bf16 v60, v20, v62, v60
    v_dot2_f32_bf16 v61, v20, v20, v61
    v_dot2_f32_bf16 v60, v21, v62, v60
    v_dot2_f32_bf16 v61, v21, v21, v61
    v_dot2_f32_bf16 v60, v22, v62, v60
    v_dot2_f32_bf16 v61, v22, v22, v61
    v_dot2_f32_bf16 v60, v23, v62, v60
    v_dot2_f32_bf16 v61, v23, v23, v61
    s_waitcnt vmcnt(31)
    v_dot2_f32_bf16 v60, v24, v62, v60
    v_dot2_f32_bf16 v61, v24, v24, v61
    v_dot2_f32_bf16 v60, v25, v62, v60
    v_dot2_f32_bf16 v61, v25, v25, v61
    v_dot2_f32_bf16 v60, v26, v62, v60
    v_dot2_f32_bf16 v61, v26, v26, v61
    v_dot2_f32_bf16 v60, v27, v62, v60
    v_dot2_f32_bf16 v61, v27, v27, v61
    s_waitcnt vmcnt(30)
    v_dot2_f32_bf16 v60, v28, v62, v60
    v_dot2_f32_bf16 v61, v28, v28, v61
    v_dot2_f32_bf16 v60, v29, v62, v60
    v_dot2_f32_bf16 v61, v29, v29, v61
    v_dot2_f32_bf16 v60, v30, v62, v60
    v_dot2_f32_bf16 v61, v30, v30, v61
    v_dot2_f32_bf16 v60, v31, v62, v60
    v_dot2_f32_bf16 v61, v31, v31, v61
    s_waitcnt vmcnt(29)
    v_dot2_f32_bf16 v60, v32, v62, v60
    v_dot2_f32_bf16 v61, v32, v32, v61
    v_dot2_f32_bf16 v60, v33, v62, v60
    v_dot2_f32_bf16 v61, v33, v33, v61
    v_dot2_f32_bf16 v60, v34, v62, v60
    v_dot2_f32_bf16 v61, v34, v34, v61
    v_dot2_f32_bf16 v60, v35, v62, v60
    v_dot2_f32_bf16 v61, v35, v35, v61
    s_waitcnt vmcnt(28)
    v_dot2_f32_bf16 v60, v36, v62, v60
    v_dot2_f32_bf16 v61, v36, v36, v61
    v_dot2_f32_bf16 v60, v37, v62, v60
    v_dot2_f32_bf16 v61, v37, v37, v61
    v_dot2_f32_bf16 v60, v38, v62, v60
    v_dot2_f32_bf16 v61, v38, v38, v61
    v_dot2_f32_bf16 v60, v39, v62, v60
    v_dot2_f32_bf16 v61, v39, v39, v61
    s_waitcnt vmcnt(27)
    v_dot2_f32_bf16 v60, v40, v62, v60
    v_dot2_f32_bf16 v61, v40, v40, v61
    v_dot2_f32_bf16 v60, v41, v62, v60
    v_dot2_f32_bf16 v61, v41, v41, v61
    v_dot2_f32_bf16 v60, v42, v62, v60
    v_dot2_f32_bf16 v61, v42, v42, v61
    v_dot2_f32_bf16 v60, v43, v62, v60
    v_dot2_f32_bf16 v61, v43, v43, v61
    s_waitcnt vmcnt(26)
    v_dot2_f32_bf16 v60, v44, v62, v60
    v_dot2_f32_bf16 v61, v44, v44, v61
    v_dot2_f32_bf16 v60, v45, v62, v60
    v_dot2_f32_bf16 v61, v45, v45, v61
    v_dot2_f32_bf16 v60, v46, v62, v60
    v_dot2_f32_bf16 v61, v46, v46, v61
    v_dot2_f32_bf16 v60, v47, v62, v60
    v_dot2_f32_bf16 v61, v47, v47, v61
    s_waitcnt vmcnt(25)
    v_dot2_f32_bf16 v60, v48, v62, v60
    v_dot2_f32_bf16 v61, v48, v48, v61
    v_dot2_f32_bf16 v60, v49, v62, v60
    v_dot2_f32_bf16 v61, v49, v49, v61
    v_dot2_f32_bf16 v60, v50, v62, v60
    v_dot2_f32_bf16 v61, v50, v50, v61
    v_dot2_f32_bf16 v60, v51, v62, v60
    v_dot2_f32_bf16 v61, v51, v51, v61
    s_waitcnt vmcnt(24)
    v_dot2_f32_bf16 v60, v52, v62, v60
    v_dot2_f32_bf16 v61, v52, v52, v61
    v_dot2_f32_bf16 v60, v53, v62, v60
    v_dot2_f32_bf16 v61, v53, v53, v61
    v_dot2_f32_bf16 v60, v54, v62, v60
    v_dot2_f32_bf16 v61, v54, v54, v61
    v_dot2_f32_bf16 v60, v55, v62, v60
    v_dot2_f32_bf16 v61, v55, v55, v61
    s_nop 1
    v_add_f32_dpp v60, v60, v60 quad_perm:[1,0,3,2] row_mask:0xf bank_mask:0xf
    v_add_f32_dpp v61, v61, v61 quad_perm:[1,0,3,2] row_mask:0xf bank_mask:0xf
    s_nop 0
    v_add_f32_dpp v60, v60, v60 quad_perm:[2,3,0,1] row_mask:0xf bank_mask:0xf
    v_add_f32_dpp v61, v61, v61 quad_perm:[2,3,0,1] row_mask:0xf bank_mask:0xf
    s_nop 0
    v_add_f32_dpp v60, v60, v60 row_half_mirror row_mask:0xf bank_mask:0xf
    v_add_f32_dpp v61, v61, v61 row_half_mirror row_mask:0xf bank_mask:0xf
    v_mul_f32 v60, 0xbacccccd, v60
    v_mul_f32 v61, 0x3acccccd, v61
    v_fma_f32 v61, -v60, v60, v61
    v_max_f32 v61, 0, v61
    v_add_f32 v61, 0x3727c5ac, v61
    v_rsq_f32 v61, v61
    v_and_b32 v9, 7, v1
    v_lshlrev_b32 v9, 13, v9
    v_lshrrev_b32 v8, 3, v1
    v_lshlrev_b32 v8, 2, v8
    v_add_u32 v8, v9, v8
    v_mov_b32 v9, 0x40000000
    v_and_b32 v7, 7, v1
    v_cmp_lt_i32 s[100:101], v7, 2
    s_nop 1
    v_cndmask_b32 v11, v9, v8, s[100:101]
    v_and_b32 v62, 7, v1
    v_cmp_eq_u32 vcc, 0, v62
    s_nop 1
    v_cndmask_b32 v60, v60, v61, vcc
    s_lshl_b32 s59, s49, 5
    buffer_store_dword v60, v11, s[40:43], s59 offen sc1
    v_mov_b32 v9, 0x40000000
    v_cmp_eq_i32 s[100:101], v1, 0
    s_nop 1
    v_cndmask_b32 v10, v9, 0, s[100:101]
    v_mov_b32 v62, 1
    s_waitcnt vmcnt(0)
    s_barrier
    v_lshrrev_b32 v9, 4, v1
    v_lshlrev_b32 v9, 2, v9
    v_lshrrev_b32 v8, 2, v1
    v_and_b32 v8, 3, v8
    v_add_u32 v8, v9, v8
    v_lshlrev_b32 v8, 7, v8
    v_and_b32 v9, 3, v1
    v_lshlrev_b32 v9, 4, v9
    v_add_u32 v9, v8, v9
    v_add_u32 v70, s55, v9
    v_lshrrev_b32 v9, 2, v1
    v_and_b32 v9, 3, v9
    v_mul_u32_u24 v9, 20, v9
    v_add_u32 v9, 16, v9
    v_lshrrev_b32 v8, 4, v1
    v_add_u32 v8, v9, v8
    v_lshlrev_b32 v8, 7, v8
    v_and_b32 v9, 3, v1
    v_lshlrev_b32 v9, 4, v9
    v_add_u32 v9, v8, v9
    v_add_u32 v71, s55, v9
    s_mul_i32 s56, s58, 81920
    s_mul_i32 s54, s57, 10240
    s_add_u32 s56, s56, s54
    s_add_u32 s56, s56, 13631488
    ds_read_b64_tr_b16 v[72:73], v70 offset:0
    ds_read_b64_tr_b16 v[74:75], v70 offset:2560
    ds_read_b64_tr_b16 v[76:77], v70 offset:8
    ds_read_b64_tr_b16 v[78:79], v70 offset:2568
    ds_read_b64_tr_b16 v[80:81], v70 offset:5120
    ds_read_b64_tr_b16 v[82:83], v70 offset:7680
    ds_read_b64_tr_b16 v[84:85], v70 offset:5128
    ds_read_b64_tr_b16 v[86:87], v70 offset:7688
    ds_read_b64_tr_b16 v[88:89], v70 offset:10240
    ds_read_b64_tr_b16 v[90:91], v70 offset:12800
    ds_read_b64_tr_b16 v[92:93], v70 offset:10248
    ds_read_b64_tr_b16 v[94:95], v70 offset:12808
    s_waitcnt lgkmcnt(10)
    buffer_store_dwordx4 v[72:75], v0, s[40:43], s56 offen offset:0 sc1
    ds_read_b64_tr_b16 v[96:97], v70 offset:15360
    ds_read_b64_tr_b16 v[98:99], v70 offset:17920
    s_waitcnt lgkmcnt(10)
    buffer_store_dwordx4 v[76:79], v0, s[40:43], s56 offen offset:1024 sc1
    ds_read_b64_tr_b16 v[100:101], v70 offset:15368
    ds_read_b64_tr_b16 v[102:103], v70 offset:17928
    s_waitcnt lgkmcnt(10)
    buffer_store_dwordx4 v[80:83], v0, s[40:43], s56 offen offset:2048 sc1
    ds_read_b64_tr_b16 v[104:105], v71 offset:0
    ds_read_b64_tr_b16 v[106:107], v71 offset:10240
    s_waitcnt lgkmcnt(10)
    buffer_store_dwordx4 v[84:87], v0, s[40:43], s56 offen offset:3072 sc1
    ds_read_b64_tr_b16 v[108:109], v71 offset:8
    ds_read_b64_tr_b16 v[110:111], v71 offset:10248
    s_add_u32 s56, s56, 4096
    s_waitcnt lgkmcnt(10)
    buffer_store_dwordx4 v[88:91], v0, s[40:43], s56 offen offset:0 sc1
    ds_read_b64_tr_b16 v[112:113], v70 offset:64
    ds_read_b64_tr_b16 v[114:115], v70 offset:2624
    s_waitcnt lgkmcnt(10)
    buffer_store_dwordx4 v[92:95], v0, s[40:43], s56 offen offset:1024 sc1
    ds_read_b64_tr_b16 v[116:117], v70 offset:72
    ds_read_b64_tr_b16 v[118:119], v70 offset:2632
    s_waitcnt lgkmcnt(10)
    buffer_store_dwordx4 v[96:99], v0, s[40:43], s56 offen offset:2048 sc1
    ds_read_b64_tr_b16 v[120:121], v70 offset:5184
    ds_read_b64_tr_b16 v[122:123], v70 offset:7744
    s_waitcnt lgkmcnt(10)
    buffer_store_dwordx4 v[100:103], v0, s[40:43], s56 offen offset:3072 sc1
    ds_read_b64_tr_b16 v[124:125], v70 offset:5192
    ds_read_b64_tr_b16 v[126:127], v70 offset:7752
    s_add_u32 s56, s56, 4096
    s_waitcnt lgkmcnt(10)
    buffer_store_dwordx4 v[104:107], v0, s[40:43], s56 offen offset:0 sc1
    ds_read_b64_tr_b16 v[128:129], v70 offset:10304
    ds_read_b64_tr_b16 v[130:131], v70 offset:12864
    s_waitcnt lgkmcnt(10)
    buffer_store_dwordx4 v[108:111], v0, s[40:43], s56 offen offset:1024 sc1
    ds_read_b64_tr_b16 v[132:133], v70 offset:10312
    ds_read_b64_tr_b16 v[134:135], v70 offset:12872
    s_add_u32 s56, s56, 32768
    s_waitcnt lgkmcnt(10)
    buffer_store_dwordx4 v[112:115], v0, s[40:43], s56 offen offset:0 sc1
    ds_read_b64_tr_b16 v[136:137], v70 offset:15424
    ds_read_b64_tr_b16 v[138:139], v70 offset:17984
    s_waitcnt lgkmcnt(10)
    buffer_store_dwordx4 v[116:119], v0, s[40:43], s56 offen offset:1024 sc1
    ds_read_b64_tr_b16 v[140:141], v70 offset:15432
    ds_read_b64_tr_b16 v[142:143], v70 offset:17992
    s_waitcnt lgkmcnt(10)
    buffer_store_dwordx4 v[120:123], v0, s[40:43], s56 offen offset:2048 sc1
    ds_read_b64_tr_b16 v[144:145], v71 offset:64
    ds_read_b64_tr_b16 v[146:147], v71 offset:10304
    s_waitcnt lgkmcnt(10)
    buffer_store_dwordx4 v[124:127], v0, s[40:43], s56 offen offset:3072 sc1
    ds_read_b64_tr_b16 v[148:149], v71 offset:72
Lwh_0:
    s_cbranch_execz Lwh_1
    ds_read_b64_tr_b16 v[150:151], v71 offset:10312
    s_add_u32 s56, s56, 4096
    s_waitcnt lgkmcnt(10)
    buffer_store_dwordx4 v[128:131], v0, s[40:43], s56 offen offset:0 sc1
    s_waitcnt lgkmcnt(8)
    buffer_store_dwordx4 v[132:135], v0, s[40:43], s56 offen offset:1024 sc1
    s_waitcnt lgkmcnt(6)
    buffer_store_dwordx4 v[136:139], v0, s[40:43], s56 offen offset:2048 sc1
    s_waitcnt lgkmcnt(4)
    buffer_store_dwordx4 v[140:143], v0, s[40:43], s56 offen offset:3072 sc1
    s_add_u32 s56, s56, 4096
    s_waitcnt lgkmcnt(2)
    buffer_store_dwordx4 v[144:147], v0, s[40:43], s56 offen offset:0 sc1
    s_waitcnt lgkmcnt(0)
    buffer_store_dwordx4 v[148:151], v0, s[40:43], s56 offen offset:1024 sc1
    s_branch Lunitend
Lh2:
Lwh_1:
    s_cbranch_execz Lwh_2
    v_mov_b32 v60, 0
    v_mov_b32 v61, 0
    v_mov_b32 v62, 0x3f803f80
    s_waitcnt vmcnt(12)
    v_dot2_f32_bf16 v60, v16, v62, v60
    v_dot2_f32_bf16 v61, v16, v16, v61
    v_dot2_f32_bf16 v60, v17, v62, v60
    v_dot2_f32_bf16 v61, v17, v17, v61
    v_dot2_f32_bf16 v60, v18, v62, v60
    v_dot2_f32_bf16 v61, v18, v18, v61
    v_dot2_f32_bf16 v60, v19, v62, v60
    v_dot2_f32_bf16 v61, v19, v19, v61
    s_waitcnt vmcnt(11)
    v_dot2_f32_bf16 v60, v20, v62, v60
    v_dot2_f32_bf16 v61, v20, v20, v61
    v_dot2_f32_bf16 v60, v21, v62, v60
    v_dot2_f32_bf16 v61, v21, v21, v61
    v_dot2_f32_bf16 v60, v22, v62, v60
    v_dot2_f32_bf16 v61, v22, v22, v61
    v_dot2_f32_bf16 v60, v23, v62, v60
    v_dot2_f32_bf16 v61, v23, v23, v61
    s_waitcnt vmcnt(10)
    v_dot2_f32_bf16 v60, v24, v62, v60
    v_dot2_f32_bf16 v61, v24, v24, v61
    v_dot2_f32_bf16 v60, v25, v62, v60
    v_dot2_f32_bf16 v61, v25, v25, v61
    v_dot2_f32_bf16 v60, v26, v62, v60
    v_dot2_f32_bf16 v61, v26, v26, v61
    v_dot2_f32_bf16 v60, v27, v62, v60
    v_dot2_f32_bf16 v61, v27, v27, v61
    s_waitcnt vmcnt(9)
    v_dot2_f32_bf16 v60, v28, v62, v60
    v_dot2_f32_bf16 v61, v28, v28, v61
    v_dot2_f32_bf16 v60, v29, v62, v60
    v_dot2_f32_bf16 v61, v29, v29, v61
    v_dot2_f32_bf16 v60, v30, v62, v60
    v_dot2_f32_bf16 v61, v30, v30, v61
    v_dot2_f32_bf16 v60, v31, v62, v60
    v_dot2_f32_bf16 v61, v31, v31, v61
    s_waitcnt vmcnt(8)
    v_dot2_f32_bf16 v60, v32, v62, v60
    v_dot2_f32_bf16 v61, v32, v32, v61
    v_dot2_f32_bf16 v60, v33, v62, v60
    v_dot2_f32_bf16 v61, v33, v33, v61
    v_dot2_f32_bf16 v60, v34, v62, v60
    v_dot2_f32_bf16 v61, v34, v34, v61
    v_dot2_f32_bf16 v60, v35, v62, v60
    v_dot2_f32_bf16 v61, v35, v35, v61
    s_waitcnt vmcnt(7)
    v_dot2_f32_bf16 v60, v36, v62, v60
    v_dot2_f32_bf16 v61, v36, v36, v61
    v_dot2_f32_bf16 v60, v37, v62, v60
    v_dot2_f32_bf16 v61, v37, v37, v61
    v_dot2_f32_bf16 v60, v38, v62, v60
    v_dot2_f32_bf16 v61, v38, v38, v61
    v_dot2_f32_bf16 v60, v39, v62, v60
    v_dot2_f32_bf16 v61, v39, v39, v61
    s_waitcnt vmcnt(6)
    v_dot2_f32_bf16 v60, v40, v62, v60
    v_dot2_f32_bf16 v61, v40, v40, v61
    v_dot2_f32_bf16 v60, v41, v62, v60
    v_dot2_f32_bf16 v61, v41, v41, v61
    v_dot2_f32_bf16 v60, v42, v62, v60
    v_dot2_f32_bf16 v61, v42, v42, v61
    v_dot2_f32_bf16 v60, v43, v62, v60
    v_dot2_f32_bf16 v61, v43, v43, v61
    s_waitcnt vmcnt(5)
    v_dot2_f32_bf16 v60, v44, v62, v60
    v_dot2_f32_bf16 v61, v44, v44, v61
    v_dot2_f32_bf16 v60, v45, v62, v60
    v_dot2_f32_bf16 v61, v45, v45, v61
    v_dot2_f32_bf16 v60, v46, v62, v60
    v_dot2_f32_bf16 v61, v46, v46, v61
    v_dot2_f32_bf16 v60, v47, v62, v60
    v_dot2_f32_bf16 v61, v47, v47, v61
    s_waitcnt vmcnt(4)
    v_dot2_f32_bf16 v60, v48, v62, v60
    v_dot2_f32_bf16 v61, v48, v48, v61
    v_dot2_f32_bf16 v60, v49, v62, v60
    v_dot2_f32_bf16 v61, v49, v49, v61
    v_dot2_f32_bf16 v60, v50, v62, v60
    v_dot2_f32_bf16 v61, v50, v50, v61
    v_dot2_f32_bf16 v60, v51, v62, v60
    v_dot2_f32_bf16 v61, v51, v51, v61
    s_waitcnt vmcnt(3)
    v_dot2_f32_bf16 v60, v52, v62, v60
    v_dot2_f32_bf16 v61, v52, v52, v61
    v_dot2_f32_bf16 v60, v53, v62, v60
    v_dot2_f32_bf16 v61, v53, v53, v61
    v_dot2_f32_bf16 v60, v54, v62, v60
    v_dot2_f32_bf16 v61, v54, v54, v61
    v_dot2_f32_bf16 v60, v55, v62, v60
    v_dot2_f32_bf16 v61, v55, v55, v61
    s_nop 1
    v_add_f32_dpp v60, v60, v60 quad_perm:[1,0,3,2] row_mask:0xf bank_mask:0xf
    v_add_f32_dpp v61, v61, v61 quad_perm:[1,0,3,2] row_mask:0xf bank_mask:0xf
    s_nop 0
    v_add_f32_dpp v60, v60, v60 quad_perm:[2,3,0,1] row_mask:0xf bank_mask:0xf
    v_add_f32_dpp v61, v61, v61 quad_perm:[2,3,0,1] row_mask:0xf bank_mask:0xf
    s_nop 0
    v_add_f32_dpp v60, v60, v60 row_half_mirror row_mask:0xf bank_mask:0xf
    v_add_f32_dpp v61, v61, v61 row_half_mirror row_mask:0xf bank_mask:0xf
    v_mul_f32 v60, 0xbacccccd, v60
    v_mul_f32 v61, 0x3acccccd, v61
    v_fma_f32 v61, -v60, v60, v61
    v_max_f32 v61, 0, v61
    v_add_f32 v61, 0x3727c5ac, v61
    v_rsq_f32 v61, v61
    v_and_b32 v9, 7, v1
    v_lshlrev_b32 v9, 13, v9
    v_lshrrev_b32 v8, 3, v1
    v_lshlrev_b32 v8, 2, v8
    v_add_u32 v8, v9, v8
    v_mov_b32 v9, 0x40000000
    v_and_b32 v7, 7, v1
    v_cmp_lt_i32 s[100:101], v7, 2
    s_nop 1
    v_cndmask_b32 v11, v9, v8, s[100:101]
    v_and_b32 v62, 7, v1
    v_cmp_eq_u32 vcc, 0, v62
    s_nop 1
    v_cndmask_b32 v60, v60, v61, vcc
    s_lshl_b32 s59, s49, 5
    buffer_store_dword v60, v11, s[40:43], s59 offen sc1
    v_mov_b32 v9, 0x40000000
    v_cmp_eq_i32 s[100:101], v1, 0
    s_nop 1
    v_cndmask_b32 v10, v9, 0, s[100:101]
    v_mov_b32 v62, 1
    s_waitcnt vmcnt(0)
    s_barrier
    s_mov_b32 s53, 1073741824
    s_branch Lunitend
Lh13:
Lwh_2:
    s_cbranch_execz Lwh_3
    v_lshlrev_b32 v57, 2, v1
    s_mul_i32 s55, s3, 40960
    s_add_u32 s55, s55, 0
    v_mul_u32_u24 v9, 0xaab, v1
    v_lshrrev_b32 v70, 16, v9
    v_mul_u32_u24 v9, 0xc00, v70
    v_mul_u32_u24 v8, 24, v70
    v_sub_u32 v8, v1, v8
    v_lshlrev_b32 v8, 4, v8
    v_add_u32 v64, v9, v8
    v_add_u32 v9, 64, v1
    v_mul_u32_u24 v9, 0xaab, v9
    v_lshrrev_b32 v70, 16, v9
    v_mul_u32_u24 v9, 0xc00, v70
    v_add_u32 v8, 64, v1
    v_mul_u32_u24 v7, 24, v70
    v_sub_u32 v7, v8, v7
    v_lshlrev_b32 v7, 4, v7
    v_add_u32 v65, v9, v7
    v_add_u32 v9, 0x80, v1
    v_mul_u32_u24 v9, 0xaab, v9
    v_lshrrev_b32 v70, 16, v9
    v_mul_u32_u24 v9, 0xc00, v70
    v_add_u32 v8, 0x80, v1
    v_mul_u32_u24 v7, 24, v70
    v_sub_u32 v7, v8, v7
    v_lshlrev_b32 v7, 4, v7
    v_add_u32 v66, v9, v7
    s_mul_i32 s58, s52, 3277
    s_lshr_b32 s58, s58, 16
    s_mul_i32 s57, s58, 20
    s_sub_u32 s57, s52, s57
    s_mul_i32 s54, s57, 98304
    s_mul_i32 s56, s58, 384
    s_add_u32 s54, s54, s56
    s_add_u32 m0, s55, 0
    s_nop 0
    buffer_load_dwordx4 v64, s[20:23], s54 offen lds
    s_add_u32 m0, s55, 12304
    s_nop 0
    buffer_load_dwordx4 v64, s[24:27], s54 offen lds
    s_add_u32 m0, s55, 1024
    s_nop 0
    buffer_load_dwordx4 v65, s[20:23], s54 offen lds
    s_add_u32 m0, s55, 13328
    s_nop 0
    buffer_load_dwordx4 v65, s[24:27], s54 offen lds
    v_mov_b32 v60, 0
    v_mov_b32 v61, 0
    v_mov_b32 v62, 0x3f803f80
    s_waitcnt vmcnt(16)
    v_dot2_f32_bf16 v60, v16, v62, v60
    v_dot2_f32_bf16 v61, v16, v16, v61
    v_dot2_f32_bf16 v60, v17, v62, v60
    v_dot2_f32_bf16 v61, v17, v17, v61
    v_dot2_f32_bf16 v60, v18, v62, v60
    v_dot2_f32_bf16 v61, v18, v18, v61
    v_dot2_f32_bf16 v60, v19, v62, v60
    v_dot2_f32_bf16 v61, v19, v19, v61
    s_waitcnt vmcnt(15)
    v_dot2_f32_bf16 v60, v20, v62, v60
    v_dot2_f32_bf16 v61, v20, v20, v61
    v_dot2_f32_bf16 v60, v21, v62, v60
    v_dot2_f32_bf16 v61, v21, v21, v61
    v_dot2_f32_bf16 v60, v22, v62, v60
    v_dot2_f32_bf16 v61, v22, v22, v61
    v_dot2_f32_bf16 v60, v23, v62, v60
    v_dot2_f32_bf16 v61, v23, v23, v61
    s_waitcnt vmcnt(14)
    v_dot2_f32_bf16 v60, v24, v62, v60
    v_dot2_f32_bf16 v61, v24, v24, v61
    v_dot2_f32_bf16 v60, v25, v62, v60
    v_dot2_f32_bf16 v61, v25, v25, v61
    v_dot2_f32_bf16 v60, v26, v62, v60
    v_dot2_f32_bf16 v61, v26, v26, v61
    v_dot2_f32_bf16 v60, v27, v62, v60
    v_dot2_f32_bf16 v61, v27, v27, v61
    s_waitcnt vmcnt(13)
    v_dot2_f32_bf16 v60, v28, v62, v60
    v_dot2_f32_bf16 v61, v28, v28, v61
    v_dot2_f32_bf16 v60, v29, v62, v60
    v_dot2_f32_bf16 v61, v29, v29, v61
    v_dot2_f32_bf16 v60, v30, v62, v60
    v_dot2_f32_bf16 v61, v30, v30, v61
    v_dot2_f32_bf16 v60, v31, v62, v60
    v_dot2_f32_bf16 v61, v31, v31, v61
    s_waitcnt vmcnt(12)
    v_dot2_f32_bf16 v60, v32, v62, v60
    v_dot2_f32_bf16 v61, v32, v32, v61
    v_dot2_f32_bf16 v60, v33, v62, v60
    v_dot2_f32_bf16 v61, v33, v33, v61
    v_dot2_f32_bf16 v60, v34, v62, v60
    v_dot2_f32_bf16 v61, v34, v34, v61
    v_dot2_f32_bf16 v60, v35, v62, v60
    v_dot2_f32_bf16 v61, v35, v35, v61
    s_waitcnt vmcnt(11)
    v_dot2_f32_bf16 v60, v36, v62, v60
    v_dot2_f32_bf16 v61, v36, v36, v61
    v_dot2_f32_bf16 v60, v37, v62, v60
    v_dot2_f32_bf16 v61, v37, v37, v61
    v_dot2_f32_bf16 v60, v38, v62, v60
    v_dot2_f32_bf16 v61, v38, v38, v61
    v_dot2_f32_bf16 v60, v39, v62, v60
    v_dot2_f32_bf16 v61, v39, v39, v61
    s_waitcnt vmcnt(10)
    v_dot2_f32_bf16 v60, v40, v62, v60
    v_dot2_f32_bf16 v61, v40, v40, v61
    v_dot2_f32_bf16 v60, v41, v62, v60
    v_dot2_f32_bf16 v61, v41, v41, v61
    v_dot2_f32_bf16 v60, v42, v62, v60
    v_dot2_f32_bf16 v61, v42, v42, v61
    v_dot2_f32_bf16 v60, v43, v62, v60
    v_dot2_f32_bf16 v61, v43, v43, v61
    s_waitcnt vmcnt(9)
    v_dot2_f32_bf16 v60, v44, v62, v60
    v_dot2_f32_bf16 v61, v44, v44, v61
    v_dot2_f32_bf16 v60, v45, v62, v60
    v_dot2_f32_bf16 v61, v45, v45, v61
    v_dot2_f32_bf16 v60, v46, v62, v60
    v_dot2_f32_bf16 v61, v46, v46, v61
    v_dot2_f32_bf16 v60, v47, v62, v60
    v_dot2_f32_bf16 v61, v47, v47, v61
    s_waitcnt vmcnt(8)
    v_dot2_f32_bf16 v60, v48, v62, v60
    v_dot2_f32_bf16 v61, v48, v48, v61
    v_dot2_f32_bf16 v60, v49, v62, v60
    v_dot2_f32_bf16 v61, v49, v49, v61
    v_dot2_f32_bf16 v60, v50, v62, v60
    v_dot2_f32_bf16 v61, v50, v50, v61
    v_dot2_f32_bf16 v60, v51, v62, v60
    v_dot2_f32_bf16 v61, v51, v51, v61
    s_waitcnt vmcnt(7)
    v_dot2_f32_bf16 v60, v52, v62, v60
    v_dot2_f32_bf16 v61, v52, v52, v61
    v_dot2_f32_bf16 v60, v53, v62, v60
    v_dot2_f32_bf16 v61, v53, v53, v61
    v_dot2_f32_bf16 v60, v54, v62, v60
    v_dot2_f32_bf16 v61, v54, v54, v61
    v_dot2_f32_bf16 v60, v55, v62, v60
    v_dot2_f32_bf16 v61, v55, v55, v61
    s_nop 1
    v_add_f32_dpp v60, v60, v60 quad_perm:[1,0,3,2] row_mask:0xf bank_mask:0xf
    v_add_f32_dpp v61, v61, v61 quad_perm:[1,0,3,2] row_mask:0xf bank_mask:0xf
    s_nop 0
    v_add_f32_dpp v60, v60, v60 quad_perm:[2,3,0,1] row_mask:0xf bank_mask:0xf
    v_add_f32_dpp v61, v61, v61 quad_perm:[2,3,0,1] row_mask:0xf bank_mask:0xf
    s_nop 0
    v_add_f32_dpp v60, v60, v60 row_half_mirror row_mask:0xf bank_mask:0xf
    v_add_f32_dpp v61, v61, v61 row_half_mirror row_mask:0xf bank_mask:0xf
    v_mul_f32 v60, 0xbacccccd, v60
    v_mul_f32 v61, 0x3acccccd, v61
    v_fma_f32 v61, -v60, v60, v61
    v_max_f32 v61, 0, v61
    v_add_f32 v61, 0x3727c5ac, v61
    v_rsq_f32 v61, v61
    v_and_b32 v9, 7, v1
    v_lshlrev_b32 v9, 13, v9
    v_lshrrev_b32 v8, 3, v1
    v_lshlrev_b32 v8, 2, v8
    v_add_u32 v8, v9, v8
    v_mov_b32 v9, 0x40000000
    v_and_b32 v7, 7, v1
    v_cmp_lt_i32 s[100:101], v7, 2
    s_nop 1
    v_cndmask_b32 v11, v9, v8, s[100:101]
    v_and_b32 v62, 7, v1
    v_cmp_eq_u32 vcc, 0, v62
    s_nop 1
    v_cndmask_b32 v60, v60, v61, vcc
    s_lshl_b32 s59, s49, 5
    buffer_store_dword v60, v11, s[40:43], s59 offen sc1
    v_mov_b32 v9, 0x40000000
    v_cmp_eq_i32 s[100:101], v1, 0
    s_nop 1
    v_cndmask_b32 v10, v9, 0, s[100:101]
    v_mov_b32 v62, 1
    s_add_u32 m0, s55, 2048
    s_nop 0
    buffer_load_dwordx4 v66, s[20:23], s54 offen lds
    s_add_u32 m0, s55, 14352
    s_nop 0
    buffer_load_dwordx4 v66, s[24:27], s54 offen lds
    s_add_u32 s54, s54, 24576
    s_add_u32 m0, s55, 3072
    s_nop 0
    buffer_load_dwordx4 v64, s[20:23], s54 offen lds
    s_add_u32 m0, s55, 15376
    s_nop 0
    buffer_load_dwordx4 v64, s[24:27], s54 offen lds
    s_add_u32 m0, s55, 4096
    s_nop 0
    buffer_load_dwordx4 v65, s[20:23], s54 offen lds
    s_add_u32 m0, s55, 16400
    s_nop 0
    buffer_load_dwordx4 v65, s[24:27], s54 offen lds
    s_add_u32 m0, s55, 5120
    s_nop 0
    buffer_load_dwordx4 v66, s[20:23], s54 offen lds
    s_add_u32 m0, s55, 17424
    s_nop 0
    buffer_load_dwordx4 v66, s[24:27], s54 offen lds
    s_add_u32 s54, s54, 24576
    s_add_u32 m0, s55, 6144
    s_nop 0
    buffer_load_dwordx4 v64, s[20:23], s54 offen lds
    s_add_u32 m0, s55, 18448
    s_nop 0
    buffer_load_dwordx4 v64, s[24:27], s54 offen lds
    s_add_u32 m0, s55, 7168
    s_nop 0
    buffer_load_dwordx4 v65, s[20:23], s54 offen lds
    s_add_u32 m0, s55, 19472
    s_nop 0
    buffer_load_dwordx4 v65, s[24:27], s54 offen lds
    s_lshl_b32 s59, s48, 2
    s_cmp_eq_u32 s3, 0
    s_cselect_b32 s59, s59, 1073741824
    s_waitcnt vmcnt(12)
    s_barrier
    buffer_store_dword v62, v10, s[36:39], s59 offen sc1
    s_add_u32 m0, s55, 8192
    s_nop 0
    buffer_load_dwordx4 v66, s[20:23], s54 offen lds
    s_add_u32 m0, s55, 20496
    s_nop 0
    buffer_load_dwordx4 v66, s[24:27], s54 offen lds
    s_add_u32 s54, s54, 24576
    s_add_u32 m0, s55, 9216
    s_nop 0
    buffer_load_dwordx4 v64, s[20:23], s54 offen lds
    s_add_u32 m0, s55, 21520
    s_nop 0
    buffer_load_dwordx4 v64, s[24:27], s54 offen lds
    s_add_u32 m0, s55, 10240
    s_nop 0
    buffer_load_dwordx4 v65, s[20:23], s54 offen lds
    s_add_u32 m0, s55, 22544
    s_nop 0
    buffer_load_dwordx4 v65, s[24:27], s54 offen lds
    s_add_u32 m0, s55, 11264
    s_nop 0
    buffer_load_dwordx4 v66, s[20:23], s54 offen lds
    s_add_u32 m0, s55, 23568
    s_nop 0
    buffer_load_dwordx4 v66, s[24:27], s54 offen lds
    s_add_u32 s54, s54, 24576
    v_lshrrev_b32 v9, 4, v1
    v_lshlrev_b32 v9, 3, v9
    v_lshrrev_b32 v8, 2, v1
    v_and_b32 v8, 3, v8
    v_add_u32 v8, v9, v8
    v_mul_u32_u24 v8, 0x180, v8
    v_add_u32 v71, s55, v8
    v_and_b32 v9, 3, v1
    v_lshlrev_b32 v9, 3, v9
    v_add_u32 v70, v71, v9
    v_add_u32 v9, 32, v71
    v_and_b32 v8, 3, v1
    v_and_b32 v8, 1, v8
    v_lshlrev_b32 v8, 3, v8
    v_add_u32 v8, v9, v8
    v_and_b32 v9, 3, v1
    v_lshrrev_b32 v9, 1, v9
    v_mul_u32_u24 v9, 0x3010, v9
    v_add_u32 v71, v8, v9
    v_and_b32 v9, 48, v1
    v_and_b32 v8, 6, v1
    v_lshlrev_b32 v8, 1, v8
    v_add_u32 v8, v9, v8
    v_and_b32 v9, 8, v1
    v_lshrrev_b32 v9, 2, v9
    v_add_u32 v9, v8, v9
    v_and_b32 v8, 1, v1
    v_add_u32 v8, v9, v8
    v_lshlrev_b32 v64, 4, v8
    s_mul_i32 s56, s58, 491520
    s_mul_i32 s54, s57, 3072
    s_add_u32 s56, s56, s54
    s_add_u32 s56, s56, 14680064
    v_mov_b32 v9, 0x3f803f80
    v_and_b32 v8, 15, v1
    v_lshrrev_b32 v8, 2, v8
    v_cmp_eq_i32 s[100:101], v8, 0
    s_nop 1
    v_cndmask_b32 v168, 0, v9, s[100:101]
    v_mov_b32 v169, v168
    v_mov_b32 v170, v168
    v_mov_b32 v171, v168
    v_mov_b32 v9, 0x3f803f80
    v_and_b32 v8, 15, v1
    v_lshrrev_b32 v8, 2, v8
    v_cmp_eq_i32 s[100:101], v8, 1
    s_nop 1
    v_cndmask_b32 v172, 0, v9, s[100:101]
    v_mov_b32 v173, v172
    v_mov_b32 v174, v172
    v_mov_b32 v175, v172
    v_mov_b32 v9, 0x3f803f80
    v_and_b32 v8, 15, v1
    v_lshrrev_b32 v8, 2, v8
    v_cmp_eq_i32 s[100:101], v8, 2
    s_nop 1
    v_cndmask_b32 v176, 0, v9, s[100:101]
    v_mov_b32 v177, v176
    v_mov_b32 v178, v176
    v_mov_b32 v179, v176
    v_mov_b32 v9, 0x3f803f80
    v_and_b32 v8, 15, v1
    v_lshrrev_b32 v8, 2, v8
    v_cmp_eq_i32 s[100:101], v8, 3
    s_nop 1
    v_cndmask_b32 v180, 0, v9, s[100:101]
    v_mov_b32 v181, v180
    v_mov_b32 v182, v180
    v_mov_b32 v183, v180
    v_lshrrev_b32 v9, 4, v1
    v_mul_u32_u24 v9, 0xc0, v9
    v_and_b32 v8, 15, v1
    v_lshlrev_b32 v8, 2, v8
    v_add_u32 v65, v9, v8
    v_lshrrev_b32 v9, 4, v1
    v_mul_u32_u24 v9, 0xc0, v9
    v_lshrrev_b32 v8, 2, v64
    v_and_b32 v8, 60, v8
    v_add_u32 v66, v9, v8
    s_mul_i32 s54, s58, 1536
    s_add_u32 s54, s54, 90112
    s_waitcnt vmcnt(0)
    ds_read_b64_tr_b16 v[72:73], v70 offset:0
    ds_read_b64_tr_b16 v[74:75], v70 offset:1536
    ds_read_b64_tr_b16 v[76:77], v70 offset:12304
    ds_read_b64_tr_b16 v[78:79], v70 offset:13840
    ds_read_b64_tr_b16 v[80:81], v71 offset:0
    ds_read_b64_tr_b16 v[82:83], v71 offset:1536
    ds_read_b64_tr_b16 v[84:85], v70 offset:48
    ds_read_b64_tr_b16 v[86:87], v70 offset:1584
    ds_read_b64_tr_b16 v[88:89], v70 offset:12352
    ds_read_b64_tr_b16 v[90:91], v70 offset:13888
    ds_read_b64_tr_b16 v[92:93], v71 offset:48
    ds_read_b64_tr_b16 v[94:95], v71 offset:1584
    s_waitcnt lgkmcnt(10)
    buffer_store_dwordx4 v[72:75], v0, s[40:43], s56 offen offset:0 sc1
    ds_read_b64_tr_b16 v[96:97], v70 offset:96
    ds_read_b64_tr_b16 v[98:99], v70 offset:1632
    s_waitcnt lgkmcnt(10)
    buffer_store_dwordx4 v[76:79], v0, s[40:43], s56 offen offset:1024 sc1
    ds_read_b64_tr_b16 v[100:101], v70 offset:12400
    ds_read_b64_tr_b16 v[102:103], v70 offset:13936
    s_waitcnt lgkmcnt(10)
    buffer_store_dwordx4 v[80:83], v64, s[40:43], s56 offen offset:2048 sc1
    ds_read_b64_tr_b16 v[104:105], v71 offset:96
    ds_read_b64_tr_b16 v[106:107], v71 offset:1632
    s_add_u32 s56, s56, 61440
    s_waitcnt lgkmcnt(10)
    buffer_store_dwordx4 v[84:87], v0, s[40:43], s56 offen offset:0 sc1
    ds_read_b64_tr_b16 v[108:109], v70 offset:144
    ds_read_b64_tr_b16 v[110:111], v70 offset:1680
    s_waitcnt lgkmcnt(10)
    buffer_store_dwordx4 v[88:91], v0, s[40:43], s56 offen offset:1024 sc1
    ds_read_b64_tr_b16 v[112:113], v70 offset:12448
    ds_read_b64_tr_b16 v[114:115], v70 offset:13984
    s_waitcnt lgkmcnt(10)
    buffer_store_dwordx4 v[92:95], v64, s[40:43], s56 offen offset:2048 sc1
    ds_read_b64_tr_b16 v[116:117], v71 offset:144
    ds_read_b64_tr_b16 v[118:119], v71 offset:1680
    s_add_u32 s56, s56, 61440
    s_waitcnt lgkmcnt(10)
    buffer_store_dwordx4 v[96:99], v0, s[40:43], s56 offen offset:0 sc1
    ds_read_b64_tr_b16 v[120:121], v70 offset:192
    ds_read_b64_tr_b16 v[122:123], v70 offset:1728
    s_waitcnt lgkmcnt(10)
    buffer_store_dwordx4 v[100:103], v0, s[40:43], s56 offen offset:1024 sc1
    ds_read_b64_tr_b16 v[124:125], v70 offset:12496
    ds_read_b64_tr_b16 v[126:127], v70 offset:14032
    s_waitcnt lgkmcnt(10)
    buffer_store_dwordx4 v[104:107], v64, s[40:43], s56 offen offset:2048 sc1
    ds_read_b64_tr_b16 v[128:129], v71 offset:192
    ds_read_b64_tr_b16 v[130:131], v71 offset:1728
    s_add_u32 s56, s56, 61440
    s_waitcnt lgkmcnt(10)
    buffer_store_dwordx4 v[108:111], v0, s[40:43], s56 offen offset:0 sc1
    ds_read_b64_tr_b16 v[132:133], v70 offset:240
    ds_read_b64_tr_b16 v[134:135], v70 offset:1776
    s_waitcnt lgkmcnt(10)
    buffer_store_dwordx4 v[112:115], v0, s[40:43], s56 offen offset:1024 sc1
    ds_read_b64_tr_b16 v[136:137], v70 offset:12544
    ds_read_b64_tr_b16 v[138:139], v70 offset:14080
    s_waitcnt lgkmcnt(10)
    buffer_store_dwordx4 v[116:119], v64, s[40:43], s56 offen offset:2048 sc1
    ds_read_b64_tr_b16 v[140:141], v71 offset:240
    ds_read_b64_tr_b16 v[142:143], v71 offset:1776
    s_add_u32 s56, s56, 61440
    s_waitcnt lgkmcnt(10)
    buffer_store_dwordx4 v[120:123], v0, s[40:43], s56 offen offset:0 sc1
    ds_read_b64_tr_b16 v[144:145], v70 offset:288
    ds_read_b64_tr_b16 v[146:147], v70 offset:1824
    s_waitcnt lgkmcnt(10)
    buffer_store_dwordx4 v[124:127], v0, s[40:43], s56 offen offset:1024 sc1
    ds_read_b64_tr_b16 v[148:149], v70 offset:12592
    ds_read_b64_tr_b16 v[150:151], v70 offset:14128
    s_waitcnt lgkmcnt(10)
    buffer_store_dwordx4 v[128:131], v64, s[40:43], s56 offen offset:2048 sc1
    ds_read_b64_tr_b16 v[152:153], v71 offset:288
    ds_read_b64_tr_b16 v[154:155], v71 offset:1824
    s_add_u32 s56, s56, 61440
    s_waitcnt lgkmcnt(10)
    buffer_store_dwordx4 v[132:135], v0, s[40:43], s56 offen offset:0 sc1
    ds_read_b64_tr_b16 v[156:157], v70 offset:336
    ds_read_b64_tr_b16 v[158:159], v70 offset:1872
    s_waitcnt lgkmcnt(10)
    buffer_store_dwordx4 v[136:139], v0, s[40:43], s56 offen offset:1024 sc1
    ds_read_b64_tr_b16 v[160:161], v70 offset:12640
    ds_read_b64_tr_b16 v[162:163], v70 offset:14176
    s_waitcnt lgkmcnt(10)
    buffer_store_dwordx4 v[140:143], v64, s[40:43], s56 offen offset:2048 sc1
    ds_read_b64_tr_b16 v[164:165], v71 offset:336
    ds_read_b64_tr_b16 v[166:167], v71 offset:1872
    s_add_u32 s56, s56, 61440
    s_waitcnt lgkmcnt(10)
    buffer_store_dwordx4 v[144:147], v0, s[40:43], s56 offen offset:0 sc1
    s_waitcnt lgkmcnt(8)
    buffer_store_dwordx4 v[148:151], v0, s[40:43], s56 offen offset:1024 sc1
    s_waitcnt lgkmcnt(6)
    buffer_store_dwordx4 v[152:155], v64, s[40:43], s56 offen offset:2048 sc1
    s_add_u32 s56, s56, 61440
    s_waitcnt lgkmcnt(4)
    buffer_store_dwordx4 v[156:159], v0, s[40:43], s56 offen offset:0 sc1
    s_waitcnt lgkmcnt(2)
    buffer_store_dwordx4 v[160:163], v0, s[40:43], s56 offen offset:1024 sc1
    s_waitcnt lgkmcnt(0)
    buffer_store_dwordx4 v[164:167], v64, s[40:43], s56 offen offset:2048 sc1
    buffer_load_dword v58, v57, s[36:39], 0 offen offset:0 sc1
    v_mfma_f32_16x16x32_bf16 v[184:187], v[168:171], v[72:75], 0
    v_mfma_f32_16x16x32_bf16 v[184:187], v[172:175], v[84:87], v[184:187]
    v_mfma_f32_16x16x32_bf16 v[184:187], v[176:179], v[96:99], v[184:187]
    v_mfma_f32_16x16x32_bf16 v[184:187], v[180:183], v[108:111], v[184:187]
    v_mfma_f32_16x16x32_bf16 v[188:191], v[168:171], v[120:123], 0
    v_mfma_f32_16x16x32_bf16 v[188:191], v[172:175], v[132:135], v[188:191]
    v_mfma_f32_16x16x32_bf16 v[188:191], v[176:179], v[144:147], v[188:191]
    v_mfma_f32_16x16x32_bf16 v[188:191], v[180:183], v[156:159], v[188:191]
    v_mfma_f32_16x16x32_bf16 v[192:195], v[168:171], v[76:79], 0
    v_mfma_f32_16x16x32_bf16 v[192:195], v[172:175], v[88:91], v[192:195]
    v_mfma_f32_16x16x32_bf16 v[192:195], v[176:179], v[100:103], v[192:195]
    v_mfma_f32_16x16x32_bf16 v[192:195], v[180:183], v[112:115], v[192:195]
    v_mfma_f32_16x16x32_bf16 v[196:199], v[168:171], v[124:127], 0
    v_mfma_f32_16x16x32_bf16 v[196:199], v[172:175], v[136:139], v[196:199]
    v_mfma_f32_16x16x32_bf16 v[196:199], v[176:179], v[148:151], v[196:199]
    v_mfma_f32_16x16x32_bf16 v[196:199], v[180:183], v[160:163], v[196:199]
    v_mfma_f32_16x16x32_bf16 v[200:203], v[168:171], v[80:83], 0
    v_mfma_f32_16x16x32_bf16 v[200:203], v[172:175], v[92:95], v[200:203]
    v_mfma_f32_16x16x32_bf16 v[200:203], v[176:179], v[104:107], v[200:203]
    v_mfma_f32_16x16x32_bf16 v[200:203], v[180:183], v[116:119], v[200:203]
    v_mfma_f32_16x16x32_bf16 v[204:207], v[168:171], v[128:131], 0
    v_mfma_f32_16x16x32_bf16 v[204:207], v[172:175], v[140:143], v[204:207]
    v_mfma_f32_16x16x32_bf16 v[204:207], v[176:179], v[152:155], v[204:207]
    v_mfma_f32_16x16x32_bf16 v[204:207], v[180:183], v[164:167], v[204:207]
    s_waitcnt vmcnt(0)
    v_cmp_gt_u32 vcc, 1, v58
    s_nop 0
    s_cbranch_vccnz Lslow7
Lback7:
    buffer_atomic_add_f32 v184, v65, s[40:43], s54 offen offset:0
    buffer_atomic_add_f32 v188, v65, s[40:43], s54 offen offset:768
    buffer_atomic_add_f32 v192, v65, s[40:43], s54 offen offset:64
    buffer_atomic_add_f32 v196, v65, s[40:43], s54 offen offset:832
    buffer_atomic_add_f32 v200, v66, s[40:43], s54 offen offset:128
    buffer_atomic_add_f32 v204, v66, s[40:43], s54 offen offset:896
Lunitend:
Lwh_3:
    s_cbranch_execz Lwh_4
    s_waitcnt vmcnt(0)
    buffer_store_dword v62, v10, s[40:43], s53 offen sc1
    s_barrier
    v_lshlrev_b32 v57, 2, v1
    buffer_load_dword v11, v57, s[36:39], 0 offen offset:0 sc1
    s_lshr_b32 s52, s48, 1
    s_mul_i32 s52, s52, 3
    s_add_u32 s52, s52, s3
    s_mov_b64 s[12:13], s[88:89]
    s_mov_b32 s14, 1966080
    s_mov_b32 s15, 0x20000
    s_bitcmp0_b32 s48, 0
    s_cbranch_scc1 Lnow2
    s_cmp_eq_u32 s3, 3
    s_cbranch_scc1 Lnow2
    s_mul_i32 s60, s3, 40960
    s_add_u32 s60, s60, 0
    v_mul_u32_u24 v9, 0x667, v1
    v_lshrrev_b32 v70, 16, v9
    v_mul_u32_u24 v9, 0x500, v70
    v_mul_u32_u24 v8, 40, v70
    v_sub_u32 v8, v1, v8
    v_lshlrev_b32 v8, 4, v8
    v_add_u32 v64, v9, v8
    v_add_u32 v9, 64, v1
    v_mul_u32_u24 v9, 0x667, v9
    v_lshrrev_b32 v70, 16, v9
    v_mul_u32_u24 v9, 0x500, v70
    v_add_u32 v8, 64, v1
    v_mul_u32_u24 v7, 40, v70
    v_sub_u32 v7, v8, v7
    v_lshlrev_b32 v7, 4, v7
    v_add_u32 v65, v9, v7
    v_add_u32 v9, 0x80, v1
    v_mul_u32_u24 v9, 0x667, v9
    v_lshrrev_b32 v70, 16, v9
    v_mul_u32_u24 v9, 0x500, v70
    v_add_u32 v8, 0x80, v1
    v_mul_u32_u24 v7, 40, v70
    v_sub_u32 v7, v8, v7
    v_lshlrev_b32 v7, 4, v7
    v_add_u32 v66, v9, v7
    v_add_u32 v9, 0xc0, v1
    v_mul_u32_u24 v9, 0x667, v9
    v_lshrrev_b32 v70, 16, v9
    v_mul_u32_u24 v9, 0x500, v70
    v_add_u32 v8, 0xc0, v1
    v_mul_u32_u24 v7, 40, v70
    v_sub_u32 v7, v8, v7
    v_lshlrev_b32 v7, 4, v7
    v_add_u32 v67, v9, v7
    v_add_u32 v9, 0x100, v1
    v_mul_u32_u24 v9, 0x667, v9
    v_lshrrev_b32 v70, 16, v9
    v_mul_u32_u24 v9, 0x500, v70
    v_add_u32 v8, 0x100, v1
    v_mul_u32_u24 v7, 40, v70
    v_sub_u32 v7, v8, v7
    v_lshlrev_b32 v7, 4, v7
    v_add_u32 v68, v9, v7
    s_cmp_ge_u32 s52, 48
    s_cselect_b32 s62, 1, 0
    s_mul_i32 s61, s62, 48
    s_sub_u32 s61, s52, s61
    s_mul_i32 s54, s61, 40960
    s_mul_i32 s56, s62, 640
    s_add_u32 s54, s54, s56
    s_add_u32 m0, s60, 0
    s_nop 0
    buffer_load_dwordx4 v64, s[12:15], s54 offen lds
    s_add_u32 m0, s60, 1024
    s_nop 0
    buffer_load_dwordx4 v65, s[12:15], s54 offen lds
    s_add_u32 m0, s60, 2048
    s_nop 0
    buffer_load_dwordx4 v66, s[12:15], s54 offen lds
    s_add_u32 m0, s60, 3072
    s_nop 0
    buffer_load_dwordx4 v67, s[12:15], s54 offen lds
    s_add_u32 m0, s60, 4096
    s_nop 0
    buffer_load_dwordx4 v68, s[12:15], s54 offen lds
    s_add_u32 s54, s54, 10240
    s_add_u32 m0, s60, 5120
    s_nop 0
    buffer_load_dwordx4 v64, s[12:15], s54 offen lds
    s_add_u32 m0, s60, 6144
    s_nop 0
    buffer_load_dwordx4 v65, s[12:15], s54 offen lds
    s_add_u32 m0, s60, 7168
    s_nop 0
    buffer_load_dwordx4 v66, s[12:15], s54 offen lds
    s_add_u32 m0, s60, 8192
    s_nop 0
    buffer_load_dwordx4 v67, s[12:15], s54 offen lds
    s_add_u32 m0, s60, 9216
    s_nop 0
    buffer_load_dwordx4 v68, s[12:15], s54 offen lds
    s_add_u32 s54, s54, 10240
    s_add_u32 m0, s60, 10240
    s_nop 0
    buffer_load_dwordx4 v64, s[12:15], s54 offen lds
    s_add_u32 m0, s60, 11264
    s_nop 0
    buffer_load_dwordx4 v65, s[12:15], s54 offen lds
    s_add_u32 m0, s60, 12288
    s_nop 0
    buffer_load_dwordx4 v66, s[12:15], s54 offen lds
    s_add_u32 m0, s60, 13312
    s_nop 0
    buffer_load_dwordx4 v67, s[12:15], s54 offen lds
    s_add_u32 m0, s60, 14336
    s_nop 0
    buffer_load_dwordx4 v68, s[12:15], s54 offen lds
    s_add_u32 s54, s54, 10240
    s_add_u32 m0, s60, 15360
    s_nop 0
    buffer_load_dwordx4 v64, s[12:15], s54 offen lds
    s_add_u32 m0, s60, 16384
    s_nop 0
    buffer_load_dwordx4 v65, s[12:15], s54 offen lds
    s_add_u32 m0, s60, 17408
    s_nop 0
    buffer_load_dwordx4 v66, s[12:15], s54 offen lds
    s_add_u32 m0, s60, 18432
    s_nop 0
    buffer_load_dwordx4 v67, s[12:15], s54 offen lds
    s_add_u32 m0, s60, 19456
    s_nop 0
    buffer_load_dwordx4 v68, s[12:15], s54 offen lds
    s_add_u32 s54, s54, 10240
Lnow2:
    s_lshl_b32 s30, s52, 7
    s_add_u32 s30, s30, 675840
    s_and_b32 s31, s48, 1
    s_and_b32 s16, s2, 7
    s_lshl_b32 s16, s16, 1
    s_lshr_b32 s44, s2, 7
    s_add_u32 s16, s16, s44
    s_bfe_u32 s29, s2, 0x40003
    s_and_b32 s18, s2, 4
    s_lshl_b32 s18, s18, 1
    s_lshr_b32 s44, s2, 5
    s_add_u32 s18, s18, s44
    s_lshr_b32 s19, s2, 3
    s_lshr_b32 s44, s2, 6
    s_add_u32 s19, s19, s44
    s_and_b32 s19, s19, 3
    s_and_b32 s44, s2, 3
    s_lshl_b32 s44, s44, 2
    s_add_u32 s19, s19, s44
    s_mov_b32 s46, 0xc0ba4321
    s_mov_b32 s47, 0xf7ed9865
    s_lshl_b32 s44, s29, 2
    s_lshr_b64 s[46:47], s[46:47], s44
    s_and_b32 s17, s46, 15
    s_mul_i32 s23, s17, 52
    s_lshr_b32 s23, s23, 8
    s_mul_i32 s44, s23, 5
    s_sub_u32 s24, s17, s44
    s_and_b32 s45, s16, 1
    s_add_u32 s24, s24, s45
    s_cmp_ge_u32 s24, 5
    s_cselect_b32 s24, 0, s24
    s_cmp_ge_u32 s17, 10
    s_cselect_b32 s45, 10, s44
    s_add_u32 s17, s45, s24
    s_lshr_b32 s44, s2, 6
    s_lshl_b32 s44, s44, 1
    s_add_u32 s44, s44, s29
    s_and_b32 s44, s44, 7
    s_and_b32 s29, s29, 8
    s_add_u32 s29, s29, s44
    s_lshl_b32 s44, s16, 4
    s_add_u32 s29, s29, s44
    s_lshl_b32 s44, s24, 2
    s_add_u32 s44, s44, s3
    s_mul_i32 s20, s44, 40960
    s_add_u32 s20, s20, 13631488
    s_cmp_ge_u32 s17, 10
    s_cselect_b32 s20, 1073741824, s20
    s_lshr_b32 s44, s44, 1
    s_lshl_b32 s44, s44, 9
    s_add_u32 s25, s44, 688128
    s_lshl_b32 s44, s19, 2
    s_add_u32 s44, s44, s3
    s_mul_i32 s21, s44, 61440
    s_add_u32 s21, s21, 14680064
    s_lshr_b32 s44, s19, 1
    s_mul_i32 s44, s44, 2560
    s_add_u32 s26, s44, 655360
    s_and_b32 s44, s29, 7
    s_lshl_b32 s44, s44, 2
    s_add_u32 s44, s44, s3
    s_mul_i32 s22, s44, 61440
    s_add_u32 s22, s22, 18874368
    s_bfe_u32 s44, s29, 0x10002
    s_lshl_b32 s44, s44, 2
    s_add_u32 s44, s44, s3
    s_mul_i32 s44, s44, 1536
    s_add_u32 s27, s44, 675840
    s_mul_i32 s28, s3, 20480
    s_waitcnt vmcnt(0)
    v_cmp_gt_u32 vcc, 1, v11
    s_nop 0
    s_cbranch_vccnz Lslow8
Lback8:
    v_lshlrev_b32 v9, 7, v1
    v_mov_b32 v8, 0x40000000
    v_cmp_lt_i32 s[100:101], v1, 20
    s_nop 1
    v_cndmask_b32 v251, v8, v9, s[100:101]
    s_cmp_eq_u32 s31, 0
    s_cbranch_scc1 Lheven
    v_mov_b32 v11, 1
    v_mov_b32 v9, 0x40000000
    v_cmp_eq_i32 s[100:101], v1, 0
    s_nop 1
    v_cndmask_b32 v15, v9, 0, s[100:101]
    s_lshl_b32 s55, s16, 3
    s_add_u32 s55, s55, s23
    s_mul_i32 s52, s55, 20
    s_lshl_b32 s51, s24, 2
    s_add_u32 s52, s52, s51
    s_add_u32 s52, s52, s3
    s_lshl_b32 s52, s52, 10
    s_add_u32 s52, s52, 4194304
    s_mul_i32 s58, s16, 6144
    s_lshl_b32 s51, s3, 7
    s_add_u32 s58, s58, s51
    s_add_u32 s58, s58, 22021632
    s_cmp_ge_u32 s17, 10
    s_cselect_b32 s52, 1073741824, s52
    s_cselect_b32 s58, 1073741824, s58
    s_add_u32 s63, s52, 40960
    v_mov_b32 v34, -1
    v_mov_b32 v35, -1
    v_mov_b32 v36, -1
    v_mov_b32 v37, -1
    buffer_store_dwordx4 v[34:37], v0, s[40:43], s52 offen sc1
    buffer_store_dwordx4 v[34:37], v0, s[40:43], s63 offen sc1
    v_lshlrev_b32 v10, 3, v1
    v_lshlrev_b32 v9, 7, v1
    v_mov_b32 v8, 0x40000000
    v_cmp_lt_i32 s[100:101], v1, 12
    s_nop 1
    v_cndmask_b32 v30, v8, v9, s[100:101]
    s_mul_i32 s50, s3, 5120
    v_add_u32 v13, s50, v0
    v_and_b32 v9, 15, v1
    v_lshlrev_b32 v9, 3, v9
    v_lshrrev_b32 v8, 5, v1
    v_lshlrev_b32 v8, 2, v8
    v_add_u32 v8, v9, v8
    v_mov_b32 v9, 0x40000000
    v_and_b32 v7, 16, v1
    v_cmp_eq_i32 s[100:101], v7, 0
    s_nop 1
    v_cndmask_b32 v14, v9, v8, s[100:101]
    buffer_load_dword v250, v251, s[40:43], s26 offen offset:0 sc1
    s_lshl_b32 s51, s24, 2
    s_add_u32 s51, s51, s3
    s_lshl_b32 s51, s51, 6
    v_lshrrev_b32 v9, 2, v1
    v_mul_u32_u24 v9, 0x500, v9
    v_and_b32 v8, 3, v1
    v_lshlrev_b32 v8, 4, v8
    v_add_u32 v8, v9, v8
    s_waitcnt vmcnt(1)
    buffer_atomic_add v11, v15, s[40:43], s58 offen offset:0 sc1
    s_add_u32 s58, s58, 512
    v_add_u32 v16, s51, v8
    s_lshl_b32 s31, s3, 12
    s_add_u32 s31, s31, 143360
    v_and_b32 v9, 15, v1
    v_lshlrev_b32 v9, 6, v9
    v_lshrrev_b32 v8, 4, v1
    v_lshlrev_b32 v8, 4, v8
    v_add_u32 v8, v9, v8
    v_add_u32 v17, s31, v8
    v_lshlrev_b32 v9, 7, v1
    v_mov_b32 v8, 0x40000000
    v_cmp_lt_i32 s[100:101], v1, 4
    s_nop 1
    v_cndmask_b32 v19, v8, v9, s[100:101]
    v_add_u32 v20, s28, v0
    s_lshl_b32 s51, s3, 12
    s_add_u32 s51, s51, 143360
    v_and_b32 v9, 15, v1
    v_lshlrev_b32 v9, 4, v9
    v_add_u32 v21, s51, v9
    v_and_b32 v9, 15, v1
    v_mul_u32_u24 v9, 48, v9
    v_add_u32 v9, s51, v9
    v_add_u32 v22, 0xa00, v9
    v_lshrrev_b32 v9, 4, v1
    v_lshlrev_b32 v9, 3, v9
    v_add_u32 v23, v22, v9
    v_add_u32 v9, 32, v22
    v_lshrrev_b32 v8, 4, v1
    v_lshlrev_b32 v8, 2, v8
    v_add_u32 v24, v9, v8
    v_lshrrev_b32 v9, 4, v1
    v_min_u32 v9, 2, v9
    v_lshlrev_b32 v9, 4, v9
    v_add_u32 v22, v22, v9
    v_mov_b32 v9, 0x40000000
    v_cmp_lt_i32 s[100:101], v1, 48
    s_nop 1
    v_cndmask_b32 v25, v9, v0, s[100:101]
    s_mul_i32 s48, s18, 6144
    s_add_u32 s48, s48, 22020096
    s_mul_i32 s49, s18, 163840
    s_add_u32 s49, s49, s50
    s_add_u32 s49, s49, 4194304
    s_mul_i32 s51, s3, 5376
    s_add_u32 s51, s51, 81920
    v_and_b32 v9, 15, v1
    v_mul_u32_u24 v9, 0x150, v9
    v_lshrrev_b32 v8, 4, v1
    v_lshlrev_b32 v8, 4, v8
    v_add_u32 v8, v9, v8
    v_add_u32 v26, s51, v8
    v_mul_u32_u24 v9, 0x199a, v1
    v_lshrrev_b32 v32, 16, v9
    v_mul_u32_u24 v9, 10, v32
    v_sub_u32 v33, v1, v9
    s_lshl_b32 s51, s3, 2
    v_min_u32 v9, 3, v32
    v_add_u32 v32, s51, v9
    v_mul_u32_u24 v9, 0x150, v32
    v_lshlrev_b32 v8, 5, v33
    v_add_u32 v8, v9, v8
    v_add_u32 v27, 0x14000, v8
    s_and_b32 s51, s29, 7
    s_mul_i32 s51, s51, 10
    v_add_u32 v33, s51, v33
    s_lshl_b32 s51, s51, 8
    s_lshl_b32 s53, s3, 6
    s_add_u32 s51, s51, s53
    v_lshrrev_b32 v9, 2, v1
    v_lshlrev_b32 v9, 8, v9
    v_and_b32 v8, 3, v1
    v_lshlrev_b32 v8, 4, v8
    v_add_u32 v8, v9, v8
    v_add_u32 v8, s51, v8
    v_mov_b32 v9, 0x40000000
    v_cmp_lt_i32 s[100:101], v1, 40
    s_nop 1
    v_cndmask_b32 v28, v9, v8, s[100:101]
    v_mul_u32_u24 v9, 0x500, v32
    v_lshlrev_b32 v8, 4, v33
    v_add_u32 v8, v9, v8
    v_mov_b32 v9, 0x40000000
    v_cmp_lt_i32 s[100:101], v1, 40
    s_nop 1
    v_cndmask_b32 v29, v9, v8, s[100:101]
    v_mul_u32_u24 v9, 0x300, v1
    v_add_u32 v9, 0x2fc, v9
    v_mov_b32 v8, 0x40000000
    v_cmp_lt_i32 s[100:101], v1, 16
    s_nop 1
    v_cndmask_b32 v31, v8, v9, s[100:101]
    s_cmp_eq_u32 s3, 3
    s_cbranch_scc1 Lnow2b
    v_lshrrev_b32 v9, 4, v1
    v_lshlrev_b32 v9, 3, v9
    v_lshrrev_b32 v8, 2, v1
    v_and_b32 v8, 3, v8
    v_add_u32 v8, v9, v8
    v_mul_u32_u24 v8, 0x280, v8
    v_and_b32 v9, 3, v1
    v_lshlrev_b32 v9, 3, v9
    v_add_u32 v9, v8, v9
    v_add_u32 v17, s60, v9
    s_mul_i32 s56, s62, 983040
    s_mul_i32 s54, s61, 5120
    s_add_u32 s56, s56, s54
    s_add_u32 s56, s56, 18874368
    ds_read_b64_tr_b16 v[32:33], v17 offset:0
    ds_read_b64_tr_b16 v[34:35], v17 offset:2560
    ds_read_b64_tr_b16 v[36:37], v17 offset:32
    ds_read_b64_tr_b16 v[38:39], v17 offset:2592
    ds_read_b64_tr_b16 v[40:41], v17 offset:64
    ds_read_b64_tr_b16 v[42:43], v17 offset:2624
    ds_read_b64_tr_b16 v[44:45], v17 offset:96
    ds_read_b64_tr_b16 v[46:47], v17 offset:2656
    ds_read_b64_tr_b16 v[48:49], v17 offset:128
    ds_read_b64_tr_b16 v[50:51], v17 offset:2688
    ds_read_b64_tr_b16 v[52:53], v17 offset:160
    ds_read_b64_tr_b16 v[54:55], v17 offset:2720
    s_waitcnt lgkmcnt(10)
    buffer_store_dwordx4 v[32:35], v0, s[40:43], s56 offen offset:0 sc1
    ds_read_b64_tr_b16 v[56:57], v17 offset:192
    ds_read_b64_tr_b16 v[58:59], v17 offset:2752
    s_waitcnt lgkmcnt(10)
    buffer_store_dwordx4 v[36:39], v0, s[40:43], s56 offen offset:1024 sc1
    ds_read_b64_tr_b16 v[60:61], v17 offset:224
    ds_read_b64_tr_b16 v[62:63], v17 offset:2784
    s_waitcnt lgkmcnt(10)
    buffer_store_dwordx4 v[40:43], v0, s[40:43], s56 offen offset:2048 sc1
    ds_read_b64_tr_b16 v[64:65], v17 offset:256
    ds_read_b64_tr_b16 v[66:67], v17 offset:2816
    s_waitcnt lgkmcnt(10)
    buffer_store_dwordx4 v[44:47], v0, s[40:43], s56 offen offset:3072 sc1
    ds_read_b64_tr_b16 v[68:69], v17 offset:288
    ds_read_b64_tr_b16 v[70:71], v17 offset:2848
    s_add_u32 s56, s56, 4096
    s_waitcnt lgkmcnt(10)
    buffer_store_dwordx4 v[48:51], v0, s[40:43], s56 offen offset:0 sc1
    ds_read_b64_tr_b16 v[72:73], v17 offset:320
    ds_read_b64_tr_b16 v[74:75], v17 offset:2880
    s_add_u32 s56, s56, 241664
    s_waitcnt lgkmcnt(10)
    buffer_store_dwordx4 v[52:55], v0, s[40:43], s56 offen offset:0 sc1
    ds_read_b64_tr_b16 v[76:77], v17 offset:352
    ds_read_b64_tr_b16 v[78:79], v17 offset:2912
    s_waitcnt lgkmcnt(10)
    buffer_store_dwordx4 v[56:59], v0, s[40:43], s56 offen offset:1024 sc1
    ds_read_b64_tr_b16 v[80:81], v17 offset:384
    ds_read_b64_tr_b16 v[82:83], v17 offset:2944
    s_waitcnt lgkmcnt(10)
    buffer_store_dwordx4 v[60:63], v0, s[40:43], s56 offen offset:2048 sc1
    ds_read_b64_tr_b16 v[84:85], v17 offset:416
    ds_read_b64_tr_b16 v[86:87], v17 offset:2976
    s_waitcnt lgkmcnt(10)
    buffer_store_dwordx4 v[64:67], v0, s[40:43], s56 offen offset:3072 sc1
    ds_read_b64_tr_b16 v[88:89], v17 offset:448
    ds_read_b64_tr_b16 v[90:91], v17 offset:3008
    s_add_u32 s56, s56, 4096
    s_waitcnt lgkmcnt(10)
    buffer_store_dwordx4 v[68:71], v0, s[40:43], s56 offen offset:0 sc1
    ds_read_b64_tr_b16 v[92:93], v17 offset:480
    ds_read_b64_tr_b16 v[94:95], v17 offset:3040
    s_add_u32 s56, s56, 241664
    s_waitcnt lgkmcnt(10)
    buffer_store_dwordx4 v[72:75], v0, s[40:43], s56 offen offset:0 sc1
    ds_read_b64_tr_b16 v[96:97], v17 offset:512
    ds_read_b64_tr_b16 v[98:99], v17 offset:3072
    s_waitcnt lgkmcnt(10)
    buffer_store_dwordx4 v[76:79], v0, s[40:43], s56 offen offset:1024 sc1
    ds_read_b64_tr_b16 v[100:101], v17 offset:544
    ds_read_b64_tr_b16 v[102:103], v17 offset:3104
    s_waitcnt lgkmcnt(10)
    buffer_store_dwordx4 v[80:83], v0, s[40:43], s56 offen offset:2048 sc1
    ds_read_b64_tr_b16 v[104:105], v17 offset:576
    ds_read_b64_tr_b16 v[106:107], v17 offset:3136
    s_waitcnt lgkmcnt(10)
    buffer_store_dwordx4 v[84:87], v0, s[40:43], s56 offen offset:3072 sc1
    ds_read_b64_tr_b16 v[108:109], v17 offset:608
    ds_read_b64_tr_b16 v[110:111], v17 offset:3168
    s_add_u32 s56, s56, 4096
    s_waitcnt lgkmcnt(10)
    buffer_store_dwordx4 v[88:91], v0, s[40:43], s56 offen offset:0 sc1
    s_add_u32 s56, s56, 241664
    s_waitcnt lgkmcnt(8)
    buffer_store_dwordx4 v[92:95], v0, s[40:43], s56 offen offset:0 sc1
    s_waitcnt lgkmcnt(6)
    buffer_store_dwordx4 v[96:99], v0, s[40:43], s56 offen offset:1024 sc1
    s_waitcnt lgkmcnt(4)
    buffer_store_dwordx4 v[100:103], v0, s[40:43], s56 offen offset:2048 sc1
    s_waitcnt lgkmcnt(2)
    buffer_store_dwordx4 v[104:107], v0, s[40:43], s56 offen offset:3072 sc1
    s_add_u32 s56, s56, 4096
    s_waitcnt lgkmcnt(0)
    buffer_store_dwordx4 v[108:111], v0, s[40:43], s56 offen offset:0 sc1
Lnow2b:
    buffer_load_dword v17, v0, s[36:39], 0 offen offset:2048
    s_cmp_eq_u32 s3, 3
    s_cselect_b32 s30, 1073741824, s30
    s_waitcnt vmcnt(2)
    v_cmp_gt_u32 s[96:97], 1, v250
    s_nop 0
    s_and_b32 s96, s96, 0xfffff
    s_cbranch_scc1 Lslow9
Lback9:
    buffer_load_dwordx4 a[160:163], v0, s[40:43], s21 offen offset:0 sc1
    buffer_load_dwordx4 a[164:167], v0, s[40:43], s21 offen offset:1024 sc1
    buffer_load_dwordx4 a[168:171], v0, s[40:43], s21 offen offset:2048 sc1
    buffer_load_dwordx4 a[172:175], v0, s[40:43], s21 offen offset:3072 sc1
    s_add_u32 s21, s21, 4096
    buffer_load_dwordx4 a[176:179], v0, s[40:43], s21 offen offset:0 sc1
    buffer_load_dwordx4 a[180:183], v0, s[40:43], s21 offen offset:1024 sc1
    buffer_load_dwordx4 a[184:187], v0, s[40:43], s21 offen offset:2048 sc1
    buffer_load_dwordx4 a[188:191], v0, s[40:43], s21 offen offset:3072 sc1
    s_add_u32 s21, s21, 4096
    buffer_load_dwordx4 a[192:195], v0, s[40:43], s21 offen offset:0 sc1
    buffer_load_dwordx4 a[196:199], v0, s[40:43], s21 offen offset:1024 sc1
    s_waitcnt vmcnt(10)
    buffer_store_dword v11, v15, s[40:43], s30 offen sc1
    buffer_load_dwordx4 a[200:203], v0, s[40:43], s21 offen offset:2048 sc1
    buffer_load_dwordx4 a[204:207], v0, s[40:43], s21 offen offset:3072 sc1
    s_add_u32 s21, s21, 4096
    buffer_load_dwordx4 a[208:211], v0, s[40:43], s21 offen offset:0 sc1
    buffer_load_dwordx4 a[212:215], v0, s[40:43], s21 offen offset:1024 sc1
    buffer_load_dwordx4 a[216:219], v0, s[40:43], s21 offen offset:2048 sc1
    buffer_load_dwordx4 a[220:223], v0, s[40:43], s21 offen offset:3072 sc1
    s_add_u32 s21, s21, 4096
    buffer_load_dwordx4 a[224:227], v0, s[40:43], s21 offen offset:0 sc1
    buffer_load_dwordx4 a[228:231], v0, s[40:43], s21 offen offset:1024 sc1
    buffer_load_dwordx4 a[232:235], v0, s[40:43], s21 offen offset:2048 sc1
    buffer_load_dwordx4 a[236:239], v0, s[40:43], s21 offen offset:3072 sc1
    s_add_u32 s21, s21, 4096
    buffer_load_dwordx4 a[240:243], v0, s[40:43], s21 offen offset:0 sc1
    buffer_load_dwordx4 a[244:247], v0, s[40:43], s21 offen offset:1024 sc1
    buffer_load_dwordx4 a[248:251], v0, s[40:43], s21 offen offset:2048 sc1
    buffer_load_dwordx4 a[252:255], v0, s[40:43], s21 offen offset:3072 sc1
    s_add_u32 s21, s21, 4096
    buffer_load_dwordx4 v[168:171], v0, s[40:43], s21 offen offset:0 sc1
    buffer_load_dwordx4 v[172:175], v0, s[40:43], s21 offen offset:1024 sc1
    buffer_load_dwordx4 v[176:179], v0, s[40:43], s21 offen offset:2048 sc1
    buffer_load_dwordx4 v[180:183], v0, s[40:43], s21 offen offset:3072 sc1
    s_add_u32 s21, s21, 4096
    buffer_load_dwordx4 v[184:187], v0, s[40:43], s21 offen offset:0 sc1
    buffer_load_dwordx4 v[188:191], v0, s[40:43], s21 offen offset:1024 sc1
    buffer_load_dwordx4 v[192:195], v0, s[40:43], s21 offen offset:2048 sc1
    buffer_load_dwordx4 v[196:199], v0, s[40:43], s21 offen offset:3072 sc1
    s_add_u32 s21, s21, 4096
    buffer_load_dwordx4 v[200:203], v0, s[40:43], s21 offen offset:0 sc1
    buffer_load_dwordx4 v[204:207], v0, s[40:43], s21 offen offset:1024 sc1
    buffer_load_dwordx4 v[208:211], v0, s[40:43], s21 offen offset:2048 sc1
    buffer_load_dwordx4 v[212:215], v0, s[40:43], s21 offen offset:3072 sc1
    s_add_u32 s21, s21, 4096
    buffer_load_dwordx4 v[216:219], v0, s[40:43], s21 offen offset:0 sc1
    buffer_load_dwordx4 v[220:223], v0, s[40:43], s21 offen offset:1024 sc1
    buffer_load_dwordx4 v[224:227], v0, s[40:43], s21 offen offset:2048 sc1
    buffer_load_dwordx4 v[228:231], v0, s[40:43], s21 offen offset:3072 sc1
    s_add_u32 s21, s21, 4096
    buffer_load_dwordx4 v[232:235], v0, s[40:43], s21 offen offset:0 sc1
    buffer_load_dwordx4 v[236:239], v0, s[40:43], s21 offen offset:1024 sc1
    buffer_load_dwordx4 v[240:243], v0, s[40:43], s21 offen offset:2048 sc1
    buffer_load_dwordx4 v[244:247], v0, s[40:43], s21 offen offset:3072 sc1
    s_add_u32 s21, s21, 4096
    buffer_load_dwordx4 v[248:251], v0, s[40:43], s21 offen offset:0 sc1
    buffer_load_dwordx4 v[252:255], v0, s[40:43], s21 offen offset:1024 sc1
    buffer_load_dwordx4 v[112:115], v0, s[40:43], s21 offen offset:2048 sc1
    buffer_load_dwordx4 v[116:119], v0, s[40:43], s21 offen offset:3072 sc1
    s_add_u32 s21, s21, 4096
    buffer_load_dwordx4 v[120:123], v0, s[40:43], s21 offen offset:0 sc1
    buffer_load_dwordx4 v[124:127], v0, s[40:43], s21 offen offset:1024 sc1
    buffer_load_dwordx4 v[128:131], v0, s[40:43], s21 offen offset:2048 sc1
    buffer_load_dwordx4 v[132:135], v0, s[40:43], s21 offen offset:3072 sc1
    s_add_u32 s21, s21, 4096
    buffer_load_dwordx4 v[136:139], v0, s[40:43], s21 offen offset:0 sc1
    buffer_load_dwordx4 v[140:143], v0, s[40:43], s21 offen offset:1024 sc1
    buffer_load_dwordx4 v[144:147], v0, s[40:43], s21 offen offset:2048 sc1
    buffer_load_dwordx4 v[148:151], v0, s[40:43], s21 offen offset:3072 sc1
    s_add_u32 s21, s21, 4096
    buffer_load_dwordx4 v[152:155], v0, s[40:43], s21 offen offset:0 sc1
    buffer_load_dwordx4 v[156:159], v0, s[40:43], s21 offen offset:1024 sc1
    buffer_load_dwordx4 v[160:163], v0, s[40:43], s21 offen offset:2048 sc1
    buffer_load_dwordx4 v[164:167], v0, s[40:43], s21 offen offset:3072 sc1
    s_add_u32 s21, s21, 4096
    s_lshl_b32 s30, s18, 7
    s_add_u32 s30, s30, s19
    s_lshl_b32 s30, s30, 2
    s_add_u32 s30, s30, s3
    s_mul_i32 s30, s30, 768
    s_add_u32 s30, s30, 7536640
    v_mov_b32 v6, -1
    v_mov_b32 v7, -1
    v_mov_b32 v8, -1
    v_mov_b32 v9, -1
    v_add_u32 v5, 81920, v13
    s_branch LidleQ
Lheven:
Lwh_4:
    s_cbranch_execz Lwh_5
    v_lshlrev_b32 v9, 7, v1
    v_mov_b32 v8, 0x40000000
    v_cmp_lt_i32 s[100:101], v1, 4
    s_nop 1
    v_cndmask_b32 v10, v8, v9, s[100:101]
    buffer_load_dword v11, v10, s[40:43], s25 offen offset:0 sc1
    s_waitcnt vmcnt(0)
    v_cmp_gt_u32 vcc, 1, v11
    s_nop 0
    s_and_b32 vcc_lo, vcc_lo, 0xf
    s_cbranch_scc1 Lslow10
Lback10:
    v_mov_b32 v11, 1
    v_mov_b32 v9, 0x40000000
    v_cmp_eq_i32 s[100:101], v1, 0
    s_nop 1
    v_cndmask_b32 v15, v9, 0, s[100:101]
    s_lshl_b32 s55, s16, 3
    s_add_u32 s55, s55, s23
    s_mul_i32 s52, s55, 20
    s_lshl_b32 s51, s24, 2
    s_add_u32 s52, s52, s51
    s_add_u32 s52, s52, s3
    s_lshl_b32 s52, s52, 10
    s_add_u32 s52, s52, 4194304
    s_mul_i32 s58, s16, 6144
    s_lshl_b32 s51, s3, 7
    s_add_u32 s58, s58, s51
    s_add_u32 s58, s58, 22021632
    s_cmp_ge_u32 s17, 10
    s_cselect_b32 s52, 1073741824, s52
    s_cselect_b32 s58, 1073741824, s58
    s_add_u32 s63, s52, 40960
    v_mov_b32 v34, -1
    v_mov_b32 v35, -1
    v_mov_b32 v36, -1
    v_mov_b32 v37, -1
    buffer_store_dwordx4 v[34:37], v0, s[40:43], s52 offen sc1
    buffer_store_dwordx4 v[34:37], v0, s[40:43], s63 offen sc1
    v_lshlrev_b32 v10, 3, v1
    v_lshlrev_b32 v9, 7, v1
    v_mov_b32 v8, 0x40000000
    v_cmp_lt_i32 s[100:101], v1, 12
    s_nop 1
    v_cndmask_b32 v30, v8, v9, s[100:101]
    s_mul_i32 s50, s3, 5120
    v_add_u32 v13, s50, v0
    v_and_b32 v9, 15, v1
    v_lshlrev_b32 v9, 3, v9
    v_lshrrev_b32 v8, 5, v1
    v_lshlrev_b32 v8, 2, v8
    v_add_u32 v8, v9, v8
    v_mov_b32 v9, 0x40000000
    v_and_b32 v7, 16, v1
    v_cmp_eq_i32 s[100:101], v7, 0
    s_nop 1
    v_cndmask_b32 v14, v9, v8, s[100:101]
    buffer_load_dwordx4 a[0:3], v0, s[40:43], s20 offen offset:0 sc1
    s_lshl_b32 s51, s24, 2
    s_add_u32 s51, s51, s3
    s_lshl_b32 s51, s51, 6
    v_lshrrev_b32 v9, 2, v1
    v_mul_u32_u24 v9, 0x500, v9
    v_and_b32 v8, 3, v1
    v_lshlrev_b32 v8, 4, v8
    v_add_u32 v8, v9, v8
    buffer_load_dwordx4 a[4:7], v0, s[40:43], s20 offen offset:1024 sc1
    v_add_u32 v16, s51, v8
    s_lshl_b32 s31, s3, 12
    s_add_u32 s31, s31, 143360
    v_and_b32 v9, 15, v1
    v_lshlrev_b32 v9, 6, v9
    v_lshrrev_b32 v8, 4, v1
    v_lshlrev_b32 v8, 4, v8
    v_add_u32 v8, v9, v8
    buffer_load_dwordx4 a[8:11], v0, s[40:43], s20 offen offset:2048 sc1
    v_add_u32 v17, s31, v8
    v_lshlrev_b32 v9, 7, v1
    v_mov_b32 v8, 0x40000000
    v_cmp_lt_i32 s[100:101], v1, 4
    s_nop 1
    v_cndmask_b32 v19, v8, v9, s[100:101]
    v_add_u32 v20, s28, v0
    s_lshl_b32 s51, s3, 12
    s_add_u32 s51, s51, 143360
    v_and_b32 v9, 15, v1
    buffer_load_dwordx4 a[12:15], v0, s[40:43], s20 offen offset:3072 sc1
    s_add_u32 s20, s20, 4096
    v_lshlrev_b32 v9, 4, v9
    v_add_u32 v21, s51, v9
    v_and_b32 v9, 15, v1
    v_mul_u32_u24 v9, 48, v9
    v_add_u32 v9, s51, v9
    v_add_u32 v22, 0xa00, v9
    v_lshrrev_b32 v9, 4, v1
    v_lshlrev_b32 v9, 3, v9
    buffer_load_dwordx4 a[16:19], v0, s[40:43], s20 offen offset:0 sc1
    v_add_u32 v23, v22, v9
    v_add_u32 v9, 32, v22
    v_lshrrev_b32 v8, 4, v1
    v_lshlrev_b32 v8, 2, v8
    v_add_u32 v24, v9, v8
    v_lshrrev_b32 v9, 4, v1
    v_min_u32 v9, 2, v9
    v_lshlrev_b32 v9, 4, v9
    buffer_load_dwordx4 a[20:23], v0, s[40:43], s20 offen offset:1024 sc1
    v_add_u32 v22, v22, v9
    v_mov_b32 v9, 0x40000000
    v_cmp_lt_i32 s[100:101], v1, 48
    s_nop 1
    v_cndmask_b32 v25, v9, v0, s[100:101]
    s_mul_i32 s48, s18, 6144
    s_add_u32 s48, s48, 22020096
    s_mul_i32 s49, s18, 163840
    s_add_u32 s49, s49, s50
    s_add_u32 s49, s49, 4194304
    s_mul_i32 s51, s3, 5376
    s_add_u32 s51, s51, 81920
    v_and_b32 v9, 15, v1
    buffer_load_dwordx4 a[24:27], v0, s[40:43], s20 offen offset:2048 sc1
    v_mul_u32_u24 v9, 0x150, v9
    v_lshrrev_b32 v8, 4, v1
    v_lshlrev_b32 v8, 4, v8
    v_add_u32 v8, v9, v8
    v_add_u32 v26, s51, v8
    v_mul_u32_u24 v9, 0x199a, v1
    v_lshrrev_b32 v32, 16, v9
    v_mul_u32_u24 v9, 10, v32
    buffer_load_dwordx4 a[28:31], v0, s[40:43], s20 offen offset:3072 sc1
    s_add_u32 s20, s20, 4096
    v_sub_u32 v33, v1, v9
    s_lshl_b32 s51, s3, 2
    v_min_u32 v9, 3, v32
    v_add_u32 v32, s51, v9
    v_mul_u32_u24 v9, 0x150, v32
    v_lshlrev_b32 v8, 5, v33
    v_add_u32 v8, v9, v8
    v_add_u32 v27, 0x14000, v8
    s_waitcnt vmcnt(8)
    buffer_atomic_add v11, v15, s[40:43], s58 offen offset:0 sc1
    s_add_u32 s58, s58, 512
    s_and_b32 s51, s29, 7
    s_mul_i32 s51, s51, 10
    v_add_u32 v33, s51, v33
Lwh_5:
    s_cbranch_execz Lwh_6
    s_lshl_b32 s51, s51, 8
    s_lshl_b32 s53, s3, 6
    s_add_u32 s51, s51, s53
    v_lshrrev_b32 v9, 2, v1
    v_lshlrev_b32 v9, 8, v9
    buffer_load_dwordx4 a[32:35], v0, s[40:43], s20 offen offset:0 sc1
    v_and_b32 v8, 3, v1
    v_lshlrev_b32 v8, 4, v8
    v_add_u32 v8, v9, v8
    v_add_u32 v8, s51, v8
    v_mov_b32 v9, 0x40000000
    v_cmp_lt_i32 s[100:101], v1, 40
    s_nop 1
    v_cndmask_b32 v28, v9, v8, s[100:101]
    v_mul_u32_u24 v9, 0x500, v32
    buffer_load_dwordx4 a[36:39], v0, s[40:43], s20 offen offset:1024 sc1
    v_lshlrev_b32 v8, 4, v33
    v_add_u32 v8, v9, v8
    v_mov_b32 v9, 0x40000000
    v_cmp_lt_i32 s[100:101], v1, 40
    s_nop 1
    v_cndmask_b32 v29, v9, v8, s[100:101]
    v_mul_u32_u24 v9, 0x300, v1
    v_add_u32 v9, 0x2fc, v9
    v_mov_b32 v8, 0x40000000
    buffer_load_dwordx4 a[40:43], v0, s[40:43], s20 offen offset:2048 sc1
    v_cmp_lt_i32 s[100:101], v1, 16
    s_nop 1
    v_cndmask_b32 v31, v8, v9, s[100:101]
    buffer_load_dwordx4 a[44:47], v0, s[40:43], s20 offen offset:3072 sc1
    s_add_u32 s20, s20, 4096
    buffer_load_dwordx4 a[48:51], v0, s[40:43], s20 offen offset:0 sc1
    buffer_load_dwordx4 a[52:55], v0, s[40:43], s20 offen offset:1024 sc1
    s_mov_b64 exec, 0
    s_cmp_eq_u32 s3, 2
    s_cbranch_scc1 Lidbev
    s_cmp_eq_u32 s3, 3
    s_cbranch_scc1 Lidcev
    s_cmp_eq_u32 s3, 0
    s_cbranch_scc1 Liddev
    s_call_b64 s[98:99], Lwc0_0
    s_branch Liddev
Lidbev:
    s_call_b64 s[98:99], Lwc1_0
    s_branch Liddev
Lidcev:
    s_call_b64 s[98:99], Lwc2_0
Liddev:
    s_mov_b64 exec, -1
    buffer_load_dwordx4 a[56:59], v0, s[40:43], s20 offen offset:2048 sc1
    buffer_load_dwordx4 a[60:63], v0, s[40:43], s20 offen offset:3072 sc1
    s_add_u32 s20, s20, 4096
    buffer_load_dwordx4 a[64:67], v0, s[40:43], s20 offen offset:0 sc1
    buffer_load_dwordx4 a[68:71], v0, s[40:43], s20 offen offset:1024 sc1
    buffer_load_dwordx4 a[72:75], v0, s[40:43], s20 offen offset:2048 sc1
    buffer_load_dwordx4 a[76:79], v0, s[40:43], s20 offen offset:3072 sc1
    s_add_u32 s20, s20, 4096
    buffer_load_dwordx4 a[80:83], v0, s[40:43], s20 offen offset:0 sc1
    buffer_load_dwordx4 a[84:87], v0, s[40:43], s20 offen offset:1024 sc1
    buffer_load_dwordx4 a[88:91], v0, s[40:43], s20 offen offset:2048 sc1
    buffer_load_dwordx4 a[92:95], v0, s[40:43], s20 offen offset:3072 sc1
    s_add_u32 s20, s20, 4096
    buffer_load_dwordx4 a[96:99], v0, s[40:43], s20 offen offset:0 sc1
    buffer_load_dwordx4 a[100:103], v0, s[40:43], s20 offen offset:1024 sc1
    buffer_load_dwordx4 a[104:107], v0, s[40:43], s20 offen offset:2048 sc1
    buffer_load_dword v250, v251, s[40:43], s26 offen offset:0 sc1
    buffer_load_dwordx4 a[108:111], v0, s[40:43], s20 offen offset:3072 sc1
    s_add_u32 s20, s20, 4096
    buffer_load_dwordx4 a[112:115], v0, s[40:43], s20 offen offset:0 sc1
    buffer_load_dwordx4 a[116:119], v0, s[40:43], s20 offen offset:1024 sc1
    buffer_load_dwordx4 a[120:123], v0, s[40:43], s20 offen offset:2048 sc1
    buffer_load_dwordx4 a[124:127], v0, s[40:43], s20 offen offset:3072 sc1
    s_add_u32 s20, s20, 4096
    buffer_load_dwordx4 a[128:131], v0, s[40:43], s20 offen offset:0 sc1
    buffer_load_dwordx4 a[132:135], v0, s[40:43], s20 offen offset:1024 sc1
    buffer_load_dwordx4 a[136:139], v0, s[40:43], s20 offen offset:2048 sc1
    buffer_load_dwordx4 a[140:143], v0, s[40:43], s20 offen offset:3072 sc1
    s_add_u32 s20, s20, 4096
    buffer_load_dwordx4 a[144:147], v0, s[40:43], s20 offen offset:0 sc1
    buffer_load_dwordx4 a[148:151], v0, s[40:43], s20 offen offset:1024 sc1
    buffer_load_dwordx4 a[152:155], v0, s[40:43], s20 offen offset:2048 sc1
    buffer_load_dwordx4 a[156:159], v0, s[40:43], s20 offen offset:3072 sc1
    s_add_u32 s20, s20, 4096
    s_waitcnt vmcnt(13)
    v_cmp_gt_u32 s[96:97], 1, v250
    s_nop 0
    s_and_b32 s96, s96, 0xfffff
    s_cbranch_scc1 Lslow11
Lback11:
    buffer_load_dwordx4 a[160:163], v0, s[40:43], s21 offen offset:0 sc1
    buffer_load_dwordx4 a[164:167], v0, s[40:43], s21 offen offset:1024 sc1
    buffer_load_dwordx4 a[168:171], v0, s[40:43], s21 offen offset:2048 sc1
    buffer_load_dwordx4 a[172:175], v0, s[40:43], s21 offen offset:3072 sc1
    s_add_u32 s21, s21, 4096
    buffer_load_dwordx4 a[176:179], v0, s[40:43], s21 offen offset:0 sc1
    buffer_load_dwordx4 a[180:183], v0, s[40:43], s21 offen offset:1024 sc1
    buffer_load_dwordx4 a[184:187], v0, s[40:43], s21 offen offset:2048 sc1
    buffer_load_dwordx4 a[188:191], v0, s[40:43], s21 offen offset:3072 sc1
    s_add_u32 s21, s21, 4096
    buffer_load_dwordx4 a[192:195], v0, s[40:43], s21 offen offset:0 sc1
    buffer_load_dwordx4 a[196:199], v0, s[40:43], s21 offen offset:1024 sc1
    buffer_load_dwordx4 a[200:203], v0, s[40:43], s21 offen offset:2048 sc1
    buffer_load_dwordx4 a[204:207], v0, s[40:43], s21 offen offset:3072 sc1
    s_add_u32 s21, s21, 4096
    buffer_load_dwordx4 a[208:211], v0, s[40:43], s21 offen offset:0 sc1
    buffer_load_dwordx4 a[212:215], v0, s[40:43], s21 offen offset:1024 sc1
    buffer_load_dwordx4 a[216:219], v0, s[40:43], s21 offen offset:2048 sc1
    buffer_load_dwordx4 a[220:223], v0, s[40:43], s21 offen offset:3072 sc1
    s_add_u32 s21, s21, 4096
    buffer_load_dwordx4 a[224:227], v0, s[40:43], s21 offen offset:0 sc1
    buffer_load_dwordx4 a[228:231], v0, s[40:43], s21 offen offset:1024 sc1
    buffer_load_dwordx4 a[232:235], v0, s[40:43], s21 offen offset:2048 sc1
    buffer_load_dwordx4 a[236:239], v0, s[40:43], s21 offen offset:3072 sc1
    s_add_u32 s21, s21, 4096
    buffer_load_dwordx4 a[240:243], v0, s[40:43], s21 offen offset:0 sc1
    buffer_load_dwordx4 a[244:247], v0, s[40:43], s21 offen offset:1024 sc1
    buffer_load_dwordx4 a[248:251], v0, s[40:43], s21 offen offset:2048 sc1
    buffer_load_dwordx4 a[252:255], v0, s[40:43], s21 offen offset:3072 sc1
    s_add_u32 s21, s21, 4096
    buffer_load_dwordx4 v[168:171], v0, s[40:43], s21 offen offset:0 sc1
    buffer_load_dwordx4 v[172:175], v0, s[40:43], s21 offen offset:1024 sc1
    buffer_load_dwordx4 v[176:179], v0, s[40:43], s21 offen offset:2048 sc1
    buffer_load_dwordx4 v[180:183], v0, s[40:43], s21 offen offset:3072 sc1
    s_add_u32 s21, s21, 4096
    buffer_load_dwordx4 v[184:187], v0, s[40:43], s21 offen offset:0 sc1
    buffer_load_dwordx4 v[188:191], v0, s[40:43], s21 offen offset:1024 sc1
    buffer_load_dwordx4 v[192:195], v0, s[40:43], s21 offen offset:2048 sc1
    buffer_load_dwordx4 v[196:199], v0, s[40:43], s21 offen offset:3072 sc1
    s_add_u32 s21, s21, 4096
    buffer_load_dwordx4 v[200:203], v0, s[40:43], s21 offen offset:0 sc1
    buffer_load_dwordx4 v[204:207], v0, s[40:43], s21 offen offset:1024 sc1
    buffer_load_dwordx4 v[208:211], v0, s[40:43], s21 offen offset:2048 sc1
    buffer_load_dwordx4 v[212:215], v0, s[40:43], s21 offen offset:3072 sc1
    s_add_u32 s21, s21, 4096
    buffer_load_dwordx4 v[216:219], v0, s[40:43], s21 offen offset:0 sc1
    buffer_load_dwordx4 v[220:223], v0, s[40:43], s21 offen offset:1024 sc1
    buffer_load_dwordx4 v[224:227], v0, s[40:43], s21 offen offset:2048 sc1
    buffer_load_dwordx4 v[228:231], v0, s[40:43], s21 offen offset:3072 sc1
    s_add_u32 s21, s21, 4096
    buffer_load_dwordx4 v[232:235], v0, s[40:43], s21 offen offset:0 sc1
    buffer_load_dwordx4 v[236:239], v0, s[40:43], s21 offen offset:1024 sc1
    buffer_load_dwordx4 v[240:243], v0, s[40:43], s21 offen offset:2048 sc1
    buffer_load_dwordx4 v[244:247], v0, s[40:43], s21 offen offset:3072 sc1
    s_add_u32 s21, s21, 4096
    buffer_load_dwordx4 v[248:251], v0, s[40:43], s21 offen offset:0 sc1
    buffer_load_dwordx4 v[252:255], v0, s[40:43], s21 offen offset:1024 sc1
Ljoin:
Lwc0_0:
    s_cbranch_execz Lwc0_1
    s_lshl_b32 s30, s18, 7
    s_add_u32 s30, s30, s19
    s_lshl_b32 s30, s30, 2
    s_add_u32 s30, s30, s3
    s_mul_i32 s30, s30, 768
    s_add_u32 s30, s30, 7536640
    v_mov_b32 v6, -1
    v_mov_b32 v7, -1
    v_mov_b32 v8, -1
    v_mov_b32 v9, -1
    v_add_u32 v5, 81920, v13
LcodeB:
    s_mul_i32 s59, s55, 20480
    s_add_u32 m0, s31, 0
    s_add_u32 s51, s59, 0
    buffer_load_dwordx4 v16, s[8:11], s51 offen lds
    s_add_u32 m0, s31, 1024
    s_add_u32 s51, s59, 40960
    buffer_load_dwordx4 v16, s[8:11], s51 offen lds
    s_add_u32 m0, s31, 2048
    s_add_u32 s51, s59, 81920
    buffer_load_dwordx4 v16, s[8:11], s51 offen lds
    s_add_u32 m0, s31, 3072
    s_add_u32 s51, s59, 122880
    buffer_load_dwordx4 v16, s[8:11], s51 offen lds
    s_waitcnt vmcnt(62)
    buffer_load_dwordx4 v[112:115], v0, s[40:43], s21 offen offset:2048 sc1
    s_waitcnt vmcnt(62)
    buffer_load_dwordx4 v[116:119], v0, s[40:43], s21 offen offset:3072 sc1
    s_add_u32 s21, s21, 4096
    s_add_u32 s44, s59, s50
    s_add_u32 s44, s44, 1048576
    s_add_u32 s45, s44, 40960
    s_add_u32 s46, s44, 81920
    s_add_u32 s47, s44, 122880
    s_lshl_b32 s57, s55, 7
    s_add_u32 s57, s57, 73728
    s_mul_i32 s61, s16, 6144
    s_add_u32 s61, s61, 22020096
    s_lshl_b32 s51, s23, 7
    s_add_u32 s60, s61, s51
    s_cmp_eq_u32 s3, 0
    s_cselect_b32 s61, s61, 1073741824
    s_cmp_eq_u32 s3, 0
    s_cselect_b32 s60, s60, 1073741824
    v_mov_b32 v12, 0
    s_waitcnt vmcnt(62)
    buffer_atomic_or v12, v15, s[40:43], s60 offen offset:1024 sc0 sc1
    s_waitcnt vmcnt(62)
    buffer_load_dwordx4 v[120:123], v0, s[40:43], s21 offen offset:0 sc1
    s_waitcnt vmcnt(62)
    buffer_load_dwordx4 v[124:127], v0, s[40:43], s21 offen offset:1024 sc1
    s_waitcnt vmcnt(62)
    buffer_load_dwordx4 v[128:131], v0, s[40:43], s21 offen offset:2048 sc1
    s_waitcnt vmcnt(62)
    buffer_load_dwordx4 v[132:135], v0, s[40:43], s21 offen offset:3072 sc1
    s_add_u32 s21, s21, 4096
    s_waitcnt vmcnt(62)
    buffer_load_dwordx4 v[136:139], v0, s[40:43], s21 offen offset:0 sc1
    s_waitcnt vmcnt(62)
    buffer_load_dwordx4 v[140:143], v0, s[40:43], s21 offen offset:1024 sc1
    s_cmp_lg_u32 s3, 0
    s_cbranch_scc1 Lidle12
    s_waitcnt vmcnt(6)
    v_cmp_gt_u32 vcc, 8, v12
    s_nop 0
    s_and_b32 vcc_lo, vcc_lo, 0x1
    s_cbranch_scc1 Lslow12
Lback12:
    s_branch Lmeet12
Lidle12:
Lmeet12:
    s_barrier
    s_add_u32 m0, s50, 0
    s_waitcnt vmcnt(62)
    buffer_load_dwordx4 v0, s[40:43], s44 offen offset:0 sc1 lds
    s_add_u32 m0, s50, 0
    s_waitcnt vmcnt(62)
    buffer_load_dwordx4 v0, s[40:43], s44 offen offset:1024 sc1 lds
    s_add_u32 m0, s50, 0
    s_waitcnt vmcnt(62)
    buffer_load_dwordx4 v0, s[40:43], s44 offen offset:2048 sc1 lds
    s_add_u32 m0, s50, 0
    s_waitcnt vmcnt(62)
    buffer_load_dwordx4 v0, s[40:43], s44 offen offset:3072 sc1 lds
    s_add_u32 m0, s50, 4096
    s_add_u32 s7, s44, 4096
    s_waitcnt vmcnt(62)
    buffer_load_dwordx4 v0, s[40:43], s7 offen sc1 lds
    v_add_u32 v18, 61440, v13
    v_add_u32 v16, 61440, v0
    v_add_u32 v4, 61440, v10
    s_add_u32 m0, s50, 20480
    s_waitcnt vmcnt(62)
    buffer_load_dwordx4 v0, s[40:43], s45 offen offset:0 sc1 lds
    s_add_u32 m0, s50, 20480
    s_waitcnt vmcnt(62)
    buffer_load_dwordx4 v0, s[40:43], s45 offen offset:1024 sc1 lds
    s_add_u32 m0, s50, 20480
    s_waitcnt vmcnt(62)
    buffer_load_dwordx4 v0, s[40:43], s45 offen offset:2048 sc1 lds
    s_add_u32 m0, s50, 20480
    s_waitcnt vmcnt(62)
    buffer_load_dwordx4 v0, s[40:43], s45 offen offset:3072 sc1 lds
    s_add_u32 m0, s50, 24576
    s_add_u32 s7, s45, 4096
    s_waitcnt vmcnt(62)
    buffer_load_dwordx4 v0, s[40:43], s7 offen sc1 lds
    s_waitcnt vmcnt(16)
    buffer_load_dword v12, v19, s[40:43], s48 offen offset:1536 sc1
    ds_read_b128 v[32:35], v17 offset:0
    ds_read_b128 v[36:39], v17 offset:1024
    s_waitcnt lgkmcnt(1)
    v_lshlrev_b32 v40, 16, v32
    v_and_b32 v41, 0xffff0000, v32
    v_lshlrev_b32 v42, 16, v33
    v_and_b32 v43, 0xffff0000, v33
    v_lshlrev_b32 v44, 16, v34
    v_and_b32 v45, 0xffff0000, v34
    v_lshlrev_b32 v46, 16, v35
    v_and_b32 v47, 0xffff0000, v35
    s_waitcnt lgkmcnt(0)
    v_lshlrev_b32 v48, 16, v36
    v_and_b32 v49, 0xffff0000, v36
    v_lshlrev_b32 v50, 16, v37
    v_and_b32 v51, 0xffff0000, v37
    v_lshlrev_b32 v52, 16, v38
    v_and_b32 v53, 0xffff0000, v38
    v_lshlrev_b32 v54, 16, v39
    v_and_b32 v55, 0xffff0000, v39
    ds_read_b128 v[32:35], v17 offset:2048
    ds_read_b128 v[36:39], v17 offset:3072
    s_waitcnt vmcnt(6)
    ds_read_b128 v[92:95], v13 offset:0
    ds_read_b128 v[96:99], v13 offset:1024
    ds_read_b128 v[100:103], v13 offset:2048
    ds_read_b128 v[104:107], v13 offset:3072
    ds_read_b128 v[108:111], v13 offset:4096
    s_waitcnt lgkmcnt(4)
    v_max_u32 v92, v92, v93
    v_max3_u32 v92, v92, v94, v95
    s_waitcnt lgkmcnt(3)
    v_max3_u32 v92, v92, v96, v97
    v_max3_u32 v92, v92, v98, v99
    s_waitcnt lgkmcnt(2)
    v_max3_u32 v92, v92, v100, v101
    v_max3_u32 v92, v92, v102, v103
    s_waitcnt lgkmcnt(1)
    v_max3_u32 v92, v92, v104, v105
    v_max3_u32 v92, v92, v106, v107
    s_waitcnt lgkmcnt(0)
    v_max3_u32 v92, v92, v108, v109
    v_max3_u32 v92, v92, v110, v111
    v_cmp_eq_u32 s[96:97], -1, v92
    s_nop 0
    s_cmp_lg_u64 s[96:97], 0
    s_cbranch_scc1 Lslow13
Lback13:
    s_barrier
    ds_read_b128 v[56:59], v0 offset:0
    ds_read_b128 v[60:63], v0 offset:1024
    ds_read_b128 v[64:67], v0 offset:2560
    ds_read_b128 v[68:71], v0 offset:3584
    ds_read2st64_b64 v[72:75], v10 offset0:4 offset1:9
    ds_read_b128 v[76:79], v0 offset:5120
    ds_read_b128 v[80:83], v0 offset:6144
    ds_read_b128 v[84:87], v0 offset:7680
    s_waitcnt lgkmcnt(7)
    v_mfma_f32_16x16x32_bf16 v[40:43], a[0:3], v[56:59], v[40:43]
    s_add_u32 m0, s50, 40960
    s_waitcnt lgkmcnt(6)
    v_mfma_f32_16x16x32_bf16 v[40:43], a[8:11], v[60:63], v[40:43]
    buffer_load_dwordx4 v0, s[40:43], s46 offen offset:0 sc1 lds
    v_mfma_f32_16x16x32_bf16 v[44:47], a[4:7], v[56:59], v[44:47]
    s_add_u32 m0, s50, 40960
    ds_read_b128 v[56:59], v0 offset:8704
    v_mfma_f32_16x16x32_bf16 v[44:47], a[12:15], v[60:63], v[44:47]
    s_waitcnt lgkmcnt(6)
    ds_read2st64_b64 v[60:63], v10 offset0:14 offset1:19
    v_mfma_f32_16x16x32_bf16 v[40:43], a[16:19], v[64:67], v[40:43]
    s_waitcnt lgkmcnt(6)
    buffer_load_dwordx4 v0, s[40:43], s46 offen offset:1024 sc1 lds
    v_mfma_f32_16x16x32_bf16 v[40:43], a[24:27], v[68:71], v[40:43]
    s_add_u32 m0, s50, 40960
    v_mfma_f32_16x16x32_bf16 v[44:47], a[20:23], v[64:67], v[44:47]
    ds_read_b128 v[64:67], v0 offset:10240
    v_mfma_f32_16x16x32_bf16 v[44:47], a[28:31], v[68:71], v[44:47]
    s_waitcnt lgkmcnt(6)
    buffer_load_dwordx4 v0, s[40:43], s46 offen offset:2048 sc1 lds
    v_mfma_f32_16x16x32_bf16 v[40:43], a[32:35], v[72:75], v[40:43]
    s_add_u32 m0, s50, 40960
    ds_read_b128 v[68:71], v0 offset:11264
    s_waitcnt lgkmcnt(6)
    v_mfma_f32_16x16x32_bf16 v[40:43], a[40:43], v[76:79], v[40:43]
    v_mfma_f32_16x16x32_bf16 v[44:47], a[36:39], v[72:75], v[44:47]
    buffer_load_dwordx4 v0, s[40:43], s46 offen offset:3072 sc1 lds
    ds_read_b128 v[72:75], v0 offset:12800
    v_mfma_f32_16x16x32_bf16 v[44:47], a[44:47], v[76:79], v[44:47]
    s_add_u32 m0, s50, 45056
    ds_read_b128 v[76:79], v0 offset:13824
    s_waitcnt lgkmcnt(7)
    v_mfma_f32_16x16x32_bf16 v[40:43], a[48:51], v[80:83], v[40:43]
    s_waitcnt vmcnt(5) lgkmcnt(6)
    ds_read_b128 v[92:95], v13 offset:20480
    ds_read_b128 v[96:99], v13 offset:21504
    v_mfma_f32_16x16x32_bf16 v[40:43], a[56:59], v[84:87], v[40:43]
    s_add_u32 s7, s46, 4096
    ds_read_b128 v[100:103], v13 offset:22528
    ds_read_b128 v[104:107], v13 offset:23552
    v_mfma_f32_16x16x32_bf16 v[44:47], a[52:55], v[80:83], v[44:47]
    buffer_load_dwordx4 v0, s[40:43], s7 offen sc1 lds
    v_mfma_f32_16x16x32_bf16 v[44:47], a[60:63], v[84:87], v[44:47]
    s_waitcnt lgkmcnt(9)
    ds_read2st64_b64 v[80:83], v10 offset0:24 offset1:29
    ds_read_b128 v[84:87], v0 offset:15360
    ds_read_b128 v[108:111], v13 offset:24576
    v_mfma_f32_16x16x32_bf16 v[40:43], a[64:67], v[56:59], v[40:43]
    s_add_u32 m0, s50, 61440
    s_waitcnt lgkmcnt(11)
    v_mfma_f32_16x16x32_bf16 v[40:43], a[72:75], v[60:63], v[40:43]
    buffer_load_dwordx4 v0, s[40:43], s47 offen offset:0 sc1 lds
    v_mfma_f32_16x16x32_bf16 v[44:47], a[68:71], v[56:59], v[44:47]
    s_add_u32 m0, s50, 61440
    ds_read_b128 v[56:59], v0 offset:16384
    s_waitcnt lgkmcnt(7)
    v_max_u32 v92, v92, v93
    v_mfma_f32_16x16x32_bf16 v[44:47], a[76:79], v[60:63], v[44:47]
    ds_read_b128 v[60:63], v0 offset:17920
    v_max3_u32 v92, v92, v94, v95
    v_mfma_f32_16x16x32_bf16 v[40:43], a[80:83], v[64:67], v[40:43]
    buffer_load_dwordx4 v0, s[40:43], s47 offen offset:1024 sc1 lds
    s_waitcnt lgkmcnt(7)
    v_max3_u32 v92, v92, v96, v97
    v_mfma_f32_16x16x32_bf16 v[40:43], a[88:91], v[68:71], v[40:43]
    s_add_u32 m0, s50, 61440
    v_max3_u32 v92, v92, v98, v99
    s_waitcnt lgkmcnt(6)
    v_max3_u32 v92, v92, v100, v101
    v_mfma_f32_16x16x32_bf16 v[44:47], a[84:87], v[64:67], v[44:47]
    ds_read_b128 v[64:67], v0 offset:18944
    v_max3_u32 v92, v92, v102, v103
    v_mfma_f32_16x16x32_bf16 v[44:47], a[92:95], v[68:71], v[44:47]
    buffer_load_dwordx4 v0, s[40:43], s47 offen offset:2048 sc1 lds
    v_mfma_f32_16x16x32_bf16 v[40:43], a[96:99], v[72:75], v[40:43]
    s_add_u32 m0, s50, 61440
    ds_read2st64_b64 v[68:71], v10 offset0:34 offset1:39
    s_waitcnt lgkmcnt(7)
    v_max3_u32 v92, v92, v104, v105
    v_mfma_f32_16x16x32_bf16 v[40:43], a[104:107], v[76:79], v[40:43]
    v_max3_u32 v92, v92, v106, v107
    s_waitcnt lgkmcnt(4)
    v_max3_u32 v92, v92, v108, v109
    v_max3_u32 v92, v92, v110, v111
    v_mfma_f32_16x16x32_bf16 v[44:47], a[100:103], v[72:75], v[44:47]
    buffer_load_dwordx4 v0, s[40:43], s47 offen offset:3072 sc1 lds
    v_mfma_f32_16x16x32_bf16 v[44:47], a[108:111], v[76:79], v[44:47]
    s_add_u32 m0, s50, 65536
    v_cmp_eq_u32 s[96:97], -1, v92
    v_mfma_f32_16x16x32_bf16 v[40:43], a[112:115], v[80:83], v[40:43]
    s_cmp_lg_u64 s[96:97], 0
    s_cbranch_scc1 Lslow14
Lback14:
    s_barrier
    v_mfma_f32_16x16x32_bf16 v[40:43], a[120:123], v[84:87], v[40:43]
    s_add_u32 s7, s47, 4096
    ds_read_b128 v[72:75], v0 offset:20480
    ds_read_b128 v[76:79], v0 offset:21504
    v_mfma_f32_16x16x32_bf16 v[44:47], a[116:119], v[80:83], v[44:47]
    buffer_load_dwordx4 v0, s[40:43], s7 offen sc1 lds
    ds_read_b128 v[80:83], v0 offset:23040
    v_mfma_f32_16x16x32_bf16 v[44:47], a[124:127], v[84:87], v[44:47]
    ds_read_b128 v[84:87], v0 offset:24064
    s_waitcnt vmcnt(10)
    v_cmp_gt_u32 vcc, 10, v12
    s_waitcnt lgkmcnt(7)
    v_mfma_f32_16x16x32_bf16 v[40:43], a[128:131], v[56:59], v[40:43]
    s_and_b32 vcc_lo, vcc_lo, 0xf
    s_cbranch_scc1 Lslow17
Lback17:
    s_waitcnt lgkmcnt(6)
    v_mfma_f32_16x16x32_bf16 v[40:43], a[136:139], v[60:63], v[40:43]
    buffer_load_dword v12, v30, s[40:43], s27 offen offset:0 sc1
    v_mfma_f32_16x16x32_bf16 v[44:47], a[132:135], v[56:59], v[44:47]
    ds_read2st64_b64 v[56:59], v10 offset0:44 offset1:49
    v_mfma_f32_16x16x32_bf16 v[44:47], a[140:143], v[60:63], v[44:47]
    s_waitcnt lgkmcnt(6)
    buffer_load_dwordx4 v[144:147], v0, s[40:43], s21 offen offset:2048 sc1
    ds_read_b128 v[60:63], v0 offset:25600
    v_mfma_f32_16x16x32_bf16 v[40:43], a[144:147], v[64:67], v[40:43]
    s_waitcnt lgkmcnt(6)
    v_mfma_f32_16x16x32_bf16 v[40:43], a[152:155], v[68:71], v[40:43]
    v_mfma_f32_16x16x32_bf16 v[44:47], a[148:151], v[64:67], v[44:47]
    ds_read_b128 v[64:67], v0 offset:26624
    v_mfma_f32_16x16x32_bf16 v[44:47], a[156:159], v[68:71], v[44:47]
    s_waitcnt lgkmcnt(6)
    ds_read_b128 v[68:71], v0 offset:28160
    v_mfma_f32_16x16x32_bf16 v[48:51], a[0:3], v[72:75], v[48:51]
    s_waitcnt lgkmcnt(6)
    v_mfma_f32_16x16x32_bf16 v[48:51], a[8:11], v[76:79], v[48:51]
    v_mfma_f32_16x16x32_bf16 v[52:55], a[4:7], v[72:75], v[52:55]
    buffer_load_dwordx4 v[148:151], v0, s[40:43], s21 offen offset:3072 sc1
    v_mfma_f32_16x16x32_bf16 v[52:55], a[12:15], v[76:79], v[52:55]
    s_waitcnt lgkmcnt(5)
    ds_read_b128 v[72:75], v0 offset:29184
    ds_read2st64_b64 v[76:79], v10 offset0:54 offset1:59
    v_mfma_f32_16x16x32_bf16 v[48:51], a[16:19], v[80:83], v[48:51]
    s_waitcnt lgkmcnt(6)
    v_cvt_pk_bf16_f32 v88, v40, v41
    v_cvt_pk_bf16_f32 v89, v42, v43
    v_mfma_f32_16x16x32_bf16 v[48:51], a[24:27], v[84:87], v[48:51]
    v_cvt_pk_bf16_f32 v90, v44, v45
    v_cvt_pk_bf16_f32 v91, v46, v47
    v_add_f32 v2, v40, v41
    v_mfma_f32_16x16x32_bf16 v[52:55], a[20:23], v[80:83], v[52:55]
    s_waitcnt vmcnt(8)
    buffer_store_dwordx4 v[88:91], v0, s[40:43], s52 offen sc1
    v_mfma_f32_16x16x32_bf16 v[52:55], a[28:31], v[84:87], v[52:55]
    s_waitcnt lgkmcnt(5)
    ds_read_b128 v[80:83], v0 offset:30720
    ds_read_b128 v[84:87], v0 offset:31744
    v_mfma_f32_16x16x32_bf16 v[48:51], a[32:35], v[56:59], v[48:51]
    s_waitcnt lgkmcnt(6)
    buffer_store_dwordx4 v[6:9], v25, s[40:43], s30 offen sc1
    v_mfma_f32_16x16x32_bf16 v[48:51], a[40:43], v[60:63], v[48:51]
    s_add_u32 s30, s30, 49152
    s_add_u32 s52, s52, 40960
    v_mul_f32 v3, v40, v40
    v_mfma_f32_16x16x32_bf16 v[52:55], a[36:39], v[56:59], v[52:55]
    s_add_u32 s21, s21, 4096
    ds_read_b128 v[56:59], v0 offset:33280
    v_fmac_f32 v3, v41, v41
    v_add_f32 v2, v2, v42
    v_mfma_f32_16x16x32_bf16 v[52:55], a[44:47], v[60:63], v[52:55]
    s_waitcnt lgkmcnt(6)
    ds_read_b128 v[60:63], v0 offset:34304
    v_fmac_f32 v3, v42, v42
    v_mfma_f32_16x16x32_bf16 v[48:51], a[48:51], v[64:67], v[48:51]
    s_waitcnt lgkmcnt(6)
    v_add_f32 v2, v2, v43
    v_fmac_f32 v3, v43, v43
    v_mfma_f32_16x16x32_bf16 v[48:51], a[56:59], v[68:71], v[48:51]
    v_add_f32 v2, v2, v44
    v_fmac_f32 v3, v44, v44
    v_mfma_f32_16x16x32_bf16 v[52:55], a[52:55], v[64:67], v[52:55]
    ds_read2st64_b64 v[64:67], v10 offset0:64 offset1:69
    v_add_f32 v2, v2, v45
    v_mfma_f32_16x16x32_bf16 v[52:55], a[60:63], v[68:71], v[52:55]
    s_waitcnt lgkmcnt(6)
    ds_read_b128 v[68:71], v0 offset:35840
    v_fmac_f32 v3, v45, v45
    v_add_f32 v2, v2, v46
    v_mfma_f32_16x16x32_bf16 v[48:51], a[64:67], v[72:75], v[48:51]
    s_waitcnt lgkmcnt(6)
    v_fmac_f32 v3, v46, v46
    v_add_f32 v2, v2, v47
    v_mfma_f32_16x16x32_bf16 v[48:51], a[72:75], v[76:79], v[48:51]
    v_fmac_f32 v3, v47, v47
    ds_read_b128 v[92:95], v13 offset:40960
    v_mfma_f32_16x16x32_bf16 v[52:55], a[68:71], v[72:75], v[52:55]
    buffer_load_dwordx4 v[152:155], v0, s[40:43], s21 offen offset:0 sc1
    v_mfma_f32_16x16x32_bf16 v[52:55], a[76:79], v[76:79], v[52:55]
    s_waitcnt lgkmcnt(6)
    ds_read_b128 v[72:75], v0 offset:36864
    ds_read_b128 v[76:79], v0 offset:38400
    v_mfma_f32_16x16x32_bf16 v[48:51], a[80:83], v[80:83], v[48:51]
    s_waitcnt lgkmcnt(7)
    v_permlane32_swap_b32 v2, v3
    v_add_f32 v2, v2, v3
    v_mfma_f32_16x16x32_bf16 v[48:51], a[88:91], v[84:87], v[48:51]
    v_mov_b32 v3, v2
    ds_read_b128 v[96:99], v13 offset:41984
    v_mfma_f32_16x16x32_bf16 v[52:55], a[84:87], v[80:83], v[52:55]
    ds_read_b128 v[80:83], v0 offset:39424
    ds_read_b128 v[100:103], v13 offset:43008
    v_mfma_f32_16x16x32_bf16 v[52:55], a[92:95], v[84:87], v[52:55]
    s_waitcnt lgkmcnt(9)
    ds_read2st64_b64 v[84:87], v10 offset0:74 offset1:79
    ds_read_b128 v[104:107], v13 offset:44032
    v_mfma_f32_16x16x32_bf16 v[48:51], a[96:99], v[56:59], v[48:51]
    s_waitcnt lgkmcnt(10)
    v_permlane16_swap_b32 v2, v3
    v_mfma_f32_16x16x32_bf16 v[48:51], a[104:107], v[60:63], v[48:51]
    v_add_f32 v2, v2, v3
    buffer_atomic_add_f32 v2, v14, s[40:43], s57 offen
    v_mfma_f32_16x16x32_bf16 v[52:55], a[100:103], v[56:59], v[52:55]
    s_add_u32 s57, s57, 256
    v_lshlrev_b32 v40, 16, v32
    v_and_b32 v41, 0xffff0000, v32
    v_mfma_f32_16x16x32_bf16 v[52:55], a[108:111], v[60:63], v[52:55]
    s_waitcnt lgkmcnt(9)
    buffer_load_dwordx4 v[156:159], v0, s[40:43], s21 offen offset:1024 sc1
    v_mfma_f32_16x16x32_bf16 v[48:51], a[112:115], v[64:67], v[48:51]
    s_waitcnt lgkmcnt(8)
    v_lshlrev_b32 v42, 16, v33
    v_and_b32 v43, 0xffff0000, v33
    v_mfma_f32_16x16x32_bf16 v[48:51], a[120:123], v[68:71], v[48:51]
    v_lshlrev_b32 v44, 16, v34
    v_and_b32 v45, 0xffff0000, v34
    v_mfma_f32_16x16x32_bf16 v[52:55], a[116:119], v[64:67], v[52:55]
    v_lshlrev_b32 v46, 16, v35
    v_and_b32 v47, 0xffff0000, v35
    ds_read_b128 v[108:111], v13 offset:45056
    v_mfma_f32_16x16x32_bf16 v[52:55], a[124:127], v[68:71], v[52:55]
    s_waitcnt lgkmcnt(7)
    v_max_u32 v92, v92, v93
    v_max3_u32 v92, v92, v94, v95
    v_mfma_f32_16x16x32_bf16 v[48:51], a[128:131], v[72:75], v[48:51]
    s_waitcnt lgkmcnt(5)
    v_max3_u32 v92, v92, v96, v97
    v_max3_u32 v92, v92, v98, v99
    v_mfma_f32_16x16x32_bf16 v[48:51], a[136:139], v[76:79], v[48:51]
    s_waitcnt lgkmcnt(3)
    v_max3_u32 v92, v92, v100, v101
    v_max3_u32 v92, v92, v102, v103
    v_mfma_f32_16x16x32_bf16 v[52:55], a[132:135], v[72:75], v[52:55]
    buffer_load_dwordx4 v[160:163], v0, s[40:43], s21 offen offset:2048 sc1
    v_mfma_f32_16x16x32_bf16 v[52:55], a[140:143], v[76:79], v[52:55]
    s_waitcnt lgkmcnt(1)
    v_max3_u32 v92, v92, v104, v105
    v_max3_u32 v92, v92, v106, v107
    s_waitcnt lgkmcnt(0)
    v_max3_u32 v92, v92, v108, v109
    v_mfma_f32_16x16x32_bf16 v[48:51], a[144:147], v[80:83], v[48:51]
    v_max3_u32 v92, v92, v110, v111
    v_cmp_eq_u32 s[96:97], -1, v92
    v_mfma_f32_16x16x32_bf16 v[48:51], a[152:155], v[84:87], v[48:51]
    s_cmp_lg_u64 s[96:97], 0
    s_cbranch_scc1 Lslow15
Lback15:
    s_barrier
    v_mfma_f32_16x16x32_bf16 v[52:55], a[148:151], v[80:83], v[52:55]
    s_waitcnt vmcnt(9)
    ds_read_b128 v[56:59], v0 offset:40960
    ds_read_b128 v[60:63], v0 offset:41984
    v_mfma_f32_16x16x32_bf16 v[52:55], a[156:159], v[84:87], v[52:55]
    s_waitcnt lgkmcnt(1)
    ds_read_b128 v[64:67], v0 offset:43520
    ds_read_b128 v[68:71], v0 offset:44544
    v_mfma_f32_16x16x32_bf16 v[40:43], a[0:3], v[56:59], v[40:43]
    s_waitcnt lgkmcnt(2)
    ds_read2st64_b64 v[72:75], v10 offset0:84 offset1:89
    ds_read_b128 v[76:79], v0 offset:46080
    ds_read_b128 v[80:83], v0 offset:47104
    v_mfma_f32_16x16x32_bf16 v[40:43], a[8:11], v[60:63], v[40:43]
    ds_read_b128 v[84:87], v0 offset:48640
    ds_read_b128 v[92:95], v18 offset:0
    v_mfma_f32_16x16x32_bf16 v[44:47], a[4:7], v[56:59], v[44:47]
    buffer_load_dwordx4 v[164:167], v0, s[40:43], s21 offen offset:3072 sc1
    v_mfma_f32_16x16x32_bf16 v[44:47], a[12:15], v[60:63], v[44:47]
    s_waitcnt lgkmcnt(6)
    ds_read_b128 v[56:59], v0 offset:49664
    ds_read2st64_b64 v[60:63], v10 offset0:94 offset1:99
    v_mfma_f32_16x16x32_bf16 v[40:43], a[16:19], v[64:67], v[40:43]
    s_waitcnt lgkmcnt(7)
    v_cvt_pk_bf16_f32 v88, v48, v49
    v_cvt_pk_bf16_f32 v89, v50, v51
    v_mfma_f32_16x16x32_bf16 v[40:43], a[24:27], v[68:71], v[40:43]
    v_cvt_pk_bf16_f32 v90, v52, v53
    v_cvt_pk_bf16_f32 v91, v54, v55
    v_add_f32 v2, v48, v49
    v_mfma_f32_16x16x32_bf16 v[44:47], a[20:23], v[64:67], v[44:47]
    buffer_store_dwordx4 v[88:91], v0, s[40:43], s52 offen sc1
    v_mfma_f32_16x16x32_bf16 v[44:47], a[28:31], v[68:71], v[44:47]
    s_waitcnt lgkmcnt(6)
    ds_read_b128 v[64:67], v0 offset:51200
    ds_read_b128 v[68:71], v0 offset:52224
    v_mfma_f32_16x16x32_bf16 v[40:43], a[32:35], v[72:75], v[40:43]
    s_waitcnt lgkmcnt(7)
    buffer_atomic_add v11, v15, s[40:43], s61 offen offset:1280 sc1
    v_mfma_f32_16x16x32_bf16 v[40:43], a[40:43], v[76:79], v[40:43]
Lwc1_0:
    s_cbranch_execz Lwc1_1
    buffer_store_dwordx4 v[6:9], v25, s[40:43], s30 offen sc1
    v_mfma_f32_16x16x32_bf16 v[44:47], a[36:39], v[72:75], v[44:47]
    s_add_u32 s30, s30, 49152
    ds_read_b128 v[72:75], v0 offset:53760
    s_add_u32 s52, s52, 40960
    v_mul_f32 v3, v48, v48
    v_mfma_f32_16x16x32_bf16 v[44:47], a[44:47], v[76:79], v[44:47]
    s_add_u32 s21, s21, 4096
    ds_read_b128 v[76:79], v0 offset:54784
    v_fmac_f32 v3, v49, v49
    s_waitcnt lgkmcnt(8)
    v_mfma_f32_16x16x32_bf16 v[40:43], a[48:51], v[80:83], v[40:43]
    s_add_u32 s53, s49, 20480
    v_add_f32 v2, v2, v50
    v_fmac_f32 v3, v50, v50
    s_waitcnt lgkmcnt(7)
    v_mfma_f32_16x16x32_bf16 v[40:43], a[56:59], v[84:87], v[40:43]
    s_add_u32 s54, s49, 40960
    v_add_f32 v2, v2, v51
    v_fmac_f32 v3, v51, v51
    v_mfma_f32_16x16x32_bf16 v[44:47], a[52:55], v[80:83], v[44:47]
    ds_read2st64_b64 v[80:83], v10 offset0:104 offset1:109
    v_add_f32 v2, v2, v52
    v_mfma_f32_16x16x32_bf16 v[44:47], a[60:63], v[84:87], v[44:47]
    s_waitcnt lgkmcnt(6)
    ds_read_b128 v[84:87], v0 offset:56320
    v_fmac_f32 v3, v52, v52
    v_add_f32 v2, v2, v53
    v_mfma_f32_16x16x32_bf16 v[40:43], a[64:67], v[56:59], v[40:43]
    s_waitcnt lgkmcnt(6)
    v_fmac_f32 v3, v53, v53
    v_add_f32 v2, v2, v54
    v_mfma_f32_16x16x32_bf16 v[40:43], a[72:75], v[60:63], v[40:43]
    v_fmac_f32 v3, v54, v54
    v_add_f32 v2, v2, v55
    v_mfma_f32_16x16x32_bf16 v[44:47], a[68:71], v[56:59], v[44:47]
    ds_read_b128 v[56:59], v0 offset:57344
    v_fmac_f32 v3, v55, v55
    v_mfma_f32_16x16x32_bf16 v[44:47], a[76:79], v[60:63], v[44:47]
    s_waitcnt vmcnt(6) lgkmcnt(6)
    buffer_atomic_add v11, v15, s[40:43], s58 offen offset:0 sc1
    v_mfma_f32_16x16x32_bf16 v[40:43], a[80:83], v[64:67], v[40:43]
    s_add_u32 s58, s58, 512
    ds_read_b128 v[60:63], v0 offset:58880
    v_permlane32_swap_b32 v2, v3
    s_waitcnt lgkmcnt(6)
    v_mfma_f32_16x16x32_bf16 v[40:43], a[88:91], v[68:71], v[40:43]
    s_add_u32 m0, s50, 81920
    v_add_f32 v2, v2, v3
    v_mov_b32 v3, v2
    v_mfma_f32_16x16x32_bf16 v[44:47], a[84:87], v[64:67], v[44:47]
    buffer_load_dwordx4 v0, s[40:43], s49 offen offset:0 sc1 lds
    v_mfma_f32_16x16x32_bf16 v[44:47], a[92:95], v[68:71], v[44:47]
    s_waitcnt lgkmcnt(5)
    ds_read_b128 v[64:67], v0 offset:59904
    ds_read2st64_b64 v[68:71], v10 offset0:114 offset1:119
    v_mfma_f32_16x16x32_bf16 v[40:43], a[96:99], v[72:75], v[40:43]
    s_add_u32 m0, s50, 81920
    v_permlane16_swap_b32 v2, v3
    s_waitcnt lgkmcnt(6)
    v_mfma_f32_16x16x32_bf16 v[40:43], a[104:107], v[76:79], v[40:43]
    v_add_f32 v2, v2, v3
    buffer_atomic_add_f32 v2, v14, s[40:43], s57 offen
    v_mfma_f32_16x16x32_bf16 v[44:47], a[100:103], v[72:75], v[44:47]
    s_add_u32 s57, s57, 256
    v_lshlrev_b32 v48, 16, v36
    v_and_b32 v49, 0xffff0000, v36
    v_mfma_f32_16x16x32_bf16 v[44:47], a[108:111], v[76:79], v[44:47]
    s_waitcnt lgkmcnt(5)
    buffer_load_dwordx4 v0, s[40:43], s49 offen offset:1024 sc1 lds
    v_mfma_f32_16x16x32_bf16 v[40:43], a[112:115], v[80:83], v[40:43]
    s_waitcnt lgkmcnt(4)
    v_lshlrev_b32 v50, 16, v37
    v_and_b32 v51, 0xffff0000, v37
    v_mfma_f32_16x16x32_bf16 v[40:43], a[120:123], v[84:87], v[40:43]
    s_add_u32 m0, s50, 81920
    v_lshlrev_b32 v52, 16, v38
    v_and_b32 v53, 0xffff0000, v38
    v_mfma_f32_16x16x32_bf16 v[44:47], a[116:119], v[80:83], v[44:47]
    v_lshlrev_b32 v54, 16, v39
    v_and_b32 v55, 0xffff0000, v39
    ds_read_b128 v[96:99], v18 offset:1024
    v_mfma_f32_16x16x32_bf16 v[44:47], a[124:127], v[84:87], v[44:47]
    s_waitcnt lgkmcnt(4)
    buffer_load_dwordx4 v0, s[40:43], s49 offen offset:2048 sc1 lds
    v_mfma_f32_16x16x32_bf16 v[40:43], a[128:131], v[56:59], v[40:43]
    s_waitcnt lgkmcnt(3)
    ds_read_b128 v[100:103], v18 offset:2048
    ds_read_b128 v[104:107], v18 offset:3072
    v_mfma_f32_16x16x32_bf16 v[40:43], a[136:139], v[60:63], v[40:43]
    s_add_u32 m0, s50, 81920
    ds_read_b128 v[108:111], v18 offset:4096
    v_max_u32 v92, v92, v93
    v_mfma_f32_16x16x32_bf16 v[44:47], a[132:135], v[56:59], v[44:47]
    v_max3_u32 v92, v92, v94, v95
    v_mfma_f32_16x16x32_bf16 v[44:47], a[140:143], v[60:63], v[44:47]
    buffer_load_dwordx4 v0, s[40:43], s49 offen offset:3072 sc1 lds
    s_waitcnt lgkmcnt(3)
    v_max3_u32 v92, v92, v96, v97
    v_mfma_f32_16x16x32_bf16 v[40:43], a[144:147], v[64:67], v[40:43]
    v_max3_u32 v92, v92, v98, v99
    v_mfma_f32_16x16x32_bf16 v[40:43], a[152:155], v[68:71], v[40:43]
    s_waitcnt lgkmcnt(2)
    v_max3_u32 v92, v92, v100, v101
    v_max3_u32 v92, v92, v102, v103
    v_mfma_f32_16x16x32_bf16 v[44:47], a[148:151], v[64:67], v[44:47]
    s_add_u32 m0, s50, 86016
    s_waitcnt lgkmcnt(1)
    v_max3_u32 v92, v92, v104, v105
    v_max3_u32 v92, v92, v106, v107
    v_mfma_f32_16x16x32_bf16 v[44:47], a[156:159], v[68:71], v[44:47]
    s_waitcnt lgkmcnt(0)
    v_max3_u32 v92, v92, v108, v109
    v_max3_u32 v92, v92, v110, v111
    v_cmp_eq_u32 s[96:97], -1, v92
    s_nop 0
    s_cmp_lg_u64 s[96:97], 0
    s_cbranch_scc1 Lslow16
Lback16:
    s_barrier
    ds_read_b128 v[72:75], v16 offset:0
    s_waitcnt lgkmcnt(0)
    v_mfma_f32_16x16x32_bf16 v[48:51], a[0:3], v[72:75], v[48:51]
    s_add_u32 s7, s49, 4096
    ds_read_b128 v[76:79], v16 offset:1024
    ds_read_b128 v[80:83], v16 offset:2560
    ds_read_b128 v[84:87], v16 offset:3584
    s_waitcnt lgkmcnt(2)
    v_mfma_f32_16x16x32_bf16 v[48:51], a[8:11], v[76:79], v[48:51]
    ds_read2st64_b64 v[56:59], v4 offset0:4 offset1:9
    ds_read_b128 v[60:63], v16 offset:5120
    v_mfma_f32_16x16x32_bf16 v[52:55], a[4:7], v[72:75], v[52:55]
    buffer_load_dwordx4 v0, s[40:43], s7 offen sc1 lds
    v_mfma_f32_16x16x32_bf16 v[52:55], a[12:15], v[76:79], v[52:55]
    s_waitcnt lgkmcnt(3)
    ds_read_b128 v[64:67], v16 offset:6144
    ds_read_b128 v[68:71], v16 offset:7680
    v_mfma_f32_16x16x32_bf16 v[48:51], a[16:19], v[80:83], v[48:51]
    s_waitcnt lgkmcnt(4)
    ds_read_b128 v[72:75], v16 offset:8704
    ds_read2st64_b64 v[76:79], v4 offset0:14 offset1:19
    v_mfma_f32_16x16x32_bf16 v[48:51], a[24:27], v[84:87], v[48:51]
    s_add_u32 m0, s50, 102400
    v_cvt_pk_bf16_f32 v88, v40, v41
    v_cvt_pk_bf16_f32 v89, v42, v43
    v_cvt_pk_bf16_f32 v90, v44, v45
    v_mfma_f32_16x16x32_bf16 v[52:55], a[20:23], v[80:83], v[52:55]
    ds_read_b128 v[80:83], v16 offset:10240
    v_cvt_pk_bf16_f32 v91, v46, v47
    v_mfma_f32_16x16x32_bf16 v[52:55], a[28:31], v[84:87], v[52:55]
    s_waitcnt lgkmcnt(6)
    buffer_store_dwordx4 v[88:91], v0, s[40:43], s52 offen sc1
    v_mfma_f32_16x16x32_bf16 v[48:51], a[32:35], v[56:59], v[48:51]
    s_waitcnt lgkmcnt(5)
    ds_read_b128 v[84:87], v16 offset:11264
    v_add_f32 v2, v40, v41
    v_mfma_f32_16x16x32_bf16 v[48:51], a[40:43], v[60:63], v[48:51]
    buffer_store_dwordx4 v[6:9], v25, s[40:43], s30 offen sc1
    v_mfma_f32_16x16x32_bf16 v[52:55], a[36:39], v[56:59], v[52:55]
    s_add_u32 s30, s30, 49152
    ds_read_b128 v[56:59], v16 offset:12800
    s_add_u32 s52, s52, 40960
    v_mul_f32 v3, v40, v40
    v_mfma_f32_16x16x32_bf16 v[52:55], a[44:47], v[60:63], v[52:55]
    s_waitcnt lgkmcnt(6)
    buffer_load_dwordx4 v0, s[40:43], s53 offen offset:0 sc1 lds
    v_mfma_f32_16x16x32_bf16 v[48:51], a[48:51], v[64:67], v[48:51]
    s_add_u32 m0, s50, 102400
    ds_read_b128 v[60:63], v16 offset:13824
    v_fmac_f32 v3, v41, v41
    s_waitcnt lgkmcnt(6)
    v_mfma_f32_16x16x32_bf16 v[48:51], a[56:59], v[68:71], v[48:51]
    buffer_load_dwordx4 v0, s[40:43], s53 offen offset:1024 sc1 lds
    v_mfma_f32_16x16x32_bf16 v[52:55], a[52:55], v[64:67], v[52:55]
    s_add_u32 m0, s50, 102400
    ds_read2st64_b64 v[64:67], v4 offset0:24 offset1:29
    v_add_f32 v2, v2, v42
    v_mfma_f32_16x16x32_bf16 v[52:55], a[60:63], v[68:71], v[52:55]
    s_waitcnt lgkmcnt(6)
    ds_read_b128 v[68:71], v16 offset:15360
    v_fmac_f32 v3, v42, v42
    v_add_f32 v2, v2, v43
    v_mfma_f32_16x16x32_bf16 v[48:51], a[64:67], v[72:75], v[48:51]
    s_waitcnt lgkmcnt(6)
    buffer_load_dwordx4 v0, s[40:43], s53 offen offset:2048 sc1 lds
    v_mfma_f32_16x16x32_bf16 v[48:51], a[72:75], v[76:79], v[48:51]
    v_fmac_f32 v3, v43, v43
    v_add_f32 v2, v2, v44
    v_mfma_f32_16x16x32_bf16 v[52:55], a[68:71], v[72:75], v[52:55]
    s_add_u32 m0, s50, 102400
    ds_read_b128 v[72:75], v16 offset:16384
    v_fmac_f32 v3, v44, v44
    v_mfma_f32_16x16x32_bf16 v[52:55], a[76:79], v[76:79], v[52:55]
    s_waitcnt vmcnt(9) lgkmcnt(6)
    buffer_atomic_add v11, v15, s[40:43], s58 offen offset:0 sc1
    v_mfma_f32_16x16x32_bf16 v[48:51], a[80:83], v[80:83], v[48:51]
    s_add_u32 s58, s58, 512
    ds_read_b128 v[76:79], v16 offset:17920
    v_add_f32 v2, v2, v45
    v_fmac_f32 v3, v45, v45
    s_waitcnt lgkmcnt(6)
    v_mfma_f32_16x16x32_bf16 v[48:51], a[88:91], v[84:87], v[48:51]
    buffer_load_dwordx4 v0, s[40:43], s53 offen offset:3072 sc1 lds
    v_mfma_f32_16x16x32_bf16 v[52:55], a[84:87], v[80:83], v[52:55]
    ds_read_b128 v[80:83], v16 offset:18944
    v_add_f32 v2, v2, v46
    v_mfma_f32_16x16x32_bf16 v[52:55], a[92:95], v[84:87], v[52:55]
    s_add_u32 m0, s50, 106496
    ds_read2st64_b64 v[84:87], v4 offset0:34 offset1:39
    v_fmac_f32 v3, v46, v46
    s_waitcnt lgkmcnt(7)
    v_mfma_f32_16x16x32_bf16 v[48:51], a[96:99], v[56:59], v[48:51]
    s_waitcnt lgkmcnt(6)
    v_add_f32 v2, v2, v47
    v_fmac_f32 v3, v47, v47
    v_mfma_f32_16x16x32_bf16 v[48:51], a[104:107], v[60:63], v[48:51]
    s_add_u32 s7, s53, 4096
    v_permlane32_swap_b32 v2, v3
    v_add_f32 v2, v2, v3
    v_mfma_f32_16x16x32_bf16 v[52:55], a[100:103], v[56:59], v[52:55]
    v_mov_b32 v3, v2
    v_cmp_gt_u32 vcc, 1, v12
    v_mfma_f32_16x16x32_bf16 v[52:55], a[108:111], v[60:63], v[52:55]
    s_and_b32 vcc_lo, vcc_lo, 0xfff
    s_cbranch_scc1 Lslow18
Lback18:
    s_waitcnt vmcnt(7)
    ds_read_b128 v[92:95], v5 offset:0
    s_waitcnt lgkmcnt(6)
    v_mfma_f32_16x16x32_bf16 v[48:51], a[112:115], v[64:67], v[48:51]
    s_waitcnt lgkmcnt(5)
    buffer_load_dwordx4 v0, s[40:43], s7 offen sc1 lds
    v_mfma_f32_16x16x32_bf16 v[48:51], a[120:123], v[68:71], v[48:51]
    v_permlane16_swap_b32 v2, v3
    v_mfma_f32_16x16x32_bf16 v[52:55], a[116:119], v[64:67], v[52:55]
    v_add_f32 v2, v2, v3
    buffer_atomic_add_f32 v2, v14, s[40:43], s57 offen
    v_mfma_f32_16x16x32_bf16 v[52:55], a[124:127], v[68:71], v[52:55]
    s_add_u32 s57, s57, 256
    ds_read_b128 v[96:99], v5 offset:1024
    ds_read_b128 v[100:103], v5 offset:2048
    s_waitcnt lgkmcnt(6)
    v_mfma_f32_16x16x32_bf16 v[48:51], a[128:131], v[72:75], v[48:51]
    s_waitcnt lgkmcnt(5)
    ds_read_b128 v[104:107], v5 offset:3072
    ds_read_b128 v[108:111], v5 offset:4096
    v_mfma_f32_16x16x32_bf16 v[48:51], a[136:139], v[76:79], v[48:51]
    s_waitcnt lgkmcnt(4)
    v_max_u32 v92, v92, v93
    v_max3_u32 v92, v92, v94, v95
    v_mfma_f32_16x16x32_bf16 v[52:55], a[132:135], v[72:75], v[52:55]
    v_mfma_f32_16x16x32_bf16 v[52:55], a[140:143], v[76:79], v[52:55]
    v_mfma_f32_16x16x32_bf16 v[48:51], a[144:147], v[80:83], v[48:51]
    s_waitcnt lgkmcnt(3)
    v_max3_u32 v92, v92, v96, v97
    v_max3_u32 v92, v92, v98, v99
    v_mfma_f32_16x16x32_bf16 v[48:51], a[152:155], v[84:87], v[48:51]
    s_waitcnt lgkmcnt(2)
    v_max3_u32 v92, v92, v100, v101
    v_max3_u32 v92, v92, v102, v103
    v_mfma_f32_16x16x32_bf16 v[52:55], a[148:151], v[80:83], v[52:55]
    s_waitcnt lgkmcnt(1)
    v_max3_u32 v92, v92, v104, v105
    v_max3_u32 v92, v92, v106, v107
    v_mfma_f32_16x16x32_bf16 v[52:55], a[156:159], v[84:87], v[52:55]
    s_waitcnt lgkmcnt(0)
    v_max3_u32 v92, v92, v108, v109
    v_max3_u32 v92, v92, v110, v111
    v_cmp_eq_u32 s[96:97], -1, v92
    s_nop 0
    s_cmp_lg_u64 s[96:97], 0
    s_cbranch_scc1 Lslow19
Lback19:
    s_branch LendB
LidleQ:
Lwc2_0:
    s_cbranch_execz Lwc2_1
    s_add_u32 s53, s49, 20480
    s_add_u32 s54, s49, 40960
    buffer_store_dwordx4 v[6:9], v25, s[40:43], s30 offen sc1
    s_add_u32 s30, s30, 49152
    buffer_store_dwordx4 v[6:9], v25, s[40:43], s30 offen sc1
    s_add_u32 s30, s30, 49152
    buffer_store_dwordx4 v[6:9], v25, s[40:43], s30 offen sc1
    s_add_u32 s30, s30, 49152
    s_mov_b32 s57, 1073741824
    s_cmp_lg_u32 s3, 0
    s_cbranch_scc1 Lidle20
    v_mov_b32 v12, 0
    buffer_atomic_or v12, v15, s[40:43], s48 offen offset:1280 sc0 sc1
    s_waitcnt vmcnt(0)
    v_cmp_gt_u32 vcc, 10, v12
    s_nop 0
    s_and_b32 vcc_lo, vcc_lo, 0x1
    s_cbranch_scc1 Lslow20
Lback20:
    s_branch Lmeet20
Lidle20:
    s_mov_b64 exec, 0
    s_cmp_eq_u32 s3, 2
    s_cbranch_scc1 Lidb20
    s_cmp_eq_u32 s3, 3
    s_cbranch_scc1 Lidc20
    s_cmp_eq_u32 s3, 0
    s_cbranch_scc1 Lidd20
    s_call_b64 s[98:99], Lwc0_0
    s_branch Lidd20
Lidb20:
    s_call_b64 s[98:99], Lwc1_0
    s_branch Lidd20
Lidc20:
    s_call_b64 s[98:99], Lwc2_0
Lidd20:
    s_mov_b64 exec, -1
Lmeet20:
    s_barrier
    buffer_load_dword v12, v30, s[40:43], s27 offen offset:0 sc1
    s_add_u32 m0, s50, 81920
    s_nop 0
    buffer_load_dwordx4 v0, s[40:43], s49 offen offset:0 sc1 lds
    s_add_u32 m0, s50, 81920
    s_nop 0
    buffer_load_dwordx4 v0, s[40:43], s49 offen offset:1024 sc1 lds
    s_add_u32 m0, s50, 81920
    s_nop 0
    buffer_load_dwordx4 v0, s[40:43], s49 offen offset:2048 sc1 lds
    s_add_u32 m0, s50, 81920
    s_nop 0
    buffer_load_dwordx4 v0, s[40:43], s49 offen offset:3072 sc1 lds
    s_add_u32 m0, s50, 86016
    s_add_u32 s7, s49, 4096
    buffer_load_dwordx4 v0, s[40:43], s7 offen sc1 lds
    s_add_u32 m0, s50, 102400
    s_nop 0
    buffer_load_dwordx4 v0, s[40:43], s53 offen offset:0 sc1 lds
    s_add_u32 m0, s50, 102400
    s_nop 0
    buffer_load_dwordx4 v0, s[40:43], s53 offen offset:1024 sc1 lds
    s_add_u32 m0, s50, 102400
    s_nop 0
    buffer_load_dwordx4 v0, s[40:43], s53 offen offset:2048 sc1 lds
    s_add_u32 m0, s50, 102400
    s_nop 0
    buffer_load_dwordx4 v0, s[40:43], s53 offen offset:3072 sc1 lds
    s_add_u32 m0, s50, 106496
    s_add_u32 s7, s53, 4096
    buffer_load_dwordx4 v0, s[40:43], s7 offen sc1 lds
    s_waitcnt vmcnt(10)
    v_cmp_gt_u32 vcc, 1, v12
    s_nop 0
    s_and_b32 vcc_lo, vcc_lo, 0xfff
    s_cbranch_scc1 Lslow21
Lback21:
    s_waitcnt vmcnt(5)
    ds_read_b128 v[92:95], v5 offset:0
    ds_read_b128 v[96:99], v5 offset:1024
    ds_read_b128 v[100:103], v5 offset:2048
    ds_read_b128 v[104:107], v5 offset:3072
    ds_read_b128 v[108:111], v5 offset:4096
    s_waitcnt lgkmcnt(4)
    v_max_u32 v92, v92, v93
    v_max3_u32 v92, v92, v94, v95
    s_waitcnt lgkmcnt(3)
    v_max3_u32 v92, v92, v96, v97
    v_max3_u32 v92, v92, v98, v99
    s_waitcnt lgkmcnt(2)
    v_max3_u32 v92, v92, v100, v101
    v_max3_u32 v92, v92, v102, v103
    s_waitcnt lgkmcnt(1)
    v_max3_u32 v92, v92, v104, v105
    v_max3_u32 v92, v92, v106, v107
    s_waitcnt lgkmcnt(0)
    v_max3_u32 v92, v92, v108, v109
    v_max3_u32 v92, v92, v110, v111
    v_cmp_eq_u32 s[96:97], -1, v92
    s_nop 0
    s_cmp_lg_u64 s[96:97], 0
    s_cbranch_scc1 Lslow22
Lback22:
LendB:
Lwc0_1:
    s_cbranch_execz Lwc0_2
    v_add_u32 v16, 81920, v0
    s_barrier
    ds_read_b128 v[56:59], v16 offset:0
    ds_read_b128 v[60:63], v16 offset:1024
    ds_read_b128 v[64:67], v16 offset:2048
    ds_read_b128 v[68:71], v16 offset:3072
    ds_read_b128 v[72:75], v16 offset:4096
    ds_read_b128 v[76:79], v16 offset:5120
    ds_read_b128 v[80:83], v16 offset:6144
    ds_read_b128 v[84:87], v16 offset:7168
    s_mov_b32 s47, s31
    v_add_u32 v13, s31, v0
    s_lshl_b32 s51, s19, 2
    s_add_u32 s51, s51, s3
    s_mul_i32 s59, s51, 192
    s_add_u32 s59, s59, 90112
    s_sub_u32 s44, s30, 344064
    s_lshr_b32 s55, s19, 2
    s_lshl_b32 s55, s55, 7
    s_add_u32 s55, s55, s48
    s_add_u32 s55, s55, 4096
    s_lshl_b32 s56, s18, 10
    s_add_u32 s56, s56, 73728
    s_waitcnt lgkmcnt(7)
    v_mfma_f32_16x16x32_bf16 v[32:35], a[160:163], v[56:59], 0
    s_waitcnt lgkmcnt(6)
    buffer_load_dword v12, v19, s[40:43], s48 offen offset:2048 sc1
    v_mfma_f32_16x16x32_bf16 v[32:35], a[172:175], v[60:63], v[32:35]
    v_cvt_pk_bf16_f32 v88, v48, v49
    v_cvt_pk_bf16_f32 v89, v50, v51
    v_mfma_f32_16x16x32_bf16 v[36:39], a[164:167], v[56:59], 0
    v_cvt_pk_bf16_f32 v90, v52, v53
    v_cvt_pk_bf16_f32 v91, v54, v55
    v_mfma_f32_16x16x32_bf16 v[36:39], a[176:179], v[60:63], v[36:39]
    buffer_store_dwordx4 v[88:91], v0, s[40:43], s52 offen sc1
    v_mfma_f32_16x16x32_bf16 v[40:43], a[168:171], v[56:59], 0
    s_add_u32 m0, s50, 122880
    ds_read_b128 v[56:59], v16 offset:8192
    v_mfma_f32_16x16x32_bf16 v[40:43], a[180:183], v[60:63], v[40:43]
    s_waitcnt lgkmcnt(6)
    buffer_store_dwordx4 v[6:9], v25, s[40:43], s30 offen sc1
    v_mfma_f32_16x16x32_bf16 v[32:35], a[184:187], v[64:67], v[32:35]
    s_add_u32 s30, s30, 49152
    ds_read_b128 v[60:63], v16 offset:9216
    s_add_u32 s52, s52, 40960
    s_waitcnt lgkmcnt(6)
    v_mfma_f32_16x16x32_bf16 v[32:35], a[196:199], v[68:71], v[32:35]
    buffer_load_dwordx4 v0, s[40:43], s54 offen offset:0 sc1 lds
    v_mfma_f32_16x16x32_bf16 v[36:39], a[188:191], v[64:67], v[36:39]
    s_add_u32 m0, s50, 122880
    v_add_f32 v2, v48, v49
    v_mul_f32 v3, v48, v48
    v_mfma_f32_16x16x32_bf16 v[36:39], a[200:203], v[68:71], v[36:39]
    buffer_load_dwordx4 v0, s[40:43], s54 offen offset:1024 sc1 lds
    v_mfma_f32_16x16x32_bf16 v[40:43], a[192:195], v[64:67], v[40:43]
    s_add_u32 m0, s50, 122880
    ds_read_b128 v[64:67], v16 offset:10240
    v_fmac_f32 v3, v49, v49
    v_mfma_f32_16x16x32_bf16 v[40:43], a[204:207], v[68:71], v[40:43]
    s_waitcnt lgkmcnt(6)
    buffer_load_dwordx4 v0, s[40:43], s54 offen offset:2048 sc1 lds
    v_mfma_f32_16x16x32_bf16 v[32:35], a[208:211], v[72:75], v[32:35]
    s_waitcnt lgkmcnt(5)
    ds_read_b128 v[68:71], v16 offset:11264
    v_add_f32 v2, v2, v50
    v_mfma_f32_16x16x32_bf16 v[32:35], a[220:223], v[76:79], v[32:35]
    s_add_u32 m0, s50, 122880
    v_fmac_f32 v3, v50, v50
    v_add_f32 v2, v2, v51
    v_mfma_f32_16x16x32_bf16 v[36:39], a[212:215], v[72:75], v[36:39]
    buffer_load_dwordx4 v0, s[40:43], s54 offen offset:3072 sc1 lds
    v_mfma_f32_16x16x32_bf16 v[36:39], a[224:227], v[76:79], v[36:39]
    v_fmac_f32 v3, v51, v51
    v_add_f32 v2, v2, v52
    v_mfma_f32_16x16x32_bf16 v[40:43], a[216:219], v[72:75], v[40:43]
    s_add_u32 m0, s50, 126976
    ds_read_b128 v[72:75], v16 offset:12288
    s_add_u32 s7, s54, 4096
    v_mfma_f32_16x16x32_bf16 v[40:43], a[228:231], v[76:79], v[40:43]
    s_waitcnt lgkmcnt(6)
    buffer_load_dwordx4 v0, s[40:43], s7 offen sc1 lds
    v_mfma_f32_16x16x32_bf16 v[32:35], a[232:235], v[80:83], v[32:35]
    s_waitcnt lgkmcnt(5)
    ds_read_b128 v[76:79], v16 offset:13312
    v_fmac_f32 v3, v52, v52
    v_mfma_f32_16x16x32_bf16 v[32:35], a[244:247], v[84:87], v[32:35]
    v_add_f32 v2, v2, v53
    v_fmac_f32 v3, v53, v53
    v_mfma_f32_16x16x32_bf16 v[36:39], a[236:239], v[80:83], v[36:39]
    v_add_f32 v2, v2, v54
    v_fmac_f32 v3, v54, v54
    v_mfma_f32_16x16x32_bf16 v[36:39], a[248:251], v[84:87], v[36:39]
    v_add_f32 v2, v2, v55
    v_fmac_f32 v3, v55, v55
    v_mfma_f32_16x16x32_bf16 v[40:43], a[240:243], v[80:83], v[40:43]
    ds_read_b128 v[80:83], v16 offset:14336
    v_mfma_f32_16x16x32_bf16 v[40:43], a[252:255], v[84:87], v[40:43]
    s_waitcnt vmcnt(8) lgkmcnt(6)
    ds_read_b128 v[84:87], v16 offset:15360
    ds_read_b128 v[92:95], v5 offset:20480
    v_mfma_f32_16x16x32_bf16 v[32:35], v[168:171], v[56:59], v[32:35]
    s_waitcnt lgkmcnt(7)
    ds_read_b128 v[96:99], v5 offset:21504
    ds_read_b128 v[100:103], v5 offset:22528
    v_mfma_f32_16x16x32_bf16 v[32:35], v[180:183], v[60:63], v[32:35]
    ds_read_b128 v[104:107], v5 offset:23552
    ds_read_b128 v[108:111], v5 offset:24576
    v_mfma_f32_16x16x32_bf16 v[36:39], v[172:175], v[56:59], v[36:39]
    s_waitcnt vmcnt(7)
    buffer_atomic_add v11, v15, s[40:43], s58 offen offset:0 sc1
    v_mfma_f32_16x16x32_bf16 v[36:39], v[184:187], v[60:63], v[36:39]
    v_permlane32_swap_b32 v2, v3
    v_mfma_f32_16x16x32_bf16 v[40:43], v[176:179], v[56:59], v[40:43]
    ds_read_b128 v[56:59], v16 offset:16384
    s_waitcnt lgkmcnt(5)
    v_max_u32 v92, v92, v93
    v_mfma_f32_16x16x32_bf16 v[40:43], v[188:191], v[60:63], v[40:43]
    ds_read_b128 v[60:63], v16 offset:17408
    v_max3_u32 v92, v92, v94, v95
    v_mfma_f32_16x16x32_bf16 v[32:35], v[192:195], v[64:67], v[32:35]
    s_waitcnt lgkmcnt(5)
    v_max3_u32 v92, v92, v96, v97
    v_max3_u32 v92, v92, v98, v99
    v_mfma_f32_16x16x32_bf16 v[32:35], v[204:207], v[68:71], v[32:35]
    s_waitcnt lgkmcnt(4)
    v_max3_u32 v92, v92, v100, v101
    v_max3_u32 v92, v92, v102, v103
    v_mfma_f32_16x16x32_bf16 v[36:39], v[196:199], v[64:67], v[36:39]
    s_waitcnt lgkmcnt(3)
    v_max3_u32 v92, v92, v104, v105
    v_max3_u32 v92, v92, v106, v107
    v_mfma_f32_16x16x32_bf16 v[36:39], v[208:211], v[68:71], v[36:39]
    s_waitcnt lgkmcnt(2)
    v_max3_u32 v92, v92, v108, v109
    v_max3_u32 v92, v92, v110, v111
    v_mfma_f32_16x16x32_bf16 v[40:43], v[200:203], v[64:67], v[40:43]
    ds_read_b128 v[64:67], v16 offset:18432
    v_cmp_eq_u32 s[96:97], -1, v92
    v_mfma_f32_16x16x32_bf16 v[40:43], v[212:215], v[68:71], v[40:43]
    s_cmp_lg_u64 s[96:97], 0
    s_cbranch_scc1 Lslow27
Lback27:
    ds_read_b128 v[68:71], v16 offset:19456
    v_mfma_f32_16x16x32_bf16 v[32:35], v[216:219], v[72:75], v[32:35]
    v_and_b32 v18, 48, v1
    v_cmp_gt_u32 vcc, 10, v12
    v_mfma_f32_16x16x32_bf16 v[32:35], v[228:231], v[76:79], v[32:35]
    s_and_b32 vcc_lo, vcc_lo, 0xf
    s_cbranch_scc1 Lslow23
Lback23:
    v_add_f32 v2, v2, v3
    v_mfma_f32_16x16x32_bf16 v[36:39], v[220:223], v[72:75], v[36:39]
    buffer_load_dwordx4 v[100:103], v18, s[40:43], s59 offen offset:0 sc1
    v_mfma_f32_16x16x32_bf16 v[36:39], v[232:235], v[76:79], v[36:39]
    buffer_load_dwordx4 v[104:107], v18, s[40:43], s59 offen offset:64 sc1
    v_mfma_f32_16x16x32_bf16 v[40:43], v[224:227], v[72:75], v[40:43]
    buffer_load_dwordx4 v[108:111], v18, s[40:43], s59 offen offset:128 sc1
    v_mfma_f32_16x16x32_bf16 v[40:43], v[236:239], v[76:79], v[40:43]
    buffer_load_dwordx2 v[88:89], v10, s[40:43], s56 offen offset:0 sc1
    v_mfma_f32_16x16x32_bf16 v[32:35], v[240:243], v[80:83], v[32:35]
    v_mov_b32 v3, v2
    v_mfma_f32_16x16x32_bf16 v[32:35], v[252:255], v[84:87], v[32:35]
    s_nop 0
    v_permlane16_swap_b32 v2, v3
    v_mfma_f32_16x16x32_bf16 v[36:39], v[244:247], v[80:83], v[36:39]
    v_add_f32 v2, v2, v3
    v_mfma_f32_16x16x32_bf16 v[36:39], v[112:115], v[84:87], v[36:39]
    s_waitcnt lgkmcnt(0)
    buffer_atomic_add_f32 v2, v14, s[40:43], s57 offen
    v_mfma_f32_16x16x32_bf16 v[40:43], v[248:251], v[80:83], v[40:43]
    s_barrier
    ds_read_b128 v[72:75], v16 offset:20480
    ds_read_b128 v[76:79], v16 offset:21504
    v_mfma_f32_16x16x32_bf16 v[40:43], v[116:119], v[84:87], v[40:43]
    s_add_u32 s57, s57, 256
    ds_read_b128 v[80:83], v16 offset:22528
    ds_read_b128 v[84:87], v16 offset:23552
    v_mfma_f32_16x16x32_bf16 v[32:35], v[120:123], v[56:59], v[32:35]
    s_bfe_u32 s45, s29, 0x10003
    s_lshr_b32 s16, s29, 4
    s_lshl_b32 s51, s16, 3
    v_mfma_f32_16x16x32_bf16 v[32:35], v[132:135], v[60:63], v[32:35]
    s_add_u32 s51, s51, s45
    s_mul_i32 s13, s51, 20480
    s_add_u32 s12, s13, 4194304
    v_mfma_f32_16x16x32_bf16 v[36:39], v[124:127], v[56:59], v[36:39]
    s_mul_i32 s30, s51, 48
    buffer_load_dword v12, v19, s[40:43], s48 offen offset:2560 sc1
    v_mfma_f32_16x16x32_bf16 v[36:39], v[136:139], v[60:63], v[36:39]
    s_mul_i32 s51, s3, 12
    s_add_u32 s30, s30, s51
    s_lshl_b32 s30, s30, 10
    v_mfma_f32_16x16x32_bf16 v[40:43], v[128:131], v[56:59], v[40:43]
    s_add_u32 s30, s30, 7340032
    buffer_load_dwordx4 a[0:3], v0, s[40:43], s22 offen offset:0 sc1
    v_mfma_f32_16x16x32_bf16 v[40:43], v[140:143], v[60:63], v[40:43]
    s_mul_i32 s31, s16, 6144
    ds_read_b128 v[56:59], v16 offset:24576
    ds_read_b128 v[60:63], v16 offset:25600
    v_mfma_f32_16x16x32_bf16 v[32:35], v[144:147], v[64:67], v[32:35]
    s_lshl_b32 s51, s3, 7
    s_add_u32 s31, s31, s51
    s_add_u32 s31, s31, 22024192
    v_mfma_f32_16x16x32_bf16 v[32:35], v[156:159], v[68:71], v[32:35]
    s_add_u32 s62, s30, 196608
    s_add_u32 s63, s30, 294912
    v_mul_u32_u24 v17, 6554, v1
    v_mfma_f32_16x16x32_bf16 v[36:39], v[148:151], v[64:67], v[36:39]
    s_waitcnt vmcnt(8)
    buffer_load_dwordx4 a[4:7], v0, s[40:43], s22 offen offset:1024 sc1
    v_mfma_f32_16x16x32_bf16 v[36:39], v[160:163], v[68:71], v[36:39]
    v_lshrrev_b32 v17, 16, v17
    v_mul_u32_u24 v17, 624, v17
    v_mfma_f32_16x16x32_bf16 v[40:43], v[152:155], v[64:67], v[40:43]
    ds_read_b128 v[64:67], v16 offset:26624
    v_lshlrev_b32 v18, 6, v1
    v_mfma_f32_16x16x32_bf16 v[40:43], v[164:167], v[68:71], v[40:43]
    ds_read_b128 v[68:71], v16 offset:27648
    v_sub_u32 v17, v18, v17
    ds_read_b128 v[44:47], v5 offset:40960
    ds_read_b128 v[48:51], v5 offset:41984
    ds_read_b128 v[52:55], v5 offset:43008
    ds_read_b128 v[92:95], v5 offset:44032
    ds_read_b128 v[96:99], v5 offset:45056
    s_waitcnt lgkmcnt(4)
    v_max_u32 v44, v44, v45
    v_max3_u32 v44, v44, v46, v47
    s_waitcnt lgkmcnt(3)
    v_max3_u32 v44, v44, v48, v49
    v_max3_u32 v44, v44, v50, v51
    s_waitcnt lgkmcnt(2)
    v_max3_u32 v44, v44, v52, v53
    v_max3_u32 v44, v44, v54, v55
    s_waitcnt lgkmcnt(1)
    v_max3_u32 v44, v44, v92, v93
    v_max3_u32 v44, v44, v94, v95
    s_waitcnt lgkmcnt(0)
    v_max3_u32 v44, v44, v96, v97
    v_max3_u32 v44, v44, v98, v99
    v_cmp_eq_u32 s[96:97], -1, v44
    s_nop 0
    s_cmp_lg_u64 s[96:97], 0
    s_cbranch_scc1 Lslow28
Lback28:
    v_mfma_f32_16x16x32_bf16 v[44:47], a[160:163], v[72:75], 0
    buffer_load_dwordx4 a[8:11], v0, s[40:43], s22 offen offset:2048 sc1
    v_add_u32 v17, s47, v17
    v_mfma_f32_16x16x32_bf16 v[44:47], a[172:175], v[76:79], v[44:47]
    v_mfma_f32_16x16x32_bf16 v[48:51], a[164:167], v[72:75], 0
    v_mfma_f32_16x16x32_bf16 v[48:51], a[176:179], v[76:79], v[48:51]
    v_mfma_f32_16x16x32_bf16 v[52:55], a[168:171], v[72:75], 0
    ds_read_b128 v[72:75], v16 offset:28672
    v_mfma_f32_16x16x32_bf16 v[52:55], a[180:183], v[76:79], v[52:55]
    buffer_load_dwordx4 a[12:15], v0, s[40:43], s22 offen offset:3072 sc1
    ds_read_b128 v[76:79], v16 offset:29696
    v_mfma_f32_16x16x32_bf16 v[44:47], a[184:187], v[80:83], v[44:47]
    s_add_u32 s22, s22, 4096
    v_mfma_f32_16x16x32_bf16 v[44:47], a[196:199], v[84:87], v[44:47]
Lwc1_1:
    s_cbranch_execz Lwc1_2
    v_mfma_f32_16x16x32_bf16 v[48:51], a[188:191], v[80:83], v[48:51]
    v_mfma_f32_16x16x32_bf16 v[48:51], a[200:203], v[84:87], v[48:51]
    buffer_load_dwordx4 a[16:19], v0, s[40:43], s22 offen offset:0 sc1
    v_mfma_f32_16x16x32_bf16 v[52:55], a[192:195], v[80:83], v[52:55]
    ds_read_b128 v[80:83], v16 offset:30720
    v_mfma_f32_16x16x32_bf16 v[52:55], a[204:207], v[84:87], v[52:55]
    ds_read_b128 v[84:87], v16 offset:31744
    s_waitcnt vmcnt(7)
    v_mul_f32 v88, 0xbacccccd, v88
    v_mfma_f32_16x16x32_bf16 v[44:47], a[208:211], v[56:59], v[44:47]
    v_mul_f32 v89, 0x3acccccd, v89
    v_fma_f32 v89, -v88, v88, v89
    v_mfma_f32_16x16x32_bf16 v[44:47], a[220:223], v[60:63], v[44:47]
    v_max_f32 v89, 0, v89
    v_add_f32 v89, 0x3727c5ac, v89
    v_mfma_f32_16x16x32_bf16 v[48:51], a[212:215], v[56:59], v[48:51]
    buffer_load_dwordx4 a[20:23], v0, s[40:43], s22 offen offset:1024 sc1
    v_mfma_f32_16x16x32_bf16 v[48:51], a[224:227], v[60:63], v[48:51]
    v_rsq_f32 v90, v89
    v_mfma_f32_16x16x32_bf16 v[52:55], a[216:219], v[56:59], v[52:55]
    ds_read_b128 v[56:59], v16 offset:32768
    v_mul_f32 v90, 0xbfb8aa3b, v90
    v_mfma_f32_16x16x32_bf16 v[52:55], a[228:231], v[60:63], v[52:55]
    ds_read_b128 v[60:63], v16 offset:33792
    ds_write_b128 v13, v[88:91] offset:0
    v_mfma_f32_16x16x32_bf16 v[44:47], a[232:235], v[64:67], v[44:47]
    buffer_load_dwordx4 a[24:27], v0, s[40:43], s22 offen offset:2048 sc1
    v_mfma_f32_16x16x32_bf16 v[44:47], a[244:247], v[68:71], v[44:47]
    ds_read_b96 v[92:94], v21 offset:0
    v_mfma_f32_16x16x32_bf16 v[48:51], a[236:239], v[64:67], v[48:51]
    v_mfma_f32_16x16x32_bf16 v[48:51], a[248:251], v[68:71], v[48:51]
    v_mfma_f32_16x16x32_bf16 v[52:55], a[240:243], v[64:67], v[52:55]
    ds_read_b128 v[64:67], v16 offset:34816
    v_mfma_f32_16x16x32_bf16 v[52:55], a[252:255], v[68:71], v[52:55]
    s_waitcnt lgkmcnt(8)
    buffer_load_dwordx4 a[28:31], v0, s[40:43], s22 offen offset:3072 sc1
    v_mfma_f32_16x16x32_bf16 v[44:47], v[168:171], v[72:75], v[44:47]
    s_add_u32 s22, s22, 4096
    ds_read_b128 v[68:71], v16 offset:35840
    s_waitcnt lgkmcnt(2)
    v_fmac_f32 v32, v92, v100
    v_mfma_f32_16x16x32_bf16 v[44:47], v[180:183], v[76:79], v[44:47]
    v_mul_f32 v6, v94, v32
    v_exp_f32 v6, v6
    v_mfma_f32_16x16x32_bf16 v[48:51], v[172:175], v[72:75], v[48:51]
    v_fmac_f32 v36, v92, v104
    v_fma_f32 v6, v6, v93, v93
    v_mfma_f32_16x16x32_bf16 v[48:51], v[184:187], v[76:79], v[48:51]
    buffer_load_dwordx4 a[32:35], v0, s[40:43], s22 offen offset:0 sc1
    v_mfma_f32_16x16x32_bf16 v[52:55], v[176:179], v[72:75], v[52:55]
    ds_read_b128 v[72:75], v16 offset:36864
    v_mul_f32 v32, v32, v36
    v_mfma_f32_16x16x32_bf16 v[52:55], v[188:191], v[76:79], v[52:55]
    s_waitcnt vmcnt(10)
    buffer_atomic_add v11, v15, s[40:43], s58 offen offset:512 sc1
    v_mfma_f32_16x16x32_bf16 v[44:47], v[192:195], v[80:83], v[44:47]
    ds_read_b128 v[76:79], v16 offset:37888
    ds_read_b96 v[96:98], v21 offset:256
    v_fmac_f32 v33, v92, v101
    v_mfma_f32_16x16x32_bf16 v[44:47], v[204:207], v[84:87], v[44:47]
    v_rcp_f32 v6, v6
    v_mfma_f32_16x16x32_bf16 v[48:51], v[196:199], v[80:83], v[48:51]
    buffer_load_dwordx4 a[36:39], v0, s[40:43], s22 offen offset:1024 sc1
    v_mfma_f32_16x16x32_bf16 v[48:51], v[208:211], v[84:87], v[48:51]
    v_mul_f32 v6, v6, v32
    v_mul_f32 v7, v94, v33
    v_mfma_f32_16x16x32_bf16 v[52:55], v[200:203], v[80:83], v[52:55]
    ds_read_b128 v[80:83], v16 offset:38912
    s_waitcnt vmcnt(11)
    v_cmp_gt_u32 vcc, 10, v12
    v_mfma_f32_16x16x32_bf16 v[52:55], v[212:215], v[84:87], v[52:55]
    s_and_b32 vcc_lo, vcc_lo, 0xf
    s_cbranch_scc1 Lslow24
Lback24:
    buffer_load_dwordx2 v[88:89], v10, s[40:43], s56 offen offset:256 sc1
    v_mfma_f32_16x16x32_bf16 v[44:47], v[216:219], v[56:59], v[44:47]
    s_add_u32 s49, s49, 61440
    ds_read_b128 v[84:87], v16 offset:39936
    s_add_u32 m0, s50, 81920
    v_mfma_f32_16x16x32_bf16 v[44:47], v[228:231], v[60:63], v[44:47]
    buffer_load_dwordx4 v0, s[40:43], s49 offen offset:0 sc1 lds
    v_mfma_f32_16x16x32_bf16 v[48:51], v[220:223], v[56:59], v[48:51]
    v_exp_f32 v7, v7
    v_mfma_f32_16x16x32_bf16 v[48:51], v[232:235], v[60:63], v[48:51]
    v_fmac_f32 v37, v92, v105
    v_fma_f32 v7, v7, v93, v93
    v_mfma_f32_16x16x32_bf16 v[52:55], v[224:227], v[56:59], v[52:55]
    s_add_u32 m0, s50, 81920
    v_rcp_f32 v7, v7
    v_mul_f32 v33, v33, v37
    v_mfma_f32_16x16x32_bf16 v[52:55], v[236:239], v[60:63], v[52:55]
    s_waitcnt lgkmcnt(6)
    buffer_load_dwordx4 v0, s[40:43], s49 offen offset:1024 sc1 lds
    v_mfma_f32_16x16x32_bf16 v[44:47], v[240:243], v[64:67], v[44:47]
    s_waitcnt lgkmcnt(5)
    v_mul_f32 v7, v7, v33
    v_cvt_pk_bf16_f32 v6, v6, v7
    v_mfma_f32_16x16x32_bf16 v[44:47], v[252:255], v[68:71], v[44:47]
    v_fmac_f32 v34, v92, v102
    v_mul_f32 v8, v94, v34
    v_mfma_f32_16x16x32_bf16 v[48:51], v[244:247], v[64:67], v[48:51]
    v_exp_f32 v8, v8
    v_mfma_f32_16x16x32_bf16 v[48:51], v[112:115], v[68:71], v[48:51]
    s_waitcnt lgkmcnt(0)
    s_barrier
    ds_read_b128 v[56:59], v16 offset:40960
    ds_read_b128 v[60:63], v16 offset:41984
    v_mfma_f32_16x16x32_bf16 v[52:55], v[248:251], v[64:67], v[52:55]
    s_add_u32 m0, s50, 81920
    ds_read_b128 v[64:67], v16 offset:43008
    v_fmac_f32 v38, v92, v106
    v_mfma_f32_16x16x32_bf16 v[52:55], v[116:119], v[68:71], v[52:55]
    buffer_load_dwordx4 v0, s[40:43], s49 offen offset:2048 sc1 lds
    v_mfma_f32_16x16x32_bf16 v[44:47], v[120:123], v[72:75], v[44:47]
    ds_read_b128 v[68:71], v16 offset:44032
    v_fma_f32 v8, v8, v93, v93
    v_mfma_f32_16x16x32_bf16 v[44:47], v[132:135], v[76:79], v[44:47]
    s_add_u32 m0, s50, 81920
    v_rcp_f32 v8, v8
    v_mfma_f32_16x16x32_bf16 v[48:51], v[124:127], v[72:75], v[48:51]
    buffer_load_dwordx4 v0, s[40:43], s49 offen offset:3072 sc1 lds
    v_mul_f32 v34, v34, v38
    v_mfma_f32_16x16x32_bf16 v[48:51], v[136:139], v[76:79], v[48:51]
    v_mul_f32 v8, v8, v34
    v_fmac_f32 v35, v92, v103
    v_mfma_f32_16x16x32_bf16 v[52:55], v[128:131], v[72:75], v[52:55]
    ds_read_b128 v[72:75], v16 offset:45056
    v_mul_f32 v9, v94, v35
    v_mfma_f32_16x16x32_bf16 v[52:55], v[140:143], v[76:79], v[52:55]
    ds_read_b128 v[76:79], v16 offset:46080
    v_fmac_f32 v39, v92, v107
    v_mfma_f32_16x16x32_bf16 v[44:47], v[144:147], v[80:83], v[44:47]
    buffer_load_dword v12, v19, s[40:43], s48 offen offset:3072 sc1
    v_mfma_f32_16x16x32_bf16 v[44:47], v[156:159], v[84:87], v[44:47]
    s_add_u32 m0, s50, 86016
    s_add_u32 s7, s49, 4096
    buffer_load_dwordx4 v0, s[40:43], s7 offen sc1 lds
    v_mfma_f32_16x16x32_bf16 v[48:51], v[148:151], v[80:83], v[48:51]
    v_exp_f32 v9, v9
    v_mfma_f32_16x16x32_bf16 v[48:51], v[160:163], v[84:87], v[48:51]
    v_fma_f32 v9, v9, v93, v93
    v_mul_f32 v35, v35, v39
    v_mfma_f32_16x16x32_bf16 v[52:55], v[152:155], v[80:83], v[52:55]
    buffer_load_dwordx4 a[40:43], v0, s[40:43], s22 offen offset:2048 sc1
    v_mfma_f32_16x16x32_bf16 v[52:55], v[164:167], v[84:87], v[52:55]
    ds_read_b128 v[80:83], v16 offset:47104
    ds_read_b128 v[84:87], v16 offset:48128
    v_rcp_f32 v9, v9
    s_nop 0
    v_mul_f32 v9, v9, v35
    v_cvt_pk_bf16_f32 v7, v8, v9
    ds_write_b64 v23, v[6:7] offset:0
    v_fmac_f32 v40, v92, v108
    v_mul_f32 v95, v94, v40
    v_exp_f32 v95, v95
    v_fmac_f32 v42, v92, v110
    v_fma_f32 v95, v95, v93, v93
    v_rcp_f32 v95, v95
    v_mul_f32 v40, v40, v42
    v_mul_f32 v95, v95, v40
    v_fmac_f32 v41, v92, v109
    v_mul_f32 v99, v94, v41
    v_exp_f32 v99, v99
    v_fmac_f32 v43, v92, v111
    v_fma_f32 v99, v99, v93, v93
    v_rcp_f32 v99, v99
    v_mul_f32 v41, v41, v43
    v_mul_f32 v99, v99, v41
    v_cvt_pk_bf16_f32 v95, v95, v99
    ds_write_b32 v24, v95 offset:0
    s_waitcnt lgkmcnt(9)
    v_mfma_f32_16x16x32_bf16 v[32:35], a[160:163], v[56:59], 0
    s_waitcnt lgkmcnt(8)
    ds_read_b128 v[2:5], v22 offset:0
    v_mfma_f32_16x16x32_bf16 v[32:35], a[172:175], v[60:63], v[32:35]
    v_mfma_f32_16x16x32_bf16 v[36:39], a[164:167], v[56:59], 0
    v_fmac_f32 v44, v96, v100
    v_mul_f32 v6, v98, v44
    v_mfma_f32_16x16x32_bf16 v[36:39], a[176:179], v[60:63], v[36:39]
    buffer_load_dwordx4 a[44:47], v0, s[40:43], s22 offen offset:3072 sc1
    v_mfma_f32_16x16x32_bf16 v[40:43], a[168:171], v[56:59], 0
    s_add_u32 s22, s22, 4096
    ds_read_b128 v[56:59], v16 offset:49152
    v_fmac_f32 v48, v96, v104
    v_mfma_f32_16x16x32_bf16 v[40:43], a[180:183], v[60:63], v[40:43]
    s_waitcnt lgkmcnt(9)
    ds_read_b128 v[60:63], v16 offset:50176
    v_exp_f32 v6, v6
    v_mfma_f32_16x16x32_bf16 v[32:35], a[184:187], v[64:67], v[32:35]
    s_waitcnt lgkmcnt(9)
    v_fma_f32 v6, v6, v97, v97
    v_mul_f32 v44, v44, v48
    v_mfma_f32_16x16x32_bf16 v[32:35], a[196:199], v[68:71], v[32:35]
    buffer_load_dwordx4 a[48:51], v0, s[40:43], s22 offen offset:0 sc1
    v_mfma_f32_16x16x32_bf16 v[36:39], a[188:191], v[64:67], v[36:39]
    v_rcp_f32 v6, v6
    v_mfma_f32_16x16x32_bf16 v[36:39], a[200:203], v[68:71], v[36:39]
    v_mul_f32 v6, v6, v44
    v_fmac_f32 v45, v96, v101
    v_mfma_f32_16x16x32_bf16 v[40:43], a[192:195], v[64:67], v[40:43]
    ds_read_b128 v[64:67], v16 offset:51200
    v_mul_f32 v7, v98, v45
    v_fmac_f32 v49, v96, v105
    v_mfma_f32_16x16x32_bf16 v[40:43], a[204:207], v[68:71], v[40:43]
    s_waitcnt lgkmcnt(9)
    ds_read_b128 v[68:71], v16 offset:52224
    v_mul_f32 v45, v45, v49
    v_mfma_f32_16x16x32_bf16 v[32:35], a[208:211], v[72:75], v[32:35]
    s_waitcnt lgkmcnt(9)
    buffer_load_dwordx4 a[52:55], v0, s[40:43], s22 offen offset:1024 sc1
    v_mfma_f32_16x16x32_bf16 v[32:35], a[220:223], v[76:79], v[32:35]
    v_exp_f32 v7, v7
    v_mfma_f32_16x16x32_bf16 v[36:39], a[212:215], v[72:75], v[36:39]
    v_fma_f32 v7, v7, v97, v97
    v_fmac_f32 v46, v96, v102
    v_mfma_f32_16x16x32_bf16 v[36:39], a[224:227], v[76:79], v[36:39]
    v_rcp_f32 v7, v7
    v_mul_f32 v8, v98, v46
    v_mfma_f32_16x16x32_bf16 v[40:43], a[216:219], v[72:75], v[40:43]
    buffer_load_dwordx4 a[56:59], v0, s[40:43], s22 offen offset:2048 sc1
    v_mfma_f32_16x16x32_bf16 v[40:43], a[228:231], v[76:79], v[40:43]
    s_waitcnt lgkmcnt(8)
    ds_read_b128 v[72:75], v16 offset:53248
    ds_read_b128 v[76:79], v16 offset:54272
    v_mfma_f32_16x16x32_bf16 v[32:35], a[232:235], v[80:83], v[32:35]
    s_waitcnt lgkmcnt(9)
    v_exp_f32 v8, v8
    v_mfma_f32_16x16x32_bf16 v[32:35], a[244:247], v[84:87], v[32:35]
    v_mul_f32 v7, v7, v45
    v_cvt_pk_bf16_f32 v6, v6, v7
    v_mfma_f32_16x16x32_bf16 v[36:39], a[236:239], v[80:83], v[36:39]
    buffer_load_dwordx4 a[60:63], v0, s[40:43], s22 offen offset:3072 sc1
    s_add_u32 s22, s22, 4096
    v_mfma_f32_16x16x32_bf16 v[36:39], a[248:251], v[84:87], v[36:39]
    v_fmac_f32 v50, v96, v106
    v_fma_f32 v8, v8, v97, v97
    v_mfma_f32_16x16x32_bf16 v[40:43], a[240:243], v[80:83], v[40:43]
    ds_read_b128 v[80:83], v16 offset:55296
    v_mul_f32 v46, v46, v50
    v_mfma_f32_16x16x32_bf16 v[40:43], a[252:255], v[84:87], v[40:43]
    s_waitcnt lgkmcnt(6)
    ds_read_b128 v[84:87], v16 offset:56320
    v_fmac_f32 v47, v96, v103
    v_mfma_f32_16x16x32_bf16 v[32:35], v[168:171], v[56:59], v[32:35]
    s_waitcnt lgkmcnt(6)
    v_rcp_f32 v8, v8
    v_mfma_f32_16x16x32_bf16 v[32:35], v[180:183], v[60:63], v[32:35]
    buffer_load_dwordx4 a[64:67], v0, s[40:43], s22 offen offset:0 sc1
    v_mul_f32 v8, v8, v46
    v_mfma_f32_16x16x32_bf16 v[36:39], v[172:175], v[56:59], v[36:39]
    v_mul_f32 v9, v98, v47
    v_fmac_f32 v51, v96, v107
    v_mfma_f32_16x16x32_bf16 v[36:39], v[184:187], v[60:63], v[36:39]
    v_exp_f32 v9, v9
    v_mfma_f32_16x16x32_bf16 v[40:43], v[176:179], v[56:59], v[40:43]
    ds_read_b128 v[56:59], v16 offset:57344
    v_fma_f32 v9, v9, v97, v97
    v_mfma_f32_16x16x32_bf16 v[40:43], v[188:191], v[60:63], v[40:43]
    s_waitcnt lgkmcnt(6)
    buffer_load_dwordx4 a[68:71], v0, s[40:43], s22 offen offset:1024 sc1
    v_mfma_f32_16x16x32_bf16 v[32:35], v[192:195], v[64:67], v[32:35]
    s_waitcnt lgkmcnt(5)
    ds_read_b128 v[60:63], v16 offset:58368
    v_rcp_f32 v9, v9
    v_mfma_f32_16x16x32_bf16 v[32:35], v[204:207], v[68:71], v[32:35]
    s_waitcnt vmcnt(14)
    v_mul_f32 v88, 0xbacccccd, v88
    v_mul_f32 v89, 0x3acccccd, v89
    v_mfma_f32_16x16x32_bf16 v[36:39], v[196:199], v[64:67], v[36:39]
    v_fma_f32 v89, -v88, v88, v89
    v_max_f32 v89, 0, v89
    v_mfma_f32_16x16x32_bf16 v[36:39], v[208:211], v[68:71], v[36:39]
    v_add_f32 v89, 0x3727c5ac, v89
    v_mul_f32 v47, v47, v51
    v_mfma_f32_16x16x32_bf16 v[40:43], v[200:203], v[64:67], v[40:43]
    buffer_load_dwordx4 a[72:75], v0, s[40:43], s22 offen offset:2048 sc1
    v_mfma_f32_16x16x32_bf16 v[40:43], v[212:215], v[68:71], v[40:43]
    s_waitcnt lgkmcnt(5)
    ds_read_b128 v[64:67], v16 offset:59392
    ds_read_b128 v[68:71], v16 offset:60416
    v_mul_f32 v9, v9, v47
    v_mfma_f32_16x16x32_bf16 v[32:35], v[216:219], v[72:75], v[32:35]
    s_waitcnt lgkmcnt(6)
    v_rsq_f32 v90, v89
    v_mfma_f32_16x16x32_bf16 v[32:35], v[228:231], v[76:79], v[32:35]
    v_mul_f32 v90, 0xbfb8aa3b, v90
    ds_write_b128 v13, v[88:91] offset:512
    v_mfma_f32_16x16x32_bf16 v[36:39], v[220:223], v[72:75], v[36:39]
    s_waitcnt vmcnt(10)
    v_cmp_gt_u32 vcc, 10, v12
    ds_read_b96 v[92:94], v21 offset:512
    v_mfma_f32_16x16x32_bf16 v[36:39], v[232:235], v[76:79], v[36:39]
    s_and_b32 vcc_lo, vcc_lo, 0xf
    s_cbranch_scc1 Lslow25
Lback25:
    v_cvt_pk_bf16_f32 v7, v8, v9
    v_mfma_f32_16x16x32_bf16 v[40:43], v[224:227], v[72:75], v[40:43]
    buffer_load_dwordx4 a[76:79], v0, s[40:43], s22 offen offset:3072 sc1
    s_add_u32 s22, s22, 4096
    v_mfma_f32_16x16x32_bf16 v[40:43], v[236:239], v[76:79], v[40:43]
    s_waitcnt lgkmcnt(7)
    ds_write_b64 v23, v[6:7] offset:768
    v_fmac_f32 v52, v96, v108
    v_mfma_f32_16x16x32_bf16 v[32:35], v[240:243], v[80:83], v[32:35]
    s_waitcnt lgkmcnt(7)
    v_mul_f32 v95, v98, v52
    v_fmac_f32 v54, v96, v110
    v_mfma_f32_16x16x32_bf16 v[32:35], v[252:255], v[84:87], v[32:35]
    s_add_u32 s49, s49, 20480
    s_add_u32 m0, s50, 102400
    v_mul_f32 v52, v52, v54
    v_mfma_f32_16x16x32_bf16 v[36:39], v[244:247], v[80:83], v[36:39]
    buffer_load_dwordx4 v0, s[40:43], s49 offen offset:0 sc1 lds
    v_mfma_f32_16x16x32_bf16 v[36:39], v[112:115], v[84:87], v[36:39]
    s_waitcnt vmcnt(11) lgkmcnt(3)
    s_barrier
    ds_read_b128 v[72:75], v16 offset:0
    ds_read_b128 v[76:79], v16 offset:1024
    v_mfma_f32_16x16x32_bf16 v[40:43], v[248:251], v[80:83], v[40:43]
    ds_read_b128 v[80:83], v16 offset:2048
    v_fmac_f32 v53, v96, v109
    v_mfma_f32_16x16x32_bf16 v[40:43], v[116:119], v[84:87], v[40:43]
    s_add_u32 m0, s50, 102400
    ds_read_b128 v[84:87], v16 offset:3072
    v_mul_f32 v99, v98, v53
    v_mfma_f32_16x16x32_bf16 v[32:35], v[120:123], v[56:59], v[32:35]
    buffer_load_dwordx4 v0, s[40:43], s49 offen offset:1024 sc1 lds
    v_mfma_f32_16x16x32_bf16 v[32:35], v[132:135], v[60:63], v[32:35]
    v_exp_f32 v95, v95
    v_mfma_f32_16x16x32_bf16 v[36:39], v[124:127], v[56:59], v[36:39]
    v_exp_f32 v99, v99
    v_fma_f32 v95, v95, v97, v97
    v_mfma_f32_16x16x32_bf16 v[36:39], v[136:139], v[60:63], v[36:39]
    v_rcp_f32 v95, v95
    v_mfma_f32_16x16x32_bf16 v[40:43], v[128:131], v[56:59], v[40:43]
    s_add_u32 m0, s50, 102400
    ds_read_b128 v[56:59], v16 offset:4096
    v_mul_f32 v95, v95, v52
    v_mfma_f32_16x16x32_bf16 v[40:43], v[140:143], v[60:63], v[40:43]
    buffer_load_dwordx4 v0, s[40:43], s49 offen offset:2048 sc1 lds
    v_mfma_f32_16x16x32_bf16 v[32:35], v[144:147], v[64:67], v[32:35]
    ds_read_b128 v[60:63], v16 offset:5120
    v_fmac_f32 v55, v96, v111
    v_mfma_f32_16x16x32_bf16 v[32:35], v[156:159], v[68:71], v[32:35]
    v_fma_f32 v99, v99, v97, v97
    v_rcp_f32 v99, v99
    v_mfma_f32_16x16x32_bf16 v[36:39], v[148:151], v[64:67], v[36:39]
    s_add_u32 m0, s50, 102400
    v_mul_f32 v53, v53, v55
    v_mul_f32 v99, v99, v53
    v_mfma_f32_16x16x32_bf16 v[36:39], v[160:163], v[68:71], v[36:39]
    buffer_store_dwordx4 v[2:5], v25, s[40:43], s44 offen sc1
    v_mfma_f32_16x16x32_bf16 v[40:43], v[152:155], v[64:67], v[40:43]
    s_add_u32 s44, s44, 49152
    ds_read_b128 v[64:67], v16 offset:6144
    v_cvt_pk_bf16_f32 v95, v95, v99
    v_mfma_f32_16x16x32_bf16 v[40:43], v[164:167], v[68:71], v[40:43]
    s_waitcnt lgkmcnt(6)
    buffer_load_dwordx4 v0, s[40:43], s49 offen offset:3072 sc1 lds
    ds_write_b32 v24, v95 offset:768
    v_mfma_f32_16x16x32_bf16 v[44:47], a[160:163], v[72:75], 0
    s_waitcnt lgkmcnt(6)
    ds_read_b128 v[68:71], v16 offset:7168
    ds_read_b128 v[2:5], v22 offset:768
    v_mfma_f32_16x16x32_bf16 v[44:47], a[172:175], v[76:79], v[44:47]
    buffer_load_dword v12, v19, s[40:43], s48 offen offset:3584 sc1
    v_mfma_f32_16x16x32_bf16 v[48:51], a[164:167], v[72:75], 0
    s_add_u32 m0, s50, 106496
    s_add_u32 s7, s49, 4096
    v_fmac_f32 v32, v92, v100
    v_mfma_f32_16x16x32_bf16 v[48:51], a[176:179], v[76:79], v[48:51]
    buffer_load_dwordx4 v0, s[40:43], s7 offen sc1 lds
    v_mfma_f32_16x16x32_bf16 v[52:55], a[168:171], v[72:75], 0
    ds_read_b128 v[72:75], v16 offset:8192
    v_mul_f32 v6, v94, v32
    v_mfma_f32_16x16x32_bf16 v[52:55], a[180:183], v[76:79], v[52:55]
    s_add_u32 s49, s49, 20480
    s_waitcnt lgkmcnt(1)
    buffer_store_dwordx4 v[2:5], v25, s[40:43], s44 offen sc1
    ds_read_b128 v[76:79], v16 offset:9216
    v_mfma_f32_16x16x32_bf16 v[44:47], a[184:187], v[80:83], v[44:47]
    s_add_u32 s44, s44, 49152
    s_add_u32 m0, s50, 122880
    v_fmac_f32 v36, v92, v104
    v_mfma_f32_16x16x32_bf16 v[44:47], a[196:199], v[84:87], v[44:47]
    buffer_load_dwordx4 v0, s[40:43], s49 offen offset:0 sc1 lds
    v_mfma_f32_16x16x32_bf16 v[48:51], a[188:191], v[80:83], v[48:51]
    v_exp_f32 v6, v6
    v_mfma_f32_16x16x32_bf16 v[48:51], a[200:203], v[84:87], v[48:51]
    s_add_u32 m0, s50, 122880
    v_fma_f32 v6, v6, v93, v93
    v_mul_f32 v32, v32, v36
    v_mfma_f32_16x16x32_bf16 v[52:55], a[192:195], v[80:83], v[52:55]
    buffer_load_dwordx4 v0, s[40:43], s49 offen offset:1024 sc1 lds
    ds_read_b128 v[80:83], v16 offset:10240
    v_mfma_f32_16x16x32_bf16 v[52:55], a[204:207], v[84:87], v[52:55]
    ds_read_b128 v[84:87], v16 offset:11264
    v_fmac_f32 v33, v92, v101
    v_mfma_f32_16x16x32_bf16 v[44:47], a[208:211], v[56:59], v[44:47]
    v_rcp_f32 v6, v6
    v_mfma_f32_16x16x32_bf16 v[44:47], a[220:223], v[60:63], v[44:47]
    v_mul_f32 v6, v6, v32
    v_mul_f32 v7, v94, v33
    v_mfma_f32_16x16x32_bf16 v[48:51], a[212:215], v[56:59], v[48:51]
    s_add_u32 m0, s50, 122880
    v_exp_f32 v7, v7
    v_mfma_f32_16x16x32_bf16 v[48:51], a[224:227], v[60:63], v[48:51]
    buffer_load_dwordx4 v0, s[40:43], s49 offen offset:2048 sc1 lds
    v_fmac_f32 v37, v92, v105
    v_mfma_f32_16x16x32_bf16 v[52:55], a[216:219], v[56:59], v[52:55]
    ds_read_b128 v[56:59], v16 offset:12288
    v_fma_f32 v7, v7, v93, v93
    v_mfma_f32_16x16x32_bf16 v[52:55], a[228:231], v[60:63], v[52:55]
    ds_read_b128 v[60:63], v16 offset:13312
    v_mul_f32 v33, v33, v37
    v_mfma_f32_16x16x32_bf16 v[44:47], a[232:235], v[64:67], v[44:47]
    s_add_u32 m0, s50, 122880
    v_rcp_f32 v7, v7
    v_mfma_f32_16x16x32_bf16 v[44:47], a[244:247], v[68:71], v[44:47]
    buffer_load_dwordx4 v0, s[40:43], s49 offen offset:3072 sc1 lds
    v_mfma_f32_16x16x32_bf16 v[48:51], a[236:239], v[64:67], v[48:51]
    v_mul_f32 v7, v7, v33
    v_cvt_pk_bf16_f32 v6, v6, v7
    v_fmac_f32 v34, v92, v102
    v_mfma_f32_16x16x32_bf16 v[48:51], a[248:251], v[68:71], v[48:51]
    v_mul_f32 v8, v94, v34
    v_fmac_f32 v38, v92, v106
    v_mfma_f32_16x16x32_bf16 v[52:55], a[240:243], v[64:67], v[52:55]
    ds_read_b128 v[64:67], v16 offset:14336
    v_mul_f32 v34, v34, v38
    v_mfma_f32_16x16x32_bf16 v[52:55], a[252:255], v[68:71], v[52:55]
    s_add_u32 m0, s50, 126976
    ds_read_b128 v[68:71], v16 offset:15360
    s_add_u32 s7, s49, 4096
    s_waitcnt lgkmcnt(7)
    v_mfma_f32_16x16x32_bf16 v[44:47], v[168:171], v[72:75], v[44:47]
    s_waitcnt lgkmcnt(6)
    buffer_load_dwordx4 v0, s[40:43], s7 offen sc1 lds
    v_mfma_f32_16x16x32_bf16 v[44:47], v[180:183], v[76:79], v[44:47]
    v_exp_f32 v8, v8
    v_fmac_f32 v35, v92, v103
    v_mfma_f32_16x16x32_bf16 v[48:51], v[172:175], v[72:75], v[48:51]
    v_fma_f32 v8, v8, v93, v93
    v_mul_f32 v9, v94, v35
    v_mfma_f32_16x16x32_bf16 v[48:51], v[184:187], v[76:79], v[48:51]
    buffer_load_dwordx4 a[80:83], v0, s[40:43], s22 offen offset:0 sc1
    v_mfma_f32_16x16x32_bf16 v[52:55], v[176:179], v[72:75], v[52:55]
    ds_read_b128 v[72:75], v16 offset:16384
    v_fmac_f32 v39, v92, v107
    v_mfma_f32_16x16x32_bf16 v[52:55], v[188:191], v[76:79], v[52:55]
    s_waitcnt lgkmcnt(6)
    ds_read_b128 v[76:79], v16 offset:17408
    v_mul_f32 v35, v35, v39
    v_mfma_f32_16x16x32_bf16 v[44:47], v[192:195], v[80:83], v[44:47]
    s_waitcnt lgkmcnt(6)
    ds_read_b96 v[96:98], v21 offset:768
    v_rcp_f32 v8, v8
    v_mfma_f32_16x16x32_bf16 v[44:47], v[204:207], v[84:87], v[44:47]
    v_exp_f32 v9, v9
    v_mfma_f32_16x16x32_bf16 v[48:51], v[196:199], v[80:83], v[48:51]
    buffer_load_dwordx4 a[84:87], v0, s[40:43], s22 offen offset:1024 sc1
    v_mfma_f32_16x16x32_bf16 v[48:51], v[208:211], v[84:87], v[48:51]
    v_mul_f32 v8, v8, v34
    v_fma_f32 v9, v9, v93, v93
    v_mfma_f32_16x16x32_bf16 v[52:55], v[200:203], v[80:83], v[52:55]
    ds_read_b128 v[80:83], v16 offset:18432
    v_fmac_f32 v40, v92, v108
    v_mfma_f32_16x16x32_bf16 v[52:55], v[212:215], v[84:87], v[52:55]
    s_waitcnt lgkmcnt(7)
    ds_read_b128 v[84:87], v16 offset:19456
    v_rcp_f32 v9, v9
    v_mfma_f32_16x16x32_bf16 v[44:47], v[216:219], v[56:59], v[44:47]
    s_waitcnt lgkmcnt(7)
    buffer_load_dwordx4 a[88:91], v0, s[40:43], s22 offen offset:2048 sc1
    v_mfma_f32_16x16x32_bf16 v[44:47], v[228:231], v[60:63], v[44:47]
    v_mul_f32 v9, v9, v35
    v_cvt_pk_bf16_f32 v7, v8, v9
    v_mfma_f32_16x16x32_bf16 v[48:51], v[220:223], v[56:59], v[48:51]
    ds_write_b64 v23, v[6:7] offset:0
    v_mul_f32 v95, v94, v40
    v_mfma_f32_16x16x32_bf16 v[48:51], v[232:235], v[60:63], v[48:51]
    v_exp_f32 v95, v95
    v_mfma_f32_16x16x32_bf16 v[52:55], v[224:227], v[56:59], v[52:55]
    buffer_load_dwordx4 a[92:95], v0, s[40:43], s22 offen offset:3072 sc1
    s_add_u32 s22, s22, 4096
    v_mfma_f32_16x16x32_bf16 v[52:55], v[236:239], v[60:63], v[52:55]
    s_waitcnt lgkmcnt(7)
    v_fmac_f32 v42, v92, v110
    v_fma_f32 v95, v95, v93, v93
    v_mfma_f32_16x16x32_bf16 v[44:47], v[240:243], v[64:67], v[44:47]
    s_waitcnt lgkmcnt(6)
    v_rcp_f32 v95, v95
    v_mfma_f32_16x16x32_bf16 v[44:47], v[252:255], v[68:71], v[44:47]
    v_mul_f32 v40, v40, v42
    v_mul_f32 v95, v95, v40
    v_mfma_f32_16x16x32_bf16 v[48:51], v[244:247], v[64:67], v[48:51]
    s_waitcnt vmcnt(11)
    v_cmp_gt_u32 vcc, 10, v12
    v_fmac_f32 v41, v92, v109
    v_mfma_f32_16x16x32_bf16 v[48:51], v[112:115], v[68:71], v[48:51]
    s_waitcnt vmcnt(10) lgkmcnt(1)
    s_barrier
    ds_read_b128 v[56:59], v16 offset:20480
    ds_read_b128 v[60:63], v16 offset:21504
    v_mfma_f32_16x16x32_bf16 v[52:55], v[248:251], v[64:67], v[52:55]
    s_and_b32 vcc_lo, vcc_lo, 0xf
    s_cbranch_scc1 Lslow26
Lback26:
    ds_read_b128 v[64:67], v16 offset:22528
    v_mfma_f32_16x16x32_bf16 v[52:55], v[116:119], v[68:71], v[52:55]
    buffer_load_dwordx2 v[88:89], v10, s[40:43], s56 offen offset:512 sc1
    v_mfma_f32_16x16x32_bf16 v[44:47], v[120:123], v[72:75], v[44:47]
    ds_read_b128 v[68:71], v16 offset:23552
    v_mul_f32 v99, v94, v41
    v_mfma_f32_16x16x32_bf16 v[44:47], v[132:135], v[76:79], v[44:47]
    buffer_load_dwordx4 a[96:99], v0, s[40:43], s22 offen offset:0 sc1
    v_mfma_f32_16x16x32_bf16 v[48:51], v[124:127], v[72:75], v[48:51]
    s_add_u32 s49, s49, 20480
    s_add_u32 m0, s50, 81920
    v_exp_f32 v99, v99
    v_mfma_f32_16x16x32_bf16 v[48:51], v[136:139], v[76:79], v[48:51]
    buffer_load_dwordx4 v0, s[40:43], s49 offen offset:0 sc1 lds
    v_mfma_f32_16x16x32_bf16 v[52:55], v[128:131], v[72:75], v[52:55]
    ds_read_b128 v[72:75], v16 offset:24576
    v_fmac_f32 v43, v92, v111
    v_mfma_f32_16x16x32_bf16 v[52:55], v[140:143], v[76:79], v[52:55]
    ds_read_b128 v[76:79], v16 offset:25600
    v_fma_f32 v99, v99, v93, v93
    v_mfma_f32_16x16x32_bf16 v[44:47], v[144:147], v[80:83], v[44:47]
    s_add_u32 m0, s50, 81920
    v_rcp_f32 v99, v99
    v_mfma_f32_16x16x32_bf16 v[44:47], v[156:159], v[84:87], v[44:47]
    buffer_load_dwordx4 v0, s[40:43], s49 offen offset:1024 sc1 lds
    v_mul_f32 v41, v41, v43
    v_mfma_f32_16x16x32_bf16 v[48:51], v[148:151], v[80:83], v[48:51]
    v_mul_f32 v99, v99, v41
    v_cvt_pk_bf16_f32 v95, v95, v99
    v_mfma_f32_16x16x32_bf16 v[48:51], v[160:163], v[84:87], v[48:51]
    ds_write_b32 v24, v95 offset:0
    ds_read_b128 v[2:5], v22 offset:0
    v_mfma_f32_16x16x32_bf16 v[52:55], v[152:155], v[80:83], v[52:55]
    s_add_u32 m0, s50, 81920
    ds_read_b128 v[80:83], v16 offset:26624
    v_mfma_f32_16x16x32_bf16 v[52:55], v[164:167], v[84:87], v[52:55]
    s_waitcnt lgkmcnt(8)
    buffer_load_dwordx4 v0, s[40:43], s49 offen offset:2048 sc1 lds
    v_mfma_f32_16x16x32_bf16 v[32:35], a[160:163], v[56:59], 0
    s_waitcnt lgkmcnt(7)
    ds_read_b128 v[84:87], v16 offset:27648
    v_mfma_f32_16x16x32_bf16 v[32:35], a[172:175], v[60:63], v[32:35]
    v_mfma_f32_16x16x32_bf16 v[36:39], a[164:167], v[56:59], 0
    v_fmac_f32 v44, v96, v100
    v_mul_f32 v6, v98, v44
    v_mfma_f32_16x16x32_bf16 v[36:39], a[176:179], v[60:63], v[36:39]
    s_add_u32 m0, s50, 81920
    v_exp_f32 v6, v6
    v_mfma_f32_16x16x32_bf16 v[40:43], a[168:171], v[56:59], 0
    buffer_load_dwordx4 v0, s[40:43], s49 offen offset:3072 sc1 lds
    v_mfma_f32_16x16x32_bf16 v[40:43], a[180:183], v[60:63], v[40:43]
    s_waitcnt lgkmcnt(7)
    ds_read_b128 v[56:59], v16 offset:28672
    ds_read_b128 v[60:63], v16 offset:29696
    v_fmac_f32 v48, v96, v104
    v_mfma_f32_16x16x32_bf16 v[32:35], a[184:187], v[64:67], v[32:35]
    s_waitcnt lgkmcnt(8)
    v_fma_f32 v6, v6, v97, v97
    v_mul_f32 v44, v44, v48
    v_mfma_f32_16x16x32_bf16 v[32:35], a[196:199], v[68:71], v[32:35]
    s_add_u32 m0, s50, 86016
    s_add_u32 s7, s49, 4096
    v_fmac_f32 v45, v96, v101
    v_mfma_f32_16x16x32_bf16 v[36:39], a[188:191], v[64:67], v[36:39]
    buffer_load_dwordx4 v0, s[40:43], s7 offen sc1 lds
    v_mfma_f32_16x16x32_bf16 v[36:39], a[200:203], v[68:71], v[36:39]
    s_waitcnt vmcnt(16)
    buffer_atomic_add v11, v15, s[40:43], s55 offen offset:0 sc1
    v_mfma_f32_16x16x32_bf16 v[40:43], a[192:195], v[64:67], v[40:43]
    s_add_u32 s55, s55, 512
    ds_read_b128 v[64:67], v16 offset:30720
    v_rcp_f32 v6, v6
    v_mfma_f32_16x16x32_bf16 v[40:43], a[204:207], v[68:71], v[40:43]
    s_waitcnt lgkmcnt(8)
    ds_read_b128 v[68:71], v16 offset:31744
    v_mul_f32 v6, v6, v44
    v_mfma_f32_16x16x32_bf16 v[32:35], a[208:211], v[72:75], v[32:35]
    s_waitcnt lgkmcnt(8)
    buffer_load_dwordx4 a[100:103], v0, s[40:43], s22 offen offset:1024 sc1
    v_mfma_f32_16x16x32_bf16 v[32:35], a[220:223], v[76:79], v[32:35]
    v_mul_f32 v7, v98, v45
    v_fmac_f32 v49, v96, v105
    v_mfma_f32_16x16x32_bf16 v[36:39], a[212:215], v[72:75], v[36:39]
    v_exp_f32 v7, v7
    v_mfma_f32_16x16x32_bf16 v[36:39], a[224:227], v[76:79], v[36:39]
    v_fma_f32 v7, v7, v97, v97
    v_rcp_f32 v7, v7
    v_mfma_f32_16x16x32_bf16 v[40:43], a[216:219], v[72:75], v[40:43]
    buffer_load_dwordx4 a[104:107], v0, s[40:43], s22 offen offset:2048 sc1
    v_mfma_f32_16x16x32_bf16 v[40:43], a[228:231], v[76:79], v[40:43]
    s_waitcnt lgkmcnt(5)
    ds_read_b128 v[72:75], v16 offset:32768
    ds_read_b128 v[76:79], v16 offset:33792
    v_mfma_f32_16x16x32_bf16 v[32:35], a[232:235], v[80:83], v[32:35]
    s_waitcnt lgkmcnt(6)
    v_mul_f32 v45, v45, v49
    v_mul_f32 v7, v7, v45
    v_mfma_f32_16x16x32_bf16 v[32:35], a[244:247], v[84:87], v[32:35]
    v_cvt_pk_bf16_f32 v6, v6, v7
    v_fmac_f32 v46, v96, v102
    v_mfma_f32_16x16x32_bf16 v[36:39], a[236:239], v[80:83], v[36:39]
    v_mul_f32 v8, v98, v46
    v_exp_f32 v8, v8
    v_mfma_f32_16x16x32_bf16 v[36:39], a[248:251], v[84:87], v[36:39]
    buffer_load_dwordx4 a[108:111], v0, s[40:43], s22 offen offset:3072 sc1
    v_mfma_f32_16x16x32_bf16 v[40:43], a[240:243], v[80:83], v[40:43]
    s_add_u32 s22, s22, 4096
    ds_read_b128 v[80:83], v16 offset:34816
    v_fmac_f32 v50, v96, v106
    v_mfma_f32_16x16x32_bf16 v[40:43], a[252:255], v[84:87], v[40:43]
    s_waitcnt lgkmcnt(6)
    ds_read_b128 v[84:87], v16 offset:35840
    v_fma_f32 v8, v8, v97, v97
    v_mfma_f32_16x16x32_bf16 v[32:35], v[168:171], v[56:59], v[32:35]
    s_waitcnt lgkmcnt(6)
Lwc2_1:
    s_cbranch_execz Lwc2_2
    v_rcp_f32 v8, v8
    v_mfma_f32_16x16x32_bf16 v[32:35], v[180:183], v[60:63], v[32:35]
    buffer_load_dwordx4 a[112:115], v0, s[40:43], s22 offen offset:0 sc1
    v_mul_f32 v46, v46, v50
    v_mfma_f32_16x16x32_bf16 v[36:39], v[172:175], v[56:59], v[36:39]
    v_mul_f32 v8, v8, v46
    v_fmac_f32 v47, v96, v103
    v_mfma_f32_16x16x32_bf16 v[36:39], v[184:187], v[60:63], v[36:39]
    v_mul_f32 v9, v98, v47
    v_fmac_f32 v51, v96, v107
    v_mfma_f32_16x16x32_bf16 v[40:43], v[176:179], v[56:59], v[40:43]
    ds_read_b128 v[56:59], v16 offset:36864
    v_mul_f32 v47, v47, v51
    v_mfma_f32_16x16x32_bf16 v[40:43], v[188:191], v[60:63], v[40:43]
    s_waitcnt lgkmcnt(6)
    buffer_load_dwordx4 a[116:119], v0, s[40:43], s22 offen offset:1024 sc1
    v_mfma_f32_16x16x32_bf16 v[32:35], v[192:195], v[64:67], v[32:35]
    s_waitcnt lgkmcnt(5)
    ds_read_b128 v[60:63], v16 offset:37888
    v_exp_f32 v9, v9
    v_mfma_f32_16x16x32_bf16 v[32:35], v[204:207], v[68:71], v[32:35]
    v_fma_f32 v9, v9, v97, v97
    v_fmac_f32 v52, v96, v108
    v_mfma_f32_16x16x32_bf16 v[36:39], v[196:199], v[64:67], v[36:39]
    v_rcp_f32 v9, v9
    v_mfma_f32_16x16x32_bf16 v[36:39], v[208:211], v[68:71], v[36:39]
    v_mul_f32 v9, v9, v47
    v_cvt_pk_bf16_f32 v7, v8, v9
    v_mfma_f32_16x16x32_bf16 v[40:43], v[200:203], v[64:67], v[40:43]
    buffer_load_dwordx4 a[120:123], v0, s[40:43], s22 offen offset:2048 sc1
    v_mfma_f32_16x16x32_bf16 v[40:43], v[212:215], v[68:71], v[40:43]
    s_waitcnt lgkmcnt(5)
    ds_read_b128 v[64:67], v16 offset:38912
    ds_read_b128 v[68:71], v16 offset:39936
    ds_write_b64 v23, v[6:7] offset:768
    v_mfma_f32_16x16x32_bf16 v[32:35], v[216:219], v[72:75], v[32:35]
    s_waitcnt lgkmcnt(7)
    v_mul_f32 v95, v98, v52
    v_fmac_f32 v54, v96, v110
    v_mfma_f32_16x16x32_bf16 v[32:35], v[228:231], v[76:79], v[32:35]
    v_exp_f32 v95, v95
    v_mfma_f32_16x16x32_bf16 v[36:39], v[220:223], v[72:75], v[36:39]
    buffer_load_dwordx4 a[124:127], v0, s[40:43], s22 offen offset:3072 sc1
    v_mfma_f32_16x16x32_bf16 v[36:39], v[232:235], v[76:79], v[36:39]
    s_add_u32 s22, s22, 4096
    v_fma_f32 v95, v95, v97, v97
    v_mul_f32 v52, v52, v54
    v_mfma_f32_16x16x32_bf16 v[40:43], v[224:227], v[72:75], v[40:43]
    v_rcp_f32 v95, v95
    v_fmac_f32 v53, v96, v109
    v_mfma_f32_16x16x32_bf16 v[40:43], v[236:239], v[76:79], v[40:43]
    s_waitcnt lgkmcnt(6)
    v_mul_f32 v95, v95, v52
    v_mul_f32 v99, v98, v53
    v_mfma_f32_16x16x32_bf16 v[32:35], v[240:243], v[80:83], v[32:35]
    s_waitcnt lgkmcnt(5)
    v_exp_f32 v99, v99
    v_mfma_f32_16x16x32_bf16 v[32:35], v[252:255], v[84:87], v[32:35]
    buffer_load_dwordx4 a[128:131], v0, s[40:43], s22 offen offset:0 sc1
    v_mfma_f32_16x16x32_bf16 v[36:39], v[244:247], v[80:83], v[36:39]
    s_waitcnt vmcnt(15)
    v_mul_f32 v88, 0xbacccccd, v88
    v_mul_f32 v89, 0x3acccccd, v89
    v_mfma_f32_16x16x32_bf16 v[36:39], v[112:115], v[84:87], v[36:39]
    s_waitcnt lgkmcnt(1)
    s_barrier
    ds_read_b128 v[72:75], v16 offset:40960
    ds_read_b128 v[76:79], v16 offset:41984
    v_mfma_f32_16x16x32_bf16 v[40:43], v[248:251], v[80:83], v[40:43]
    ds_read_b128 v[80:83], v16 offset:43008
    v_fma_f32 v89, -v88, v88, v89
    v_mfma_f32_16x16x32_bf16 v[40:43], v[116:119], v[84:87], v[40:43]
    s_add_u32 s49, s49, 20480
    ds_read_b128 v[84:87], v16 offset:44032
    s_add_u32 m0, s50, 102400
    v_mfma_f32_16x16x32_bf16 v[32:35], v[120:123], v[56:59], v[32:35]
    buffer_load_dwordx4 v0, s[40:43], s49 offen offset:0 sc1 lds
    v_mfma_f32_16x16x32_bf16 v[32:35], v[132:135], v[60:63], v[32:35]
    v_max_f32 v89, 0, v89
    v_add_f32 v89, 0x3727c5ac, v89
    v_mfma_f32_16x16x32_bf16 v[36:39], v[124:127], v[56:59], v[36:39]
    v_rsq_f32 v90, v89
    v_fmac_f32 v55, v96, v111
    v_mfma_f32_16x16x32_bf16 v[36:39], v[136:139], v[60:63], v[36:39]
    v_mul_f32 v90, 0xbfb8aa3b, v90
    ds_write_b128 v13, v[88:91] offset:1024
    v_mfma_f32_16x16x32_bf16 v[40:43], v[128:131], v[56:59], v[40:43]
    s_add_u32 m0, s50, 102400
    ds_read_b128 v[56:59], v16 offset:45056
    ds_read_b96 v[92:94], v21 offset:1024
    v_mfma_f32_16x16x32_bf16 v[40:43], v[140:143], v[60:63], v[40:43]
    buffer_load_dwordx4 v0, s[40:43], s49 offen offset:1024 sc1 lds
    v_mfma_f32_16x16x32_bf16 v[32:35], v[144:147], v[64:67], v[32:35]
    ds_read_b128 v[60:63], v16 offset:46080
    v_fma_f32 v99, v99, v97, v97
    v_mfma_f32_16x16x32_bf16 v[32:35], v[156:159], v[68:71], v[32:35]
    v_rcp_f32 v99, v99
    v_mul_f32 v53, v53, v55
    v_mfma_f32_16x16x32_bf16 v[36:39], v[148:151], v[64:67], v[36:39]
    s_add_u32 m0, s50, 102400
    buffer_store_dwordx4 v[2:5], v25, s[40:43], s44 offen sc1
    v_mfma_f32_16x16x32_bf16 v[36:39], v[160:163], v[68:71], v[36:39]
    s_add_u32 s44, s44, 49152
    buffer_load_dwordx4 v0, s[40:43], s49 offen offset:2048 sc1 lds
    v_mfma_f32_16x16x32_bf16 v[40:43], v[152:155], v[64:67], v[40:43]
    ds_read_b128 v[64:67], v16 offset:47104
    v_mul_f32 v99, v99, v53
    v_mfma_f32_16x16x32_bf16 v[40:43], v[164:167], v[68:71], v[40:43]
    s_waitcnt lgkmcnt(8)
    ds_read_b128 v[68:71], v16 offset:48128
    v_cvt_pk_bf16_f32 v95, v95, v99
    ds_write_b32 v24, v95 offset:768
    v_mfma_f32_16x16x32_bf16 v[44:47], a[160:163], v[72:75], 0
    s_waitcnt lgkmcnt(9)
    ds_read_b128 v[2:5], v22 offset:768
    v_mfma_f32_16x16x32_bf16 v[44:47], a[172:175], v[76:79], v[44:47]
    s_add_u32 m0, s50, 102400
    v_mfma_f32_16x16x32_bf16 v[48:51], a[164:167], v[72:75], 0
    buffer_load_dwordx4 v0, s[40:43], s49 offen offset:3072 sc1 lds
    v_mfma_f32_16x16x32_bf16 v[48:51], a[176:179], v[76:79], v[48:51]
    s_waitcnt lgkmcnt(5)
    v_fmac_f32 v32, v92, v100
    v_mul_f32 v6, v94, v32
    v_mfma_f32_16x16x32_bf16 v[52:55], a[168:171], v[72:75], 0
    ds_read_b128 v[72:75], v16 offset:49152
    v_fmac_f32 v36, v92, v104
    v_mfma_f32_16x16x32_bf16 v[52:55], a[180:183], v[76:79], v[52:55]
    s_add_u32 m0, s50, 106496
    s_waitcnt lgkmcnt(1)
    buffer_store_dwordx4 v[2:5], v25, s[40:43], s44 offen sc1
    ds_read_b128 v[76:79], v16 offset:50176
    v_mfma_f32_16x16x32_bf16 v[44:47], a[184:187], v[80:83], v[44:47]
    s_add_u32 s44, s44, 49152
    s_add_u32 s7, s49, 4096
    v_mul_f32 v32, v32, v36
    v_mfma_f32_16x16x32_bf16 v[44:47], a[196:199], v[84:87], v[44:47]
    buffer_load_dwordx4 v0, s[40:43], s7 offen sc1 lds
    v_mfma_f32_16x16x32_bf16 v[48:51], a[188:191], v[80:83], v[48:51]
    v_exp_f32 v6, v6
    v_mfma_f32_16x16x32_bf16 v[48:51], a[200:203], v[84:87], v[48:51]
    buffer_load_dwordx4 a[132:135], v0, s[40:43], s22 offen offset:1024 sc1
    v_mfma_f32_16x16x32_bf16 v[52:55], a[192:195], v[80:83], v[52:55]
    ds_read_b128 v[80:83], v16 offset:51200
    v_fma_f32 v6, v6, v93, v93
    v_fmac_f32 v33, v92, v101
    v_mfma_f32_16x16x32_bf16 v[52:55], a[204:207], v[84:87], v[52:55]
    ds_read_b128 v[84:87], v16 offset:52224
    v_mul_f32 v7, v94, v33
    v_mfma_f32_16x16x32_bf16 v[44:47], a[208:211], v[56:59], v[44:47]
    v_rcp_f32 v6, v6
    v_mfma_f32_16x16x32_bf16 v[44:47], a[220:223], v[60:63], v[44:47]
    v_exp_f32 v7, v7
    v_mfma_f32_16x16x32_bf16 v[48:51], a[212:215], v[56:59], v[48:51]
    buffer_load_dwordx4 a[136:139], v0, s[40:43], s22 offen offset:2048 sc1
    v_mfma_f32_16x16x32_bf16 v[48:51], a[224:227], v[60:63], v[48:51]
    v_mul_f32 v6, v6, v32
    v_fmac_f32 v37, v92, v105
    v_fma_f32 v7, v7, v93, v93
    v_mfma_f32_16x16x32_bf16 v[52:55], a[216:219], v[56:59], v[52:55]
    ds_read_b128 v[56:59], v16 offset:53248
    v_mul_f32 v33, v33, v37
    v_mfma_f32_16x16x32_bf16 v[52:55], a[228:231], v[60:63], v[52:55]
    ds_read_b128 v[60:63], v16 offset:54272
    v_fmac_f32 v34, v92, v102
    v_mfma_f32_16x16x32_bf16 v[44:47], a[232:235], v[64:67], v[44:47]
    buffer_load_dwordx4 a[140:143], v0, s[40:43], s22 offen offset:3072 sc1
    v_mfma_f32_16x16x32_bf16 v[44:47], a[244:247], v[68:71], v[44:47]
    s_add_u32 s22, s22, 4096
    v_rcp_f32 v7, v7
    v_mfma_f32_16x16x32_bf16 v[48:51], a[236:239], v[64:67], v[48:51]
    v_mul_f32 v7, v7, v33
    v_cvt_pk_bf16_f32 v6, v6, v7
    v_mul_f32 v8, v94, v34
    v_mfma_f32_16x16x32_bf16 v[48:51], a[248:251], v[68:71], v[48:51]
    v_exp_f32 v8, v8
    v_mfma_f32_16x16x32_bf16 v[52:55], a[240:243], v[64:67], v[52:55]
    ds_read_b128 v[64:67], v16 offset:55296
    v_fmac_f32 v38, v92, v106
    v_mfma_f32_16x16x32_bf16 v[52:55], a[252:255], v[68:71], v[52:55]
    s_waitcnt lgkmcnt(6)
    buffer_load_dwordx4 a[144:147], v0, s[40:43], s22 offen offset:0 sc1
    v_mfma_f32_16x16x32_bf16 v[44:47], v[168:171], v[72:75], v[44:47]
    s_waitcnt lgkmcnt(5)
    ds_read_b128 v[68:71], v16 offset:56320
    v_fma_f32 v8, v8, v93, v93
    v_mfma_f32_16x16x32_bf16 v[44:47], v[180:183], v[76:79], v[44:47]
    v_rcp_f32 v8, v8
    v_mul_f32 v34, v34, v38
    v_mfma_f32_16x16x32_bf16 v[48:51], v[172:175], v[72:75], v[48:51]
    v_mul_f32 v8, v8, v34
    v_fmac_f32 v35, v92, v103
    v_mfma_f32_16x16x32_bf16 v[48:51], v[184:187], v[76:79], v[48:51]
    buffer_load_dwordx4 a[148:151], v0, s[40:43], s22 offen offset:1024 sc1
    v_mfma_f32_16x16x32_bf16 v[52:55], v[176:179], v[72:75], v[52:55]
    ds_read_b128 v[72:75], v16 offset:57344
    v_mul_f32 v9, v94, v35
    v_mfma_f32_16x16x32_bf16 v[52:55], v[188:191], v[76:79], v[52:55]
    s_waitcnt lgkmcnt(6)
    ds_read_b128 v[76:79], v16 offset:58368
    v_fmac_f32 v39, v92, v107
    v_mfma_f32_16x16x32_bf16 v[44:47], v[192:195], v[80:83], v[44:47]
    s_waitcnt lgkmcnt(6)
    ds_read_b96 v[96:98], v21 offset:1280
    v_exp_f32 v9, v9
    v_mfma_f32_16x16x32_bf16 v[44:47], v[204:207], v[84:87], v[44:47]
    v_fma_f32 v9, v9, v93, v93
    v_mul_f32 v35, v35, v39
    v_mfma_f32_16x16x32_bf16 v[48:51], v[196:199], v[80:83], v[48:51]
    buffer_load_dwordx4 a[152:155], v0, s[40:43], s22 offen offset:2048 sc1
    v_mfma_f32_16x16x32_bf16 v[48:51], v[208:211], v[84:87], v[48:51]
    v_rcp_f32 v9, v9
    v_mfma_f32_16x16x32_bf16 v[52:55], v[200:203], v[80:83], v[52:55]
    ds_read_b128 v[80:83], v16 offset:59392
    v_mul_f32 v9, v9, v35
    v_mfma_f32_16x16x32_bf16 v[52:55], v[212:215], v[84:87], v[52:55]
    s_waitcnt lgkmcnt(7)
    ds_read_b128 v[84:87], v16 offset:60416
    v_cvt_pk_bf16_f32 v7, v8, v9
    ds_write_b64 v23, v[6:7] offset:0
    v_mfma_f32_16x16x32_bf16 v[44:47], v[216:219], v[56:59], v[44:47]
    s_waitcnt lgkmcnt(8)
    buffer_load_dwordx4 a[156:159], v0, s[40:43], s22 offen offset:3072 sc1
    v_mfma_f32_16x16x32_bf16 v[44:47], v[228:231], v[60:63], v[44:47]
    s_add_u32 s22, s22, 4096
    v_fmac_f32 v40, v92, v108
    v_mul_f32 v95, v94, v40
    v_mfma_f32_16x16x32_bf16 v[48:51], v[220:223], v[56:59], v[48:51]
    v_exp_f32 v95, v95
    v_mfma_f32_16x16x32_bf16 v[48:51], v[232:235], v[60:63], v[48:51]
    v_fmac_f32 v42, v92, v110
    v_fma_f32 v95, v95, v93, v93
    v_mfma_f32_16x16x32_bf16 v[52:55], v[224:227], v[56:59], v[52:55]
    v_rcp_f32 v95, v95
    v_mul_f32 v40, v40, v42
    v_mfma_f32_16x16x32_bf16 v[52:55], v[236:239], v[60:63], v[52:55]
    s_add_u32 m0, s28, 0
    v_mul_f32 v95, v95, v40
    v_fmac_f32 v41, v92, v109
    s_waitcnt lgkmcnt(7)
    v_mfma_f32_16x16x32_bf16 v[44:47], v[240:243], v[64:67], v[44:47]
    s_waitcnt lgkmcnt(6)
    buffer_load_dwordx4 v0, s[40:43], s22 offen offset:0 sc1 lds
    v_mfma_f32_16x16x32_bf16 v[44:47], v[252:255], v[68:71], v[44:47]
    v_mul_f32 v99, v94, v41
    v_fmac_f32 v43, v92, v111
    v_mfma_f32_16x16x32_bf16 v[48:51], v[244:247], v[64:67], v[48:51]
    v_exp_f32 v99, v99
    v_mfma_f32_16x16x32_bf16 v[48:51], v[112:115], v[68:71], v[48:51]
    s_waitcnt vmcnt(24) lgkmcnt(1)
    s_barrier
    ds_read_b128 v[56:59], v16 offset:0
    ds_read_b128 v[60:63], v16 offset:1024
    v_mfma_f32_16x16x32_bf16 v[52:55], v[248:251], v[64:67], v[52:55]
    s_add_u32 m0, s28, 0
    ds_read_b128 v[64:67], v16 offset:2048
    v_fma_f32 v99, v99, v93, v93
    v_mfma_f32_16x16x32_bf16 v[52:55], v[116:119], v[68:71], v[52:55]
    buffer_load_dwordx4 v0, s[40:43], s22 offen offset:1024 sc1 lds
    v_mfma_f32_16x16x32_bf16 v[44:47], v[120:123], v[72:75], v[44:47]
    ds_read_b128 v[68:71], v16 offset:3072
    v_mul_f32 v41, v41, v43
    v_mfma_f32_16x16x32_bf16 v[44:47], v[132:135], v[76:79], v[44:47]
    s_add_u32 m0, s28, 0
    v_rcp_f32 v99, v99
    v_mfma_f32_16x16x32_bf16 v[48:51], v[124:127], v[72:75], v[48:51]
    buffer_load_dwordx4 v0, s[40:43], s22 offen offset:2048 sc1 lds
    v_mul_f32 v99, v99, v41
    v_mfma_f32_16x16x32_bf16 v[48:51], v[136:139], v[76:79], v[48:51]
    v_cvt_pk_bf16_f32 v95, v95, v99
    ds_write_b32 v24, v95 offset:0
    v_mfma_f32_16x16x32_bf16 v[52:55], v[128:131], v[72:75], v[52:55]
    ds_read_b128 v[72:75], v16 offset:4096
    ds_read_b128 v[2:5], v22 offset:0
    v_mfma_f32_16x16x32_bf16 v[52:55], v[140:143], v[76:79], v[52:55]
    ds_read_b128 v[76:79], v16 offset:5120
    v_mfma_f32_16x16x32_bf16 v[44:47], v[144:147], v[80:83], v[44:47]
    s_add_u32 m0, s28, 0
    v_mfma_f32_16x16x32_bf16 v[44:47], v[156:159], v[84:87], v[44:47]
    buffer_load_dwordx4 v0, s[40:43], s22 offen offset:3072 sc1 lds
    s_add_u32 s22, s22, 4096
    v_mfma_f32_16x16x32_bf16 v[48:51], v[148:151], v[80:83], v[48:51]
    v_mfma_f32_16x16x32_bf16 v[48:51], v[160:163], v[84:87], v[48:51]
    v_mfma_f32_16x16x32_bf16 v[52:55], v[152:155], v[80:83], v[52:55]
    s_add_u32 m0, s28, 4096
    ds_read_b128 v[80:83], v16 offset:6144
    v_mfma_f32_16x16x32_bf16 v[52:55], v[164:167], v[84:87], v[52:55]
    s_waitcnt lgkmcnt(8)
    buffer_load_dwordx4 v0, s[40:43], s22 offen offset:0 sc1 lds
    v_mfma_f32_16x16x32_bf16 v[32:35], a[160:163], v[56:59], 0
    s_waitcnt lgkmcnt(7)
    ds_read_b128 v[84:87], v16 offset:7168
    v_mfma_f32_16x16x32_bf16 v[32:35], a[172:175], v[60:63], v[32:35]
    v_mfma_f32_16x16x32_bf16 v[36:39], a[164:167], v[56:59], 0
    v_fmac_f32 v44, v96, v100
    v_mul_f32 v6, v98, v44
    v_mfma_f32_16x16x32_bf16 v[36:39], a[176:179], v[60:63], v[36:39]
    s_add_u32 m0, s28, 4096
    v_exp_f32 v6, v6
    v_mfma_f32_16x16x32_bf16 v[40:43], a[168:171], v[56:59], 0
    buffer_load_dwordx4 v0, s[40:43], s22 offen offset:1024 sc1 lds
    v_mfma_f32_16x16x32_bf16 v[40:43], a[180:183], v[60:63], v[40:43]
    s_waitcnt lgkmcnt(7)
    ds_read_b128 v[56:59], v16 offset:8192
    ds_read_b128 v[60:63], v16 offset:9216
    v_fmac_f32 v48, v96, v104
    v_mfma_f32_16x16x32_bf16 v[32:35], a[184:187], v[64:67], v[32:35]
    s_waitcnt lgkmcnt(8)
    v_fma_f32 v6, v6, v97, v97
    v_mul_f32 v44, v44, v48
    v_mfma_f32_16x16x32_bf16 v[32:35], a[196:199], v[68:71], v[32:35]
    s_add_u32 m0, s28, 4096
    v_rcp_f32 v6, v6
    v_mfma_f32_16x16x32_bf16 v[36:39], a[188:191], v[64:67], v[36:39]
    buffer_load_dwordx4 v0, s[40:43], s22 offen offset:2048 sc1 lds
    v_mfma_f32_16x16x32_bf16 v[36:39], a[200:203], v[68:71], v[36:39]
    s_waitcnt vmcnt(15)
    buffer_atomic_add v11, v15, s[40:43], s55 offen offset:0 sc1
    v_mfma_f32_16x16x32_bf16 v[40:43], a[192:195], v[64:67], v[40:43]
    s_add_u32 s55, s55, 512
    ds_read_b128 v[64:67], v16 offset:10240
    v_mul_f32 v6, v6, v44
    v_fmac_f32 v45, v96, v101
    v_mfma_f32_16x16x32_bf16 v[40:43], a[204:207], v[68:71], v[40:43]
    s_waitcnt lgkmcnt(7)
    ds_read_b128 v[68:71], v16 offset:11264
    v_mul_f32 v7, v98, v45
    v_mfma_f32_16x16x32_bf16 v[32:35], a[208:211], v[72:75], v[32:35]
    s_add_u32 m0, s28, 4096
    v_exp_f32 v7, v7
    s_waitcnt lgkmcnt(6)
    v_mfma_f32_16x16x32_bf16 v[32:35], a[220:223], v[76:79], v[32:35]
    buffer_load_dwordx4 v0, s[40:43], s22 offen offset:3072 sc1 lds
    v_mfma_f32_16x16x32_bf16 v[36:39], a[212:215], v[72:75], v[36:39]
    s_add_u32 s22, s22, 4096
    v_fmac_f32 v49, v96, v105
    v_fma_f32 v7, v7, v97, v97
    v_mfma_f32_16x16x32_bf16 v[36:39], a[224:227], v[76:79], v[36:39]
    v_rcp_f32 v7, v7
    v_mul_f32 v45, v45, v49
    v_mfma_f32_16x16x32_bf16 v[40:43], a[216:219], v[72:75], v[40:43]
    s_add_u32 m0, s28, 8192
    ds_read_b128 v[72:75], v16 offset:12288
    v_mul_f32 v7, v7, v45
    v_mfma_f32_16x16x32_bf16 v[40:43], a[228:231], v[76:79], v[40:43]
    s_waitcnt lgkmcnt(6)
    buffer_load_dwordx4 v0, s[40:43], s22 offen offset:0 sc1 lds
    v_mfma_f32_16x16x32_bf16 v[32:35], a[232:235], v[80:83], v[32:35]
    s_waitcnt lgkmcnt(5)
    ds_read_b128 v[76:79], v16 offset:13312
    v_cvt_pk_bf16_f32 v6, v6, v7
    v_mfma_f32_16x16x32_bf16 v[32:35], a[244:247], v[84:87], v[32:35]
    v_fmac_f32 v46, v96, v102
    v_mul_f32 v8, v98, v46
    v_mfma_f32_16x16x32_bf16 v[36:39], a[236:239], v[80:83], v[36:39]
    v_exp_f32 v8, v8
    v_fmac_f32 v50, v96, v106
    v_mfma_f32_16x16x32_bf16 v[36:39], a[248:251], v[84:87], v[36:39]
    s_add_u32 m0, s28, 8192
    v_fma_f32 v8, v8, v97, v97
    v_mul_f32 v46, v46, v50
    v_mfma_f32_16x16x32_bf16 v[40:43], a[240:243], v[80:83], v[40:43]
    buffer_load_dwordx4 v0, s[40:43], s22 offen offset:1024 sc1 lds
    v_mfma_f32_16x16x32_bf16 v[40:43], a[252:255], v[84:87], v[40:43]
    s_waitcnt lgkmcnt(5)
    ds_read_b128 v[80:83], v16 offset:14336
    ds_read_b128 v[84:87], v16 offset:15360
    v_mfma_f32_16x16x32_bf16 v[32:35], v[168:171], v[56:59], v[32:35]
    s_waitcnt lgkmcnt(6)
    buffer_load_dword v14, v15, s[40:43], s31 offen offset:0 sc1
    v_mfma_f32_16x16x32_bf16 v[32:35], v[180:183], v[60:63], v[32:35]
    s_add_u32 m0, s28, 8192
    v_rcp_f32 v8, v8
    v_fmac_f32 v47, v96, v103
    v_mfma_f32_16x16x32_bf16 v[36:39], v[172:175], v[56:59], v[36:39]
    buffer_load_dwordx4 v0, s[40:43], s22 offen offset:2048 sc1 lds
    v_mfma_f32_16x16x32_bf16 v[36:39], v[184:187], v[60:63], v[36:39]
    v_mul_f32 v8, v8, v46
    v_mul_f32 v9, v98, v47
    v_mfma_f32_16x16x32_bf16 v[40:43], v[176:179], v[56:59], v[40:43]
    ds_read_b128 v[56:59], v16 offset:16384
    v_fmac_f32 v51, v96, v107
    v_mfma_f32_16x16x32_bf16 v[40:43], v[188:191], v[60:63], v[40:43]
    s_add_u32 m0, s28, 8192
    ds_read_b128 v[60:63], v16 offset:17408
    v_mul_f32 v47, v47, v51
    s_waitcnt lgkmcnt(7)
    v_mfma_f32_16x16x32_bf16 v[32:35], v[192:195], v[64:67], v[32:35]
    buffer_load_dwordx4 v0, s[40:43], s22 offen offset:3072 sc1 lds
    s_add_u32 s22, s22, 4096
    s_waitcnt lgkmcnt(6)
    v_mfma_f32_16x16x32_bf16 v[32:35], v[204:207], v[68:71], v[32:35]
    ds_read_b96 v[92:94], v21 offset:1536
    v_fmac_f32 v52, v96, v108
    v_mfma_f32_16x16x32_bf16 v[36:39], v[196:199], v[64:67], v[36:39]
    v_exp_f32 v9, v9
    v_mfma_f32_16x16x32_bf16 v[36:39], v[208:211], v[68:71], v[36:39]
    v_fma_f32 v9, v9, v97, v97
    v_mul_f32 v95, v98, v52
    v_mfma_f32_16x16x32_bf16 v[40:43], v[200:203], v[64:67], v[40:43]
    s_add_u32 m0, s28, 12288
    ds_read_b128 v[64:67], v16 offset:18432
    v_fmac_f32 v54, v96, v110
    v_mfma_f32_16x16x32_bf16 v[40:43], v[212:215], v[68:71], v[40:43]
    s_waitcnt lgkmcnt(7)
    buffer_load_dwordx4 v0, s[40:43], s22 offen offset:0 sc1 lds
    ds_read_b128 v[68:71], v16 offset:19456
    v_mfma_f32_16x16x32_bf16 v[32:35], v[216:219], v[72:75], v[32:35]
    s_waitcnt lgkmcnt(7)
    v_rcp_f32 v9, v9
    v_mfma_f32_16x16x32_bf16 v[32:35], v[228:231], v[76:79], v[32:35]
    v_exp_f32 v95, v95
    v_mfma_f32_16x16x32_bf16 v[36:39], v[220:223], v[72:75], v[36:39]
    s_add_u32 m0, s28, 12288
    v_mul_f32 v9, v9, v47
    v_cvt_pk_bf16_f32 v7, v8, v9
    v_mfma_f32_16x16x32_bf16 v[36:39], v[232:235], v[76:79], v[36:39]
    buffer_load_dwordx4 v0, s[40:43], s22 offen offset:1024 sc1 lds
    v_mfma_f32_16x16x32_bf16 v[40:43], v[224:227], v[72:75], v[40:43]
    ds_write_b64 v23, v[6:7] offset:768
    v_fma_f32 v95, v95, v97, v97
    v_mul_f32 v52, v52, v54
    v_mfma_f32_16x16x32_bf16 v[40:43], v[236:239], v[76:79], v[40:43]
    s_waitcnt lgkmcnt(7)
    v_rcp_f32 v95, v95
    v_mfma_f32_16x16x32_bf16 v[32:35], v[240:243], v[80:83], v[32:35]
    s_waitcnt lgkmcnt(6)
    v_mul_f32 v95, v95, v52
    v_fmac_f32 v53, v96, v109
    v_mfma_f32_16x16x32_bf16 v[32:35], v[252:255], v[84:87], v[32:35]
    s_add_u32 m0, s28, 12288
    v_mul_f32 v99, v98, v53
    v_fmac_f32 v55, v96, v111
    v_mfma_f32_16x16x32_bf16 v[36:39], v[244:247], v[80:83], v[36:39]
    buffer_load_dwordx4 v0, s[40:43], s22 offen offset:2048 sc1 lds
    v_mfma_f32_16x16x32_bf16 v[36:39], v[112:115], v[84:87], v[36:39]
    s_waitcnt vmcnt(24) lgkmcnt(1)
    s_barrier
    ds_read_b128 v[72:75], v16 offset:20480
    ds_read_b128 v[76:79], v16 offset:21504
    v_mfma_f32_16x16x32_bf16 v[40:43], v[248:251], v[80:83], v[40:43]
    ds_read_b128 v[80:83], v16 offset:22528
    v_mul_f32 v53, v53, v55
    v_mfma_f32_16x16x32_bf16 v[40:43], v[116:119], v[84:87], v[40:43]
    s_add_u32 m0, s28, 12288
    buffer_store_dwordx4 v[2:5], v25, s[40:43], s44 offen sc1
    v_mfma_f32_16x16x32_bf16 v[32:35], v[120:123], v[56:59], v[32:35]
    s_add_u32 s44, s44, 49152
    ds_read_b128 v[84:87], v16 offset:23552
    v_mfma_f32_16x16x32_bf16 v[32:35], v[132:135], v[60:63], v[32:35]
    buffer_load_dwordx4 v0, s[40:43], s22 offen offset:3072 sc1 lds
    v_mfma_f32_16x16x32_bf16 v[36:39], v[124:127], v[56:59], v[36:39]
    s_add_u32 s22, s22, 4096
    v_exp_f32 v99, v99
    v_mfma_f32_16x16x32_bf16 v[36:39], v[136:139], v[60:63], v[36:39]
    v_fma_f32 v99, v99, v97, v97
    v_mfma_f32_16x16x32_bf16 v[40:43], v[128:131], v[56:59], v[40:43]
    s_add_u32 m0, s28, 16384
    ds_read_b128 v[56:59], v16 offset:24576
    v_mfma_f32_16x16x32_bf16 v[40:43], v[140:143], v[60:63], v[40:43]
    buffer_load_dwordx4 v0, s[40:43], s22 offen offset:0 sc1 lds
    v_mfma_f32_16x16x32_bf16 v[32:35], v[144:147], v[64:67], v[32:35]
    ds_read_b128 v[60:63], v16 offset:25600
    v_mfma_f32_16x16x32_bf16 v[32:35], v[156:159], v[68:71], v[32:35]
    v_rcp_f32 v99, v99
    v_mfma_f32_16x16x32_bf16 v[36:39], v[148:151], v[64:67], v[36:39]
    s_add_u32 m0, s28, 16384
    v_mul_f32 v99, v99, v53
    v_cvt_pk_bf16_f32 v95, v95, v99
    v_mfma_f32_16x16x32_bf16 v[36:39], v[160:163], v[68:71], v[36:39]
    buffer_load_dwordx4 v0, s[40:43], s22 offen offset:1024 sc1 lds
    v_mfma_f32_16x16x32_bf16 v[40:43], v[152:155], v[64:67], v[40:43]
    ds_read_b128 v[64:67], v16 offset:26624
    ds_write_b32 v24, v95 offset:768
    v_mfma_f32_16x16x32_bf16 v[40:43], v[164:167], v[68:71], v[40:43]
    s_waitcnt lgkmcnt(7)
    ds_read_b128 v[68:71], v16 offset:27648
    ds_read_b128 v[2:5], v22 offset:768
    v_mfma_f32_16x16x32_bf16 v[44:47], a[160:163], v[72:75], 0
    s_waitcnt lgkmcnt(8)
    v_mfma_f32_16x16x32_bf16 v[44:47], a[172:175], v[76:79], v[44:47]
    s_add_u32 m0, s28, 16384
    v_mfma_f32_16x16x32_bf16 v[48:51], a[164:167], v[72:75], 0
    buffer_load_dwordx4 v0, s[40:43], s22 offen offset:2048 sc1 lds
    v_mfma_f32_16x16x32_bf16 v[48:51], a[176:179], v[76:79], v[48:51]
    v_fmac_f32 v32, v92, v100
    v_mul_f32 v6, v94, v32
    v_mfma_f32_16x16x32_bf16 v[52:55], a[168:171], v[72:75], 0
    s_waitcnt lgkmcnt(0)
    buffer_store_dwordx4 v[2:5], v25, s[40:43], s44 offen sc1
    v_mfma_f32_16x16x32_bf16 v[52:55], a[180:183], v[76:79], v[52:55]
    s_add_u32 s44, s44, 49152
    ds_read_b128 v[72:75], v16 offset:28672
    ds_read_b128 v[76:79], v16 offset:29696
    s_add_u32 m0, s28, 16384
    v_mfma_f32_16x16x32_bf16 v[44:47], a[184:187], v[80:83], v[44:47]
    buffer_load_dwordx4 v0, s[40:43], s22 offen offset:3072 sc1 lds
    v_mfma_f32_16x16x32_bf16 v[44:47], a[196:199], v[84:87], v[44:47]
    s_add_u32 s22, s22, 4096
    v_exp_f32 v6, v6
    v_mfma_f32_16x16x32_bf16 v[48:51], a[188:191], v[80:83], v[48:51]
    v_fmac_f32 v36, v92, v104
    v_fma_f32 v6, v6, v93, v93
    v_mfma_f32_16x16x32_bf16 v[48:51], a[200:203], v[84:87], v[48:51]
    v_rcp_f32 v6, v6
    v_mfma_f32_16x16x32_bf16 v[52:55], a[192:195], v[80:83], v[52:55]
    ds_read_b128 v[80:83], v16 offset:30720
    v_mul_f32 v32, v32, v36
    v_mul_f32 v6, v6, v32
    v_mfma_f32_16x16x32_bf16 v[52:55], a[204:207], v[84:87], v[52:55]
    ds_read_b128 v[84:87], v16 offset:31744
    v_fmac_f32 v33, v92, v101
    v_mfma_f32_16x16x32_bf16 v[44:47], a[208:211], v[56:59], v[44:47]
    s_waitcnt vmcnt(12)
    v_cmp_gt_u32 vcc, 16, v14
    v_mul_f32 v7, v94, v33
    v_mfma_f32_16x16x32_bf16 v[44:47], a[220:223], v[60:63], v[44:47]
    s_and_b32 vcc_lo, vcc_lo, 0x1
    s_cbranch_scc1 Lslow29
Lback29:
    v_fmac_f32 v37, v92, v105
    v_mfma_f32_16x16x32_bf16 v[48:51], a[212:215], v[56:59], v[48:51]
    buffer_load_dwordx4 a[160:163], v0, s[40:43], s30 offen offset:0 sc1
    v_mfma_f32_16x16x32_bf16 v[48:51], a[224:227], v[60:63], v[48:51]
    v_exp_f32 v7, v7
    v_mul_f32 v33, v33, v37
    v_mfma_f32_16x16x32_bf16 v[52:55], a[216:219], v[56:59], v[52:55]
    buffer_load_dwordx4 a[164:167], v0, s[40:43], s30 offen offset:1024 sc1
    v_mfma_f32_16x16x32_bf16 v[52:55], a[228:231], v[60:63], v[52:55]
    ds_read_b128 v[56:59], v16 offset:32768
    ds_read_b128 v[60:63], v16 offset:33792
    v_mfma_f32_16x16x32_bf16 v[44:47], a[232:235], v[64:67], v[44:47]
    v_fma_f32 v7, v7, v93, v93
    v_fmac_f32 v34, v92, v102
    v_mfma_f32_16x16x32_bf16 v[44:47], a[244:247], v[68:71], v[44:47]
    v_rcp_f32 v7, v7
    v_mfma_f32_16x16x32_bf16 v[48:51], a[236:239], v[64:67], v[48:51]
    v_mul_f32 v7, v7, v33
    v_cvt_pk_bf16_f32 v6, v6, v7
    v_mul_f32 v8, v94, v34
    v_mfma_f32_16x16x32_bf16 v[48:51], a[248:251], v[68:71], v[48:51]
    buffer_load_dwordx4 a[168:171], v0, s[40:43], s30 offen offset:2048 sc1
    v_mfma_f32_16x16x32_bf16 v[52:55], a[240:243], v[64:67], v[52:55]
    ds_read_b128 v[64:67], v16 offset:34816
    v_fmac_f32 v38, v92, v106
    v_mfma_f32_16x16x32_bf16 v[52:55], a[252:255], v[68:71], v[52:55]
    s_waitcnt lgkmcnt(6)
    ds_read_b128 v[68:71], v16 offset:35840
    v_mul_f32 v34, v34, v38
    v_mfma_f32_16x16x32_bf16 v[44:47], v[168:171], v[72:75], v[44:47]
    s_waitcnt lgkmcnt(6)
    v_exp_f32 v8, v8
    v_mfma_f32_16x16x32_bf16 v[44:47], v[180:183], v[76:79], v[44:47]
    buffer_load_dwordx4 a[172:175], v0, s[40:43], s30 offen offset:3072 sc1
    s_add_u32 s30, s30, 4096
    v_mfma_f32_16x16x32_bf16 v[48:51], v[172:175], v[72:75], v[48:51]
    v_fma_f32 v8, v8, v93, v93
    v_fmac_f32 v35, v92, v103
    v_mfma_f32_16x16x32_bf16 v[48:51], v[184:187], v[76:79], v[48:51]
    v_rcp_f32 v8, v8
    v_mfma_f32_16x16x32_bf16 v[52:55], v[176:179], v[72:75], v[52:55]
    ds_read_b128 v[72:75], v16 offset:36864
    v_mul_f32 v8, v8, v34
    v_mfma_f32_16x16x32_bf16 v[52:55], v[188:191], v[76:79], v[52:55]
    s_waitcnt lgkmcnt(6)
    ds_read_b128 v[76:79], v16 offset:37888
    v_mul_f32 v9, v94, v35
    v_mfma_f32_16x16x32_bf16 v[44:47], v[192:195], v[80:83], v[44:47]
    s_waitcnt lgkmcnt(6)
    buffer_load_dwordx4 a[176:179], v0, s[40:43], s30 offen offset:0 sc1
    ds_read_b96 v[96:98], v21 offset:1792
    v_mfma_f32_16x16x32_bf16 v[44:47], v[204:207], v[84:87], v[44:47]
    v_exp_f32 v9, v9
    v_mfma_f32_16x16x32_bf16 v[48:51], v[196:199], v[80:83], v[48:51]
    v_fmac_f32 v39, v92, v107
    v_fma_f32 v9, v9, v93, v93
    v_mfma_f32_16x16x32_bf16 v[48:51], v[208:211], v[84:87], v[48:51]
    v_rcp_f32 v9, v9
    v_mfma_f32_16x16x32_bf16 v[52:55], v[200:203], v[80:83], v[52:55]
    buffer_load_dwordx4 a[180:183], v0, s[40:43], s30 offen offset:1024 sc1
    v_mfma_f32_16x16x32_bf16 v[52:55], v[212:215], v[84:87], v[52:55]
    s_waitcnt lgkmcnt(6)
    ds_read_b128 v[80:83], v16 offset:38912
    ds_read_b128 v[84:87], v16 offset:39936
    v_mul_f32 v35, v35, v39
    v_mfma_f32_16x16x32_bf16 v[44:47], v[216:219], v[56:59], v[44:47]
    s_waitcnt lgkmcnt(7)
    v_mul_f32 v9, v9, v35
    v_cvt_pk_bf16_f32 v7, v8, v9
    v_mfma_f32_16x16x32_bf16 v[44:47], v[228:231], v[60:63], v[44:47]
    ds_write_b64 v23, v[6:7] offset:0
    v_fmac_f32 v40, v92, v108
    v_mfma_f32_16x16x32_bf16 v[48:51], v[220:223], v[56:59], v[48:51]
    v_mul_f32 v95, v94, v40
    v_fmac_f32 v42, v92, v110
    v_mfma_f32_16x16x32_bf16 v[48:51], v[232:235], v[60:63], v[48:51]
    buffer_load_dwordx4 a[184:187], v0, s[40:43], s30 offen offset:2048 sc1
    v_mfma_f32_16x16x32_bf16 v[52:55], v[224:227], v[56:59], v[52:55]
    buffer_load_dword v14, v15, s[40:43], s31 offen offset:512 sc1
    v_mul_f32 v40, v40, v42
    v_mfma_f32_16x16x32_bf16 v[52:55], v[236:239], v[60:63], v[52:55]
    s_waitcnt lgkmcnt(7)
    v_exp_f32 v95, v95
    v_mfma_f32_16x16x32_bf16 v[44:47], v[240:243], v[64:67], v[44:47]
    s_waitcnt lgkmcnt(6)
    v_fma_f32 v95, v95, v93, v93
    v_fmac_f32 v41, v92, v109
    v_mfma_f32_16x16x32_bf16 v[44:47], v[252:255], v[68:71], v[44:47]
    buffer_load_dwordx4 a[188:191], v0, s[40:43], s30 offen offset:3072 sc1
    v_mfma_f32_16x16x32_bf16 v[48:51], v[244:247], v[64:67], v[48:51]
    s_add_u32 s30, s30, 4096
    v_rcp_f32 v95, v95
    v_mfma_f32_16x16x32_bf16 v[48:51], v[112:115], v[68:71], v[48:51]
    s_waitcnt lgkmcnt(1)
    s_barrier
    v_mul_f32 v95, v95, v40
    v_mul_f32 v99, v94, v41
    v_mfma_f32_16x16x32_bf16 v[52:55], v[248:251], v[64:67], v[52:55]
Lwc0_2:
    s_cbranch_execz Lwc0_3
    v_exp_f32 v99, v99
    v_mfma_f32_16x16x32_bf16 v[52:55], v[116:119], v[68:71], v[52:55]
    v_fmac_f32 v43, v92, v111
    v_fma_f32 v99, v99, v93, v93
    v_mfma_f32_16x16x32_bf16 v[44:47], v[120:123], v[72:75], v[44:47]
    buffer_load_dwordx4 a[192:195], v0, s[40:43], s30 offen offset:0 sc1
    v_mfma_f32_16x16x32_bf16 v[44:47], v[132:135], v[76:79], v[44:47]
    v_rcp_f32 v99, v99
    v_mfma_f32_16x16x32_bf16 v[48:51], v[124:127], v[72:75], v[48:51]
    v_mul_f32 v41, v41, v43
    v_mul_f32 v99, v99, v41
    v_cvt_pk_bf16_f32 v95, v95, v99
    v_mfma_f32_16x16x32_bf16 v[48:51], v[136:139], v[76:79], v[48:51]
    ds_write_b32 v24, v95 offset:0
    ds_read_b128 v[2:5], v22 offset:0
    v_mfma_f32_16x16x32_bf16 v[52:55], v[128:131], v[72:75], v[52:55]
    s_waitcnt vmcnt(10)
    buffer_load_dwordx4 a[196:199], v0, s[40:43], s30 offen offset:1024 sc1
    v_mfma_f32_16x16x32_bf16 v[52:55], v[140:143], v[76:79], v[52:55]
    ds_read_b128 v[168:171], v20 offset:0
    ds_read_b128 v[172:175], v20 offset:1024
    v_mfma_f32_16x16x32_bf16 v[44:47], v[144:147], v[80:83], v[44:47]
    ds_read_b128 v[176:179], v20 offset:2048
    ds_read_b128 v[180:183], v20 offset:3072
    v_mfma_f32_16x16x32_bf16 v[44:47], v[156:159], v[84:87], v[44:47]
    ds_read_b128 v[184:187], v20 offset:4096
    ds_read_b128 v[188:191], v20 offset:5120
    ds_read_b128 v[192:195], v20 offset:6144
    v_mfma_f32_16x16x32_bf16 v[48:51], v[148:151], v[80:83], v[48:51]
    s_waitcnt lgkmcnt(7)
    buffer_store_dwordx4 v[2:5], v25, s[40:43], s44 offen sc1
    v_mfma_f32_16x16x32_bf16 v[48:51], v[160:163], v[84:87], v[48:51]
    s_add_u32 s44, s44, 49152
    ds_read_b128 v[196:199], v20 offset:7168
    ds_read_b128 v[200:203], v20 offset:8192
    v_mfma_f32_16x16x32_bf16 v[52:55], v[152:155], v[80:83], v[52:55]
    buffer_load_dwordx4 a[200:203], v0, s[40:43], s30 offen offset:2048 sc1
    v_mfma_f32_16x16x32_bf16 v[52:55], v[164:167], v[84:87], v[52:55]
    s_waitcnt vmcnt(12)
    ds_read_b128 v[204:207], v20 offset:9216
    ds_read_b128 v[208:211], v20 offset:10240
    v_mfma_f32_16x16x32_bf16 v[112:115], a[0:3], a[160:163], 0
    s_waitcnt vmcnt(11)
    ds_read_b128 v[212:215], v20 offset:11264
    ds_read_b128 v[216:219], v20 offset:12288
    ds_read_b128 v[220:223], v20 offset:13312
    v_mfma_f32_16x16x32_bf16 v[112:115], a[20:23], a[164:167], v[112:115]
    buffer_load_dwordx4 a[204:207], v0, s[40:43], s30 offen offset:3072 sc1
    v_mfma_f32_16x16x32_bf16 v[116:119], a[4:7], a[160:163], 0
    s_add_u32 s30, s30, 90112
    ds_read_b128 v[224:227], v20 offset:14336
    ds_read_b128 v[228:231], v20 offset:15360
    v_mfma_f32_16x16x32_bf16 v[116:119], a[24:27], a[164:167], v[116:119]
    ds_read_b128 v[232:235], v20 offset:16384
    ds_read_b128 v[236:239], v20 offset:17408
    v_mfma_f32_16x16x32_bf16 v[120:123], a[8:11], a[160:163], 0
    ds_read_b128 v[240:243], v20 offset:18432
    ds_read_b128 v[244:247], v20 offset:19456
    v_mfma_f32_16x16x32_bf16 v[120:123], a[28:31], a[164:167], v[120:123]
    v_fmac_f32 v44, v96, v100
    v_mul_f32 v6, v98, v44
    v_fmac_f32 v48, v96, v104
    v_mfma_f32_16x16x32_bf16 v[124:127], a[12:15], a[160:163], 0
    v_exp_f32 v6, v6
    v_mfma_f32_16x16x32_bf16 v[124:127], a[32:35], a[164:167], v[124:127]
    v_fma_f32 v6, v6, v97, v97
    v_mul_f32 v44, v44, v48
    v_mfma_f32_16x16x32_bf16 v[128:131], a[16:19], a[160:163], 0
    v_rcp_f32 v6, v6
    v_mfma_f32_16x16x32_bf16 v[128:131], a[36:39], a[164:167], v[128:131]
    s_waitcnt vmcnt(11)
    v_mul_f32 v6, v6, v44
    v_fmac_f32 v45, v96, v101
    v_mfma_f32_16x16x32_bf16 v[112:115], a[40:43], a[168:171], v[112:115]
    s_waitcnt vmcnt(10)
    v_mul_f32 v7, v98, v45
    v_exp_f32 v7, v7
    v_mfma_f32_16x16x32_bf16 v[112:115], a[60:63], a[172:175], v[112:115]
    v_fmac_f32 v49, v96, v105
    v_fma_f32 v7, v7, v97, v97
    v_mfma_f32_16x16x32_bf16 v[116:119], a[44:47], a[168:171], v[116:119]
    v_rcp_f32 v7, v7
    v_mfma_f32_16x16x32_bf16 v[116:119], a[64:67], a[172:175], v[116:119]
    v_mul_f32 v45, v45, v49
    v_mul_f32 v7, v7, v45
    v_mfma_f32_16x16x32_bf16 v[120:123], a[48:51], a[168:171], v[120:123]
    v_cvt_pk_bf16_f32 v6, v6, v7
    v_fmac_f32 v46, v96, v102
    v_mfma_f32_16x16x32_bf16 v[120:123], a[68:71], a[172:175], v[120:123]
    v_mul_f32 v8, v98, v46
    v_exp_f32 v8, v8
    v_mfma_f32_16x16x32_bf16 v[124:127], a[52:55], a[168:171], v[124:127]
    v_fmac_f32 v50, v96, v106
    v_fma_f32 v8, v8, v97, v97
    v_mfma_f32_16x16x32_bf16 v[124:127], a[72:75], a[172:175], v[124:127]
    v_rcp_f32 v8, v8
    v_mfma_f32_16x16x32_bf16 v[128:131], a[56:59], a[168:171], v[128:131]
    v_mul_f32 v46, v46, v50
    v_mul_f32 v8, v8, v46
    v_mfma_f32_16x16x32_bf16 v[128:131], a[76:79], a[172:175], v[128:131]
    s_waitcnt vmcnt(9)
    v_fmac_f32 v47, v96, v103
    v_mul_f32 v9, v98, v47
    v_mfma_f32_16x16x32_bf16 v[112:115], a[80:83], a[176:179], v[112:115]
    s_add_u32 m0, s47, 0
    v_exp_f32 v9, v9
    v_fmac_f32 v51, v96, v107
    s_waitcnt vmcnt(8)
    v_mfma_f32_16x16x32_bf16 v[112:115], a[100:103], a[180:183], v[112:115]
    buffer_load_dwordx4 v28, s[40:43], s12 offen sc1 lds
    v_mfma_f32_16x16x32_bf16 v[116:119], a[84:87], a[176:179], v[116:119]
    s_add_u32 s12, s12, 40960
    s_waitcnt vmcnt(7)
    v_cmp_gt_u32 vcc, 16, v14
    v_fma_f32 v9, v9, v97, v97
    v_mfma_f32_16x16x32_bf16 v[116:119], a[104:107], a[180:183], v[116:119]
    s_and_b32 vcc_lo, vcc_lo, 0x1
    s_cbranch_scc1 Lslow30
Lback30:
    v_mul_f32 v47, v47, v51
    v_mfma_f32_16x16x32_bf16 v[120:123], a[88:91], a[176:179], v[120:123]
    buffer_load_dwordx4 a[208:211], v0, s[40:43], s30 offen offset:0 sc1
    v_mfma_f32_16x16x32_bf16 v[120:123], a[108:111], a[180:183], v[120:123]
    buffer_load_dwordx4 a[212:215], v0, s[40:43], s30 offen offset:1024 sc1
    v_fmac_f32 v52, v96, v108
    v_mfma_f32_16x16x32_bf16 v[124:127], a[92:95], a[176:179], v[124:127]
    v_rcp_f32 v9, v9
    v_mfma_f32_16x16x32_bf16 v[124:127], a[112:115], a[180:183], v[124:127]
    v_mul_f32 v9, v9, v47
    v_cvt_pk_bf16_f32 v7, v8, v9
    v_mfma_f32_16x16x32_bf16 v[128:131], a[96:99], a[176:179], v[128:131]
    ds_write_b64 v23, v[6:7] offset:768
    v_mul_f32 v95, v98, v52
    v_mfma_f32_16x16x32_bf16 v[128:131], a[116:119], a[180:183], v[128:131]
    buffer_load_dwordx4 a[216:219], v0, s[40:43], s30 offen offset:2048 sc1
    v_mfma_f32_16x16x32_bf16 v[112:115], a[120:123], a[184:187], v[112:115]
    s_waitcnt vmcnt(9)
    v_exp_f32 v95, v95
    v_fmac_f32 v54, v96, v110
    v_mfma_f32_16x16x32_bf16 v[112:115], a[140:143], a[188:191], v[112:115]
    v_fma_f32 v95, v95, v97, v97
    v_mul_f32 v52, v52, v54
    v_mfma_f32_16x16x32_bf16 v[116:119], a[124:127], a[184:187], v[116:119]
    v_rcp_f32 v95, v95
    v_mfma_f32_16x16x32_bf16 v[116:119], a[144:147], a[188:191], v[116:119]
    buffer_load_dwordx4 a[220:223], v0, s[40:43], s30 offen offset:3072 sc1
    v_mfma_f32_16x16x32_bf16 v[120:123], a[128:131], a[184:187], v[120:123]
    s_add_u32 s30, s30, 4096
    v_mul_f32 v95, v95, v52
    v_fmac_f32 v53, v96, v109
    v_mfma_f32_16x16x32_bf16 v[120:123], a[148:151], a[188:191], v[120:123]
    v_mul_f32 v99, v98, v53
    v_exp_f32 v99, v99
    v_mfma_f32_16x16x32_bf16 v[124:127], a[132:135], a[184:187], v[124:127]
    buffer_load_dword v14, v31, s[40:43], s62 offen offset:0 sc1
    v_mfma_f32_16x16x32_bf16 v[124:127], a[152:155], a[188:191], v[124:127]
    v_fmac_f32 v55, v96, v111
    v_fma_f32 v99, v99, v97, v97
    v_mfma_f32_16x16x32_bf16 v[128:131], a[136:139], a[184:187], v[128:131]
    buffer_load_dwordx4 a[224:227], v0, s[40:43], s30 offen offset:0 sc1
    v_mfma_f32_16x16x32_bf16 v[128:131], a[156:159], a[188:191], v[128:131]
    s_waitcnt vmcnt(11) lgkmcnt(15)
    v_rcp_f32 v99, v99
    v_mfma_f32_16x16x32_bf16 v[112:115], v[168:171], a[192:195], v[112:115]
    s_waitcnt vmcnt(10) lgkmcnt(15)
    v_mul_f32 v53, v53, v55
    v_mul_f32 v99, v99, v53
    v_cvt_pk_bf16_f32 v95, v95, v99
    v_mfma_f32_16x16x32_bf16 v[112:115], v[188:191], a[196:199], v[112:115]
    ds_write_b32 v24, v95 offset:768
    ds_read_b128 v[2:5], v22 offset:768
    v_mfma_f32_16x16x32_bf16 v[116:119], v[172:175], a[192:195], v[116:119]
    s_waitcnt lgkmcnt(15)
    buffer_load_dwordx4 a[228:231], v0, s[40:43], s30 offen offset:1024 sc1
    v_mfma_f32_16x16x32_bf16 v[116:119], v[192:195], a[196:199], v[116:119]
    v_mfma_f32_16x16x32_bf16 v[120:123], v[176:179], a[192:195], v[120:123]
    s_waitcnt lgkmcnt(15)
    v_mfma_f32_16x16x32_bf16 v[120:123], v[196:199], a[196:199], v[120:123]
    v_mfma_f32_16x16x32_bf16 v[124:127], v[180:183], a[192:195], v[124:127]
    s_waitcnt lgkmcnt(0)
    buffer_store_dwordx4 v[2:5], v25, s[40:43], s44 offen sc1
    v_mfma_f32_16x16x32_bf16 v[124:127], v[200:203], a[196:199], v[124:127]
    s_add_u32 s44, s44, 49152
    buffer_load_dwordx4 a[232:235], v0, s[40:43], s30 offen offset:2048 sc1
    v_mfma_f32_16x16x32_bf16 v[128:131], v[184:187], a[192:195], v[128:131]
    v_mfma_f32_16x16x32_bf16 v[128:131], v[204:207], a[196:199], v[128:131]
    s_waitcnt vmcnt(11)
    v_mfma_f32_16x16x32_bf16 v[112:115], v[208:211], a[200:203], v[112:115]
    s_waitcnt vmcnt(10)
    v_mfma_f32_16x16x32_bf16 v[112:115], v[228:231], a[204:207], v[112:115]
    buffer_load_dwordx4 a[236:239], v0, s[40:43], s30 offen offset:3072 sc1
    v_mfma_f32_16x16x32_bf16 v[116:119], v[212:215], a[200:203], v[116:119]
    s_add_u32 s30, s30, 4096
    v_mfma_f32_16x16x32_bf16 v[116:119], v[232:235], a[204:207], v[116:119]
    v_mfma_f32_16x16x32_bf16 v[120:123], v[216:219], a[200:203], v[120:123]
    v_mfma_f32_16x16x32_bf16 v[120:123], v[236:239], a[204:207], v[120:123]
    v_mfma_f32_16x16x32_bf16 v[124:127], v[220:223], a[200:203], v[124:127]
    buffer_load_dwordx4 a[240:243], v0, s[40:43], s30 offen offset:0 sc1
    v_mfma_f32_16x16x32_bf16 v[124:127], v[240:243], a[204:207], v[124:127]
    v_mfma_f32_16x16x32_bf16 v[128:131], v[224:227], a[200:203], v[128:131]
    v_mfma_f32_16x16x32_bf16 v[128:131], v[244:247], a[204:207], v[128:131]
    s_waitcnt vmcnt(10)
    v_mfma_f32_16x16x32_bf16 v[132:135], a[0:3], a[208:211], 0
    s_waitcnt vmcnt(9)
    buffer_load_dwordx4 a[244:247], v0, s[40:43], s30 offen offset:1024 sc1
    v_mfma_f32_16x16x32_bf16 v[132:135], a[20:23], a[212:215], v[132:135]
    v_mfma_f32_16x16x32_bf16 v[136:139], a[4:7], a[208:211], 0
    v_mfma_f32_16x16x32_bf16 v[136:139], a[24:27], a[212:215], v[136:139]
    ds_write_b128 v26, v[112:115] offset:0
    v_mfma_f32_16x16x32_bf16 v[140:143], a[8:11], a[208:211], 0
    v_mfma_f32_16x16x32_bf16 v[140:143], a[28:31], a[212:215], v[140:143]
    buffer_load_dwordx4 a[248:251], v0, s[40:43], s30 offen offset:2048 sc1
    v_mfma_f32_16x16x32_bf16 v[144:147], a[12:15], a[208:211], 0
    v_mfma_f32_16x16x32_bf16 v[144:147], a[32:35], a[212:215], v[144:147]
    ds_write_b128 v26, v[116:119] offset:64
    v_mfma_f32_16x16x32_bf16 v[148:151], a[16:19], a[208:211], 0
    v_mfma_f32_16x16x32_bf16 v[148:151], a[36:39], a[212:215], v[148:151]
    s_waitcnt vmcnt(10)
    buffer_load_dwordx4 a[252:255], v0, s[40:43], s30 offen offset:3072 sc1
    v_mfma_f32_16x16x32_bf16 v[132:135], a[40:43], a[216:219], v[132:135]
    s_add_u32 s30, s30, 90112
    s_waitcnt vmcnt(10)
    v_mfma_f32_16x16x32_bf16 v[132:135], a[60:63], a[220:223], v[132:135]
    ds_write_b128 v26, v[120:123] offset:128
    v_mfma_f32_16x16x32_bf16 v[136:139], a[44:47], a[216:219], v[136:139]
    v_mfma_f32_16x16x32_bf16 v[136:139], a[64:67], a[220:223], v[136:139]
    v_mfma_f32_16x16x32_bf16 v[140:143], a[48:51], a[216:219], v[140:143]
    s_add_u32 m0, s47, 1024
    v_mfma_f32_16x16x32_bf16 v[140:143], a[68:71], a[220:223], v[140:143]
    buffer_load_dwordx4 v28, s[40:43], s12 offen sc1 lds
    v_mfma_f32_16x16x32_bf16 v[144:147], a[52:55], a[216:219], v[144:147]
    s_add_u32 s12, s12, 40960
    ds_write_b128 v26, v[124:127] offset:192
    s_waitcnt vmcnt(10)
    v_cmp_eq_u32 vcc, -1, v14
    v_mfma_f32_16x16x32_bf16 v[144:147], a[72:75], a[220:223], v[144:147]
    s_and_b32 vcc_lo, vcc_lo, 0xffff
    s_cbranch_scc1 Lslow31
Lback31:
    v_mfma_f32_16x16x32_bf16 v[148:151], a[56:59], a[216:219], v[148:151]
    buffer_load_dwordx4 a[160:163], v0, s[40:43], s30 offen offset:0 sc1
    v_mfma_f32_16x16x32_bf16 v[148:151], a[76:79], a[220:223], v[148:151]
    s_waitcnt vmcnt(10)
    v_mfma_f32_16x16x32_bf16 v[132:135], a[80:83], a[224:227], v[132:135]
    s_waitcnt vmcnt(9)
    buffer_load_dwordx4 a[164:167], v0, s[40:43], s30 offen offset:1024 sc1
    v_mfma_f32_16x16x32_bf16 v[132:135], a[100:103], a[228:231], v[132:135]
    ds_write_b128 v26, v[128:131] offset:256
    v_mfma_f32_16x16x32_bf16 v[136:139], a[84:87], a[224:227], v[136:139]
    v_mfma_f32_16x16x32_bf16 v[136:139], a[104:107], a[228:231], v[136:139]
    v_mfma_f32_16x16x32_bf16 v[140:143], a[88:91], a[224:227], v[140:143]
    v_mfma_f32_16x16x32_bf16 v[140:143], a[108:111], a[228:231], v[140:143]
    buffer_load_dwordx4 a[168:171], v0, s[40:43], s30 offen offset:2048 sc1
    v_mfma_f32_16x16x32_bf16 v[144:147], a[92:95], a[224:227], v[144:147]
    v_mfma_f32_16x16x32_bf16 v[144:147], a[112:115], a[228:231], v[144:147]
    s_waitcnt lgkmcnt(0)
    s_barrier
    ds_read_b128 v[32:35], v17 offset:0
    v_mfma_f32_16x16x32_bf16 v[148:151], a[96:99], a[224:227], v[148:151]
    ds_read_b128 v[56:59], v27 offset:0
    ds_read_b128 v[60:63], v27 offset:16
    v_mfma_f32_16x16x32_bf16 v[148:151], a[116:119], a[228:231], v[148:151]
    s_waitcnt vmcnt(9)
    buffer_load_dwordx4 a[172:175], v0, s[40:43], s30 offen offset:3072 sc1
    v_mfma_f32_16x16x32_bf16 v[132:135], a[120:123], a[232:235], v[132:135]
    s_add_u32 s30, s30, 4096
    ds_read_b128 v[64:67], v27 offset:5376
    ds_read_b128 v[68:71], v27 offset:5392
    s_waitcnt vmcnt(9)
    v_mfma_f32_16x16x32_bf16 v[132:135], a[140:143], a[236:239], v[132:135]
    ds_read_b128 v[72:75], v27 offset:10752
    ds_read_b128 v[76:79], v27 offset:10768
    v_mfma_f32_16x16x32_bf16 v[136:139], a[124:127], a[232:235], v[136:139]
    ds_read_b128 v[80:83], v27 offset:16128
    ds_read_b128 v[84:87], v27 offset:16144
    v_mfma_f32_16x16x32_bf16 v[136:139], a[144:147], a[236:239], v[136:139]
    s_waitcnt lgkmcnt(8)
    v_lshlrev_b32 v40, 16, v32
    v_and_b32 v32, 0xffff0000, v32
    v_mfma_f32_16x16x32_bf16 v[140:143], a[128:131], a[232:235], v[140:143]
    buffer_load_dwordx4 a[176:179], v0, s[40:43], s30 offen offset:0 sc1
    v_mfma_f32_16x16x32_bf16 v[140:143], a[148:151], a[236:239], v[140:143]
    v_lshlrev_b32 v41, 16, v33
    v_and_b32 v33, 0xffff0000, v33
    v_mfma_f32_16x16x32_bf16 v[144:147], a[132:135], a[232:235], v[144:147]
    v_lshlrev_b32 v42, 16, v34
    v_and_b32 v34, 0xffff0000, v34
    v_mfma_f32_16x16x32_bf16 v[144:147], a[152:155], a[236:239], v[144:147]
    v_lshlrev_b32 v43, 16, v35
    v_and_b32 v35, 0xffff0000, v35
    v_mfma_f32_16x16x32_bf16 v[148:151], a[136:139], a[232:235], v[148:151]
    buffer_load_dwordx4 a[180:183], v0, s[40:43], s30 offen offset:1024 sc1
    v_mfma_f32_16x16x32_bf16 v[148:151], a[156:159], a[236:239], v[148:151]
    s_waitcnt vmcnt(10) lgkmcnt(7)
    v_add_f32 v56, v56, v40
    v_add_f32 v57, v57, v32
    v_mfma_f32_16x16x32_bf16 v[132:135], v[168:171], a[240:243], v[132:135]
    s_waitcnt vmcnt(9)
    v_add_f32 v58, v58, v41
    v_add_f32 v59, v59, v33
    v_mfma_f32_16x16x32_bf16 v[132:135], v[188:191], a[244:247], v[132:135]
    s_waitcnt lgkmcnt(6)
    v_add_f32 v60, v60, v42
    v_add_f32 v61, v61, v34
    v_mfma_f32_16x16x32_bf16 v[136:139], v[172:175], a[240:243], v[136:139]
    v_add_f32 v62, v62, v43
    v_add_f32 v63, v63, v35
    v_mfma_f32_16x16x32_bf16 v[136:139], v[192:195], a[244:247], v[136:139]
    buffer_load_dwordx4 a[184:187], v0, s[40:43], s30 offen offset:2048 sc1
    v_mfma_f32_16x16x32_bf16 v[140:143], v[176:179], a[240:243], v[140:143]
    s_waitcnt lgkmcnt(5)
    v_add_f32 v56, v56, v64
    v_add_f32 v57, v57, v65
    v_mfma_f32_16x16x32_bf16 v[140:143], v[196:199], a[244:247], v[140:143]
    v_add_f32 v58, v58, v66
    v_add_f32 v59, v59, v67
    v_mfma_f32_16x16x32_bf16 v[144:147], v[180:183], a[240:243], v[144:147]
    s_waitcnt lgkmcnt(4)
    v_add_f32 v60, v60, v68
    v_add_f32 v61, v61, v69
    v_mfma_f32_16x16x32_bf16 v[144:147], v[200:203], a[244:247], v[144:147]
    buffer_load_dwordx4 a[188:191], v0, s[40:43], s30 offen offset:3072 sc1
    v_mfma_f32_16x16x32_bf16 v[148:151], v[184:187], a[240:243], v[148:151]
    s_add_u32 s30, s30, 4096
    v_add_f32 v62, v62, v70
    v_add_f32 v63, v63, v71
    v_mfma_f32_16x16x32_bf16 v[148:151], v[204:207], a[244:247], v[148:151]
    s_waitcnt vmcnt(10) lgkmcnt(3)
    v_add_f32 v56, v56, v72
    v_add_f32 v57, v57, v73
    v_mfma_f32_16x16x32_bf16 v[132:135], v[208:211], a[248:251], v[132:135]
    s_waitcnt vmcnt(9)
    buffer_atomic_add v11, v15, s[40:43], s55 offen offset:0 sc1
    v_mfma_f32_16x16x32_bf16 v[132:135], v[228:231], a[252:255], v[132:135]
    s_add_u32 s55, s55, 512
    v_add_f32 v58, v58, v74
    v_add_f32 v59, v59, v75
    v_mfma_f32_16x16x32_bf16 v[136:139], v[212:215], a[248:251], v[136:139]
    buffer_load_dwordx4 a[192:195], v0, s[40:43], s30 offen offset:0 sc1
    v_mfma_f32_16x16x32_bf16 v[136:139], v[232:235], a[252:255], v[136:139]
    s_waitcnt lgkmcnt(2)
    v_add_f32 v60, v60, v76
    v_add_f32 v61, v61, v77
    v_mfma_f32_16x16x32_bf16 v[140:143], v[216:219], a[248:251], v[140:143]
    v_add_f32 v62, v62, v78
    v_add_f32 v63, v63, v79
    v_mfma_f32_16x16x32_bf16 v[140:143], v[236:239], a[252:255], v[140:143]
    s_waitcnt lgkmcnt(1)
    v_add_f32 v56, v56, v80
    v_add_f32 v57, v57, v81
    v_mfma_f32_16x16x32_bf16 v[144:147], v[220:223], a[248:251], v[144:147]
    buffer_load_dwordx4 a[196:199], v0, s[40:43], s30 offen offset:1024 sc1
    v_mfma_f32_16x16x32_bf16 v[144:147], v[240:243], a[252:255], v[144:147]
    v_add_f32 v58, v58, v82
    v_add_f32 v59, v59, v83
    v_mfma_f32_16x16x32_bf16 v[148:151], v[224:227], a[248:251], v[148:151]
    s_waitcnt lgkmcnt(0)
    v_add_f32 v60, v60, v84
    v_add_f32 v61, v61, v85
    v_mfma_f32_16x16x32_bf16 v[148:151], v[244:247], a[252:255], v[148:151]
    s_waitcnt vmcnt(10)
    v_add_f32 v62, v62, v86
    v_add_f32 v63, v63, v87
    v_mfma_f32_16x16x32_bf16 v[112:115], a[0:3], a[160:163], 0
    s_waitcnt vmcnt(9)
    v_cvt_pk_bf16_f32 v40, v56, v57
    v_cvt_pk_bf16_f32 v41, v58, v59
    v_mfma_f32_16x16x32_bf16 v[112:115], a[20:23], a[164:167], v[112:115]
    buffer_load_dwordx4 a[200:203], v0, s[40:43], s30 offen offset:2048 sc1
    v_mfma_f32_16x16x32_bf16 v[116:119], a[4:7], a[160:163], 0
    buffer_load_dword v14, v31, s[40:43], s63 offen offset:0 sc1
    v_mfma_f32_16x16x32_bf16 v[116:119], a[24:27], a[164:167], v[116:119]
    ds_write_b128 v26, v[132:135] offset:21504
    v_cvt_pk_bf16_f32 v42, v60, v61
    v_mfma_f32_16x16x32_bf16 v[120:123], a[8:11], a[160:163], 0
    v_cvt_pk_bf16_f32 v43, v62, v63
    v_mfma_f32_16x16x32_bf16 v[120:123], a[28:31], a[164:167], v[120:123]
    buffer_load_dwordx4 a[204:207], v0, s[40:43], s30 offen offset:3072 sc1
    v_mfma_f32_16x16x32_bf16 v[124:127], a[12:15], a[160:163], 0
    s_add_u32 s30, s30, 90112
    buffer_store_dwordx4 v[40:43], v29, s[32:35], s13 offen
    v_mfma_f32_16x16x32_bf16 v[124:127], a[32:35], a[164:167], v[124:127]
    s_add_u32 s13, s13, 40960
    ds_write_b128 v26, v[136:139] offset:21568
    v_mfma_f32_16x16x32_bf16 v[128:131], a[16:19], a[160:163], 0
    v_mfma_f32_16x16x32_bf16 v[128:131], a[36:39], a[164:167], v[128:131]
    s_waitcnt vmcnt(12)
    v_mfma_f32_16x16x32_bf16 v[112:115], a[40:43], a[168:171], v[112:115]
    s_add_u32 m0, s47, 0
    s_waitcnt vmcnt(11)
    v_mfma_f32_16x16x32_bf16 v[112:115], a[60:63], a[172:175], v[112:115]
    buffer_load_dwordx4 v28, s[40:43], s12 offen sc1 lds
    v_mfma_f32_16x16x32_bf16 v[116:119], a[44:47], a[168:171], v[116:119]
    s_add_u32 s12, s12, 40960
    ds_write_b128 v26, v[140:143] offset:21632
    v_mfma_f32_16x16x32_bf16 v[116:119], a[64:67], a[172:175], v[116:119]
    v_mfma_f32_16x16x32_bf16 v[120:123], a[48:51], a[168:171], v[120:123]
    v_mfma_f32_16x16x32_bf16 v[120:123], a[68:71], a[172:175], v[120:123]
    v_mfma_f32_16x16x32_bf16 v[124:127], a[52:55], a[168:171], v[124:127]
    ds_write_b128 v26, v[144:147] offset:21696
    v_mfma_f32_16x16x32_bf16 v[124:127], a[72:75], a[172:175], v[124:127]
    v_mfma_f32_16x16x32_bf16 v[128:131], a[56:59], a[168:171], v[128:131]
    v_mfma_f32_16x16x32_bf16 v[128:131], a[76:79], a[172:175], v[128:131]
    s_waitcnt vmcnt(11)
    v_mfma_f32_16x16x32_bf16 v[112:115], a[80:83], a[176:179], v[112:115]
    s_waitcnt vmcnt(10)
    ds_write_b128 v26, v[148:151] offset:21760
    v_mfma_f32_16x16x32_bf16 v[112:115], a[100:103], a[180:183], v[112:115]
    v_mfma_f32_16x16x32_bf16 v[116:119], a[84:87], a[176:179], v[116:119]
    v_mfma_f32_16x16x32_bf16 v[116:119], a[104:107], a[180:183], v[116:119]
    v_mfma_f32_16x16x32_bf16 v[120:123], a[88:91], a[176:179], v[120:123]
    v_mfma_f32_16x16x32_bf16 v[120:123], a[108:111], a[180:183], v[120:123]
    v_mfma_f32_16x16x32_bf16 v[124:127], a[92:95], a[176:179], v[124:127]
    s_waitcnt lgkmcnt(0)
    s_barrier
    ds_read_b128 v[32:35], v17 offset:1024
    v_mfma_f32_16x16x32_bf16 v[124:127], a[112:115], a[180:183], v[124:127]
    ds_read_b128 v[56:59], v27 offset:21504
    ds_read_b128 v[60:63], v27 offset:21520
    v_mfma_f32_16x16x32_bf16 v[128:131], a[96:99], a[176:179], v[128:131]
    ds_read_b128 v[64:67], v27 offset:26880
    ds_read_b128 v[68:71], v27 offset:26896
    v_mfma_f32_16x16x32_bf16 v[128:131], a[116:119], a[180:183], v[128:131]
    s_waitcnt vmcnt(9)
    ds_read_b128 v[72:75], v27 offset:32256
    ds_read_b128 v[76:79], v27 offset:32272
    v_mfma_f32_16x16x32_bf16 v[112:115], a[120:123], a[184:187], v[112:115]
    s_waitcnt vmcnt(8)
    ds_read_b128 v[80:83], v27 offset:37632
    ds_read_b128 v[84:87], v27 offset:37648
    v_mfma_f32_16x16x32_bf16 v[112:115], a[140:143], a[188:191], v[112:115]
    s_waitcnt lgkmcnt(8)
    v_lshlrev_b32 v40, 16, v32
    v_and_b32 v32, 0xffff0000, v32
    v_mfma_f32_16x16x32_bf16 v[116:119], a[124:127], a[184:187], v[116:119]
    v_lshlrev_b32 v41, 16, v33
    v_and_b32 v33, 0xffff0000, v33
    v_mfma_f32_16x16x32_bf16 v[116:119], a[144:147], a[188:191], v[116:119]
    v_lshlrev_b32 v42, 16, v34
    v_and_b32 v34, 0xffff0000, v34
    v_mfma_f32_16x16x32_bf16 v[120:123], a[128:131], a[184:187], v[120:123]
    v_lshlrev_b32 v43, 16, v35
    v_and_b32 v35, 0xffff0000, v35
    v_mfma_f32_16x16x32_bf16 v[120:123], a[148:151], a[188:191], v[120:123]
    s_waitcnt lgkmcnt(7)
    v_add_f32 v56, v56, v40
    v_add_f32 v57, v57, v32
    v_mfma_f32_16x16x32_bf16 v[124:127], a[132:135], a[184:187], v[124:127]
    s_waitcnt vmcnt(3)
    v_cmp_eq_u32 vcc, -1, v14
    v_add_f32 v58, v58, v41
    v_mfma_f32_16x16x32_bf16 v[124:127], a[152:155], a[188:191], v[124:127]
    s_and_b32 vcc_lo, vcc_lo, 0xffff
    s_cbranch_scc1 Lslow32
Lback32:
    v_add_f32 v59, v59, v33
    v_mfma_f32_16x16x32_bf16 v[128:131], a[136:139], a[184:187], v[128:131]
    buffer_load_dwordx4 a[208:211], v0, s[40:43], s30 offen offset:0 sc1
    v_mfma_f32_16x16x32_bf16 v[128:131], a[156:159], a[188:191], v[128:131]
    s_waitcnt lgkmcnt(6)
    v_add_f32 v60, v60, v42
    v_add_f32 v61, v61, v34
    v_mfma_f32_16x16x32_bf16 v[112:115], v[168:171], a[192:195], v[112:115]
    buffer_load_dwordx4 a[212:215], v0, s[40:43], s30 offen offset:1024 sc1
    v_mfma_f32_16x16x32_bf16 v[112:115], v[188:191], a[196:199], v[112:115]
    v_add_f32 v62, v62, v43
    v_add_f32 v63, v63, v35
    v_mfma_f32_16x16x32_bf16 v[116:119], v[172:175], a[192:195], v[116:119]
    s_waitcnt lgkmcnt(5)
    v_add_f32 v56, v56, v64
    v_add_f32 v57, v57, v65
    v_mfma_f32_16x16x32_bf16 v[116:119], v[192:195], a[196:199], v[116:119]
    v_add_f32 v58, v58, v66
    v_add_f32 v59, v59, v67
    v_mfma_f32_16x16x32_bf16 v[120:123], v[176:179], a[192:195], v[120:123]
    s_waitcnt lgkmcnt(4)
    v_add_f32 v60, v60, v68
    v_add_f32 v61, v61, v69
    v_mfma_f32_16x16x32_bf16 v[120:123], v[196:199], a[196:199], v[120:123]
    buffer_load_dwordx4 a[216:219], v0, s[40:43], s30 offen offset:2048 sc1
    v_mfma_f32_16x16x32_bf16 v[124:127], v[180:183], a[192:195], v[124:127]
    v_add_f32 v62, v62, v70
    v_add_f32 v63, v63, v71
    v_mfma_f32_16x16x32_bf16 v[124:127], v[200:203], a[196:199], v[124:127]
    s_waitcnt lgkmcnt(3)
    v_add_f32 v56, v56, v72
    v_add_f32 v57, v57, v73
    v_mfma_f32_16x16x32_bf16 v[128:131], v[184:187], a[192:195], v[128:131]
    v_add_f32 v58, v58, v74
    v_add_f32 v59, v59, v75
    v_mfma_f32_16x16x32_bf16 v[128:131], v[204:207], a[196:199], v[128:131]
    buffer_load_dwordx4 a[220:223], v0, s[40:43], s30 offen offset:3072 sc1
    v_mfma_f32_16x16x32_bf16 v[112:115], v[208:211], a[200:203], v[112:115]
    s_add_u32 s30, s30, 4096
    s_waitcnt lgkmcnt(2)
    v_add_f32 v60, v60, v76
    v_add_f32 v61, v61, v77
    s_waitcnt vmcnt(6)
    v_mfma_f32_16x16x32_bf16 v[112:115], v[228:231], a[204:207], v[112:115]
    v_add_f32 v62, v62, v78
    v_add_f32 v63, v63, v79
    v_mfma_f32_16x16x32_bf16 v[116:119], v[212:215], a[200:203], v[116:119]
    s_waitcnt lgkmcnt(1)
    v_add_f32 v56, v56, v80
    v_add_f32 v57, v57, v81
    v_mfma_f32_16x16x32_bf16 v[116:119], v[232:235], a[204:207], v[116:119]
    v_add_f32 v58, v58, v82
    v_add_f32 v59, v59, v83
    v_mfma_f32_16x16x32_bf16 v[120:123], v[216:219], a[200:203], v[120:123]
    buffer_load_dwordx4 a[224:227], v0, s[40:43], s30 offen offset:0 sc1
    v_mfma_f32_16x16x32_bf16 v[120:123], v[236:239], a[204:207], v[120:123]
    s_waitcnt lgkmcnt(0)
    v_add_f32 v60, v60, v84
    v_add_f32 v61, v61, v85
    v_mfma_f32_16x16x32_bf16 v[124:127], v[220:223], a[200:203], v[124:127]
    v_add_f32 v62, v62, v86
    v_add_f32 v63, v63, v87
    v_mfma_f32_16x16x32_bf16 v[124:127], v[240:243], a[204:207], v[124:127]
    v_cvt_pk_bf16_f32 v40, v56, v57
    v_cvt_pk_bf16_f32 v41, v58, v59
    v_mfma_f32_16x16x32_bf16 v[128:131], v[224:227], a[200:203], v[128:131]
    buffer_load_dwordx4 a[228:231], v0, s[40:43], s30 offen offset:1024 sc1
    v_mfma_f32_16x16x32_bf16 v[128:131], v[244:247], a[204:207], v[128:131]
    s_waitcnt vmcnt(5)
    v_cvt_pk_bf16_f32 v42, v60, v61
    v_cvt_pk_bf16_f32 v43, v62, v63
    v_mfma_f32_16x16x32_bf16 v[132:135], a[0:3], a[208:211], 0
    s_waitcnt vmcnt(4)
    buffer_store_dwordx4 v[40:43], v29, s[32:35], s13 offen
    v_mfma_f32_16x16x32_bf16 v[132:135], a[20:23], a[212:215], v[132:135]
    s_add_u32 s13, s13, 40960
    v_mfma_f32_16x16x32_bf16 v[136:139], a[4:7], a[208:211], 0
    v_cmp_u_f32 vcc, v112, v112
    v_mfma_f32_16x16x32_bf16 v[136:139], a[24:27], a[212:215], v[136:139]
    buffer_load_dwordx4 a[232:235], v0, s[40:43], s30 offen offset:2048 sc1
    v_mfma_f32_16x16x32_bf16 v[140:143], a[8:11], a[208:211], 0
    s_cbranch_vccnz Lslow33
Lback33:
    ds_write_b128 v26, v[112:115] offset:0
    v_mfma_f32_16x16x32_bf16 v[140:143], a[28:31], a[212:215], v[140:143]
    v_mfma_f32_16x16x32_bf16 v[144:147], a[12:15], a[208:211], 0
    v_mfma_f32_16x16x32_bf16 v[144:147], a[32:35], a[212:215], v[144:147]
    buffer_load_dwordx4 a[236:239], v0, s[40:43], s30 offen offset:3072 sc1
    v_mfma_f32_16x16x32_bf16 v[148:151], a[16:19], a[208:211], 0
    s_add_u32 s30, s30, 4096
    ds_write_b128 v26, v[116:119] offset:64
    v_mfma_f32_16x16x32_bf16 v[148:151], a[36:39], a[212:215], v[148:151]
    s_waitcnt vmcnt(6)
    v_mfma_f32_16x16x32_bf16 v[132:135], a[40:43], a[216:219], v[132:135]
    s_waitcnt vmcnt(5)
    v_mfma_f32_16x16x32_bf16 v[132:135], a[60:63], a[220:223], v[132:135]
    v_mfma_f32_16x16x32_bf16 v[136:139], a[44:47], a[216:219], v[136:139]
    buffer_load_dwordx4 a[240:243], v0, s[40:43], s30 offen offset:0 sc1
    v_mfma_f32_16x16x32_bf16 v[136:139], a[64:67], a[220:223], v[136:139]
    ds_write_b128 v26, v[120:123] offset:128
    v_mfma_f32_16x16x32_bf16 v[140:143], a[48:51], a[216:219], v[140:143]
    v_mfma_f32_16x16x32_bf16 v[140:143], a[68:71], a[220:223], v[140:143]
    v_mfma_f32_16x16x32_bf16 v[144:147], a[52:55], a[216:219], v[144:147]
    buffer_load_dwordx4 a[244:247], v0, s[40:43], s30 offen offset:1024 sc1
    v_mfma_f32_16x16x32_bf16 v[144:147], a[72:75], a[220:223], v[144:147]
    ds_write_b128 v26, v[124:127] offset:192
    v_mfma_f32_16x16x32_bf16 v[148:151], a[56:59], a[216:219], v[148:151]
    v_mfma_f32_16x16x32_bf16 v[148:151], a[76:79], a[220:223], v[148:151]
    s_waitcnt vmcnt(6)
    v_mfma_f32_16x16x32_bf16 v[132:135], a[80:83], a[224:227], v[132:135]
    s_waitcnt vmcnt(5)
    v_mfma_f32_16x16x32_bf16 v[132:135], a[100:103], a[228:231], v[132:135]
    buffer_load_dwordx4 a[248:251], v0, s[40:43], s30 offen offset:2048 sc1
    v_mfma_f32_16x16x32_bf16 v[136:139], a[84:87], a[224:227], v[136:139]
    ds_write_b128 v26, v[128:131] offset:256
    v_mfma_f32_16x16x32_bf16 v[136:139], a[104:107], a[228:231], v[136:139]
    v_mfma_f32_16x16x32_bf16 v[140:143], a[88:91], a[224:227], v[140:143]
    v_mfma_f32_16x16x32_bf16 v[140:143], a[108:111], a[228:231], v[140:143]
    buffer_load_dwordx4 a[252:255], v0, s[40:43], s30 offen offset:3072 sc1
    v_mfma_f32_16x16x32_bf16 v[144:147], a[92:95], a[224:227], v[144:147]
    s_add_u32 s30, s30, 90112
    v_mfma_f32_16x16x32_bf16 v[144:147], a[112:115], a[228:231], v[144:147]
    v_mfma_f32_16x16x32_bf16 v[148:151], a[96:99], a[224:227], v[148:151]
    s_waitcnt lgkmcnt(0)
    s_barrier
    ds_read_b128 v[32:35], v17 offset:0
    v_mfma_f32_16x16x32_bf16 v[148:151], a[116:119], a[228:231], v[148:151]
    s_waitcnt vmcnt(5)
    ds_read_b128 v[56:59], v27 offset:0
    ds_read_b128 v[60:63], v27 offset:16
    v_mfma_f32_16x16x32_bf16 v[132:135], a[120:123], a[232:235], v[132:135]
    s_add_u32 m0, s47, 1024
    ds_read_b128 v[64:67], v27 offset:5376
    ds_read_b128 v[68:71], v27 offset:5392
    s_waitcnt vmcnt(4)
    v_mfma_f32_16x16x32_bf16 v[132:135], a[140:143], a[236:239], v[132:135]
    buffer_load_dwordx4 v28, s[40:43], s12 offen sc1 lds
    v_mfma_f32_16x16x32_bf16 v[136:139], a[124:127], a[232:235], v[136:139]
    s_add_u32 s12, s12, 40960
    ds_read_b128 v[72:75], v27 offset:10752
    ds_read_b128 v[76:79], v27 offset:10768
    v_mfma_f32_16x16x32_bf16 v[136:139], a[144:147], a[236:239], v[136:139]
    ds_read_b128 v[80:83], v27 offset:16128
    ds_read_b128 v[84:87], v27 offset:16144
    v_mfma_f32_16x16x32_bf16 v[140:143], a[128:131], a[232:235], v[140:143]
    s_waitcnt lgkmcnt(8)
    v_lshlrev_b32 v40, 16, v32
    v_and_b32 v32, 0xffff0000, v32
    v_mfma_f32_16x16x32_bf16 v[140:143], a[148:151], a[236:239], v[140:143]
    v_lshlrev_b32 v41, 16, v33
    v_and_b32 v33, 0xffff0000, v33
    v_mfma_f32_16x16x32_bf16 v[144:147], a[132:135], a[232:235], v[144:147]
    v_lshlrev_b32 v42, 16, v34
    v_and_b32 v34, 0xffff0000, v34
    v_mfma_f32_16x16x32_bf16 v[144:147], a[152:155], a[236:239], v[144:147]
    v_lshlrev_b32 v43, 16, v35
    v_and_b32 v35, 0xffff0000, v35
    v_mfma_f32_16x16x32_bf16 v[148:151], a[136:139], a[232:235], v[148:151]
    s_waitcnt lgkmcnt(7)
    v_add_f32 v56, v56, v40
    v_add_f32 v57, v57, v32
    v_mfma_f32_16x16x32_bf16 v[148:151], a[156:159], a[236:239], v[148:151]
    s_waitcnt vmcnt(4)
    v_add_f32 v58, v58, v41
    v_add_f32 v59, v59, v33
    v_mfma_f32_16x16x32_bf16 v[132:135], v[168:171], a[240:243], v[132:135]
    s_waitcnt vmcnt(3) lgkmcnt(6)
Lwc1_2:
    s_cbranch_execz Lwc1_3
    v_add_f32 v60, v60, v42
    v_add_f32 v61, v61, v34
    v_mfma_f32_16x16x32_bf16 v[132:135], v[188:191], a[244:247], v[132:135]
    s_waitcnt vmcnt(2)
    v_add_f32 v62, v62, v43
    v_add_f32 v63, v63, v35
    v_mfma_f32_16x16x32_bf16 v[132:135], v[208:211], a[248:251], v[132:135]
    s_waitcnt vmcnt(1) lgkmcnt(5)
    v_add_f32 v56, v56, v64
    v_add_f32 v57, v57, v65
    v_mfma_f32_16x16x32_bf16 v[132:135], v[228:231], a[252:255], v[132:135]
    v_add_f32 v58, v58, v66
    v_add_f32 v59, v59, v67
    v_mfma_f32_16x16x32_bf16 v[136:139], v[172:175], a[240:243], v[136:139]
    s_waitcnt lgkmcnt(4)
    v_add_f32 v60, v60, v68
    v_add_f32 v61, v61, v69
    v_mfma_f32_16x16x32_bf16 v[136:139], v[192:195], a[244:247], v[136:139]
    v_add_f32 v62, v62, v70
    v_add_f32 v63, v63, v71
    v_mfma_f32_16x16x32_bf16 v[136:139], v[212:215], a[248:251], v[136:139]
    s_waitcnt lgkmcnt(3)
    v_add_f32 v56, v56, v72
    v_add_f32 v57, v57, v73
    v_mfma_f32_16x16x32_bf16 v[136:139], v[232:235], a[252:255], v[136:139]
    ds_write_b128 v26, v[132:135] offset:21504
    v_add_f32 v58, v58, v74
    v_mfma_f32_16x16x32_bf16 v[140:143], v[176:179], a[240:243], v[140:143]
    v_add_f32 v59, v59, v75
    s_waitcnt lgkmcnt(3)
    v_add_f32 v60, v60, v76
    v_mfma_f32_16x16x32_bf16 v[140:143], v[196:199], a[244:247], v[140:143]
    v_add_f32 v61, v61, v77
    v_add_f32 v62, v62, v78
    v_mfma_f32_16x16x32_bf16 v[140:143], v[216:219], a[248:251], v[140:143]
    v_add_f32 v63, v63, v79
    s_waitcnt lgkmcnt(2)
    v_add_f32 v56, v56, v80
    v_mfma_f32_16x16x32_bf16 v[140:143], v[236:239], a[252:255], v[140:143]
    ds_write_b128 v26, v[136:139] offset:21568
    v_add_f32 v57, v57, v81
    v_mfma_f32_16x16x32_bf16 v[144:147], v[180:183], a[240:243], v[144:147]
    v_add_f32 v58, v58, v82
    v_add_f32 v59, v59, v83
    v_mfma_f32_16x16x32_bf16 v[144:147], v[200:203], a[244:247], v[144:147]
    s_waitcnt lgkmcnt(2)
    v_add_f32 v60, v60, v84
    v_add_f32 v61, v61, v85
    v_mfma_f32_16x16x32_bf16 v[144:147], v[220:223], a[248:251], v[144:147]
    v_add_f32 v62, v62, v86
    v_add_f32 v63, v63, v87
    v_mfma_f32_16x16x32_bf16 v[144:147], v[240:243], a[252:255], v[144:147]
    ds_write_b128 v26, v[140:143] offset:21632
    v_cvt_pk_bf16_f32 v40, v56, v57
    v_mfma_f32_16x16x32_bf16 v[148:151], v[184:187], a[240:243], v[148:151]
    v_cvt_pk_bf16_f32 v41, v58, v59
    v_cvt_pk_bf16_f32 v42, v60, v61
    v_mfma_f32_16x16x32_bf16 v[148:151], v[204:207], a[244:247], v[148:151]
    v_cvt_pk_bf16_f32 v43, v62, v63
    v_mfma_f32_16x16x32_bf16 v[148:151], v[224:227], a[248:251], v[148:151]
    buffer_store_dwordx4 v[40:43], v29, s[32:35], s13 offen
    v_mfma_f32_16x16x32_bf16 v[148:151], v[244:247], a[252:255], v[148:151]
    s_add_u32 s13, s13, 40960
    v_cmp_u_f32 vcc, v132, v132
    s_nop 0
    s_cbranch_vccnz Lslow34
Lback34:
    ds_write_b128 v26, v[144:147] offset:21696
    s_nop 2
    ds_write_b128 v26, v[148:151] offset:21760
    s_waitcnt lgkmcnt(0)
    s_barrier
    s_waitcnt vmcnt(1)
    ds_read_b128 v[32:35], v17 offset:1024
    ds_read_b128 v[56:59], v27 offset:21504
    ds_read_b128 v[60:63], v27 offset:21520
    ds_read_b128 v[64:67], v27 offset:26880
    ds_read_b128 v[68:71], v27 offset:26896
    ds_read_b128 v[72:75], v27 offset:32256
    ds_read_b128 v[76:79], v27 offset:32272
    ds_read_b128 v[80:83], v27 offset:37632
    ds_read_b128 v[84:87], v27 offset:37648
    s_waitcnt lgkmcnt(8)
    v_lshlrev_b32 v40, 16, v32
    v_and_b32 v32, 0xffff0000, v32
    v_lshlrev_b32 v41, 16, v33
    v_and_b32 v33, 0xffff0000, v33
    v_lshlrev_b32 v42, 16, v34
    v_and_b32 v34, 0xffff0000, v34
    v_lshlrev_b32 v43, 16, v35
    v_and_b32 v35, 0xffff0000, v35
    s_waitcnt lgkmcnt(7)
    v_add_f32 v56, v56, v40
    v_add_f32 v57, v57, v32
    v_add_f32 v58, v58, v41
    v_add_f32 v59, v59, v33
    s_waitcnt lgkmcnt(6)
    v_add_f32 v60, v60, v42
    v_add_f32 v61, v61, v34
    v_add_f32 v62, v62, v43
    v_add_f32 v63, v63, v35
    s_waitcnt lgkmcnt(5)
    v_pk_add_f32 v[56:57], v[56:57], v[64:65]
    v_pk_add_f32 v[58:59], v[58:59], v[66:67]
    s_waitcnt lgkmcnt(4)
    v_pk_add_f32 v[60:61], v[60:61], v[68:69]
    v_pk_add_f32 v[62:63], v[62:63], v[70:71]
    s_waitcnt lgkmcnt(3)
    v_pk_add_f32 v[56:57], v[56:57], v[72:73]
    v_pk_add_f32 v[58:59], v[58:59], v[74:75]
    s_waitcnt lgkmcnt(2)
    v_pk_add_f32 v[60:61], v[60:61], v[76:77]
    v_pk_add_f32 v[62:63], v[62:63], v[78:79]
    s_waitcnt lgkmcnt(1)
    v_pk_add_f32 v[56:57], v[56:57], v[80:81]
    v_pk_add_f32 v[58:59], v[58:59], v[82:83]
    s_waitcnt lgkmcnt(0)
    v_pk_add_f32 v[60:61], v[60:61], v[84:85]
    v_pk_add_f32 v[62:63], v[62:63], v[86:87]
    v_cvt_pk_bf16_f32 v40, v56, v57
    v_cvt_pk_bf16_f32 v41, v58, v59
    v_cvt_pk_bf16_f32 v42, v60, v61
    v_cvt_pk_bf16_f32 v43, v62, v63
    buffer_store_dwordx4 v[40:43], v29, s[32:35], s13 offen
    s_add_u32 s13, s13, 40960
Lexit:
    s_endpgm
Lwkv_3:
Lwq_4:
Lwh_6:
Lwc0_3:
Lwc1_3:
Lwc2_2:
    s_setpc_b64 s[98:99]
Lslow1:
    s_cmp_eq_u32 s6, 0
    s_cbranch_scc1 Lback1
    s_sub_u32 s6, s6, 1
    buffer_load_dword v250, v251, s[36:39], 0 offen offset:0 sc1
    s_waitcnt vmcnt(0)
    v_cmp_gt_u32 vcc, 1, v250
    s_nop 1
    s_cbranch_vccnz Lslow1
    s_branch Lback1
Lslow2:
    s_cmp_eq_u32 s6, 0
    s_cbranch_scc1 Lback2
    s_sub_u32 s6, s6, 1
    buffer_load_dword v250, v254, s[40:43], s25 offen offset:0 sc1
    s_waitcnt vmcnt(0)
    v_cmp_gt_u32 vcc, 1, v250
    s_nop 1
    s_and_b32 vcc_lo, vcc_lo, 0xf
    s_cbranch_scc1 Lslow2
    s_branch Lback2
Lslow3:
    s_cmp_eq_u32 s6, 0
    s_cbranch_scc1 Lback3
    s_sub_u32 s6, s6, 1
    buffer_load_dword v250, v251, s[40:43], s26 offen offset:0 sc1
    s_waitcnt vmcnt(0)
    v_cmp_gt_u32 s[96:97], 1, v250
    s_nop 1
    s_and_b32 s96, s96, 0xfffff
    s_cbranch_scc1 Lslow3
    s_branch Lback3
Lslow4:
    s_cmp_eq_u32 s6, 0
    s_cbranch_scc1 Lback4
    s_sub_u32 s6, s6, 1
    buffer_load_dword v250, v251, s[36:39], 0 offen offset:0 sc1
    s_waitcnt vmcnt(0)
    v_cmp_gt_u32 vcc, 1, v250
    s_nop 1
    s_cbranch_vccnz Lslow4
    s_branch Lback4
Lslow5:
    s_cmp_eq_u32 s6, 0
    s_cbranch_scc1 Lback5
    s_sub_u32 s6, s6, 1
    buffer_load_dword v250, v251, s[40:43], s26 offen offset:0 sc1
    s_waitcnt vmcnt(0)
    v_cmp_gt_u32 s[96:97], 1, v250
    s_nop 1
    s_and_b32 s96, s96, 0xfffff
    s_cbranch_scc1 Lslow5
    s_branch Lback5
Lslow6:
    s_cmp_eq_u32 s6, 0
    s_cbranch_scc1 Lback6
    s_sub_u32 s6, s6, 1
    v_mov_b32 v12, 0
    buffer_atomic_or v12, v17, s[40:43], s56 offen offset:0 sc0 sc1
    s_waitcnt vmcnt(0)
    v_cmp_gt_u32 vcc, 16, v12
    s_nop 1
    s_and_b32 vcc_lo, vcc_lo, 0x3
    s_cbranch_scc1 Lslow6
    s_branch Lback6
Lslow7:
    s_cmp_eq_u32 s6, 0
    s_cbranch_scc1 Lback7
    s_sub_u32 s6, s6, 1
    buffer_load_dword v58, v57, s[36:39], 0 offen offset:0 sc1
    s_waitcnt vmcnt(0)
    v_cmp_gt_u32 vcc, 1, v58
    s_nop 1
    s_cbranch_vccnz Lslow7
    s_branch Lback7
Lslow8:
    s_cmp_eq_u32 s6, 0
    s_cbranch_scc1 Lback8
    s_sub_u32 s6, s6, 1
    buffer_load_dword v11, v57, s[36:39], 0 offen offset:0 sc1
    s_waitcnt vmcnt(0)
    v_cmp_gt_u32 vcc, 1, v11
    s_nop 1
    s_cbranch_vccnz Lslow8
    s_branch Lback8
Lslow9:
    s_cmp_eq_u32 s6, 0
    s_cbranch_scc1 Lback9
    s_sub_u32 s6, s6, 1
    buffer_load_dword v250, v251, s[40:43], s26 offen offset:0 sc1
    s_waitcnt vmcnt(0)
    v_cmp_gt_u32 s[96:97], 1, v250
    s_nop 1
    s_and_b32 s96, s96, 0xfffff
    s_cbranch_scc1 Lslow9
    s_branch Lback9
Lslow10:
    s_cmp_eq_u32 s6, 0
    s_cbranch_scc1 Lback10
    s_sub_u32 s6, s6, 1
    buffer_load_dword v11, v10, s[40:43], s25 offen offset:0 sc1
    s_waitcnt vmcnt(0)
    v_cmp_gt_u32 vcc, 1, v11
    s_nop 1
    s_and_b32 vcc_lo, vcc_lo, 0xf
    s_cbranch_scc1 Lslow10
    s_branch Lback10
Lslow11:
    s_cmp_eq_u32 s6, 0
    s_cbranch_scc1 Lback11
    s_sub_u32 s6, s6, 1
    buffer_load_dword v250, v251, s[40:43], s26 offen offset:0 sc1
    s_waitcnt vmcnt(0)
    v_cmp_gt_u32 s[96:97], 1, v250
    s_nop 1
    s_and_b32 s96, s96, 0xfffff
    s_cbranch_scc1 Lslow11
    s_branch Lback11
Lslow12:
    s_cmp_eq_u32 s6, 0
    s_cbranch_scc1 Lback12
    s_sub_u32 s6, s6, 1
    v_mov_b32 v12, 0
    buffer_atomic_or v12, v15, s[40:43], s60 offen offset:1024 sc0 sc1
    s_waitcnt vmcnt(0)
    v_cmp_gt_u32 vcc, 8, v12
    s_nop 1
    s_and_b32 vcc_lo, vcc_lo, 0x1
    s_cbranch_scc1 Lslow12
    s_branch Lback12
Lslow13:
    s_cmp_eq_u32 s6, 0
    s_cbranch_scc1 Lback13
    s_sub_u32 s6, s6, 1
    s_mov_b32 s98, m0
    s_mov_b32 s99, s7
    s_add_u32 m0, s50, 0
    s_nop 0
    buffer_load_dwordx4 v0, s[40:43], s44 offen offset:0 sc1 lds
    s_add_u32 m0, s50, 0
    s_nop 0
    buffer_load_dwordx4 v0, s[40:43], s44 offen offset:1024 sc1 lds
    s_add_u32 m0, s50, 0
    s_nop 0
    buffer_load_dwordx4 v0, s[40:43], s44 offen offset:2048 sc1 lds
    s_add_u32 m0, s50, 0
    s_nop 0
    buffer_load_dwordx4 v0, s[40:43], s44 offen offset:3072 sc1 lds
    s_add_u32 m0, s50, 4096
    s_add_u32 s7, s44, 4096
    buffer_load_dwordx4 v0, s[40:43], s7 offen sc1 lds
    s_mov_b32 m0, s98
    s_mov_b32 s7, s99
    s_waitcnt vmcnt(0)
    ds_read_b128 v[92:95], v13 offset:0
    ds_read_b128 v[96:99], v13 offset:1024
    ds_read_b128 v[100:103], v13 offset:2048
    ds_read_b128 v[104:107], v13 offset:3072
    ds_read_b128 v[108:111], v13 offset:4096
    s_waitcnt lgkmcnt(4)
    v_max_u32 v92, v92, v93
    v_max3_u32 v92, v92, v94, v95
    s_waitcnt lgkmcnt(3)
    v_max3_u32 v92, v92, v96, v97
    v_max3_u32 v92, v92, v98, v99
    s_waitcnt lgkmcnt(2)
    v_max3_u32 v92, v92, v100, v101
    v_max3_u32 v92, v92, v102, v103
    s_waitcnt lgkmcnt(1)
    v_max3_u32 v92, v92, v104, v105
    v_max3_u32 v92, v92, v106, v107
    s_waitcnt lgkmcnt(0)
    v_max3_u32 v92, v92, v108, v109
    v_max3_u32 v92, v92, v110, v111
    v_cmp_eq_u32 s[96:97], -1, v92
    s_nop 0
    s_cmp_lg_u64 s[96:97], 0
    s_cbranch_scc1 Lslow13
    s_branch Lback13
Lslow14:
    s_cmp_eq_u32 s6, 0
    s_cbranch_scc1 Lback14
    s_sub_u32 s6, s6, 1
    s_mov_b32 s98, m0
    s_mov_b32 s99, s7
    s_add_u32 m0, s50, 20480
    s_nop 0
    buffer_load_dwordx4 v0, s[40:43], s45 offen offset:0 sc1 lds
    s_add_u32 m0, s50, 20480
    s_nop 0
    buffer_load_dwordx4 v0, s[40:43], s45 offen offset:1024 sc1 lds
    s_add_u32 m0, s50, 20480
    s_nop 0
    buffer_load_dwordx4 v0, s[40:43], s45 offen offset:2048 sc1 lds
    s_add_u32 m0, s50, 20480
    s_nop 0
    buffer_load_dwordx4 v0, s[40:43], s45 offen offset:3072 sc1 lds
    s_add_u32 m0, s50, 24576
    s_add_u32 s7, s45, 4096
    buffer_load_dwordx4 v0, s[40:43], s7 offen sc1 lds
    s_mov_b32 m0, s98
    s_mov_b32 s7, s99
    s_waitcnt vmcnt(0)
    ds_read_b128 v[92:95], v13 offset:20480
    ds_read_b128 v[96:99], v13 offset:21504
    ds_read_b128 v[100:103], v13 offset:22528
    ds_read_b128 v[104:107], v13 offset:23552
    ds_read_b128 v[108:111], v13 offset:24576
    s_waitcnt lgkmcnt(4)
    v_max_u32 v92, v92, v93
    v_max3_u32 v92, v92, v94, v95
    s_waitcnt lgkmcnt(3)
    v_max3_u32 v92, v92, v96, v97
    v_max3_u32 v92, v92, v98, v99
    s_waitcnt lgkmcnt(2)
    v_max3_u32 v92, v92, v100, v101
    v_max3_u32 v92, v92, v102, v103
    s_waitcnt lgkmcnt(1)
    v_max3_u32 v92, v92, v104, v105
    v_max3_u32 v92, v92, v106, v107
    s_waitcnt lgkmcnt(0)
    v_max3_u32 v92, v92, v108, v109
    v_max3_u32 v92, v92, v110, v111
    v_cmp_eq_u32 s[96:97], -1, v92
    s_nop 0
    s_cmp_lg_u64 s[96:97], 0
    s_cbranch_scc1 Lslow14
    s_branch Lback14
Lslow15:
    s_cmp_eq_u32 s6, 0
    s_cbranch_scc1 Lback15
    s_sub_u32 s6, s6, 1
    s_mov_b32 s98, m0
    s_mov_b32 s99, s7
    s_add_u32 m0, s50, 40960
    s_nop 0
    buffer_load_dwordx4 v0, s[40:43], s46 offen offset:0 sc1 lds
    s_add_u32 m0, s50, 40960
    s_nop 0
    buffer_load_dwordx4 v0, s[40:43], s46 offen offset:1024 sc1 lds
    s_add_u32 m0, s50, 40960
    s_nop 0
    buffer_load_dwordx4 v0, s[40:43], s46 offen offset:2048 sc1 lds
    s_add_u32 m0, s50, 40960
    s_nop 0
    buffer_load_dwordx4 v0, s[40:43], s46 offen offset:3072 sc1 lds
    s_add_u32 m0, s50, 45056
    s_add_u32 s7, s46, 4096
    buffer_load_dwordx4 v0, s[40:43], s7 offen sc1 lds
    s_mov_b32 m0, s98
    s_mov_b32 s7, s99
    s_waitcnt vmcnt(0)
    ds_read_b128 v[92:95], v13 offset:40960
    ds_read_b128 v[96:99], v13 offset:41984
    ds_read_b128 v[100:103], v13 offset:43008
    ds_read_b128 v[104:107], v13 offset:44032
    ds_read_b128 v[108:111], v13 offset:45056
    s_waitcnt lgkmcnt(4)
    v_max_u32 v92, v92, v93
    v_max3_u32 v92, v92, v94, v95
    s_waitcnt lgkmcnt(3)
    v_max3_u32 v92, v92, v96, v97
    v_max3_u32 v92, v92, v98, v99
    s_waitcnt lgkmcnt(2)
    v_max3_u32 v92, v92, v100, v101
    v_max3_u32 v92, v92, v102, v103
    s_waitcnt lgkmcnt(1)
    v_max3_u32 v92, v92, v104, v105
    v_max3_u32 v92, v92, v106, v107
    s_waitcnt lgkmcnt(0)
    v_max3_u32 v92, v92, v108, v109
    v_max3_u32 v92, v92, v110, v111
    v_cmp_eq_u32 s[96:97], -1, v92
    s_nop 0
    s_cmp_lg_u64 s[96:97], 0
    s_cbranch_scc1 Lslow15
    s_branch Lback15
Lslow16:
    s_cmp_eq_u32 s6, 0
    s_cbranch_scc1 Lback16
    s_sub_u32 s6, s6, 1
    s_mov_b32 s98, m0
    s_mov_b32 s99, s7
    s_add_u32 m0, s50, 61440
    s_nop 0
    buffer_load_dwordx4 v0, s[40:43], s47 offen offset:0 sc1 lds
    s_add_u32 m0, s50, 61440
    s_nop 0
    buffer_load_dwordx4 v0, s[40:43], s47 offen offset:1024 sc1 lds
    s_add_u32 m0, s50, 61440
    s_nop 0
    buffer_load_dwordx4 v0, s[40:43], s47 offen offset:2048 sc1 lds
    s_add_u32 m0, s50, 61440
    s_nop 0
    buffer_load_dwordx4 v0, s[40:43], s47 offen offset:3072 sc1 lds
    s_add_u32 m0, s50, 65536
    s_add_u32 s7, s47, 4096
    buffer_load_dwordx4 v0, s[40:43], s7 offen sc1 lds
    s_mov_b32 m0, s98
    s_mov_b32 s7, s99
    s_waitcnt vmcnt(0)
    ds_read_b128 v[92:95], v18 offset:0
    ds_read_b128 v[96:99], v18 offset:1024
    ds_read_b128 v[100:103], v18 offset:2048
    ds_read_b128 v[104:107], v18 offset:3072
    ds_read_b128 v[108:111], v18 offset:4096
    s_waitcnt lgkmcnt(4)
    v_max_u32 v92, v92, v93
    v_max3_u32 v92, v92, v94, v95
    s_waitcnt lgkmcnt(3)
    v_max3_u32 v92, v92, v96, v97
    v_max3_u32 v92, v92, v98, v99
    s_waitcnt lgkmcnt(2)
    v_max3_u32 v92, v92, v100, v101
    v_max3_u32 v92, v92, v102, v103
    s_waitcnt lgkmcnt(1)
    v_max3_u32 v92, v92, v104, v105
    v_max3_u32 v92, v92, v106, v107
    s_waitcnt lgkmcnt(0)
    v_max3_u32 v92, v92, v108, v109
    v_max3_u32 v92, v92, v110, v111
    v_cmp_eq_u32 s[96:97], -1, v92
    s_nop 0
    s_cmp_lg_u64 s[96:97], 0
    s_cbranch_scc1 Lslow16
    s_branch Lback16
Lslow17:
    s_cmp_eq_u32 s6, 0
    s_cbranch_scc1 Lback17
    s_sub_u32 s6, s6, 1
    buffer_load_dword v12, v19, s[40:43], s48 offen offset:1536 sc1
    s_waitcnt vmcnt(0)
    v_cmp_gt_u32 vcc, 10, v12
    s_nop 1
    s_and_b32 vcc_lo, vcc_lo, 0xf
    s_cbranch_scc1 Lslow17
    s_branch Lback17
Lslow18:
    s_cmp_eq_u32 s6, 0
    s_cbranch_scc1 Lback18
    s_sub_u32 s6, s6, 1
    buffer_load_dword v12, v30, s[40:43], s27 offen offset:0 sc1
    s_waitcnt vmcnt(0)
    v_cmp_gt_u32 vcc, 1, v12
    s_nop 1
    s_and_b32 vcc_lo, vcc_lo, 0xfff
    s_cbranch_scc1 Lslow18
    s_branch Lback18
Lslow19:
    s_cmp_eq_u32 s6, 0
    s_cbranch_scc1 Lback19
    s_sub_u32 s6, s6, 1
    s_mov_b32 s98, m0
    s_mov_b32 s99, s7
    s_add_u32 m0, s50, 81920
    s_nop 0
    buffer_load_dwordx4 v0, s[40:43], s49 offen offset:0 sc1 lds
    s_add_u32 m0, s50, 81920
    s_nop 0
    buffer_load_dwordx4 v0, s[40:43], s49 offen offset:1024 sc1 lds
    s_add_u32 m0, s50, 81920
    s_nop 0
    buffer_load_dwordx4 v0, s[40:43], s49 offen offset:2048 sc1 lds
    s_add_u32 m0, s50, 81920
    s_nop 0
    buffer_load_dwordx4 v0, s[40:43], s49 offen offset:3072 sc1 lds
    s_add_u32 m0, s50, 86016
    s_add_u32 s7, s49, 4096
    buffer_load_dwordx4 v0, s[40:43], s7 offen sc1 lds
    s_mov_b32 m0, s98
    s_mov_b32 s7, s99
    s_waitcnt vmcnt(0)
    ds_read_b128 v[92:95], v5 offset:0
    ds_read_b128 v[96:99], v5 offset:1024
    ds_read_b128 v[100:103], v5 offset:2048
    ds_read_b128 v[104:107], v5 offset:3072
    ds_read_b128 v[108:111], v5 offset:4096
    s_waitcnt lgkmcnt(4)
    v_max_u32 v92, v92, v93
    v_max3_u32 v92, v92, v94, v95
    s_waitcnt lgkmcnt(3)
    v_max3_u32 v92, v92, v96, v97
    v_max3_u32 v92, v92, v98, v99
    s_waitcnt lgkmcnt(2)
    v_max3_u32 v92, v92, v100, v101
    v_max3_u32 v92, v92, v102, v103
    s_waitcnt lgkmcnt(1)
    v_max3_u32 v92, v92, v104, v105
    v_max3_u32 v92, v92, v106, v107
    s_waitcnt lgkmcnt(0)
    v_max3_u32 v92, v92, v108, v109
    v_max3_u32 v92, v92, v110, v111
    v_cmp_eq_u32 s[96:97], -1, v92
    s_nop 0
    s_cmp_lg_u64 s[96:97], 0
    s_cbranch_scc1 Lslow19
    s_branch Lback19
Lslow20:
    s_cmp_eq_u32 s6, 0
    s_cbranch_scc1 Lback20
    s_sub_u32 s6, s6, 1
    v_mov_b32 v12, 0
    buffer_atomic_or v12, v15, s[40:43], s48 offen offset:1280 sc0 sc1
    s_waitcnt vmcnt(0)
    v_cmp_gt_u32 vcc, 10, v12
    s_nop 1
    s_and_b32 vcc_lo, vcc_lo, 0x1
    s_cbranch_scc1 Lslow20
    s_branch Lback20
Lslow21:
    s_cmp_eq_u32 s6, 0
    s_cbranch_scc1 Lback21
    s_sub_u32 s6, s6, 1
    buffer_load_dword v12, v30, s[40:43], s27 offen offset:0 sc1
    s_waitcnt vmcnt(0)
    v_cmp_gt_u32 vcc, 1, v12
    s_nop 1
    s_and_b32 vcc_lo, vcc_lo, 0xfff
    s_cbranch_scc1 Lslow21
    s_branch Lback21
Lslow22:
    s_cmp_eq_u32 s6, 0
    s_cbranch_scc1 Lback22
    s_sub_u32 s6, s6, 1
    s_mov_b32 s98, m0
    s_mov_b32 s99, s7
    s_add_u32 m0, s50, 81920
    s_nop 0
    buffer_load_dwordx4 v0, s[40:43], s49 offen offset:0 sc1 lds
    s_add_u32 m0, s50, 81920
    s_nop 0
    buffer_load_dwordx4 v0, s[40:43], s49 offen offset:1024 sc1 lds
    s_add_u32 m0, s50, 81920
    s_nop 0
    buffer_load_dwordx4 v0, s[40:43], s49 offen offset:2048 sc1 lds
    s_add_u32 m0, s50, 81920
    s_nop 0
    buffer_load_dwordx4 v0, s[40:43], s49 offen offset:3072 sc1 lds
    s_add_u32 m0, s50, 86016
    s_add_u32 s7, s49, 4096
    buffer_load_dwordx4 v0, s[40:43], s7 offen sc1 lds
    s_mov_b32 m0, s98
    s_mov_b32 s7, s99
    s_waitcnt vmcnt(0)
    ds_read_b128 v[92:95], v5 offset:0
    ds_read_b128 v[96:99], v5 offset:1024
    ds_read_b128 v[100:103], v5 offset:2048
    ds_read_b128 v[104:107], v5 offset:3072
    ds_read_b128 v[108:111], v5 offset:4096
    s_waitcnt lgkmcnt(4)
    v_max_u32 v92, v92, v93
    v_max3_u32 v92, v92, v94, v95
    s_waitcnt lgkmcnt(3)
    v_max3_u32 v92, v92, v96, v97
    v_max3_u32 v92, v92, v98, v99
    s_waitcnt lgkmcnt(2)
    v_max3_u32 v92, v92, v100, v101
    v_max3_u32 v92, v92, v102, v103
    s_waitcnt lgkmcnt(1)
    v_max3_u32 v92, v92, v104, v105
    v_max3_u32 v92, v92, v106, v107
    s_waitcnt lgkmcnt(0)
    v_max3_u32 v92, v92, v108, v109
    v_max3_u32 v92, v92, v110, v111
    v_cmp_eq_u32 s[96:97], -1, v92
    s_nop 0
    s_cmp_lg_u64 s[96:97], 0
    s_cbranch_scc1 Lslow22
    s_branch Lback22
Lslow23:
    s_cmp_eq_u32 s6, 0
    s_cbranch_scc1 Lback23
    s_sub_u32 s6, s6, 1
    buffer_load_dword v12, v19, s[40:43], s48 offen offset:2048 sc1
    s_waitcnt vmcnt(0)
    v_cmp_gt_u32 vcc, 10, v12
    s_nop 1
    s_and_b32 vcc_lo, vcc_lo, 0xf
    s_cbranch_scc1 Lslow23
    s_branch Lback23
Lslow24:
    s_cmp_eq_u32 s6, 0
    s_cbranch_scc1 Lback24
    s_sub_u32 s6, s6, 1
    buffer_load_dword v12, v19, s[40:43], s48 offen offset:2560 sc1
    s_waitcnt vmcnt(0)
    v_cmp_gt_u32 vcc, 10, v12
    s_nop 1
    s_and_b32 vcc_lo, vcc_lo, 0xf
    s_cbranch_scc1 Lslow24
    s_branch Lback24
Lslow25:
    s_cmp_eq_u32 s6, 0
    s_cbranch_scc1 Lback25
    s_sub_u32 s6, s6, 1
    buffer_load_dword v12, v19, s[40:43], s48 offen offset:3072 sc1
    s_waitcnt vmcnt(0)
    v_cmp_gt_u32 vcc, 10, v12
    s_nop 1
    s_and_b32 vcc_lo, vcc_lo, 0xf
    s_cbranch_scc1 Lslow25
    s_branch Lback25
Lslow26:
    s_cmp_eq_u32 s6, 0
    s_cbranch_scc1 Lback26
    s_sub_u32 s6, s6, 1
    buffer_load_dword v12, v19, s[40:43], s48 offen offset:3584 sc1
    s_waitcnt vmcnt(0)
    v_cmp_gt_u32 vcc, 10, v12
    s_nop 1
    s_and_b32 vcc_lo, vcc_lo, 0xf
    s_cbranch_scc1 Lslow26
    s_branch Lback26
Lslow27:
    s_cmp_eq_u32 s6, 0
    s_cbranch_scc1 Lback27
    s_sub_u32 s6, s6, 1
    s_mov_b32 s98, m0
    s_mov_b32 s99, s7
    s_add_u32 m0, s50, 102400
    s_nop 0
    buffer_load_dwordx4 v0, s[40:43], s53 offen offset:0 sc1 lds
    s_add_u32 m0, s50, 102400
    s_nop 0
    buffer_load_dwordx4 v0, s[40:43], s53 offen offset:1024 sc1 lds
    s_add_u32 m0, s50, 102400
    s_nop 0
    buffer_load_dwordx4 v0, s[40:43], s53 offen offset:2048 sc1 lds
    s_add_u32 m0, s50, 102400
    s_nop 0
    buffer_load_dwordx4 v0, s[40:43], s53 offen offset:3072 sc1 lds
    s_add_u32 m0, s50, 106496
    s_add_u32 s7, s53, 4096
    buffer_load_dwordx4 v0, s[40:43], s7 offen sc1 lds
    s_mov_b32 m0, s98
    s_mov_b32 s7, s99
    s_waitcnt vmcnt(0)
    ds_read_b128 v[92:95], v5 offset:20480
    ds_read_b128 v[96:99], v5 offset:21504
    ds_read_b128 v[100:103], v5 offset:22528
    ds_read_b128 v[104:107], v5 offset:23552
    ds_read_b128 v[108:111], v5 offset:24576
    s_waitcnt lgkmcnt(4)
    v_max_u32 v92, v92, v93
    v_max3_u32 v92, v92, v94, v95
    s_waitcnt lgkmcnt(3)
    v_max3_u32 v92, v92, v96, v97
    v_max3_u32 v92, v92, v98, v99
    s_waitcnt lgkmcnt(2)
    v_max3_u32 v92, v92, v100, v101
    v_max3_u32 v92, v92, v102, v103
    s_waitcnt lgkmcnt(1)
    v_max3_u32 v92, v92, v104, v105
    v_max3_u32 v92, v92, v106, v107
    s_waitcnt lgkmcnt(0)
    v_max3_u32 v92, v92, v108, v109
    v_max3_u32 v92, v92, v110, v111
    v_cmp_eq_u32 s[96:97], -1, v92
    s_nop 0
    s_cmp_lg_u64 s[96:97], 0
    s_cbranch_scc1 Lslow27
    s_branch Lback27
Lslow28:
    s_cmp_eq_u32 s6, 0
    s_cbranch_scc1 Lback28
    s_sub_u32 s6, s6, 1
    s_mov_b32 s98, m0
    s_mov_b32 s99, s7
    s_add_u32 m0, s50, 122880
    s_nop 0
    buffer_load_dwordx4 v0, s[40:43], s54 offen offset:0 sc1 lds
    s_add_u32 m0, s50, 122880
    s_nop 0
    buffer_load_dwordx4 v0, s[40:43], s54 offen offset:1024 sc1 lds
    s_add_u32 m0, s50, 122880
    s_nop 0
    buffer_load_dwordx4 v0, s[40:43], s54 offen offset:2048 sc1 lds
    s_add_u32 m0, s50, 122880
    s_nop 0
    buffer_load_dwordx4 v0, s[40:43], s54 offen offset:3072 sc1 lds
    s_add_u32 m0, s50, 126976
    s_add_u32 s7, s54, 4096
    buffer_load_dwordx4 v0, s[40:43], s7 offen sc1 lds
    s_mov_b32 m0, s98
    s_mov_b32 s7, s99
    s_waitcnt vmcnt(0)
    ds_read_b128 v[44:47], v5 offset:40960
    ds_read_b128 v[48:51], v5 offset:41984
    ds_read_b128 v[52:55], v5 offset:43008
    ds_read_b128 v[92:95], v5 offset:44032
    ds_read_b128 v[96:99], v5 offset:45056
    s_waitcnt lgkmcnt(4)
    v_max_u32 v44, v44, v45
    v_max3_u32 v44, v44, v46, v47
    s_waitcnt lgkmcnt(3)
    v_max3_u32 v44, v44, v48, v49
    v_max3_u32 v44, v44, v50, v51
    s_waitcnt lgkmcnt(2)
    v_max3_u32 v44, v44, v52, v53
    v_max3_u32 v44, v44, v54, v55
    s_waitcnt lgkmcnt(1)
    v_max3_u32 v44, v44, v92, v93
    v_max3_u32 v44, v44, v94, v95
    s_waitcnt lgkmcnt(0)
    v_max3_u32 v44, v44, v96, v97
    v_max3_u32 v44, v44, v98, v99
    v_cmp_eq_u32 s[96:97], -1, v44
    s_nop 0
    s_cmp_lg_u64 s[96:97], 0
    s_cbranch_scc1 Lslow28
    s_branch Lback28
Lslow29:
    s_cmp_eq_u32 s6, 0
    s_cbranch_scc1 Lback29
    s_sub_u32 s6, s6, 1
    buffer_load_dword v14, v15, s[40:43], s31 offen offset:0 sc1
    s_waitcnt vmcnt(0)
    v_cmp_gt_u32 vcc, 16, v14
    s_nop 1
    s_and_b32 vcc_lo, vcc_lo, 0x1
    s_cbranch_scc1 Lslow29
    s_branch Lback29
Lslow30:
    s_cmp_eq_u32 s6, 0
    s_cbranch_scc1 Lback30
    s_sub_u32 s6, s6, 1
    buffer_load_dword v14, v15, s[40:43], s31 offen offset:512 sc1
    s_waitcnt vmcnt(0)
    v_cmp_gt_u32 vcc, 16, v14
    s_nop 1
    s_and_b32 vcc_lo, vcc_lo, 0x1
    s_cbranch_scc1 Lslow30
    s_branch Lback30
Lslow31:
    s_cmp_eq_u32 s6, 0
    s_cbranch_scc1 Lback31
    s_sub_u32 s6, s6, 1
    buffer_load_dword v14, v31, s[40:43], s62 offen offset:0 sc1
    s_waitcnt vmcnt(0)
    v_cmp_eq_u32 vcc, -1, v14
    s_nop 1
    s_and_b32 vcc_lo, vcc_lo, 0xffff
    s_cbranch_scc1 Lslow31
    s_branch Lback31
Lslow32:
    s_cmp_eq_u32 s6, 0
    s_cbranch_scc1 Lback32
    s_sub_u32 s6, s6, 1
    buffer_load_dword v14, v31, s[40:43], s63 offen offset:0 sc1
    s_waitcnt vmcnt(0)
    v_cmp_eq_u32 vcc, -1, v14
    s_nop 1
    s_and_b32 vcc_lo, vcc_lo, 0xffff
    s_cbranch_scc1 Lslow32
    s_branch Lback32
Lslow33:
    s_nop 7
    s_cmp_eq_u32 s6, 0
    s_cbranch_scc1 Lback33
    s_sub_u32 s6, s6, 1
    buffer_load_dword v94, v15, s[40:43], s31 offen offset:1024 sc1
    s_waitcnt vmcnt(0)
    v_cmp_gt_u32 vcc, 16, v94
    s_nop 0
    s_and_b32 vcc_lo, vcc_lo, 1
    s_cbranch_scc1 Lslow33
    buffer_load_dwordx4 a[160:163], v0, s[40:43], s62 offen offset:0 sc1
    buffer_load_dwordx4 a[164:167], v0, s[40:43], s62 offen offset:1024 sc1
    buffer_load_dwordx4 a[168:171], v0, s[40:43], s62 offen offset:2048 sc1
    buffer_load_dwordx4 a[172:175], v0, s[40:43], s62 offen offset:3072 sc1
    s_add_u32 s62, s62, 4096
    buffer_load_dwordx4 a[176:179], v0, s[40:43], s62 offen offset:0 sc1
    buffer_load_dwordx4 a[180:183], v0, s[40:43], s62 offen offset:1024 sc1
    buffer_load_dwordx4 a[184:187], v0, s[40:43], s62 offen offset:2048 sc1
    buffer_load_dwordx4 a[188:191], v0, s[40:43], s62 offen offset:3072 sc1
    s_add_u32 s62, s62, 4096
    buffer_load_dwordx4 a[192:195], v0, s[40:43], s62 offen offset:0 sc1
    buffer_load_dwordx4 a[196:199], v0, s[40:43], s62 offen offset:1024 sc1
    buffer_load_dwordx4 a[200:203], v0, s[40:43], s62 offen offset:2048 sc1
    buffer_load_dwordx4 a[204:207], v0, s[40:43], s62 offen offset:3072 sc1
    s_add_u32 s62, s62, 4096
    s_waitcnt vmcnt(11)
    v_mfma_f32_16x16x32_bf16 v[112:115], a[0:3], a[160:163], 0
    v_mfma_f32_16x16x32_bf16 v[116:119], a[4:7], a[160:163], 0
    v_mfma_f32_16x16x32_bf16 v[120:123], a[8:11], a[160:163], 0
    v_mfma_f32_16x16x32_bf16 v[124:127], a[12:15], a[160:163], 0
    v_mfma_f32_16x16x32_bf16 v[128:131], a[16:19], a[160:163], 0
    s_waitcnt vmcnt(10)
    v_mfma_f32_16x16x32_bf16 v[112:115], a[20:23], a[164:167], v[112:115]
    v_mfma_f32_16x16x32_bf16 v[116:119], a[24:27], a[164:167], v[116:119]
    v_mfma_f32_16x16x32_bf16 v[120:123], a[28:31], a[164:167], v[120:123]
    v_mfma_f32_16x16x32_bf16 v[124:127], a[32:35], a[164:167], v[124:127]
    v_mfma_f32_16x16x32_bf16 v[128:131], a[36:39], a[164:167], v[128:131]
    s_waitcnt vmcnt(9)
    v_mfma_f32_16x16x32_bf16 v[112:115], a[40:43], a[168:171], v[112:115]
    v_mfma_f32_16x16x32_bf16 v[116:119], a[44:47], a[168:171], v[116:119]
    v_mfma_f32_16x16x32_bf16 v[120:123], a[48:51], a[168:171], v[120:123]
    v_mfma_f32_16x16x32_bf16 v[124:127], a[52:55], a[168:171], v[124:127]
    v_mfma_f32_16x16x32_bf16 v[128:131], a[56:59], a[168:171], v[128:131]
    s_waitcnt vmcnt(8)
    v_mfma_f32_16x16x32_bf16 v[112:115], a[60:63], a[172:175], v[112:115]
    v_mfma_f32_16x16x32_bf16 v[116:119], a[64:67], a[172:175], v[116:119]
    v_mfma_f32_16x16x32_bf16 v[120:123], a[68:71], a[172:175], v[120:123]
    v_mfma_f32_16x16x32_bf16 v[124:127], a[72:75], a[172:175], v[124:127]
    v_mfma_f32_16x16x32_bf16 v[128:131], a[76:79], a[172:175], v[128:131]
    s_waitcnt vmcnt(7)
    v_mfma_f32_16x16x32_bf16 v[112:115], a[80:83], a[176:179], v[112:115]
    v_mfma_f32_16x16x32_bf16 v[116:119], a[84:87], a[176:179], v[116:119]
    v_mfma_f32_16x16x32_bf16 v[120:123], a[88:91], a[176:179], v[120:123]
    v_mfma_f32_16x16x32_bf16 v[124:127], a[92:95], a[176:179], v[124:127]
    v_mfma_f32_16x16x32_bf16 v[128:131], a[96:99], a[176:179], v[128:131]
    s_waitcnt vmcnt(6)
    v_mfma_f32_16x16x32_bf16 v[112:115], a[100:103], a[180:183], v[112:115]
    v_mfma_f32_16x16x32_bf16 v[116:119], a[104:107], a[180:183], v[116:119]
    v_mfma_f32_16x16x32_bf16 v[120:123], a[108:111], a[180:183], v[120:123]
    v_mfma_f32_16x16x32_bf16 v[124:127], a[112:115], a[180:183], v[124:127]
    v_mfma_f32_16x16x32_bf16 v[128:131], a[116:119], a[180:183], v[128:131]
    s_waitcnt vmcnt(5)
    v_mfma_f32_16x16x32_bf16 v[112:115], a[120:123], a[184:187], v[112:115]
    v_mfma_f32_16x16x32_bf16 v[116:119], a[124:127], a[184:187], v[116:119]
    v_mfma_f32_16x16x32_bf16 v[120:123], a[128:131], a[184:187], v[120:123]
    v_mfma_f32_16x16x32_bf16 v[124:127], a[132:135], a[184:187], v[124:127]
    v_mfma_f32_16x16x32_bf16 v[128:131], a[136:139], a[184:187], v[128:131]
    s_waitcnt vmcnt(4)
    v_mfma_f32_16x16x32_bf16 v[112:115], a[140:143], a[188:191], v[112:115]
    v_mfma_f32_16x16x32_bf16 v[116:119], a[144:147], a[188:191], v[116:119]
    v_mfma_f32_16x16x32_bf16 v[120:123], a[148:151], a[188:191], v[120:123]
    v_mfma_f32_16x16x32_bf16 v[124:127], a[152:155], a[188:191], v[124:127]
    v_mfma_f32_16x16x32_bf16 v[128:131], a[156:159], a[188:191], v[128:131]
    s_waitcnt vmcnt(3)
    v_mfma_f32_16x16x32_bf16 v[112:115], v[168:171], a[192:195], v[112:115]
    v_mfma_f32_16x16x32_bf16 v[116:119], v[172:175], a[192:195], v[116:119]
    v_mfma_f32_16x16x32_bf16 v[120:123], v[176:179], a[192:195], v[120:123]
    v_mfma_f32_16x16x32_bf16 v[124:127], v[180:183], a[192:195], v[124:127]
    v_mfma_f32_16x16x32_bf16 v[128:131], v[184:187], a[192:195], v[128:131]
    s_waitcnt vmcnt(2)
    v_mfma_f32_16x16x32_bf16 v[112:115], v[188:191], a[196:199], v[112:115]
    v_mfma_f32_16x16x32_bf16 v[116:119], v[192:195], a[196:199], v[116:119]
    v_mfma_f32_16x16x32_bf16 v[120:123], v[196:199], a[196:199], v[120:123]
    v_mfma_f32_16x16x32_bf16 v[124:127], v[200:203], a[196:199], v[124:127]
    v_mfma_f32_16x16x32_bf16 v[128:131], v[204:207], a[196:199], v[128:131]
    s_waitcnt vmcnt(1)
    v_mfma_f32_16x16x32_bf16 v[112:115], v[208:211], a[200:203], v[112:115]
    v_mfma_f32_16x16x32_bf16 v[116:119], v[212:215], a[200:203], v[116:119]
    v_mfma_f32_16x16x32_bf16 v[120:123], v[216:219], a[200:203], v[120:123]
    v_mfma_f32_16x16x32_bf16 v[124:127], v[220:223], a[200:203], v[124:127]
    v_mfma_f32_16x16x32_bf16 v[128:131], v[224:227], a[200:203], v[128:131]
    s_waitcnt vmcnt(0)
    v_mfma_f32_16x16x32_bf16 v[112:115], v[228:231], a[204:207], v[112:115]
    v_mfma_f32_16x16x32_bf16 v[116:119], v[232:235], a[204:207], v[116:119]
    v_mfma_f32_16x16x32_bf16 v[120:123], v[236:239], a[204:207], v[120:123]
    v_mfma_f32_16x16x32_bf16 v[124:127], v[240:243], a[204:207], v[124:127]
    v_mfma_f32_16x16x32_bf16 v[128:131], v[244:247], a[204:207], v[128:131]
    s_nop 7
    s_branch Lback33
Lslow34:
    s_nop 7
    s_cmp_eq_u32 s6, 0
    s_cbranch_scc1 Lback34
    s_sub_u32 s6, s6, 1
    buffer_load_dword v94, v15, s[40:43], s31 offen offset:1024 sc1
    s_waitcnt vmcnt(0)
    v_cmp_gt_u32 vcc, 16, v94
    s_nop 0
    s_and_b32 vcc_lo, vcc_lo, 1
    s_cbranch_scc1 Lslow34
    buffer_load_dwordx4 a[208:211], v0, s[40:43], s63 offen offset:0 sc1
    buffer_load_dwordx4 a[212:215], v0, s[40:43], s63 offen offset:1024 sc1
    buffer_load_dwordx4 a[216:219], v0, s[40:43], s63 offen offset:2048 sc1
    buffer_load_dwordx4 a[220:223], v0, s[40:43], s63 offen offset:3072 sc1
    s_add_u32 s63, s63, 4096
    buffer_load_dwordx4 a[224:227], v0, s[40:43], s63 offen offset:0 sc1
    buffer_load_dwordx4 a[228:231], v0, s[40:43], s63 offen offset:1024 sc1
    buffer_load_dwordx4 a[232:235], v0, s[40:43], s63 offen offset:2048 sc1
    buffer_load_dwordx4 a[236:239], v0, s[40:43], s63 offen offset:3072 sc1
    s_add_u32 s63, s63, 4096
    buffer_load_dwordx4 a[240:243], v0, s[40:43], s63 offen offset:0 sc1
    buffer_load_dwordx4 a[244:247], v0, s[40:43], s63 offen offset:1024 sc1
    buffer_load_dwordx4 a[248:251], v0, s[40:43], s63 offen offset:2048 sc1
    buffer_load_dwordx4 a[252:255], v0, s[40:43], s63 offen offset:3072 sc1
    s_add_u32 s63, s63, 4096
    s_waitcnt vmcnt(11)
    v_mfma_f32_16x16x32_bf16 v[132:135], a[0:3], a[208:211], 0
    v_mfma_f32_16x16x32_bf16 v[136:139], a[4:7], a[208:211], 0
    v_mfma_f32_16x16x32_bf16 v[140:143], a[8:11], a[208:211], 0
    v_mfma_f32_16x16x32_bf16 v[144:147], a[12:15], a[208:211], 0
    v_mfma_f32_16x16x32_bf16 v[148:151], a[16:19], a[208:211], 0
    s_waitcnt vmcnt(10)
    v_mfma_f32_16x16x32_bf16 v[132:135], a[20:23], a[212:215], v[132:135]
    v_mfma_f32_16x16x32_bf16 v[136:139], a[24:27], a[212:215], v[136:139]
    v_mfma_f32_16x16x32_bf16 v[140:143], a[28:31], a[212:215], v[140:143]
    v_mfma_f32_16x16x32_bf16 v[144:147], a[32:35], a[212:215], v[144:147]
    v_mfma_f32_16x16x32_bf16 v[148:151], a[36:39], a[212:215], v[148:151]
    s_waitcnt vmcnt(9)
    v_mfma_f32_16x16x32_bf16 v[132:135], a[40:43], a[216:219], v[132:135]
    v_mfma_f32_16x16x32_bf16 v[136:139], a[44:47], a[216:219], v[136:139]
    v_mfma_f32_16x16x32_bf16 v[140:143], a[48:51], a[216:219], v[140:143]
    v_mfma_f32_16x16x32_bf16 v[144:147], a[52:55], a[216:219], v[144:147]
    v_mfma_f32_16x16x32_bf16 v[148:151], a[56:59], a[216:219], v[148:151]
    s_waitcnt vmcnt(8)
    v_mfma_f32_16x16x32_bf16 v[132:135], a[60:63], a[220:223], v[132:135]
    v_mfma_f32_16x16x32_bf16 v[136:139], a[64:67], a[220:223], v[136:139]
    v_mfma_f32_16x16x32_bf16 v[140:143], a[68:71], a[220:223], v[140:143]
    v_mfma_f32_16x16x32_bf16 v[144:147], a[72:75], a[220:223], v[144:147]
    v_mfma_f32_16x16x32_bf16 v[148:151], a[76:79], a[220:223], v[148:151]
    s_waitcnt vmcnt(7)
    v_mfma_f32_16x16x32_bf16 v[132:135], a[80:83], a[224:227], v[132:135]
    v_mfma_f32_16x16x32_bf16 v[136:139], a[84:87], a[224:227], v[136:139]
    v_mfma_f32_16x16x32_bf16 v[140:143], a[88:91], a[224:227], v[140:143]
    v_mfma_f32_16x16x32_bf16 v[144:147], a[92:95], a[224:227], v[144:147]
    v_mfma_f32_16x16x32_bf16 v[148:151], a[96:99], a[224:227], v[148:151]
    s_waitcnt vmcnt(6)
    v_mfma_f32_16x16x32_bf16 v[132:135], a[100:103], a[228:231], v[132:135]
    v_mfma_f32_16x16x32_bf16 v[136:139], a[104:107], a[228:231], v[136:139]
    v_mfma_f32_16x16x32_bf16 v[140:143], a[108:111], a[228:231], v[140:143]
    v_mfma_f32_16x16x32_bf16 v[144:147], a[112:115], a[228:231], v[144:147]
    v_mfma_f32_16x16x32_bf16 v[148:151], a[116:119], a[228:231], v[148:151]
    s_waitcnt vmcnt(5)
    v_mfma_f32_16x16x32_bf16 v[132:135], a[120:123], a[232:235], v[132:135]
    v_mfma_f32_16x16x32_bf16 v[136:139], a[124:127], a[232:235], v[136:139]
    v_mfma_f32_16x16x32_bf16 v[140:143], a[128:131], a[232:235], v[140:143]
    v_mfma_f32_16x16x32_bf16 v[144:147], a[132:135], a[232:235], v[144:147]
    v_mfma_f32_16x16x32_bf16 v[148:151], a[136:139], a[232:235], v[148:151]
    s_waitcnt vmcnt(4)
    v_mfma_f32_16x16x32_bf16 v[132:135], a[140:143], a[236:239], v[132:135]
    v_mfma_f32_16x16x32_bf16 v[136:139], a[144:147], a[236:239], v[136:139]
    v_mfma_f32_16x16x32_bf16 v[140:143], a[148:151], a[236:239], v[140:143]
    v_mfma_f32_16x16x32_bf16 v[144:147], a[152:155], a[236:239], v[144:147]
    v_mfma_f32_16x16x32_bf16 v[148:151], a[156:159], a[236:239], v[148:151]
    s_waitcnt vmcnt(3)
    v_mfma_f32_16x16x32_bf16 v[132:135], v[168:171], a[240:243], v[132:135]
    v_mfma_f32_16x16x32_bf16 v[136:139], v[172:175], a[240:243], v[136:139]
    v_mfma_f32_16x16x32_bf16 v[140:143], v[176:179], a[240:243], v[140:143]
    v_mfma_f32_16x16x32_bf16 v[144:147], v[180:183], a[240:243], v[144:147]
    v_mfma_f32_16x16x32_bf16 v[148:151], v[184:187], a[240:243], v[148:151]
    s_waitcnt vmcnt(2)
    v_mfma_f32_16x16x32_bf16 v[132:135], v[188:191], a[244:247], v[132:135]
    v_mfma_f32_16x16x32_bf16 v[136:139], v[192:195], a[244:247], v[136:139]
    v_mfma_f32_16x16x32_bf16 v[140:143], v[196:199], a[244:247], v[140:143]
    v_mfma_f32_16x16x32_bf16 v[144:147], v[200:203], a[244:247], v[144:147]
    v_mfma_f32_16x16x32_bf16 v[148:151], v[204:207], a[244:247], v[148:151]
    s_waitcnt vmcnt(1)
    v_mfma_f32_16x16x32_bf16 v[132:135], v[208:211], a[248:251], v[132:135]
    v_mfma_f32_16x16x32_bf16 v[136:139], v[212:215], a[248:251], v[136:139]
    v_mfma_f32_16x16x32_bf16 v[140:143], v[216:219], a[248:251], v[140:143]
    v_mfma_f32_16x16x32_bf16 v[144:147], v[220:223], a[248:251], v[144:147]
    v_mfma_f32_16x16x32_bf16 v[148:151], v[224:227], a[248:251], v[148:151]
    s_waitcnt vmcnt(0)
    v_mfma_f32_16x16x32_bf16 v[132:135], v[228:231], a[252:255], v[132:135]
    v_mfma_f32_16x16x32_bf16 v[136:139], v[232:235], a[252:255], v[136:139]
    v_mfma_f32_16x16x32_bf16 v[140:143], v[236:239], a[252:255], v[140:143]
    v_mfma_f32_16x16x32_bf16 v[144:147], v[240:243], a[252:255], v[144:147]
    v_mfma_f32_16x16x32_bf16 v[148:151], v[244:247], a[252:255], v[148:151]
    s_nop 3
    ds_write_b128 v26, v[132:135] offset:21504
    ds_write_b128 v26, v[136:139] offset:21568
    ds_write_b128 v26, v[140:143] offset:21632
    s_nop 7
    s_branch Lback34
Lcodeend:
.section .rodata,"a"
.p2align 6
.amdhsa_kernel sequential_preLN__linear_attn_block__glu_gated_swiglu__prompt_kernel
  .amdhsa_next_free_vgpr 512
  .amdhsa_next_free_sgpr 102
  .amdhsa_accum_offset 256
  .amdhsa_group_segment_fixed_size 0
  .amdhsa_kernarg_size 80
  .amdhsa_user_sgpr_count 2
  .amdhsa_user_sgpr_kernarg_segment_ptr 1
  .amdhsa_system_sgpr_workgroup_id_x 1
.end_amdhsa_kernel
```
